```python
import torch

def _softmax(x, axis=-1):
    return torch.softmax(x, dim=axis)
def _gelu(x):
    return torch.nn.functional.gelu(x, approximate="tanh")
def _silu(x):
    return torch.nn.functional.silu(x)
def _sigmoid(x):
    return torch.sigmoid(x)
def _layernorm(x, axis=-1, eps=1e-5):
    m = x.mean(dim=axis, keepdim=True)
    v = x.var(dim=axis, keepdim=True, unbiased=False)
    return (x - m) / torch.sqrt(v + eps)
def _scatter_add(tgt, idx, src, axis=0):
    return tgt.clone().index_add_(axis, idx, src)
def _segment_sum(src, seg, n):
    out = torch.zeros((n,) + src.shape[1:], dtype=src.dtype)
    return out.index_add_(0, seg, src)
def _pad(x, pw):
    flat = tuple(v for pair in reversed(pw) for v in pair)
    return torch.nn.functional.pad(x, flat)

kernel_name = 'interleave_layers__ssm_conv_s4d__dense_activation_mish__prompt'

def setup_inputs():

    _w = (lambda a: (lambda t: t.to(torch.bfloat16) if t.is_floating_point() else t)(torch.as_tensor(a)))
    def _A_setup():
        Bsz, L, D, N = 1, 2048, 512, 128
        return {
            "u": _w((lambda *s: torch.randn(*s, dtype=torch.bfloat16) * 0.05)(Bsz, L, D)),
            "log_A_real": _w((lambda *s: torch.randn(*s, dtype=torch.bfloat16) * 3.2)(D, N) * 0.5),
            "A_imag": _w((lambda *s: torch.randn(*s, dtype=torch.bfloat16) * 0.05)(D, N) * 3.14),
            "C_real": _w((lambda *s: torch.randn(*s, dtype=torch.bfloat16) * 0.05)(D, N) / N ** 0.5),
            "C_imag": _w((lambda *s: torch.randn(*s, dtype=torch.bfloat16) * 0.05)(D, N) / N ** 0.5),
            "log_dt": _w((lambda *s: torch.randn(*s, dtype=torch.bfloat16) * 0.05)(D) * 0.5 - 4.0),
            "D_skip": _w((lambda *s: torch.randn(*s, dtype=torch.bfloat16) * 0.05)(D)),
        }
    _A_in = _A_setup()

    def _B_setup():
        B, S, D, F = 1, 2048, 512, 1792
        return {
            "x": _w((lambda *s: torch.randn(*s, dtype=torch.bfloat16) * 0.05)(B, S, D)),
            "w1": _w((lambda *s: torch.randn(*s, dtype=torch.bfloat16) * 0.8)(D, F) * (D ** -0.5)),
            "b1": _w((lambda *s: torch.randn(*s, dtype=torch.bfloat16) * 0.2)(F)),
            "w2": _w((lambda *s: torch.randn(*s, dtype=torch.bfloat16) * 0.2)(F, D) * (F ** -0.5)),
        }
    _B_in = _B_setup()

    return {
        "A_u": _A_in["u"],
        "A_log_A_real": _A_in["log_A_real"],
        "A_A_imag": _A_in["A_imag"],
        "A_C_real": _A_in["C_real"],
        "A_C_imag": _A_in["C_imag"],
        "A_log_dt": _A_in["log_dt"],
        "A_D_skip": _A_in["D_skip"],
        "B_x": _B_in["x"],
        "B_w1": _B_in["w1"],
        "B_b1": _B_in["b1"],
        "B_w2": _B_in["w2"],
    }

def reference(A_u, A_log_A_real, A_A_imag, A_C_real, A_C_imag, A_log_dt, A_D_skip, B_x, B_w1, B_b1, B_w2):
    def _A_ref(u, log_A_real, A_imag, C_real, C_imag, log_dt, D_skip):
        L = u.shape[1]
        dt = torch.exp(log_dt)
        A = -torch.exp(log_A_real) + 1j * A_imag
        C = (C_real + 1j * C_imag) * dt[:, None]
        pos = (lambda x, dt: x.to(dt))(torch.arange(L), log_dt.dtype)
        P = torch.exp((A * dt[:, None])[:, :, None] * pos[None, None, :])
        K = 2.0 * torch.einsum("dn,dnl->dl", C, P).real
        L2 = 2 * L
        u_t = (lambda x, *d: x.permute(*d))(u, 0, 2, 1)
        Kf = (lambda x, *a, **k: torch.fft.rfft(x.float(), *a, **k))(K, L2)
        Uf = (lambda x, *a, **k: torch.fft.rfft(x.float(), *a, **k))(u_t, L2)
        y = (lambda x, *a, **k: torch.fft.irfft(x, *a, **k).to(torch.bfloat16))(Uf * Kf[None, :, :], L2)[:, :, :L]
        y = (lambda x, *d: x.permute(*d))(y, 0, 2, 1)
        return y + u * D_skip[None, None, :]

    def _B_ref(x, w1, b1, w2):
        h = torch.einsum("bsd,df->bsf", x, w1) + b1
        sp = torch.log1p(torch.exp(-torch.abs(h))) + torch.where(h > 0, h, torch.zeros_like(h))
        act = h * torch.tanh(sp)
        return torch.einsum("bsf,fd->bsd", act, w2)

    x = A_u
    x = x + _A_ref(_layernorm(x, axis=-1), A_log_A_real, A_A_imag, A_C_real, A_C_imag, A_log_dt, A_D_skip)
    x = x + _B_ref(_layernorm(x, axis=-1), B_w1, B_b1, B_w2)
    x = x + _A_ref(_layernorm(x, axis=-1), A_log_A_real, A_A_imag, A_C_real, A_C_imag, A_log_dt, A_D_skip)
    x = x + _B_ref(_layernorm(x, axis=-1), B_w1, B_b1, B_w2)
    return x
```

```asm
; @launch grid=(256,1,1) block=(256,1,1) lds=163840
.amdgcn_target "amdgcn-amd-amdhsa--gfx950"
.text
.globl interleave_layers__ssm_conv_s4d__dense_activation_mish__prompt_kernel
.p2align 8
.type interleave_layers__ssm_conv_s4d__dense_activation_mish__prompt_kernel,@function
interleave_layers__ssm_conv_s4d__dense_activation_mish__prompt_kernel:
  s_load_dwordx16 s[16:31], s[0:1], 0
  s_load_dwordx8 s[32:39], s[0:1], 64
  s_load_dwordx4 s[40:43], s[0:1], 96
  v_lshrrev_b32 v1, 6, v0
  v_and_b32 v2, 63, v0
  v_readfirstlane_b32 s3, v1
  s_cmpk_ge_u32 s2, 256
  s_cbranch_scc1 ALL_end
  s_lshr_b32 s13, s2, 3
  s_getpc_b64 s[60:61]
PF_PC:
  s_lshl2_add_u32 s14, s13, s3
  s_mul_i32 s15, s14, 384
  v_min_u32 v3, 5, v2
  v_lshl_add_u32 v3, v3, 6, s15
  v_min_u32 v3, ALL_end-PF_PC, v3
  global_load_dword a255, v3, s[60:61]
  s_memrealtime s[10:11]
  s_lshl2_add_u32 s12, s2, s3
  s_lshl_b32 s12, s12, 11
  v_lshl_add_u32 v108, v2, 4, s12
  s_and_b32 s12, s2, 7
  s_lshl_b32 s4, s12, 5
  s_add_u32 s4, s4, s13
  s_lshl_b32 s12, s4, 9
  v_lshl_add_u32 v3, v0, 1, s12
  v_xor_b32 v11, 128, v3
  s_lshr_b32 s12, s2, 2
  s_lshl_b32 s12, s12, 8
  s_lshl_b32 s15, s2, 13
  s_add_u32 s12, s12, s15
  s_addk_i32 s12, 4096
  v_lshl_add_u32 v157, v0, 4, s12
  v_mov_b64 v[184:185], -1
  v_mov_b64 v[186:187], -1
  s_mul_i32 s14, s14, 14336
  v_lshl_add_u32 v173, v2, 7, s14
  v_mov_b32 v170, 0
  s_and_b32 s8, s13, 7
  s_and_b32 s6, s13, 15
  v_lshrrev_b32 v217, 4, v2
  v_bfe_u32 v28, v2, 2, 2
  s_mul_i32 s13, s3, 2112
  s_add_u32 s13, s13, 96256
  v_lshl_add_u32 v158, v2, 4, s13
  v_and_b32 v27, 1, v2
  v_lshl_add_u32 v159, v27, 2, v28
  v_mul_u32_u24 v159, 66, v159
  v_add_lshl_u32 v159, v159, v217, 1
  v_bfe_u32 v26, v2, 1, 1
  v_add_lshl_u32 v159, v159, v26, 3
  s_lshl_b32 s13, s3, 8
  s_add_u32 s13, s13, 96256
  v_add_u32 v159, s13, v159
  s_lshl_b32 s15, s4, 2
  s_or_b32 s12, s2, s3
  s_waitcnt lgkmcnt(0)
  s_cbranch_scc1 S0_nn
  s_or_b32 s10, s10, 1
  v_mov_b32 v168, s10
  v_mov_b32 v169, s11
  global_store_dwordx2 v170, v[168:169], s[40:41] sc1
S0_nn:
  global_load_dwordx4 v[96:99], v108, s[16:17]
  global_load_dwordx4 v[100:103], v108, s[16:17] offset:1024
  s_load_dword s69, s[26:27], s15
  s_load_dword s66, s[28:29], s15
  global_load_ushort v4, v3, s[18:19]
  global_load_ushort v5, v3, s[20:21]
  global_load_ushort v6, v3, s[22:23]
  global_load_ushort v7, v3, s[24:25]
  global_load_ushort v9, v11, s[22:23]
  global_load_ushort v10, v11, s[24:25]
  global_store_dwordx4 v157, v[184:187], s[42:43] offset:-4096 sc1
  global_store_dwordx4 v157, v[184:187], s[42:43] sc1
  s_mov_b32 exec_hi, 0xffff
  global_load_dword a255, v173, s[32:33] sc1
  s_mov_b64 exec, -1
S0_512:
  s_mov_b32 s44, s42
  s_mov_b32 s45, s43
  s_mov_b32 s46, 0x18c0000
  s_mov_b32 s47, 0x20000
  s_movk_i32 s9, 0x4000
  s_lshl_b32 s13, s2, 11
  s_and_b32 s14, s2, 15
  s_lshl_b32 s14, s14, 7
  s_or_b32 s13, s13, s14
  v_lshrrev_b32 v160, 1, v2
  v_xor_b32 v160, v160, v2
  v_and_b32 v160, 2, v160
  v_mul_u32_u24 v160, 3, v160
  v_xor_b32 v160, v160, v2
  v_lshlrev_b32 v160, 4, v160
  v_xor_b32 v160, s13, v160
  v_xor_b32 v165, 1024, v160
  s_mul_i32 s26, s3, 1835008
  s_add_u32 s26, s26, 0x11a0000
  s_add_u32 s27, s26, 917504
  v_lshrrev_b32 v176, 3, v2
  v_lshlrev_b32 v176, 28, v176
  v_mov_b32 v177, 0xe0000
  v_mad_u32_u24 v176, v2, v177, v176
  s_lshl2_add_u32 s25, s2, s3
  s_lshl_b32 s25, s25, 4
  s_add_u32 s25, s25, 0x1220000
  s_mov_b32 s15, 0x3f803f80
  v_mov_b64 v[104:105], 0
  v_mov_b64 v[106:107], 0
  v_and_b32 v216, 15, v2
  s_lshr_b32 s7, s4, 3
  s_lshr_b32 s5, s4, 4
  s_mov_b32 s48, s32
  s_mov_b32 s49, s33
  s_mov_b32 s50, 0x1c0000
  s_mov_b32 s51, 0x20000
  s_movk_i32 s59, 8192
  s_lshr_b32 s12, s3, 1
  s_mul_i32 s13, s12, 27984
  s_add_u32 s13, s13, 107872
  v_and_b32 v17, 127, v0
  v_lshl_add_u32 v8, v17, 2, s13
  v_mul_u32_u24 v13, 0x210, v216
  v_lshl_add_u32 v13, v217, 4, v13
  v_add_u32 v13, s13, v13
  s_mul_i32 s58, s12, 4608
  s_and_b32 s14, s3, 1
  s_mul_i32 s12, s14, 8448
  v_add_u32 v12, s12, v13
  v_min_u32 v208, 4, v216
  v_mul_u32_u24 v14, 0x210, v208
  v_lshl_add_u32 v14, v217, 4, v14
  v_add_u32 v14, s13, v14
  s_add_u32 s58, s58, 86016
  v_lshlrev_b32 v209, 8, v216
  v_add_u32 v210, 4294964996, v209
  v_cmp_le_u32 vcc, 9, v216
  s_nop 1
  v_cndmask_b32 v15, v209, v210, vcc
  v_add_u32 v210, 4294963970, v209
  v_cmp_le_u32 vcc, 13, v216
  s_nop 1
  v_cndmask_b32 v15, v15, v210, vcc
  v_cmp_gt_u32 vcc, 15, v216
  s_nop 1
  v_cndmask_b32 v15, 6, v15, vcc
  v_min_u32 v208, 4, v216
  v_lshl_add_u32 v16, v208, 1, -1
  v_mov_b32 v210, 262
  v_cmp_eq_u32 vcc, 0, v216
  s_nop 1
  v_cndmask_b32 v16, v16, v210, vcc
  s_and_b32 s14, s3, 1
  s_lshl_b32 s14, s14, 8
  s_add_u32 s14, s14, s58
  v_lshl_add_u32 v210, v217, 6, s14
  v_lshl_add_u32 v15, v15, 1, v210
  v_lshl_add_u32 v16, v16, 1, v210
  s_sub_u32 s12, s2, 32
  s_cmpk_lt_u32 s2, 224
  s_cselect_b32 s56, s2, s12
  s_lshr_b32 s57, s56, 2
  s_and_b32 s56, s56, 3
  s_lshl2_add_u32 s56, s56, s3
  s_lshl_b32 s12, s56, 6
  s_lshl_b32 s13, s57, 15
  s_add_u32 s12, s12, s13
  v_lshrrev_b32 v208, 2, v2
  v_and_b32 v209, 3, v2
  v_lshl_add_u32 v174, v208, 10, s12
  v_lshl_add_u32 v174, v209, 4, v174
  v_add_u32 v175, 0x4000, v174
  s_mul_i32 s12, s3, 2560
  s_add_u32 s12, s12, 75776
  v_lshl_add_u32 v161, v2, 4, s12
  s_mul_i32 s13, s57, 9363
  s_lshr_b32 s13, s13, 16
  s_mul_i32 s13, s13, 7
  s_sub_u32 s13, s57, s13
  s_cmp_eq_u32 s13, 3
  s_cselect_b32 s13, 9, 8
  s_cselect_b32 s14, 1, 4
  s_lshl_b32 s14, s14, 8
  v_lshlrev_b32 v210, s13, v217
  v_and_b32 v208, 3, v208
  v_lshl_add_u32 v210, v208, 6, v210
  v_lshl_add_u32 v210, v209, 3, v210
  v_add_u32 v162, s12, v210
  v_add_u32 v163, s14, v162
  s_mul_i32 s12, s56, 112
  s_add_u32 s12, s12, s57
  s_lshl_b32 s12, s12, 10
  s_add_u32 s12, s12, 0xea0000
  v_lshl_add_u32 v166, v2, 4, s12
  s_waitcnt lgkmcnt(0)
  s_lshr_b32 s12, s3, 1
  s_lshl_b32 s12, s12, 4
  s_lshr_b32 s69, s69, s12
  s_lshl_b32 s69, s69, 16
  v_mov_b32 v18, 0x3fb8aa3b
  v_mul_f32 v19, s69, v18
  v_exp_f32 v19, v19
  s_nop 0
  v_cvt_pk_bf16_f32 v19, 0, v19
  v_lshrrev_b32 v208, 2, v0
  s_bfe_u32 s12, s4, 0x40001
  v_and_b32 v153, 15, v208
  v_xor_b32 v153, s12, v153
  v_lshl_add_u32 v153, v208, 4, v153
  v_and_b32 v208, 3, v0
  v_lshl_add_u32 v153, v153, 3, v208
  v_lshlrev_b32 v153, 4, v153
  v_lshlrev_b32 v155, 4, v0
  s_lshr_b32 s12, s4, 5
  s_mul_i32 s12, s12, 917504
  s_add_u32 s24, s12, 0x1220000
  s_and_b32 s13, s4, 1
  s_lshl_b32 s13, s13, 6
  s_add_u32 s12, s12, s13
  s_add_u32 s28, s12, 0x11a0000
  s_add_u32 s29, s12, 0x11c0000
  s_add_u32 s30, s12, 0x11e0000
  s_add_u32 s31, s12, 0x1200000
  s_waitcnt vmcnt(9)
  ds_write_b128 v158, v[96:99]
  ds_write_b128 v158, v[100:103] offset:1056
  global_load_dwordx2 v[168:169], v170, s[40:41] sc1
  v_dot2c_f32_bf16 v104, s15, v96
  v_dot2c_f32_bf16 v105, v96, v96
  v_dot2c_f32_bf16 v106, s15, v100
  v_dot2c_f32_bf16 v107, v100, v100
  v_dot2c_f32_bf16 v104, s15, v97
  v_dot2c_f32_bf16 v105, v97, v97
  v_dot2c_f32_bf16 v106, s15, v101
  v_dot2c_f32_bf16 v107, v101, v101
  v_dot2c_f32_bf16 v104, s15, v98
  v_dot2c_f32_bf16 v105, v98, v98
  v_dot2c_f32_bf16 v106, s15, v102
  v_dot2c_f32_bf16 v107, v102, v102
  v_dot2c_f32_bf16 v104, s15, v99
  v_dot2c_f32_bf16 v105, v99, v99
  v_dot2c_f32_bf16 v106, s15, v103
  v_dot2c_f32_bf16 v107, v103, v103
  v_add_f32_dpp v104, v104, v104 row_shr:1 row_mask:0xf bank_mask:0xf bound_ctrl:0
  v_add_f32_dpp v105, v105, v105 row_shr:1 row_mask:0xf bank_mask:0xf bound_ctrl:0
  v_add_f32_dpp v106, v106, v106 row_shr:1 row_mask:0xf bank_mask:0xf bound_ctrl:0
  v_add_f32_dpp v107, v107, v107 row_shr:1 row_mask:0xf bank_mask:0xf bound_ctrl:0
  v_add_f32_dpp v104, v104, v104 row_shr:2 row_mask:0xf bank_mask:0xf bound_ctrl:0
  v_add_f32_dpp v105, v105, v105 row_shr:2 row_mask:0xf bank_mask:0xf bound_ctrl:0
  v_add_f32_dpp v106, v106, v106 row_shr:2 row_mask:0xf bank_mask:0xf bound_ctrl:0
  v_add_f32_dpp v107, v107, v107 row_shr:2 row_mask:0xf bank_mask:0xf bound_ctrl:0
  v_add_f32_dpp v104, v104, v104 row_shr:4 row_mask:0xf bank_mask:0xf bound_ctrl:0
  v_add_f32_dpp v105, v105, v105 row_shr:4 row_mask:0xf bank_mask:0xf bound_ctrl:0
  v_add_f32_dpp v106, v106, v106 row_shr:4 row_mask:0xf bank_mask:0xf bound_ctrl:0
  v_add_f32_dpp v107, v107, v107 row_shr:4 row_mask:0xf bank_mask:0xf bound_ctrl:0
  v_add_f32_dpp v104, v104, v104 row_shr:8 row_mask:0xf bank_mask:0xf bound_ctrl:0
  v_add_f32_dpp v105, v105, v105 row_shr:8 row_mask:0xf bank_mask:0xf bound_ctrl:0
  v_add_f32_dpp v106, v106, v106 row_shr:8 row_mask:0xf bank_mask:0xf bound_ctrl:0
  v_add_f32_dpp v107, v107, v107 row_shr:8 row_mask:0xf bank_mask:0xf bound_ctrl:0
  v_add_f32_dpp v104, v104, v104 row_bcast:15 row_mask:0xa bank_mask:0xf
  v_add_f32_dpp v105, v105, v105 row_bcast:15 row_mask:0xa bank_mask:0xf
  v_add_f32_dpp v106, v106, v106 row_bcast:15 row_mask:0xa bank_mask:0xf
  v_add_f32_dpp v107, v107, v107 row_bcast:15 row_mask:0xa bank_mask:0xf
  v_add_f32_dpp v104, v104, v104 row_bcast:31 row_mask:0xc bank_mask:0xf
  v_add_f32_dpp v105, v105, v105 row_bcast:31 row_mask:0xc bank_mask:0xf
  v_add_f32_dpp v106, v106, v106 row_bcast:31 row_mask:0xc bank_mask:0xf
  v_add_f32_dpp v107, v107, v107 row_bcast:31 row_mask:0xc bank_mask:0xf
  v_mul_f32 v104, 0x3b000000, v104
  v_mul_f32 v106, 0x3b000000, v106
  v_mul_f32 v105, 0x3b000000, v105
  v_mul_f32 v107, 0x3b000000, v107
  v_fma_f32 v105, -v104, v104, v105
  v_fma_f32 v107, -v106, v106, v107
  v_max_f32 v105, 0, v105
  v_max_f32 v107, 0, v107
  v_cvt_pk_bf16_f32 v110, 0, v105
  v_cvt_pk_bf16_f32 v111, 0, v107
  v_add_f32 v110, 0x3727c5ac, v110
  v_add_f32 v111, 0x3727c5ac, v111
  v_cvt_pk_bf16_f32 v110, 0, v110
  v_cvt_pk_bf16_f32 v111, 0, v111
  v_sqrt_f32 v110, v110
  v_sqrt_f32 v111, v111
  v_cvt_pk_bf16_f32 v108, -v104, v110
  v_cvt_pk_bf16_f32 v109, -v106, v111
  v_readlane_b32 s16, v108, 63
  v_readlane_b32 s17, v109, 63
  s_nop 1
  v_mov_b64 v[108:109], s[16:17]
  s_waitcnt vmcnt(4)
  v_lshlrev_b32 v4, 16, v4
  v_lshlrev_b32 v5, 16, v5
  v_lshlrev_b32 v6, 16, v6
  v_lshlrev_b32 v7, 16, v7
  v_lshlrev_b32 v9, 16, v9
  v_lshlrev_b32 v10, 16, v10
  v_mul_f32 v4, v4, v18
  v_exp_f32 v4, v4
  s_nop 0
  v_cvt_pk_bf16_f32 v4, 0, v4
  v_mul_f32 v4, v4, v19
  v_mul_f32 v4, v4, v18
  v_mul_f32 v5, v5, v19
  v_mul_f32 v5, 0.15915494, v5
  v_max_f32 v20, abs(v6), abs(v7)
  v_max3_f32 v20, abs(v9), abs(v10), v20
  s_nop 1
  v_max_f32_dpp v20, v20, v20 row_shr:1 row_mask:0xf bank_mask:0xf bound_ctrl:0
  s_nop 1
  v_max_f32_dpp v20, v20, v20 row_shr:2 row_mask:0xf bank_mask:0xf bound_ctrl:0
  s_nop 1
  v_max_f32_dpp v20, v20, v20 row_shr:4 row_mask:0xf bank_mask:0xf bound_ctrl:0
  s_nop 1
  v_max_f32_dpp v20, v20, v20 row_shr:8 row_mask:0xf bank_mask:0xf bound_ctrl:0
  s_nop 1
  v_max_f32_dpp v20, v20, v20 row_bcast:15 row_mask:0xa bank_mask:0xf
  s_nop 1
  v_max_f32_dpp v20, v20, v20 row_bcast:31 row_mask:0xc bank_mask:0xf
  v_frexp_exp_i32_f32 v20, v20
  s_nop 0
  v_readlane_b32 s67, v20, 63
  s_nop 0
  s_sub_i32 s68, 0, s67
  v_ldexp_f32 v22, v6, s68
  v_ldexp_f32 v23, v7, s68
  s_add_i32 s67, s67, 1
  v_ldexp_f32 v21, v19, s67
  v_mul_f32 v24, 0xbf800000, v4
  v_mul_f32 v25, 0x3f800000, v5
  v_exp_f32 v24, v24
  v_fract_f32 v25, v25
  v_cos_f32 v26, v25
  v_sin_f32 v27, v25
  v_mul_f32 v30, v24, v26
  v_mul_f32 v31, v24, v27
  v_mul_f32 v24, 0xc1000000, v4
  v_mul_f32 v25, 0x41000000, v5
  v_exp_f32 v24, v24
  v_fract_f32 v25, v25
  v_cos_f32 v26, v25
  v_sin_f32 v27, v25
  v_mul_f32 v32, v24, v26
  v_mul_f32 v33, v24, v27
  v_mul_f32 v24, 0xc2800000, v4
  v_mul_f32 v25, 0x42800000, v5
  v_exp_f32 v24, v24
  v_fract_f32 v25, v25
  v_cos_f32 v26, v25
  v_sin_f32 v27, v25
  s_waitcnt vmcnt(0)
S0_np:
  v_readfirstlane_b32 s10, v168
  v_readfirstlane_b32 s11, v169
  s_cmp_lg_u32 s10, 0
  s_cbranch_scc1 S0_nok
  s_cmp_eq_u32 s9, 0
  s_cbranch_scc1 S0_nok
  s_sub_u32 s9, s9, 1
  global_load_dwordx2 v[168:169], v170, s[40:41] sc1
  s_waitcnt vmcnt(0)
  s_branch S0_np
S0_nok:
  s_waitcnt lgkmcnt(0)
  s_barrier
  ds_read_b64_tr_b16 v[192:193], v159 offset:0
  ds_read_b64_tr_b16 v[196:197], v159 offset:64
  ds_read_b64_tr_b16 v[200:201], v159 offset:128
  ds_read_b64_tr_b16 v[204:205], v159 offset:192
  v_mov_b64 v[110:111], s[10:11]
  v_mov_b64 v[194:195], s[10:11]
  v_mov_b64 v[198:199], s[10:11]
  v_mov_b64 v[202:203], s[10:11]
  v_mov_b64 v[206:207], s[10:11]
  buffer_store_dwordx4 v[108:111], v176, s[44:47], s25 offen sc1
  v_mul_f32 v34, v24, v26
  v_mul_f32 v35, v24, v27
  v_mul_f32 v24, 0xc3800000, v4
  v_mul_f32 v25, 0x43800000, v5
  v_exp_f32 v24, v24
  v_fract_f32 v25, v25
  v_cos_f32 v26, v25
  v_sin_f32 v27, v25
  s_waitcnt lgkmcnt(3)
  buffer_store_dwordx4 v[192:195], v160, s[44:47], s26 offen sc1
  v_mul_f32 v36, v24, v26
  v_mul_f32 v37, v24, v27
  s_waitcnt lgkmcnt(2)
  buffer_store_dwordx4 v[196:199], v165, s[44:47], s26 offen sc1
  v_mov_b32 v28, 0x3c00
  ds_write_b32 v8, v28
  s_waitcnt lgkmcnt(2)
  buffer_store_dwordx4 v[200:203], v160, s[44:47], s27 offen sc1
  v_pk_mul_f32 v[38:39], v[32:33], v[32:33] op_sel:[0,0] op_sel_hi:[0,1]
  v_pk_fma_f32 v[38:39], v[32:33], v[32:33], v[38:39] op_sel:[1,1,0] op_sel_hi:[1,0,1] neg_lo:[0,1,0]
  s_waitcnt lgkmcnt(1)
  buffer_store_dwordx4 v[204:207], v165, s[44:47], s27 offen sc1
  v_pk_mul_f32 v[40:41], v[30:31], v[30:31] op_sel:[0,0] op_sel_hi:[0,1]
  v_pk_fma_f32 v[40:41], v[30:31], v[30:31], v[40:41] op_sel:[1,1,0] op_sel_hi:[1,0,1] neg_lo:[0,1,0]
  v_pk_mul_f32 v[42:43], v[38:39], v[32:33] op_sel:[0,0] op_sel_hi:[0,1]
  v_pk_fma_f32 v[42:43], v[38:39], v[32:33], v[42:43] op_sel:[1,1,0] op_sel_hi:[1,0,1] neg_lo:[0,1,0]
  v_pk_mul_f32 v[44:45], v[40:41], v[30:31] op_sel:[0,0] op_sel_hi:[0,1]
  v_pk_fma_f32 v[44:45], v[40:41], v[30:31], v[44:45] op_sel:[1,1,0] op_sel_hi:[1,0,1] neg_lo:[0,1,0]
  v_pk_mul_f32 v[46:47], v[42:43], v[32:33] op_sel:[0,0] op_sel_hi:[0,1]
  v_pk_fma_f32 v[46:47], v[42:43], v[32:33], v[46:47] op_sel:[1,1,0] op_sel_hi:[1,0,1] neg_lo:[0,1,0]
  v_pk_mul_f32 v[48:49], v[44:45], v[30:31] op_sel:[0,0] op_sel_hi:[0,1]
  v_pk_fma_f32 v[48:49], v[44:45], v[30:31], v[48:49] op_sel:[1,1,0] op_sel_hi:[1,0,1] neg_lo:[0,1,0]
  v_pk_mul_f32 v[50:51], v[46:47], v[32:33] op_sel:[0,0] op_sel_hi:[0,1]
  global_load_dwordx4 a[240:243], v174, s[36:37]
  global_load_dwordx4 a[244:247], v175, s[36:37]
  v_pk_fma_f32 v[50:51], v[46:47], v[32:33], v[50:51] op_sel:[1,1,0] op_sel_hi:[1,0,1] neg_lo:[0,1,0]
  v_pk_mul_f32 v[52:53], v[48:49], v[30:31] op_sel:[0,0] op_sel_hi:[0,1]
  v_pk_fma_f32 v[52:53], v[48:49], v[30:31], v[52:53] op_sel:[1,1,0] op_sel_hi:[1,0,1] neg_lo:[0,1,0]
  v_pk_mul_f32 v[54:55], v[50:51], v[32:33] op_sel:[0,0] op_sel_hi:[0,1]
  v_pk_fma_f32 v[54:55], v[50:51], v[32:33], v[54:55] op_sel:[1,1,0] op_sel_hi:[1,0,1] neg_lo:[0,1,0]
  s_mov_b32 exec_lo, 0x0
  s_mov_b32 exec_hi, 0xffff0000
  buffer_load_dword a255, v173, s[48:51], 0 offen sc1
  s_mov_b64 exec, -1
  s_mov_b32 exec_hi, 0xffff
  buffer_load_dword a255, v173, s[48:51], s59 offen sc1
  s_mov_b64 exec, -1
  v_pk_mul_f32 v[56:57], v[52:53], v[30:31] op_sel:[0,0] op_sel_hi:[0,1]
  v_pk_fma_f32 v[56:57], v[52:53], v[30:31], v[56:57] op_sel:[1,1,0] op_sel_hi:[1,0,1] neg_lo:[0,1,0]
  v_pk_mul_f32 v[58:59], v[54:55], v[32:33] op_sel:[0,0] op_sel_hi:[0,1]
  v_pk_fma_f32 v[58:59], v[54:55], v[32:33], v[58:59] op_sel:[1,1,0] op_sel_hi:[1,0,1] neg_lo:[0,1,0]
  v_pk_mul_f32 v[60:61], v[56:57], v[30:31] op_sel:[0,0] op_sel_hi:[0,1]
  v_pk_fma_f32 v[60:61], v[56:57], v[30:31], v[60:61] op_sel:[1,1,0] op_sel_hi:[1,0,1] neg_lo:[0,1,0]
  v_pk_mul_f32 v[62:63], v[34:35], v[34:35] op_sel:[0,0] op_sel_hi:[0,1]
  v_pk_fma_f32 v[62:63], v[34:35], v[34:35], v[62:63] op_sel:[1,1,0] op_sel_hi:[1,0,1] neg_lo:[0,1,0]
  v_pk_mul_f32 v[64:65], v[62:63], v[34:35] op_sel:[0,0] op_sel_hi:[0,1]
  v_pk_fma_f32 v[64:65], v[62:63], v[34:35], v[64:65] op_sel:[1,1,0] op_sel_hi:[1,0,1] neg_lo:[0,1,0]
  v_cvt_pk_f16_f32 v28, v32, v33
  ds_write_b32 v8, v28 offset:528
  v_cvt_pk_f16_f32 v28, v38, v39
  ds_write_b32 v8, v28 offset:1056
  v_cvt_pk_f16_f32 v28, v42, v43
  ds_write_b32 v8, v28 offset:1584
  v_cvt_pk_f16_f32 v28, v46, v47
  ds_write_b32 v8, v28 offset:2112
  v_cvt_pk_f16_f32 v28, v50, v51
  ds_write_b32 v8, v28 offset:2640
  v_cvt_pk_f16_f32 v28, v54, v55
  ds_write_b32 v8, v28 offset:3168
  v_cvt_pk_f16_f32 v28, v58, v59
  ds_write_b32 v8, v28 offset:3696
  v_cvt_pk_f16_f32 v28, v34, v35
  ds_write_b32 v8, v28 offset:4224
  v_cvt_pk_f16_f32 v28, v62, v63
  ds_write_b32 v8, v28 offset:8448
  v_cvt_pk_f16_f32 v28, v64, v65
  ds_write_b32 v8, v28 offset:12672
  v_pk_mul_f32 v[66:67], v[34:35], v[32:33] op_sel:[0,0] op_sel_hi:[0,1]
  v_pk_fma_f32 v[66:67], v[34:35], v[32:33], v[66:67] op_sel:[1,1,0] op_sel_hi:[1,0,1] neg_lo:[0,1,0]
  v_cvt_pk_f16_f32 v28, v66, v67
  ds_write_b32 v8, v28 offset:4752
  v_pk_mul_f32 v[68:69], v[34:35], v[38:39] op_sel:[0,0] op_sel_hi:[0,1]
  v_pk_fma_f32 v[68:69], v[34:35], v[38:39], v[68:69] op_sel:[1,1,0] op_sel_hi:[1,0,1] neg_lo:[0,1,0]
  v_cvt_pk_f16_f32 v28, v68, v69
  ds_write_b32 v8, v28 offset:5280
  v_pk_mul_f32 v[66:67], v[34:35], v[42:43] op_sel:[0,0] op_sel_hi:[0,1]
  v_pk_fma_f32 v[66:67], v[34:35], v[42:43], v[66:67] op_sel:[1,1,0] op_sel_hi:[1,0,1] neg_lo:[0,1,0]
  v_cvt_pk_f16_f32 v28, v66, v67
  ds_write_b32 v8, v28 offset:5808
  v_pk_mul_f32 v[68:69], v[34:35], v[46:47] op_sel:[0,0] op_sel_hi:[0,1]
  v_pk_fma_f32 v[68:69], v[34:35], v[46:47], v[68:69] op_sel:[1,1,0] op_sel_hi:[1,0,1] neg_lo:[0,1,0]
  v_cvt_pk_f16_f32 v28, v68, v69
  ds_write_b32 v8, v28 offset:6336
  v_pk_mul_f32 v[66:67], v[34:35], v[50:51] op_sel:[0,0] op_sel_hi:[0,1]
  v_pk_fma_f32 v[66:67], v[34:35], v[50:51], v[66:67] op_sel:[1,1,0] op_sel_hi:[1,0,1] neg_lo:[0,1,0]
  v_cvt_pk_f16_f32 v28, v66, v67
  ds_write_b32 v8, v28 offset:6864
  v_pk_mul_f32 v[68:69], v[34:35], v[54:55] op_sel:[0,0] op_sel_hi:[0,1]
  v_pk_fma_f32 v[68:69], v[34:35], v[54:55], v[68:69] op_sel:[1,1,0] op_sel_hi:[1,0,1] neg_lo:[0,1,0]
  v_cvt_pk_f16_f32 v28, v68, v69
  ds_write_b32 v8, v28 offset:7392
  v_pk_mul_f32 v[66:67], v[34:35], v[58:59] op_sel:[0,0] op_sel_hi:[0,1]
  v_pk_fma_f32 v[66:67], v[34:35], v[58:59], v[66:67] op_sel:[1,1,0] op_sel_hi:[1,0,1] neg_lo:[0,1,0]
  v_cvt_pk_f16_f32 v28, v66, v67
  ds_write_b32 v8, v28 offset:7920
  v_pk_mul_f32 v[66:67], v[62:63], v[32:33] op_sel:[0,0] op_sel_hi:[0,1]
  v_pk_fma_f32 v[66:67], v[62:63], v[32:33], v[66:67] op_sel:[1,1,0] op_sel_hi:[1,0,1] neg_lo:[0,1,0]
  v_cvt_pk_f16_f32 v28, v66, v67
  ds_write_b32 v8, v28 offset:8976
  v_pk_mul_f32 v[68:69], v[62:63], v[38:39] op_sel:[0,0] op_sel_hi:[0,1]
  v_pk_fma_f32 v[68:69], v[62:63], v[38:39], v[68:69] op_sel:[1,1,0] op_sel_hi:[1,0,1] neg_lo:[0,1,0]
  v_cvt_pk_f16_f32 v28, v68, v69
  ds_write_b32 v8, v28 offset:9504
  v_pk_mul_f32 v[66:67], v[62:63], v[42:43] op_sel:[0,0] op_sel_hi:[0,1]
  v_pk_fma_f32 v[66:67], v[62:63], v[42:43], v[66:67] op_sel:[1,1,0] op_sel_hi:[1,0,1] neg_lo:[0,1,0]
  v_cvt_pk_f16_f32 v28, v66, v67
  ds_write_b32 v8, v28 offset:10032
  v_pk_mul_f32 v[68:69], v[62:63], v[46:47] op_sel:[0,0] op_sel_hi:[0,1]
  v_pk_fma_f32 v[68:69], v[62:63], v[46:47], v[68:69] op_sel:[1,1,0] op_sel_hi:[1,0,1] neg_lo:[0,1,0]
  v_cvt_pk_f16_f32 v28, v68, v69
  ds_write_b32 v8, v28 offset:10560
  v_pk_mul_f32 v[66:67], v[62:63], v[50:51] op_sel:[0,0] op_sel_hi:[0,1]
  v_pk_fma_f32 v[66:67], v[62:63], v[50:51], v[66:67] op_sel:[1,1,0] op_sel_hi:[1,0,1] neg_lo:[0,1,0]
  v_cvt_pk_f16_f32 v28, v66, v67
  ds_write_b32 v8, v28 offset:11088
  v_pk_mul_f32 v[68:69], v[62:63], v[54:55] op_sel:[0,0] op_sel_hi:[0,1]
  v_pk_fma_f32 v[68:69], v[62:63], v[54:55], v[68:69] op_sel:[1,1,0] op_sel_hi:[1,0,1] neg_lo:[0,1,0]
  v_cvt_pk_f16_f32 v28, v68, v69
  ds_write_b32 v8, v28 offset:11616
  v_pk_mul_f32 v[66:67], v[62:63], v[58:59] op_sel:[0,0] op_sel_hi:[0,1]
  v_pk_fma_f32 v[66:67], v[62:63], v[58:59], v[66:67] op_sel:[1,1,0] op_sel_hi:[1,0,1] neg_lo:[0,1,0]
  v_cvt_pk_f16_f32 v28, v66, v67
  ds_write_b32 v8, v28 offset:12144
  v_pk_mul_f32 v[66:67], v[64:65], v[32:33] op_sel:[0,0] op_sel_hi:[0,1]
  v_pk_fma_f32 v[66:67], v[64:65], v[32:33], v[66:67] op_sel:[1,1,0] op_sel_hi:[1,0,1] neg_lo:[0,1,0]
  v_cvt_pk_f16_f32 v28, v66, v67
  ds_write_b32 v8, v28 offset:13200
  v_pk_mul_f32 v[68:69], v[64:65], v[38:39] op_sel:[0,0] op_sel_hi:[0,1]
  v_pk_fma_f32 v[68:69], v[64:65], v[38:39], v[68:69] op_sel:[1,1,0] op_sel_hi:[1,0,1] neg_lo:[0,1,0]
  v_cvt_pk_f16_f32 v28, v68, v69
  ds_write_b32 v8, v28 offset:13728
  v_pk_mul_f32 v[66:67], v[64:65], v[42:43] op_sel:[0,0] op_sel_hi:[0,1]
  v_pk_fma_f32 v[66:67], v[64:65], v[42:43], v[66:67] op_sel:[1,1,0] op_sel_hi:[1,0,1] neg_lo:[0,1,0]
  v_cvt_pk_f16_f32 v28, v66, v67
  ds_write_b32 v8, v28 offset:14256
  v_pk_mul_f32 v[68:69], v[64:65], v[46:47] op_sel:[0,0] op_sel_hi:[0,1]
  v_pk_fma_f32 v[68:69], v[64:65], v[46:47], v[68:69] op_sel:[1,1,0] op_sel_hi:[1,0,1] neg_lo:[0,1,0]
  v_cvt_pk_f16_f32 v28, v68, v69
  ds_write_b32 v8, v28 offset:14784
  v_pk_mul_f32 v[66:67], v[64:65], v[50:51] op_sel:[0,0] op_sel_hi:[0,1]
  v_pk_fma_f32 v[66:67], v[64:65], v[50:51], v[66:67] op_sel:[1,1,0] op_sel_hi:[1,0,1] neg_lo:[0,1,0]
  v_cvt_pk_f16_f32 v28, v66, v67
  ds_write_b32 v8, v28 offset:15312
  v_pk_mul_f32 v[68:69], v[64:65], v[54:55] op_sel:[0,0] op_sel_hi:[0,1]
  v_pk_fma_f32 v[68:69], v[64:65], v[54:55], v[68:69] op_sel:[1,1,0] op_sel_hi:[1,0,1] neg_lo:[0,1,0]
  v_cvt_pk_f16_f32 v28, v68, v69
  ds_write_b32 v8, v28 offset:15840
  v_pk_mul_f32 v[66:67], v[64:65], v[58:59] op_sel:[0,0] op_sel_hi:[0,1]
  v_pk_fma_f32 v[66:67], v[64:65], v[58:59], v[66:67] op_sel:[1,1,0] op_sel_hi:[1,0,1] neg_lo:[0,1,0]
  v_cvt_pk_f16_f32 v28, v66, v67
  ds_write_b32 v8, v28 offset:16368
  v_cvt_pk_f16_f32 v29, v22, -v23
  ds_write_b32 v8, v29 offset:16896
  v_pk_mul_f32 v[70:71], v[22:23], v[36:37] op_sel:[0,0] op_sel_hi:[0,1]
  v_pk_fma_f32 v[70:71], v[22:23], v[36:37], v[70:71] op_sel:[1,1,0] op_sel_hi:[1,0,1] neg_lo:[0,1,0]
  v_cvt_pk_f16_f32 v29, v70, -v71
  ds_write_b32 v8, v29 offset:17424
  v_pk_mul_f32 v[72:73], v[70:71], v[36:37] op_sel:[0,0] op_sel_hi:[0,1]
  v_pk_fma_f32 v[72:73], v[70:71], v[36:37], v[72:73] op_sel:[1,1,0] op_sel_hi:[1,0,1] neg_lo:[0,1,0]
  v_cvt_pk_f16_f32 v29, v72, -v73
  ds_write_b32 v8, v29 offset:17952
  v_pk_mul_f32 v[74:75], v[72:73], v[36:37] op_sel:[0,0] op_sel_hi:[0,1]
  v_pk_fma_f32 v[74:75], v[72:73], v[36:37], v[74:75] op_sel:[1,1,0] op_sel_hi:[1,0,1] neg_lo:[0,1,0]
  v_cvt_pk_f16_f32 v29, v74, -v75
  ds_write_b32 v8, v29 offset:18480
  v_pk_mul_f32 v[76:77], v[74:75], v[36:37] op_sel:[0,0] op_sel_hi:[0,1]
  v_pk_fma_f32 v[76:77], v[74:75], v[36:37], v[76:77] op_sel:[1,1,0] op_sel_hi:[1,0,1] neg_lo:[0,1,0]
  v_cvt_pk_f16_f32 v29, v76, -v77
  ds_write_b32 v8, v29 offset:19008
  v_pk_mul_f32 v[78:79], v[76:77], v[36:37] op_sel:[0,0] op_sel_hi:[0,1]
  v_pk_fma_f32 v[78:79], v[76:77], v[36:37], v[78:79] op_sel:[1,1,0] op_sel_hi:[1,0,1] neg_lo:[0,1,0]
  v_cvt_pk_f16_f32 v29, v78, -v79
  ds_write_b32 v8, v29 offset:19536
  v_pk_mul_f32 v[80:81], v[78:79], v[36:37] op_sel:[0,0] op_sel_hi:[0,1]
  v_pk_fma_f32 v[80:81], v[78:79], v[36:37], v[80:81] op_sel:[1,1,0] op_sel_hi:[1,0,1] neg_lo:[0,1,0]
  v_cvt_pk_f16_f32 v29, v80, -v81
  ds_write_b32 v8, v29 offset:20064
  v_pk_mul_f32 v[82:83], v[80:81], v[36:37] op_sel:[0,0] op_sel_hi:[0,1]
  v_pk_fma_f32 v[82:83], v[80:81], v[36:37], v[82:83] op_sel:[1,1,0] op_sel_hi:[1,0,1] neg_lo:[0,1,0]
  v_cvt_pk_f16_f32 v29, v82, -v83
  ds_write_b32 v8, v29 offset:20592
  v_pk_mul_f32 v[84:85], v[82:83], v[36:37] op_sel:[0,0] op_sel_hi:[0,1]
  v_pk_fma_f32 v[84:85], v[82:83], v[36:37], v[84:85] op_sel:[1,1,0] op_sel_hi:[1,0,1] neg_lo:[0,1,0]
  v_cvt_pk_f16_f32 v29, v84, -v85
  ds_write_b32 v8, v29 offset:21120
  v_pk_mul_f32 v[68:69], v[22:23], v[48:49] op_sel:[0,0] op_sel_hi:[0,1]
  v_pk_fma_f32 v[68:69], v[22:23], v[48:49], v[68:69] op_sel:[1,1,0] op_sel_hi:[1,0,1] neg_lo:[0,1,0]
  v_cvt_pk_f16_f32 v29, v68, -v69
  ds_write_b32 v8, v29 offset:21648
  v_pk_mul_f32 v[66:67], v[70:71], v[48:49] op_sel:[0,0] op_sel_hi:[0,1]
  v_pk_fma_f32 v[66:67], v[70:71], v[48:49], v[66:67] op_sel:[1,1,0] op_sel_hi:[1,0,1] neg_lo:[0,1,0]
  v_cvt_pk_f16_f32 v29, v66, -v67
  ds_write_b32 v8, v29 offset:22176
  v_pk_mul_f32 v[68:69], v[72:73], v[48:49] op_sel:[0,0] op_sel_hi:[0,1]
  v_pk_fma_f32 v[68:69], v[72:73], v[48:49], v[68:69] op_sel:[1,1,0] op_sel_hi:[1,0,1] neg_lo:[0,1,0]
  v_cvt_pk_f16_f32 v29, v68, -v69
  ds_write_b32 v8, v29 offset:22704
  v_pk_mul_f32 v[66:67], v[74:75], v[48:49] op_sel:[0,0] op_sel_hi:[0,1]
  v_pk_fma_f32 v[66:67], v[74:75], v[48:49], v[66:67] op_sel:[1,1,0] op_sel_hi:[1,0,1] neg_lo:[0,1,0]
  v_cvt_pk_f16_f32 v29, v66, -v67
  ds_write_b32 v8, v29 offset:23232
  v_pk_mul_f32 v[68:69], v[22:23], v[40:41] op_sel:[0,0] op_sel_hi:[0,1]
  v_pk_fma_f32 v[68:69], v[22:23], v[40:41], v[68:69] op_sel:[1,1,0] op_sel_hi:[1,0,1] neg_lo:[0,1,0]
  v_cvt_pk_f16_f32 v29, v68, -v69
  ds_write_b32 v8, v29 offset:23760
  v_pk_mul_f32 v[66:67], v[70:71], v[40:41] op_sel:[0,0] op_sel_hi:[0,1]
  v_pk_fma_f32 v[66:67], v[70:71], v[40:41], v[66:67] op_sel:[1,1,0] op_sel_hi:[1,0,1] neg_lo:[0,1,0]
  v_cvt_pk_f16_f32 v29, v66, -v67
  ds_write_b32 v8, v29 offset:24288
  v_pk_mul_f32 v[68:69], v[22:23], v[56:57] op_sel:[0,0] op_sel_hi:[0,1]
  v_pk_fma_f32 v[68:69], v[22:23], v[56:57], v[68:69] op_sel:[1,1,0] op_sel_hi:[1,0,1] neg_lo:[0,1,0]
  v_cvt_pk_f16_f32 v29, v68, -v69
  ds_write_b32 v8, v29 offset:24816
  v_pk_mul_f32 v[66:67], v[70:71], v[56:57] op_sel:[0,0] op_sel_hi:[0,1]
  v_pk_fma_f32 v[66:67], v[70:71], v[56:57], v[66:67] op_sel:[1,1,0] op_sel_hi:[1,0,1] neg_lo:[0,1,0]
  v_cvt_pk_f16_f32 v29, v66, -v67
  ds_write_b32 v8, v29 offset:25344
  v_pk_mul_f32 v[68:69], v[22:23], v[30:31] op_sel:[0,0] op_sel_hi:[0,1]
  v_pk_fma_f32 v[68:69], v[22:23], v[30:31], v[68:69] op_sel:[1,1,0] op_sel_hi:[1,0,1] neg_lo:[0,1,0]
  v_cvt_pk_f16_f32 v29, v68, -v69
  ds_write_b32 v8, v29 offset:25872
  v_pk_mul_f32 v[66:67], v[22:23], v[44:45] op_sel:[0,0] op_sel_hi:[0,1]
  v_pk_fma_f32 v[66:67], v[22:23], v[44:45], v[66:67] op_sel:[1,1,0] op_sel_hi:[1,0,1] neg_lo:[0,1,0]
  v_cvt_pk_f16_f32 v29, v66, -v67
  ds_write_b32 v8, v29 offset:26400
  v_pk_mul_f32 v[68:69], v[22:23], v[52:53] op_sel:[0,0] op_sel_hi:[0,1]
  v_pk_fma_f32 v[68:69], v[22:23], v[52:53], v[68:69] op_sel:[1,1,0] op_sel_hi:[1,0,1] neg_lo:[0,1,0]
  v_cvt_pk_f16_f32 v29, v68, -v69
  ds_write_b32 v8, v29 offset:26928
  v_pk_mul_f32 v[66:67], v[22:23], v[60:61] op_sel:[0,0] op_sel_hi:[0,1]
  v_pk_fma_f32 v[66:67], v[22:23], v[60:61], v[66:67] op_sel:[1,1,0] op_sel_hi:[1,0,1] neg_lo:[0,1,0]
  v_cvt_pk_f16_f32 v29, v66, -v67
  ds_write_b32 v8, v29 offset:27456
  s_waitcnt lgkmcnt(0)
  s_barrier
  ds_read_b128 v[32:35], v12 offset:0
  ds_read_b128 v[64:67], v13 offset:16896
  ds_read_b128 v[36:39], v12 offset:64
  ds_read_b128 v[68:71], v13 offset:16960
  ds_read_b128 v[40:43], v12 offset:128
  ds_read_b128 v[72:75], v13 offset:17024
  ds_read_b128 v[44:47], v12 offset:192
  ds_read_b128 v[76:79], v13 offset:17088
  ds_read_b128 v[48:51], v12 offset:256
  ds_read_b128 v[80:83], v13 offset:17152
  ds_read_b128 v[52:55], v12 offset:320
  ds_read_b128 v[84:87], v13 offset:17216
  ds_read_b128 v[56:59], v12 offset:384
  ds_read_b128 v[88:91], v13 offset:17280
  ds_read_b128 v[60:63], v12 offset:448
  ds_read_b128 v[92:95], v13 offset:17344
  v_lshlrev_b32 v17, 3, v17
  v_sub_u32 v17, 2048, v17
  v_cvt_f32_u32 v17, v17
  v_add_f32 v128, 0x80000000, v17
  v_add_f32 v129, 0xbf800000, v17
  v_add_f32 v130, 0xc0000000, v17
  v_add_f32 v131, 0xc0400000, v17
  v_add_f32 v132, 0xc0800000, v17
  v_add_f32 v133, 0xc0a00000, v17
  v_add_f32 v134, 0xc0c00000, v17
  v_add_f32 v135, 0xc0e00000, v17
  v_add_f32 v136, 0xc1000000, v17
  v_add_f32 v137, 0xc4800000, v17
  v_add_f32 v138, 0xc4802000, v17
  v_add_f32 v139, 0xc4804000, v17
  v_add_f32 v140, 0xc4806000, v17
  v_add_f32 v141, 0xc4808000, v17
  v_add_f32 v142, 0xc480a000, v17
  v_add_f32 v143, 0xc480c000, v17
  v_add_f32 v144, 0xc480e000, v17
  s_waitcnt lgkmcnt(14)
  v_mfma_f32_16x16x32_f16 v[4:7], v[32:35], v[64:67], 0
  ds_read_b128 v[224:227], v14 offset:25344
  v_add_f32 v145, 0xc4810000, v17
  v_cvt_pk_bf16_f32 v128, 0, v128
  s_waitcnt lgkmcnt(13)
  v_mfma_f32_16x16x32_f16 v[4:7], v[36:39], v[68:71], v[4:7]
  ds_read_b128 v[228:231], v14 offset:25408
  v_cvt_pk_bf16_f32 v129, 0, v129
  v_cvt_pk_bf16_f32 v130, 0, v130
  s_waitcnt lgkmcnt(12)
  v_mfma_f32_16x16x32_f16 v[4:7], v[40:43], v[72:75], v[4:7]
  ds_read_b128 v[232:235], v14 offset:25472
  v_cvt_pk_bf16_f32 v131, 0, v131
  v_cvt_pk_bf16_f32 v132, 0, v132
  s_waitcnt lgkmcnt(11)
  v_mfma_f32_16x16x32_f16 v[4:7], v[44:47], v[76:79], v[4:7]
  ds_read_b128 v[236:239], v14 offset:25536
  v_cvt_pk_bf16_f32 v133, 0, v133
  v_cvt_pk_bf16_f32 v134, 0, v134
  s_waitcnt lgkmcnt(10)
  v_mfma_f32_16x16x32_f16 v[4:7], v[48:51], v[80:83], v[4:7]
  ds_read_b128 v[240:243], v14 offset:25600
  v_cvt_pk_bf16_f32 v135, 0, v135
  v_cvt_pk_bf16_f32 v136, 0, v136
  s_waitcnt lgkmcnt(9)
  v_mfma_f32_16x16x32_f16 v[4:7], v[52:55], v[84:87], v[4:7]
  ds_read_b128 v[244:247], v14 offset:25664
  v_cvt_pk_bf16_f32 v137, 0, v137
  v_cvt_pk_bf16_f32 v138, 0, v138
  s_waitcnt lgkmcnt(8)
  v_mfma_f32_16x16x32_f16 v[4:7], v[56:59], v[88:91], v[4:7]
  ds_read_b128 v[248:251], v14 offset:25728
  v_cvt_pk_bf16_f32 v139, 0, v139
  v_cvt_pk_bf16_f32 v140, 0, v140
  s_waitcnt lgkmcnt(7)
  v_mfma_f32_16x16x32_f16 v[4:7], v[60:63], v[92:95], v[4:7]
  ds_read_b128 v[252:255], v14 offset:25792
  v_cvt_pk_bf16_f32 v141, 0, v141
  v_cvt_pk_bf16_f32 v142, 0, v142
  s_waitcnt lgkmcnt(7)
  v_mfma_f32_16x16x32_f16 v[24:27], v[32:35], v[224:227], 0
  v_cvt_pk_bf16_f32 v143, 0, v143
  v_cvt_pk_bf16_f32 v144, 0, v144
  s_waitcnt lgkmcnt(6)
  v_mfma_f32_16x16x32_f16 v[24:27], v[36:39], v[228:231], v[24:27]
  v_cvt_pk_bf16_f32 v145, 0, v145
  v_cvt_u32_f32 v128, v128
  s_waitcnt lgkmcnt(5)
  v_mfma_f32_16x16x32_f16 v[24:27], v[40:43], v[232:235], v[24:27]
  v_lshl_add_u32 v128, v128, 1, s58
  v_cvt_u32_f32 v129, v129
  s_waitcnt lgkmcnt(4)
  v_mfma_f32_16x16x32_f16 v[24:27], v[44:47], v[236:239], v[24:27]
  v_lshl_add_u32 v129, v129, 1, s58
  v_cvt_u32_f32 v130, v130
  s_waitcnt lgkmcnt(3)
  v_mfma_f32_16x16x32_f16 v[24:27], v[48:51], v[240:243], v[24:27]
  v_lshl_add_u32 v130, v130, 1, s58
  v_cvt_u32_f32 v131, v131
  s_waitcnt lgkmcnt(2)
  v_mfma_f32_16x16x32_f16 v[24:27], v[52:55], v[244:247], v[24:27]
  v_lshl_add_u32 v131, v131, 1, s58
  v_cvt_u32_f32 v132, v132
  s_waitcnt lgkmcnt(1)
  v_mfma_f32_16x16x32_f16 v[24:27], v[56:59], v[248:251], v[24:27]
  v_lshl_add_u32 v132, v132, 1, s58
  v_cvt_u32_f32 v133, v133
  s_waitcnt lgkmcnt(0)
  v_mfma_f32_16x16x32_f16 v[24:27], v[60:63], v[252:255], v[24:27]
  v_lshl_add_u32 v133, v133, 1, s58
  v_cvt_u32_f32 v134, v134
  v_mul_f32 v4, v4, v21
  v_mul_f32 v5, v5, v21
  v_mul_f32 v6, v6, v21
  v_mul_f32 v7, v7, v21
  v_cvt_pk_bf16_f32 v4, v4, v5
  v_cvt_pk_bf16_f32 v6, v6, v7
  ds_write_b16 v15, v4
  ds_write_b16_d16_hi v15, v4 offset:16
  ds_write_b16 v15, v6 offset:32
  ds_write_b16_d16_hi v15, v6 offset:48
  v_mul_f32 v24, v24, v21
  v_mul_f32 v25, v25, v21
  v_mul_f32 v26, v26, v21
  v_mul_f32 v27, v27, v21
  v_cvt_pk_bf16_f32 v24, v24, v25
  v_cvt_pk_bf16_f32 v26, v26, v27
  ds_write_b16 v16, v24
  ds_write_b16_d16_hi v16, v24 offset:16
  ds_write_b16 v16, v26 offset:32
  ds_write_b16_d16_hi v16, v26 offset:48
  v_lshl_add_u32 v134, v134, 1, s58
  v_cvt_u32_f32 v135, v135
  v_lshl_add_u32 v135, v135, 1, s58
  v_cvt_u32_f32 v136, v136
  v_lshl_add_u32 v136, v136, 1, s58
  v_cvt_u32_f32 v137, v137
  v_lshl_add_u32 v137, v137, 1, s58
  v_cvt_u32_f32 v138, v138
  v_lshl_add_u32 v138, v138, 1, s58
  v_cvt_u32_f32 v139, v139
  v_lshl_add_u32 v139, v139, 1, s58
  v_cvt_u32_f32 v140, v140
  v_lshl_add_u32 v140, v140, 1, s58
  v_cvt_u32_f32 v141, v141
  v_lshl_add_u32 v141, v141, 1, s58
  v_cvt_u32_f32 v142, v142
  v_lshl_add_u32 v142, v142, 1, s58
  v_cvt_u32_f32 v143, v143
  v_lshl_add_u32 v143, v143, 1, s58
  v_cvt_u32_f32 v144, v144
  v_lshl_add_u32 v144, v144, 1, s58
  v_cvt_u32_f32 v145, v145
  v_lshl_add_u32 v145, v145, 1, s58
  s_lshr_b32 s12, s3, 1
  s_mul_i32 s12, s12, 8320
  s_add_u32 s12, s12, 133120
  v_and_b32 v208, 127, v0
  v_lshl_add_u32 v171, v208, 4, s12
  v_sub_u32 v208, 127, v208
  v_and_b32 v209, 1, v208
  v_lshl_add_u32 v172, v209, 4, s12
  v_bfe_u32 v209, v208, 1, 1
  v_mul_u32_u24 v209, 0x1040, v209
  v_add3_u32 v172, v172, v209, 64
  v_add_u32 v172, 4032, v172
  s_mul_i32 s12, s6, 224
  v_lshl_add_u32 v210, v2, 4, s12
  v_add_u32 v211, 4096, v210
  v_mov_b32 v212, 3360
  v_add_u32 v213, 0, v2
  v_mul_u32_u24 v213, 4682, v213
  v_lshrrev_b32 v213, 16, v213
  v_mad_u32_u24 v146, v213, v212, v210
  v_add_u32 v213, 64, v2
  v_mul_u32_u24 v213, 4682, v213
  v_lshrrev_b32 v213, 16, v213
  v_mad_u32_u24 v147, v213, v212, v210
  v_add_u32 v213, 128, v2
  v_mul_u32_u24 v213, 4682, v213
  v_lshrrev_b32 v213, 16, v213
  v_mad_u32_u24 v148, v213, v212, v210
  v_add_u32 v213, 192, v2
  v_mul_u32_u24 v213, 4682, v213
  v_lshrrev_b32 v213, 16, v213
  v_mad_u32_u24 v149, v213, v212, v210
  v_add_u32 v213, 256, v2
  v_mul_u32_u24 v213, 4682, v213
  v_lshrrev_b32 v213, 16, v213
  v_mad_u32_u24 v150, v213, v212, v211
  v_add_u32 v213, 320, v2
  v_mul_u32_u24 v213, 4682, v213
  v_lshrrev_b32 v213, 16, v213
  v_mad_u32_u24 v151, v213, v212, v211
  v_add_u32 v213, 384, v2
  v_mul_u32_u24 v213, 4682, v213
  v_lshrrev_b32 v213, 16, v213
  v_mad_u32_u24 v152, v213, v212, v211
  s_mul_i32 m0, s3, 7168
  s_add_u32 s12, s3, 0
  s_xor_b32 s12, s12, s6
  s_mul_i32 s32, s12, 114688
  s_add_u32 s12, s3, 4
  s_xor_b32 s12, s12, s6
  s_mul_i32 s33, s12, 114688
  s_add_u32 s12, s3, 8
  s_xor_b32 s12, s12, s6
  s_mul_i32 s36, s12, 114688
  s_add_u32 s12, s3, 12
  s_xor_b32 s12, s12, s6
  s_mul_i32 s37, s12, 114688
  v_subrev_u32 v214, 28, v2
  v_max_i32 v214, 0, v214
  v_min_i32 v214, 27, v214
  s_and_b32 s12, s6, 1
  s_lshl_b32 s12, s12, 2
  v_add_u32 v214, s12, v214
  v_subrev_u32 v215, 28, v214
  v_min_u32 v214, v214, v215
  s_mul_i32 s12, s6, 224
  v_lshl_add_u32 v214, v214, 3, s12
  global_load_dwordx2 a[238:239], v214, s[34:35]
  s_waitcnt lgkmcnt(0)
  s_barrier
  ds_read_u16 v32, v128
  ds_read_u16 v64, v129
  ds_read_u16 v33, v130
  ds_read_u16 v65, v131
  ds_read_u16 v34, v132
  ds_read_u16 v66, v133
  ds_read_u16 v35, v134
  ds_read_u16 v67, v135
  ds_read_u16 v36, v136
  ds_read_u16 v40, v137
  ds_read_u16 v72, v138
  ds_read_u16 v41, v139
  ds_read_u16 v73, v140
  ds_read_u16 v42, v141
  ds_read_u16 v74, v142
  ds_read_u16 v43, v143
  ds_read_u16 v75, v144
  ds_read_u16 v44, v145
  s_add_u32 s16, s24, 0
  s_add_u32 s17, s24, 4096
  s_add_u32 s18, s24, 8192
  s_add_u32 s19, s24, 12288
  s_mul_i32 s13, s3, 14
  s_add_u32 s12, s8, 0
  s_and_b32 s12, s12, 3
  s_lshl_b32 s12, s12, 3
  s_lshr_b32 s12, 0x0b070400, s12
  s_and_b32 s12, s12, 0xff
  s_add_u32 s12, s12, s13
  s_lshl_b32 s52, s12, 10
  s_add_u32 s12, s8, 1
  s_and_b32 s12, s12, 3
  s_lshl_b32 s12, s12, 3
  s_lshr_b32 s12, 0x0b070400, s12
  s_and_b32 s12, s12, 0xff
  s_add_u32 s12, s12, s13
  s_lshl_b32 s53, s12, 10
  s_add_u32 s12, s8, 2
  s_and_b32 s12, s12, 3
  s_lshl_b32 s12, s12, 3
  s_lshr_b32 s12, 0x0b070400, s12
  s_and_b32 s12, s12, 0xff
  s_add_u32 s12, s12, s13
  s_lshl_b32 s54, s12, 10
  s_add_u32 s12, s8, 3
  s_and_b32 s12, s12, 3
  s_lshl_b32 s12, s12, 3
  s_lshr_b32 s12, 0x0b070400, s12
  s_and_b32 s12, s12, 0xff
  s_add_u32 s12, s12, s13
  s_lshl_b32 s55, s12, 10
  s_bitcmp0_b32 s8, 0
  s_cselect_b32 s12, 3, 10
  s_cselect_b32 s14, 10, 3
  s_add_u32 s12, s12, s13
  s_add_u32 s14, s14, s13
  s_lshl_b32 s64, s12, 10
  s_lshl_b32 s65, s14, 10
  s_waitcnt lgkmcnt(9)
  v_lshl_or_b32 v32, v64, 16, v32
  v_lshl_or_b32 v33, v65, 16, v33
  v_lshl_or_b32 v34, v66, 16, v34
  v_lshl_or_b32 v35, v67, 16, v35
  s_waitcnt lgkmcnt(0)
  v_lshl_or_b32 v40, v72, 16, v40
  v_lshl_or_b32 v41, v73, 16, v41
  v_lshl_or_b32 v42, v74, 16, v42
  v_lshl_or_b32 v43, v75, 16, v43
  s_waitcnt vmcnt(3)
  ds_write_b128 v161, a[240:243]
  ds_write_b128 v161, a[244:247] offset:1024
  ds_read_b64_tr_b16 a[240:241], v162 offset:0
  ds_read_b64_tr_b16 a[242:243], v163 offset:0
  ds_read_b64_tr_b16 a[244:245], v162 offset:32
  ds_read_b64_tr_b16 a[246:247], v163 offset:32
  ds_write_b128 v171, v[32:35] offset:0
  v_alignbit_b32 v48, v33, v32, 16
  v_alignbit_b32 v49, v34, v33, 16
  v_alignbit_b32 v50, v35, v34, 16
  v_alignbit_b32 v51, v36, v35, 16
  ds_write_b128 v171, v[48:51] offset:4160
  ds_write_b128 v171, v[40:43] offset:2048
  v_alignbit_b32 v52, v41, v40, 16
  v_alignbit_b32 v53, v42, v41, 16
  v_alignbit_b32 v54, v43, v42, 16
  v_alignbit_b32 v55, v44, v43, 16
  ds_write_b128 v171, v[52:55] offset:6208
  v_mov_b32 v57, 0
  v_mov_b32 v58, 0
  v_mov_b32 v59, 0
  v_mov_b32 v56, 0
  v_lshrrev_b32 v48, 5, v2
  v_mul_u32_u24 v48, 0x1000, v48
  v_lshl_add_u32 v48, v2, 4, v48
  v_add_u32 v48, 0x1c000, v48
  ds_write_b128 v48, v[56:59]
  v_and_b32 v49, 127, v0
  v_and_b32 v50, 0xffff, v44
  v_cmp_eq_u32 vcc, 127, v49
  s_nop 1
  v_cndmask_b32 v56, 0, v50, vcc
  s_bitcmp0_b32 s3, 0
  s_cbranch_scc1 KT1
  s_mov_b32 exec_lo, 0
  s_mov_b32 exec_hi, 0xf0000000
  ds_write_b128 v172, v[56:59]
  s_mov_b64 exec, -1
KT1:
  v_accvgpr_write_b32 a224, v32
  v_accvgpr_write_b32 a225, v33
  v_accvgpr_write_b32 a226, v34
  v_accvgpr_write_b32 a227, v35
  v_accvgpr_write_b32 a228, v36
  v_accvgpr_write_b32 a229, v40
  v_accvgpr_write_b32 a230, v41
  v_accvgpr_write_b32 a231, v42
  v_accvgpr_write_b32 a232, v43
  v_accvgpr_write_b32 a233, v44
  s_add_u32 s56, s52, 1024
  s_add_u32 s60, s52, 2048
  s_add_u32 s57, s53, 1024
  s_add_u32 s61, s53, 2048
  s_add_u32 s58, s54, 1024
  s_add_u32 s62, s54, 2048
  s_add_u32 s59, s55, 1024
  s_add_u32 s63, s55, 2048
  v_mov_b32 v12, v153
  v_mov_b32 v103, v166
  v_mov_b32 v96, v146
  v_mov_b32 v97, v147
  v_mov_b32 v98, v148
  v_mov_b32 v99, v149
  v_mov_b32 v100, v150
  v_mov_b32 v101, v151
  v_mov_b32 v102, v152
  s_waitcnt lgkmcnt(0)
  s_barrier
  v_and_b32 v8, 15, v2
  v_lshrrev_b32 v9, 4, v2
  v_and_b32 v10, 1, v2
  v_add_u32 v11, v8, v10
  v_mul_u32_u24 v10, 0x1040, v10
  v_lshl_add_u32 v10, v9, 4, v10
  v_lshlrev_b32 v11, 1, v11
  v_sub_u32 v10, v10, v11
  s_lshr_b32 s12, s3, 1
  s_mul_i32 s13, s12, 8320
  s_and_b32 s14, s3, 1
  s_lshl_b32 s14, s14, 8
  s_sub_u32 s13, s13, s14
  s_add_u32 s13, s13, 136480
  v_add_u32 v3, s13, v10
  v_add_u32 v4, 4294966272, v3
  v_add_u32 v5, 4294965248, v3
  v_add_u32 v6, 4294964224, v3
  s_mul_i32 s13, s12, 4608
  s_sub_u32 s13, s13, s14
  s_add_u32 s13, s13, 114976
  v_lshlrev_b32 v7, 5, v8
  v_lshl_add_u32 v7, v9, 4, v7
  v_add_u32 v7, s13, v7
  v_lshlrev_b32 v32, 4, v0
  ds_read2_b32 v[128:129], v3 offset0:176 offset1:177
  ds_read2_b32 v[130:131], v3 offset0:178 offset1:179
  ds_read2_b32 v[132:133], v3 offset0:160 offset1:161
  ds_read2_b32 v[134:135], v3 offset0:162 offset1:163
  ds_read2_b32 v[136:137], v3 offset0:144 offset1:145
  ds_read2_b32 v[138:139], v3 offset0:146 offset1:147
  ds_read2_b32 v[140:141], v3 offset0:128 offset1:129
  ds_read2_b32 v[142:143], v3 offset0:130 offset1:131
  buffer_load_dwordx4 v[112:115], v12, s[44:47], s28 offen sc1
  buffer_load_dwordx4 v[16:19], v32, s[44:47], s16 offen sc1
  buffer_load_dwordx4 v[116:119], v12, s[44:47], s29 offen sc1
  buffer_load_dwordx4 v[20:23], v32, s[44:47], s17 offen sc1
  buffer_load_dwordx4 v[120:123], v12, s[44:47], s30 offen sc1
  buffer_load_dwordx4 v[24:27], v32, s[44:47], s18 offen sc1
  buffer_load_dwordx4 v[124:127], v12, s[44:47], s31 offen sc1
  buffer_load_dwordx4 v[28:31], v32, s[44:47], s19 offen sc1
  ds_read2_b32 v[144:145], v3 offset0:48 offset1:49
  ds_read2_b32 v[146:147], v3 offset0:50 offset1:51
  ds_read2_b32 v[148:149], v3 offset0:32 offset1:33
  ds_read2_b32 v[150:151], v3 offset0:34 offset1:35
  ds_read2_b32 v[152:153], v3 offset0:16 offset1:17
  ds_read2_b32 v[154:155], v3 offset0:18 offset1:19
  ds_read2_b32 v[156:157], v3 offset0:0 offset1:1
  ds_read2_b32 v[158:159], v3 offset0:2 offset1:3
  ds_read2_b32 v[240:241], v6 offset0:48 offset1:49
  ds_read2_b32 v[242:243], v6 offset0:50 offset1:51
  ds_read2_b32 v[244:245], v6 offset0:32 offset1:33
  ds_read2_b32 v[246:247], v6 offset0:34 offset1:35
  ds_read2_b32 v[248:249], v6 offset0:16 offset1:17
  ds_read2_b32 v[250:251], v6 offset0:18 offset1:19
  ds_read2_b32 v[252:253], v6 offset0:0 offset1:1
  ds_read2_b32 v[254:255], v6 offset0:2 offset1:3
  s_mov_b32 s12, 0xe000
  buffer_store_dwordx4 a[240:243], v103, s[44:47], 0 offen sc1
  buffer_store_dwordx4 a[244:247], v103, s[44:47], s12 offen sc1
  ds_read2_b32 v[224:225], v6 offset0:176 offset1:177
  ds_read2_b32 v[226:227], v6 offset0:178 offset1:179
  ds_read2_b32 v[228:229], v6 offset0:160 offset1:161
  ds_read2_b32 v[230:231], v6 offset0:162 offset1:163
  ds_read2_b32 v[232:233], v6 offset0:144 offset1:145
  ds_read2_b32 v[234:235], v6 offset0:146 offset1:147
  ds_read2_b32 v[236:237], v6 offset0:128 offset1:129
  ds_read2_b32 v[238:239], v6 offset0:130 offset1:131
  ds_read2_b32 v[208:209], v5 offset0:48 offset1:49
  ds_read2_b32 v[210:211], v5 offset0:50 offset1:51
  ds_read2_b32 v[212:213], v5 offset0:32 offset1:33
  ds_read2_b32 v[214:215], v5 offset0:34 offset1:35
  ds_read2_b32 v[216:217], v5 offset0:16 offset1:17
  ds_read2_b32 v[218:219], v5 offset0:18 offset1:19
  ds_read2_b32 v[220:221], v5 offset0:0 offset1:1
  ds_read2_b32 v[222:223], v5 offset0:2 offset1:3
  ds_read2_b32 v[192:193], v5 offset0:176 offset1:177
  ds_read2_b32 v[194:195], v5 offset0:178 offset1:179
  ds_read2_b32 v[196:197], v5 offset0:160 offset1:161
  ds_read2_b32 v[198:199], v5 offset0:162 offset1:163
  ds_read2_b32 v[200:201], v5 offset0:144 offset1:145
  ds_read2_b32 v[202:203], v5 offset0:146 offset1:147
  ds_read2_b32 v[204:205], v5 offset0:128 offset1:129
  ds_read2_b32 v[206:207], v5 offset0:130 offset1:131
  ds_read2_b32 v[176:177], v4 offset0:48 offset1:49
  ds_read2_b32 v[178:179], v4 offset0:50 offset1:51
  ds_read2_b32 v[180:181], v4 offset0:32 offset1:33
  ds_read2_b32 v[182:183], v4 offset0:34 offset1:35
  ds_read2_b32 v[184:185], v4 offset0:16 offset1:17
  ds_read2_b32 v[186:187], v4 offset0:18 offset1:19
  ds_read2_b32 v[188:189], v4 offset0:0 offset1:1
  ds_read2_b32 v[190:191], v4 offset0:2 offset1:3
  ds_read2_b32 v[160:161], v4 offset0:176 offset1:177
  ds_read2_b32 v[162:163], v4 offset0:178 offset1:179
  ds_read2_b32 v[164:165], v4 offset0:160 offset1:161
  ds_read2_b32 v[166:167], v4 offset0:162 offset1:163
  ds_read2_b32 v[168:169], v4 offset0:144 offset1:145
  ds_read2_b32 v[170:171], v4 offset0:146 offset1:147
  ds_read2_b32 v[172:173], v4 offset0:128 offset1:129
  ds_read2_b32 v[174:175], v4 offset0:130 offset1:131
  s_getreg_b32 s69, hwreg(HW_REG_XCC_ID, 0, 4)
  s_xor_b32 s69, s69, s10
  v_mov_b32 v34, s69
  v_mov_b32 v35, s11
  v_lshlrev_b32 v36, 26, v0
  s_lshl_b32 s12, s4, 3
  s_add_u32 s12, s12, 0x18b0000
  buffer_store_dwordx2 v[34:35], v36, s[44:47], s12 offen sc1
  s_lshr_b32 s12, s3, 1
  v_and_b32 v1, 15, v2
  v_lshrrev_b32 v15, 4, v2
  s_lshl_b32 s14, s3, 6
  s_add_u32 s14, s14, 133120
  v_mul_u32_u24 v8, 272, v1
  v_lshl_add_u32 v8, v15, 4, v8
  v_add_u32 v8, s14, v8
  v_bfrev_b32 v13, v15
  v_lshrrev_b32 v13, 30, v13
  s_mul_i32 s14, s3, 2176
  s_add_u32 s14, s14, 133120
  v_mul_u32_u24 v14, 544, v13
  v_lshl_add_u32 v14, v1, 2, v14
  v_add_u32 v14, s14, v14
  v_add_u32 v9, 16640, v14
  s_lshl_b32 s14, s3, 8
  s_add_u32 s14, s14, 115200
  v_lshl_add_u32 v10, v13, 6, s14
  v_lshl_add_u32 v10, v1, 1, v10
  v_mul_u32_u24 v13, 0x8100, v13
  v_lshl_add_u32 v13, v1, 4, v13
  s_lshr_b32 s14, s4, 4
  s_lshl_b32 s14, s14, 11
  s_and_b32 s15, s4, 1
  s_lshl_b32 s15, s15, 10
  s_add_u32 s14, s14, s15
  s_and_b32 s15, s4, 6
  s_lshl_b32 s15, s15, 7
  s_add_u32 s14, s14, s15
  s_and_b32 s15, s4, 8
  s_add_u32 s14, s14, s15
  s_mul_i32 s15, s3, 132096
  s_add_u32 s14, s14, s15
  s_add_u32 s68, s14, 0x0
  v_and_b32 v1, 1, v2
  v_mul_u32_u24 v11, 0x11fc, v1
  v_lshl_add_u32 v11, v0, 2, v11
  v_add_u32 v11, 115200, v11
  s_movk_i32 s12, 0x3f80
  s_mov_b32 s13, 0x3f800000
  v_mov_b32 v33, 0x10000
  s_waitcnt vmcnt(3)
  v_cmp_ne_u64 vcc, s[10:11], v[114:115]
  v_cmp_ne_u64 s[22:23], s[10:11], v[18:19]
  v_cmp_ne_u64 s[20:21], s[10:11], v[118:119]
  s_or_b64 vcc, vcc, s[22:23]
  v_cmp_ne_u64 s[22:23], s[10:11], v[22:23]
  s_or_b64 vcc, vcc, s[20:21]
  v_cmp_ne_u64 s[20:21], s[10:11], v[122:123]
  s_or_b64 vcc, vcc, s[22:23]
  v_cmp_ne_u64 s[22:23], s[10:11], v[26:27]
  s_or_b64 vcc, vcc, s[20:21]
  v_cmp_ne_u64 s[20:21], s[10:11], v[126:127]
  s_or_b64 vcc, vcc, s[22:23]
  v_cmp_ne_u64 s[22:23], s[10:11], v[30:31]
  s_or_b64 vcc, vcc, s[20:21]
  s_or_b64 vcc, vcc, s[22:23]
  s_cbranch_vccnz Rc1u
Bc1u:
  ds_write_b64 v11, v[112:113] offset:9216
  ds_write_b64 v11, v[116:117] offset:10240
  ds_write_b64 v11, v[120:121] offset:11264
  ds_write_b64 v11, v[124:125] offset:12288
  v_and_b32 v18, 0xffff0000, v16
  v_and_b32 v19, 0xffff0000, v17
  v_mul_u32_u24_dpp v48, v16, v33 quad_perm:[0,0,2,2] row_mask:0xf bank_mask:0xf
  v_mul_u32_u24_dpp v49, v17, v33 quad_perm:[0,0,2,2] row_mask:0xf bank_mask:0xf
  v_mul_u32_u24_dpp v50, v16, v33 quad_perm:[1,1,3,3] row_mask:0xf bank_mask:0xf
  v_mul_u32_u24_dpp v51, v17, v33 quad_perm:[1,1,3,3] row_mask:0xf bank_mask:0xf
  v_and_b32 v22, 0xffff0000, v20
  v_and_b32 v23, 0xffff0000, v21
  v_mul_u32_u24_dpp v52, v20, v33 quad_perm:[0,0,2,2] row_mask:0xf bank_mask:0xf
  v_mul_u32_u24_dpp v53, v21, v33 quad_perm:[0,0,2,2] row_mask:0xf bank_mask:0xf
  v_mul_u32_u24_dpp v54, v20, v33 quad_perm:[1,1,3,3] row_mask:0xf bank_mask:0xf
  v_mul_u32_u24_dpp v55, v21, v33 quad_perm:[1,1,3,3] row_mask:0xf bank_mask:0xf
  v_and_b32 v26, 0xffff0000, v24
  v_and_b32 v27, 0xffff0000, v25
  v_mul_u32_u24_dpp v56, v24, v33 quad_perm:[0,0,2,2] row_mask:0xf bank_mask:0xf
  v_mul_u32_u24_dpp v57, v25, v33 quad_perm:[0,0,2,2] row_mask:0xf bank_mask:0xf
  v_mul_u32_u24_dpp v58, v24, v33 quad_perm:[1,1,3,3] row_mask:0xf bank_mask:0xf
  v_mul_u32_u24_dpp v59, v25, v33 quad_perm:[1,1,3,3] row_mask:0xf bank_mask:0xf
  v_and_b32 v30, 0xffff0000, v28
  v_and_b32 v31, 0xffff0000, v29
  v_mul_u32_u24_dpp v60, v28, v33 quad_perm:[0,0,2,2] row_mask:0xf bank_mask:0xf
  v_mul_u32_u24_dpp v61, v29, v33 quad_perm:[0,0,2,2] row_mask:0xf bank_mask:0xf
  v_mul_u32_u24_dpp v62, v28, v33 quad_perm:[1,1,3,3] row_mask:0xf bank_mask:0xf
  v_mul_u32_u24_dpp v63, v29, v33 quad_perm:[1,1,3,3] row_mask:0xf bank_mask:0xf
  v_rcp_f32 v18, v18
  v_rcp_f32 v19, v19
  v_dot2_f32_bf16 v80, v112, s12, v48
  v_dot2_f32_bf16 v81, v112, s13, v49
  v_dot2_f32_bf16 v82, v113, s12, v50
  v_dot2_f32_bf16 v83, v113, s13, v51
  v_rcp_f32 v22, v22
  v_rcp_f32 v23, v23
  v_dot2_f32_bf16 v84, v116, s12, v52
  v_dot2_f32_bf16 v85, v116, s13, v53
  v_dot2_f32_bf16 v86, v117, s12, v54
  v_dot2_f32_bf16 v87, v117, s13, v55
  v_rcp_f32 v26, v26
  v_rcp_f32 v27, v27
  v_dot2_f32_bf16 v88, v120, s12, v56
  v_dot2_f32_bf16 v89, v120, s13, v57
  v_dot2_f32_bf16 v90, v121, s12, v58
  v_dot2_f32_bf16 v91, v121, s13, v59
  v_rcp_f32 v30, v30
  v_rcp_f32 v31, v31
  v_dot2_f32_bf16 v92, v124, s12, v60
  v_dot2_f32_bf16 v93, v124, s13, v61
  v_dot2_f32_bf16 v94, v125, s12, v62
  v_dot2_f32_bf16 v95, v125, s13, v63
  v_cvt_pk_bf16_f32 v80, 0, v80
  v_cvt_pk_bf16_f32 v81, 0, v81
  v_cvt_pk_bf16_f32 v82, 0, v82
  v_cvt_pk_bf16_f32 v83, 0, v83
  v_mul_f32_dpp v80, v18, v80 quad_perm:[0,0,2,2] row_mask:0xf bank_mask:0xf
  v_mul_f32_dpp v81, v19, v81 quad_perm:[0,0,2,2] row_mask:0xf bank_mask:0xf
  v_mul_f32_dpp v82, v18, v82 quad_perm:[1,1,3,3] row_mask:0xf bank_mask:0xf
  v_mul_f32_dpp v83, v19, v83 quad_perm:[1,1,3,3] row_mask:0xf bank_mask:0xf
  v_cvt_pk_bf16_f32 v80, v80, v81
  v_cvt_pk_bf16_f32 v81, v82, v83
  ds_write_b64 v11, v[80:81] offset:0
  v_cvt_pk_bf16_f32 v84, 0, v84
  v_cvt_pk_bf16_f32 v85, 0, v85
  v_cvt_pk_bf16_f32 v86, 0, v86
  v_cvt_pk_bf16_f32 v87, 0, v87
  v_mul_f32_dpp v84, v22, v84 quad_perm:[0,0,2,2] row_mask:0xf bank_mask:0xf
  v_mul_f32_dpp v85, v23, v85 quad_perm:[0,0,2,2] row_mask:0xf bank_mask:0xf
  v_mul_f32_dpp v86, v22, v86 quad_perm:[1,1,3,3] row_mask:0xf bank_mask:0xf
  v_mul_f32_dpp v87, v23, v87 quad_perm:[1,1,3,3] row_mask:0xf bank_mask:0xf
  v_cvt_pk_bf16_f32 v84, v84, v85
  v_cvt_pk_bf16_f32 v85, v86, v87
  ds_write_b64 v11, v[84:85] offset:1024
  v_cvt_pk_bf16_f32 v88, 0, v88
  v_cvt_pk_bf16_f32 v89, 0, v89
  v_cvt_pk_bf16_f32 v90, 0, v90
  v_cvt_pk_bf16_f32 v91, 0, v91
  v_mul_f32_dpp v88, v26, v88 quad_perm:[0,0,2,2] row_mask:0xf bank_mask:0xf
  v_mul_f32_dpp v89, v27, v89 quad_perm:[0,0,2,2] row_mask:0xf bank_mask:0xf
  v_mul_f32_dpp v90, v26, v90 quad_perm:[1,1,3,3] row_mask:0xf bank_mask:0xf
  v_mul_f32_dpp v91, v27, v91 quad_perm:[1,1,3,3] row_mask:0xf bank_mask:0xf
  v_cvt_pk_bf16_f32 v88, v88, v89
  v_cvt_pk_bf16_f32 v89, v90, v91
  ds_write_b64 v11, v[88:89] offset:2048
  v_cvt_pk_bf16_f32 v92, 0, v92
  v_cvt_pk_bf16_f32 v93, 0, v93
  v_cvt_pk_bf16_f32 v94, 0, v94
  v_cvt_pk_bf16_f32 v95, 0, v95
  v_mul_f32_dpp v92, v30, v92 quad_perm:[0,0,2,2] row_mask:0xf bank_mask:0xf
  v_mul_f32_dpp v93, v31, v93 quad_perm:[0,0,2,2] row_mask:0xf bank_mask:0xf
  v_mul_f32_dpp v94, v30, v94 quad_perm:[1,1,3,3] row_mask:0xf bank_mask:0xf
  v_mul_f32_dpp v95, v31, v95 quad_perm:[1,1,3,3] row_mask:0xf bank_mask:0xf
  v_cvt_pk_bf16_f32 v92, v92, v93
  v_cvt_pk_bf16_f32 v93, v94, v95
  ds_write_b64 v11, v[92:93] offset:3072
  s_waitcnt lgkmcnt(0)
  s_barrier
  ds_read_b128 v[48:51], v7 offset:192
  ds_read_b128 v[52:55], v7 offset:128
  ds_read_b128 v[56:59], v7 offset:64
  ds_read_b128 v[60:63], v7 offset:0
  ds_read_b128 v[64:67], v7 offset:704
  ds_read_b128 v[68:71], v7 offset:640
  ds_read_b128 v[72:75], v7 offset:576
  ds_read_b128 v[76:79], v7 offset:512
  v_mov_b32 v120, v96
  v_mov_b32 v121, v97
  v_mov_b32 v122, v98
  v_mov_b32 v123, v99
  v_mov_b32 v124, v100
  v_mov_b32 v125, v101
  v_mov_b32 v126, v102
  v_and_b32 v15, 15, v2
  v_lshlrev_b32 v15, 3, v15
  s_lshl_b32 s30, s5, 7
  s_add_u32 s30, s30, 0x18b0000
  s_lshl_b32 s24, s66, 16
  s_and_b32 s25, s66, 0xffff0000
  s_waitcnt lgkmcnt(7)
  v_mfma_f32_16x16x32_bf16 v[16:19], v[128:131], v[48:51], 0
  buffer_load_dwordx4 v120, s[48:51], s32 offen offset:0 lds
  s_waitcnt lgkmcnt(6)
  v_mfma_f32_16x16x32_bf16 v[16:19], v[132:135], v[52:55], v[16:19]
  s_sub_u32 s16, s2, 32
  s_cmpk_lt_u32 s2, 224
  s_cselect_b32 s16, s2, s16
  s_waitcnt lgkmcnt(5)
  v_mfma_f32_16x16x32_bf16 v[16:19], v[136:139], v[56:59], v[16:19]
  s_lshl2_add_u32 s16, s16, s3
  s_lshl_b32 s16, s16, 3
  s_waitcnt lgkmcnt(4)
  v_mfma_f32_16x16x32_bf16 v[16:19], v[140:143], v[60:63], v[16:19]
  buffer_load_dwordx4 v121, s[48:51], s32 offen offset:1024 lds
  s_add_u32 s16, s16, 0x18b4000
  v_mfma_f32_16x16x32_bf16 v[20:23], v[144:147], v[48:51], 0
  v_lshlrev_b32 v117, 26, v2
  v_mov_b64 v[118:119], s[10:11]
  v_mfma_f32_16x16x32_bf16 v[20:23], v[148:151], v[52:55], v[20:23]
  s_waitcnt vmcnt(3)
  buffer_store_dwordx2 v[118:119], v117, s[44:47], s16 offen sc1
  ds_read_b128 v[80:83], v7 offset:1216
  v_mfma_f32_16x16x32_bf16 v[20:23], v[152:155], v[56:59], v[20:23]
  buffer_load_dwordx4 v122, s[48:51], s32 offen offset:2048 lds
  ds_read_b128 v[84:87], v7 offset:1152
  v_mfma_f32_16x16x32_bf16 v[20:23], v[156:159], v[60:63], v[20:23]
  ds_read_b128 v[88:91], v7 offset:1088
  ds_read_b128 v[92:95], v7 offset:1024
  s_waitcnt lgkmcnt(7)
  v_mfma_f32_16x16x32_bf16 v[20:23], v[128:131], v[64:67], v[20:23]
  ds_read_b128 v[96:99], v7 offset:1728
  ds_read_b128 v[100:103], v7 offset:1664
  s_waitcnt lgkmcnt(8)
  v_mfma_f32_16x16x32_bf16 v[20:23], v[132:135], v[68:71], v[20:23]
  buffer_load_dwordx4 v123, s[48:51], s32 offen offset:3072 lds
  ds_read_b128 v[104:107], v7 offset:1600
  s_waitcnt lgkmcnt(8)
  v_mfma_f32_16x16x32_bf16 v[20:23], v[136:139], v[72:75], v[20:23]
  ds_read_b128 v[108:111], v7 offset:1536
  s_waitcnt lgkmcnt(8)
  v_mfma_f32_16x16x32_bf16 v[20:23], v[140:143], v[76:79], v[20:23]
  v_mfma_f32_16x16x32_bf16 v[44:47], v[240:243], v[48:51], 0
  s_addk_i32 m0, 4096
  s_nop 0
  buffer_load_dwordx4 v124, s[48:51], s32 offen offset:0 lds
  v_mfma_f32_16x16x32_bf16 v[44:47], v[244:247], v[52:55], v[44:47]
  v_mfma_f32_16x16x32_bf16 v[44:47], v[248:251], v[56:59], v[44:47]
  v_mfma_f32_16x16x32_bf16 v[44:47], v[252:255], v[60:63], v[44:47]
  buffer_load_dwordx4 v125, s[48:51], s32 offen offset:1024 lds
  ds_write_b128 v8, v[16:19] offset:16640
  v_mfma_f32_16x16x32_bf16 v[40:43], v[224:227], v[48:51], 0
  ds_write_b128 v8, v[20:23] offset:20992
  v_mfma_f32_16x16x32_bf16 v[40:43], v[228:231], v[52:55], v[40:43]
  v_mov_b32 v240, 0
  v_mov_b32 v241, 0
  v_mfma_f32_16x16x32_bf16 v[40:43], v[232:235], v[56:59], v[40:43]
  buffer_load_dwordx4 v126, s[48:51], s32 offen offset:2048 lds
  v_mov_b32 v242, 0
  v_mfma_f32_16x16x32_bf16 v[40:43], v[236:239], v[60:63], v[40:43]
  v_mov_b32 v243, 0
  v_mov_b32 v244, 0
  v_mfma_f32_16x16x32_bf16 v[36:39], v[208:211], v[48:51], 0
  s_waitcnt lgkmcnt(0)
  s_barrier
  ds_read2_b32 v[248:249], v9 offset0:0 offset1:68
  v_mfma_f32_16x16x32_bf16 v[36:39], v[212:215], v[52:55], v[36:39]
  s_addk_i32 m0, 24576
  s_nop 0
  buffer_load_dwordx4 v120, s[48:51], s33 offen offset:0 lds
  ds_read2_b32 v[252:253], v9 offset0:16 offset1:84
  v_mfma_f32_16x16x32_bf16 v[36:39], v[216:219], v[56:59], v[36:39]
  ds_read2_b32 v[250:251], v9 offset0:32 offset1:100
  ds_read2_b32 v[254:255], v9 offset0:48 offset1:116
  v_mfma_f32_16x16x32_bf16 v[36:39], v[220:223], v[60:63], v[36:39]
  v_mov_b32 v245, 0
  v_mov_b32 v246, 0
  v_mfma_f32_16x16x32_bf16 v[32:35], v[192:195], v[48:51], 0
  buffer_load_dwordx4 v121, s[48:51], s33 offen offset:1024 lds
  v_mov_b32 v247, 0
  v_mfma_f32_16x16x32_bf16 v[32:35], v[196:199], v[52:55], v[32:35]
  ds_read_u16_d16_hi v240, v10 offset:0
  ds_read_u16_d16_hi v241, v10 offset:32
  v_mfma_f32_16x16x32_bf16 v[32:35], v[200:203], v[56:59], v[32:35]
  ds_read_u16_d16_hi v242, v10 offset:4608
  ds_read_u16_d16_hi v243, v10 offset:4640
  v_mfma_f32_16x16x32_bf16 v[32:35], v[204:207], v[60:63], v[32:35]
  buffer_load_dwordx4 v122, s[48:51], s33 offen offset:2048 lds
  ds_read_u16_d16_hi v244, v10 offset:9216
  v_mfma_f32_16x16x32_bf16 v[28:31], v[176:179], v[48:51], 0
  s_waitcnt lgkmcnt(5)
  v_add_f32 v248, v248, v252
  v_add_f32 v249, v249, v253
  v_mfma_f32_16x16x32_bf16 v[28:31], v[180:183], v[52:55], v[28:31]
  v_add_f32 v250, v250, v254
  v_add_f32 v251, v251, v255
  v_mfma_f32_16x16x32_bf16 v[28:31], v[184:187], v[56:59], v[28:31]
  buffer_load_dwordx4 v123, s[48:51], s33 offen offset:3072 lds
  v_cvt_pk_bf16_f32 v248, v248, v249
  v_mfma_f32_16x16x32_bf16 v[28:31], v[188:191], v[60:63], v[28:31]
  v_cvt_pk_bf16_f32 v250, v250, v251
  v_and_b32 v249, 0xffff0000, v248
  v_mfma_f32_16x16x32_bf16 v[24:27], v[160:163], v[48:51], 0
  v_and_b32 v251, 0xffff0000, v250
  v_lshlrev_b32 v248, 16, v248
  v_mfma_f32_16x16x32_bf16 v[24:27], v[164:167], v[52:55], v[24:27]
  s_addk_i32 m0, 4096
  s_nop 0
  buffer_load_dwordx4 v124, s[48:51], s33 offen offset:0 lds
  v_lshlrev_b32 v250, 16, v250
  v_mfma_f32_16x16x32_bf16 v[24:27], v[168:171], v[56:59], v[24:27]
  ds_read_u16_d16_hi v245, v10 offset:9248
  ds_read_u16_d16_hi v246, v10 offset:13824
  v_mfma_f32_16x16x32_bf16 v[24:27], v[172:175], v[60:63], v[24:27]
  ds_read_u16_d16_hi v247, v10 offset:13856
  v_mfma_f32_16x16x32_bf16 v[44:47], v[224:227], v[64:67], v[44:47]
  buffer_load_dwordx4 v125, s[48:51], s33 offen offset:1024 lds
  v_mfma_f32_16x16x32_bf16 v[44:47], v[228:231], v[68:71], v[44:47]
  v_mfma_f32_16x16x32_bf16 v[44:47], v[232:235], v[72:75], v[44:47]
  v_mfma_f32_16x16x32_bf16 v[44:47], v[236:239], v[76:79], v[44:47]
  buffer_load_dwordx4 v126, s[48:51], s33 offen offset:2048 lds
  s_waitcnt lgkmcnt(4)
  v_mul_f32 v240, s24, v240
  v_mfma_f32_16x16x32_bf16 v[40:43], v[208:211], v[64:67], v[40:43]
  s_lshl_b32 s12, s4, 2
  s_add_u32 s12, s12, s3
  v_mfma_f32_16x16x32_bf16 v[40:43], v[212:215], v[68:71], v[40:43]
  v_lshlrev_b32 v114, 7, v2
  s_lshr_b32 s13, s12, 7
  v_mfma_f32_16x16x32_bf16 v[40:43], v[216:219], v[72:75], v[40:43]
  s_addk_i32 m0, 24576
  s_nop 0
  buffer_load_dwordx4 v120, s[48:51], s36 offen offset:0 lds
  s_mul_i32 s13, s13, 524288
  v_mfma_f32_16x16x32_bf16 v[40:43], v[220:223], v[76:79], v[40:43]
  s_mul_i32 s14, s12, 3072
  s_add_u32 s13, s13, s14
  v_mfma_f32_16x16x32_bf16 v[36:39], v[192:195], v[64:67], v[36:39]
  s_add_u32 s13, s13, 0x1220000
  s_lshl_b32 s14, s12, 9
  v_mfma_f32_16x16x32_bf16 v[36:39], v[196:199], v[68:71], v[36:39]
  buffer_load_dwordx4 v121, s[48:51], s36 offen offset:1024 lds
  s_add_u32 s14, s14, 0x105f400
  v_mfma_f32_16x16x32_bf16 v[36:39], v[200:203], v[72:75], v[36:39]
  s_add_u32 s15, s14, 0x7fe00
  v_mov_b32 v115, s13
  v_mfma_f32_16x16x32_bf16 v[36:39], v[204:207], v[76:79], v[36:39]
  v_writelane_b32 v115, s14, 6
  v_writelane_b32 v115, s15, 7
  v_mfma_f32_16x16x32_bf16 v[32:35], v[176:179], v[64:67], v[32:35]
  buffer_load_dwordx4 v122, s[48:51], s36 offen offset:2048 lds
  s_lshl_b32 s14, s12, 8
  v_mfma_f32_16x16x32_bf16 v[32:35], v[180:183], v[68:71], v[32:35]
  s_add_u32 s14, s14, 0x115f000
  v_writelane_b32 v115, s14, 8
  v_mfma_f32_16x16x32_bf16 v[32:35], v[184:187], v[72:75], v[32:35]
  v_and_b32 v116, 60, v2
  ds_bpermute_b32 v115, v116, v115
  v_mfma_f32_16x16x32_bf16 v[32:35], v[188:191], v[76:79], v[32:35]
  buffer_load_dwordx4 v123, s[48:51], s36 offen offset:3072 lds
  s_lshl_b32 s14, s12, 5
  v_mfma_f32_16x16x32_bf16 v[28:31], v[160:163], v[64:67], v[28:31]
  s_add_u32 s14, s14, 0x18a0000
  s_add_u32 s15, s14, 32768
  v_mfma_f32_16x16x32_bf16 v[28:31], v[164:167], v[68:71], v[28:31]
  v_mul_f32 v241, s24, v241
  v_mul_f32 v242, s25, v242
  v_mfma_f32_16x16x32_bf16 v[28:31], v[168:171], v[72:75], v[28:31]
  s_addk_i32 m0, 4096
  s_nop 0
  buffer_load_dwordx4 v124, s[48:51], s36 offen offset:0 lds
  v_mul_f32 v243, s25, v243
  v_mfma_f32_16x16x32_bf16 v[28:31], v[172:175], v[76:79], v[28:31]
  v_cvt_pk_bf16_f32 v240, v240, v241
  v_cvt_pk_bf16_f32 v242, v242, v243
  v_mfma_f32_16x16x32_bf16 v[24:27], v[144:147], v[64:67], v[24:27]
  s_waitcnt lgkmcnt(0)
  v_add_u32 v114, v114, v115
  v_writelane_b32 v114, s14, 34
  v_mfma_f32_16x16x32_bf16 v[24:27], v[148:151], v[68:71], v[24:27]
  buffer_load_dwordx4 v125, s[48:51], s36 offen offset:1024 lds
  v_writelane_b32 v114, s15, 35
  v_mfma_f32_16x16x32_bf16 v[24:27], v[152:155], v[72:75], v[24:27]
  v_and_b32 v241, 0xffff0000, v240
  v_and_b32 v243, 0xffff0000, v242
  v_mfma_f32_16x16x32_bf16 v[24:27], v[156:159], v[76:79], v[24:27]
  v_lshlrev_b32 v240, 16, v240
  v_lshlrev_b32 v242, 16, v242
  v_mfma_f32_16x16x32_bf16 v[24:27], v[128:131], v[80:83], v[24:27]
  buffer_load_dwordx4 v126, s[48:51], s36 offen offset:2048 lds
  v_min_u32 v127, 13, v2
  v_mfma_f32_16x16x32_bf16 v[24:27], v[132:135], v[84:87], v[24:27]
  v_lshlrev_b32 v127, 7, v127
  s_mul_i32 s17, s3, 1792
  v_mfma_f32_16x16x32_bf16 v[24:27], v[136:139], v[88:91], v[24:27]
  s_lshl_b32 s16, s8, 4
  s_add_u32 s17, s17, s16
  v_mfma_f32_16x16x32_bf16 v[24:27], v[140:143], v[92:95], v[24:27]
  s_addk_i32 m0, 24576
  s_nop 0
  buffer_load_dwordx4 v120, s[48:51], s37 offen offset:0 lds
  s_add_u32 s17, s17, 0x18b4000
  v_mfma_f32_16x16x32_bf16 v[28:31], v[144:147], v[80:83], v[28:31]
  ds_read_b128 v[48:51], v7 offset:2240
  ds_read_b128 v[52:55], v7 offset:2176
  v_mfma_f32_16x16x32_bf16 v[28:31], v[148:151], v[84:87], v[28:31]
  ds_read_b128 v[56:59], v7 offset:2112
  ds_read_b128 v[60:63], v7 offset:2048
  v_mfma_f32_16x16x32_bf16 v[28:31], v[152:155], v[88:91], v[28:31]
  buffer_load_dwordx4 v121, s[48:51], s37 offen offset:1024 lds
  ds_read_b128 v[64:67], v7 offset:2752
  v_mfma_f32_16x16x32_bf16 v[28:31], v[156:159], v[92:95], v[28:31]
  ds_read_b128 v[68:71], v7 offset:2688
  ds_read_b128 v[72:75], v7 offset:2624
  v_mfma_f32_16x16x32_bf16 v[28:31], v[128:131], v[96:99], v[28:31]
  ds_read_b128 v[76:79], v7 offset:2560
  v_add_f32 v248, v248, v240
  v_mfma_f32_16x16x32_bf16 v[28:31], v[132:135], v[100:103], v[28:31]
  buffer_load_dwordx4 v122, s[48:51], s37 offen offset:2048 lds
  v_add_f32 v249, v249, v241
  v_mfma_f32_16x16x32_bf16 v[28:31], v[136:139], v[104:107], v[28:31]
  v_add_f32 v250, v250, v242
  v_add_f32 v251, v251, v243
  v_mfma_f32_16x16x32_bf16 v[28:31], v[140:143], v[108:111], v[28:31]
  v_cvt_pk_bf16_f32 v248, v248, v249
  v_cvt_pk_bf16_f32 v250, v250, v251
  v_mfma_f32_16x16x32_bf16 v[44:47], v[208:211], v[80:83], v[44:47]
  buffer_load_dwordx4 v123, s[48:51], s37 offen offset:3072 lds
  v_and_b32 v249, 0xffff0000, v248
  v_mfma_f32_16x16x32_bf16 v[44:47], v[212:215], v[84:87], v[44:47]
  v_and_b32 v251, 0xffff0000, v250
  v_lshlrev_b32 v248, 16, v248
  v_mfma_f32_16x16x32_bf16 v[44:47], v[216:219], v[88:91], v[44:47]
  v_lshlrev_b32 v250, 16, v250
  v_add_f32 v248, v248, v244
  v_mfma_f32_16x16x32_bf16 v[44:47], v[220:223], v[92:95], v[44:47]
  s_addk_i32 m0, 4096
  s_nop 0
  buffer_load_dwordx4 v124, s[48:51], s37 offen offset:0 lds
  ds_write_b128 v8, v[24:27] offset:0
  v_mfma_f32_16x16x32_bf16 v[40:43], v[192:195], v[80:83], v[40:43]
  ds_write_b128 v8, v[28:31] offset:4352
  v_add_f32 v249, v249, v245
  v_mfma_f32_16x16x32_bf16 v[40:43], v[196:199], v[84:87], v[40:43]
  v_add_f32 v250, v250, v246
  v_add_f32 v251, v251, v247
  v_mfma_f32_16x16x32_bf16 v[40:43], v[200:203], v[88:91], v[40:43]
  buffer_load_dwordx4 v125, s[48:51], s37 offen offset:1024 lds
  v_cvt_pk_bf16_f32 v252, v248, v250
  v_mfma_f32_16x16x32_bf16 v[40:43], v[204:207], v[92:95], v[40:43]
  v_cvt_pk_bf16_f32 v253, v249, v251
  v_min_u32 v252, -2, v252
  v_mfma_f32_16x16x32_bf16 v[36:39], v[176:179], v[80:83], v[36:39]
  buffer_load_dwordx2 v[112:113], v15, s[44:47], s30 offen sc1
  s_waitcnt lgkmcnt(0)
  s_barrier
  v_mfma_f32_16x16x32_bf16 v[36:39], v[180:183], v[84:87], v[36:39]
  buffer_load_dwordx4 v126, s[48:51], s37 offen offset:2048 lds
  ds_read2_b32 v[232:233], v14 offset0:0 offset1:68
  v_mfma_f32_16x16x32_bf16 v[36:39], v[184:187], v[88:91], v[36:39]
  ds_read2_b32 v[236:237], v14 offset0:16 offset1:84
  ds_read2_b32 v[234:235], v14 offset0:32 offset1:100
  v_mfma_f32_16x16x32_bf16 v[36:39], v[188:191], v[92:95], v[36:39]
  ds_read2_b32 v[238:239], v14 offset0:48 offset1:116
  v_mov_b32 v224, 0
  v_mfma_f32_16x16x32_bf16 v[32:35], v[160:163], v[80:83], v[32:35]
  buffer_load_dwordx4 v[116:119], v127, s[44:47], s17 offen sc1
  v_mov_b32 v225, 0
  v_mfma_f32_16x16x32_bf16 v[32:35], v[164:167], v[84:87], v[32:35]
  v_mov_b32 v226, 0
  v_mov_b32 v227, 0
  v_mfma_f32_16x16x32_bf16 v[32:35], v[168:171], v[88:91], v[32:35]
  buffer_store_dwordx2 v[252:253], v13, s[44:47], s68 offen sc1
  s_add_u32 s68, s68, 0x81000
  v_mov_b32 v228, 0
  v_mfma_f32_16x16x32_bf16 v[32:35], v[172:175], v[92:95], v[32:35]
  v_mov_b32 v229, 0
  v_mov_b32 v230, 0
  v_mfma_f32_16x16x32_bf16 v[44:47], v[192:195], v[96:99], v[44:47]
  v_mov_b32 v231, 0
  ds_read_u16_d16_hi v224, v10 offset:1024
  v_mfma_f32_16x16x32_bf16 v[44:47], v[196:199], v[100:103], v[44:47]
  s_waitcnt lgkmcnt(1)
  v_add_f32 v232, v232, v236
  v_add_f32 v233, v233, v237
  v_mfma_f32_16x16x32_bf16 v[44:47], v[200:203], v[104:107], v[44:47]
  v_add_f32 v234, v234, v238
  v_add_f32 v235, v235, v239
  v_mfma_f32_16x16x32_bf16 v[44:47], v[204:207], v[108:111], v[44:47]
  v_cvt_pk_bf16_f32 v232, v232, v233
  v_cvt_pk_bf16_f32 v234, v234, v235
  v_mfma_f32_16x16x32_bf16 v[40:43], v[176:179], v[96:99], v[40:43]
  v_and_b32 v233, 0xffff0000, v232
  v_and_b32 v235, 0xffff0000, v234
  v_mfma_f32_16x16x32_bf16 v[40:43], v[180:183], v[100:103], v[40:43]
  v_lshlrev_b32 v232, 16, v232
  v_lshlrev_b32 v234, 16, v234
  v_mfma_f32_16x16x32_bf16 v[40:43], v[184:187], v[104:107], v[40:43]
  ds_read_u16_d16_hi v225, v10 offset:1056
  ds_read_u16_d16_hi v226, v10 offset:5632
  v_mfma_f32_16x16x32_bf16 v[40:43], v[188:191], v[108:111], v[40:43]
  ds_read_u16_d16_hi v227, v10 offset:5664
  ds_read_u16_d16_hi v228, v10 offset:10240
  v_mfma_f32_16x16x32_bf16 v[36:39], v[160:163], v[96:99], v[36:39]
  ds_read_u16_d16_hi v229, v10 offset:10272
  ds_read_u16_d16_hi v230, v10 offset:14848
  v_mfma_f32_16x16x32_bf16 v[36:39], v[164:167], v[100:103], v[36:39]
  ds_read_u16_d16_hi v231, v10 offset:14880
  v_mfma_f32_16x16x32_bf16 v[36:39], v[168:171], v[104:107], v[36:39]
  v_mfma_f32_16x16x32_bf16 v[36:39], v[172:175], v[108:111], v[36:39]
  v_mfma_f32_16x16x32_bf16 v[32:35], v[144:147], v[96:99], v[32:35]
  v_mfma_f32_16x16x32_bf16 v[32:35], v[148:151], v[100:103], v[32:35]
  s_mov_b32 exec_hi, 15
  buffer_load_dword a255, v114, s[44:47], 0 offen sc1
  s_mov_b64 exec, -1
  s_waitcnt lgkmcnt(4)
  v_mul_f32 v224, s24, v224
  v_mfma_f32_16x16x32_bf16 v[32:35], v[152:155], v[104:107], v[32:35]
  v_mul_f32 v225, s24, v225
  v_mul_f32 v226, s25, v226
  v_mfma_f32_16x16x32_bf16 v[32:35], v[156:159], v[108:111], v[32:35]
  v_mul_f32 v227, s25, v227
  v_cvt_pk_bf16_f32 v224, v224, v225
  v_mfma_f32_16x16x32_bf16 v[32:35], v[128:131], v[48:51], v[32:35]
  v_cvt_pk_bf16_f32 v226, v226, v227
  v_and_b32 v225, 0xffff0000, v224
  v_mfma_f32_16x16x32_bf16 v[32:35], v[132:135], v[52:55], v[32:35]
  v_and_b32 v227, 0xffff0000, v226
  v_lshlrev_b32 v224, 16, v224
  v_mfma_f32_16x16x32_bf16 v[32:35], v[136:139], v[56:59], v[32:35]
  ds_read_b128 v[80:83], v7 offset:3264
  ds_read_b128 v[84:87], v7 offset:3200
  v_mfma_f32_16x16x32_bf16 v[32:35], v[140:143], v[60:63], v[32:35]
  ds_read_b128 v[88:91], v7 offset:3136
  ds_read_b128 v[92:95], v7 offset:3072
  v_mfma_f32_16x16x32_bf16 v[36:39], v[144:147], v[48:51], v[36:39]
  ds_read_b128 v[96:99], v7 offset:3776
  ds_read_b128 v[100:103], v7 offset:3712
  v_mfma_f32_16x16x32_bf16 v[36:39], v[148:151], v[52:55], v[36:39]
  ds_read_b128 v[104:107], v7 offset:3648
  ds_read_b128 v[108:111], v7 offset:3584
  v_mfma_f32_16x16x32_bf16 v[36:39], v[152:155], v[56:59], v[36:39]
  v_lshlrev_b32 v226, 16, v226
  v_add_f32 v232, v232, v224
  v_mfma_f32_16x16x32_bf16 v[36:39], v[156:159], v[60:63], v[36:39]
  v_add_f32 v233, v233, v225
  v_add_f32 v234, v234, v226
  v_mfma_f32_16x16x32_bf16 v[36:39], v[128:131], v[64:67], v[36:39]
  v_add_f32 v235, v235, v227
  v_cvt_pk_bf16_f32 v232, v232, v233
  v_mfma_f32_16x16x32_bf16 v[36:39], v[132:135], v[68:71], v[36:39]
  v_cvt_pk_bf16_f32 v234, v234, v235
  v_and_b32 v233, 0xffff0000, v232
  v_mfma_f32_16x16x32_bf16 v[36:39], v[136:139], v[72:75], v[36:39]
  v_and_b32 v235, 0xffff0000, v234
  v_lshlrev_b32 v232, 16, v232
  v_mfma_f32_16x16x32_bf16 v[36:39], v[140:143], v[76:79], v[36:39]
  v_lshlrev_b32 v234, 16, v234
  s_waitcnt lgkmcnt(8)
  v_add_f32 v232, v232, v228
  v_mfma_f32_16x16x32_bf16 v[44:47], v[176:179], v[48:51], v[44:47]
  v_add_f32 v233, v233, v229
  v_add_f32 v234, v234, v230
  v_mfma_f32_16x16x32_bf16 v[44:47], v[180:183], v[52:55], v[44:47]
  v_add_f32 v235, v235, v231
  v_cvt_pk_bf16_f32 v236, v232, v234
  v_mfma_f32_16x16x32_bf16 v[44:47], v[184:187], v[56:59], v[44:47]
  v_cvt_pk_bf16_f32 v237, v233, v235
  v_min_u32 v236, -2, v236
  v_mfma_f32_16x16x32_bf16 v[44:47], v[188:191], v[60:63], v[44:47]
  buffer_store_dwordx2 v[236:237], v13, s[44:47], s68 offen sc1
  s_add_u32 s68, s68, 0x81000
  ds_write_b128 v8, v[32:35] offset:16640
  v_mfma_f32_16x16x32_bf16 v[40:43], v[160:163], v[48:51], v[40:43]
  ds_write_b128 v8, v[36:39] offset:20992
  ds_read_u16_d16_hi v240, v10 offset:2048
  v_mfma_f32_16x16x32_bf16 v[40:43], v[164:167], v[52:55], v[40:43]
  ds_read_u16_d16_hi v241, v10 offset:2080
  ds_read_u16_d16_hi v242, v10 offset:6656
  v_mfma_f32_16x16x32_bf16 v[40:43], v[168:171], v[56:59], v[40:43]
  ds_read_u16_d16_hi v243, v10 offset:6688
  ds_read_u16_d16_hi v244, v10 offset:11264
  v_mfma_f32_16x16x32_bf16 v[40:43], v[172:175], v[60:63], v[40:43]
  ds_read_u16_d16_hi v245, v10 offset:11296
  ds_read_u16_d16_hi v246, v10 offset:15872
  v_mfma_f32_16x16x32_bf16 v[44:47], v[160:163], v[64:67], v[44:47]
  s_waitcnt lgkmcnt(7)
  s_barrier
  ds_read2_b32 v[248:249], v9 offset0:0 offset1:68
  v_mfma_f32_16x16x32_bf16 v[44:47], v[164:167], v[68:71], v[44:47]
  ds_read2_b32 v[252:253], v9 offset0:16 offset1:84
  ds_read2_b32 v[250:251], v9 offset0:32 offset1:100
  v_mfma_f32_16x16x32_bf16 v[44:47], v[168:171], v[72:75], v[44:47]
  ds_read2_b32 v[254:255], v9 offset0:48 offset1:116
  ds_read_u16_d16_hi v247, v10 offset:15904
  v_mfma_f32_16x16x32_bf16 v[44:47], v[172:175], v[76:79], v[44:47]
  v_mfma_f32_16x16x32_bf16 v[40:43], v[144:147], v[64:67], v[40:43]
  v_mfma_f32_16x16x32_bf16 v[40:43], v[148:151], v[68:71], v[40:43]
  v_mfma_f32_16x16x32_bf16 v[40:43], v[152:155], v[72:75], v[40:43]
  s_waitcnt lgkmcnt(8)
  v_mul_f32 v240, s24, v240
  v_mul_f32 v241, s24, v241
  v_mfma_f32_16x16x32_bf16 v[40:43], v[156:159], v[76:79], v[40:43]
  v_mul_f32 v242, s25, v242
  v_mul_f32 v243, s25, v243
  v_mfma_f32_16x16x32_bf16 v[40:43], v[128:131], v[80:83], v[40:43]
  s_waitcnt lgkmcnt(1)
  v_add_f32 v248, v248, v252
  v_add_f32 v249, v249, v253
  v_mfma_f32_16x16x32_bf16 v[40:43], v[132:135], v[84:87], v[40:43]
  v_add_f32 v250, v250, v254
  v_add_f32 v251, v251, v255
  v_mfma_f32_16x16x32_bf16 v[40:43], v[136:139], v[88:91], v[40:43]
  v_cvt_pk_bf16_f32 v248, v248, v249
  v_cvt_pk_bf16_f32 v250, v250, v251
  v_mfma_f32_16x16x32_bf16 v[40:43], v[140:143], v[92:95], v[40:43]
  v_and_b32 v249, 0xffff0000, v248
  v_and_b32 v251, 0xffff0000, v250
  v_mfma_f32_16x16x32_bf16 v[44:47], v[144:147], v[80:83], v[44:47]
  v_lshlrev_b32 v248, 16, v248
  v_lshlrev_b32 v250, 16, v250
  v_mfma_f32_16x16x32_bf16 v[44:47], v[148:151], v[84:87], v[44:47]
  v_cvt_pk_bf16_f32 v240, v240, v241
  v_cvt_pk_bf16_f32 v242, v242, v243
  v_mfma_f32_16x16x32_bf16 v[44:47], v[152:155], v[88:91], v[44:47]
  v_and_b32 v241, 0xffff0000, v240
  v_and_b32 v243, 0xffff0000, v242
  v_mfma_f32_16x16x32_bf16 v[44:47], v[156:159], v[92:95], v[44:47]
  v_lshlrev_b32 v240, 16, v240
  v_lshlrev_b32 v242, 16, v242
  v_mfma_f32_16x16x32_bf16 v[44:47], v[128:131], v[96:99], v[44:47]
  v_add_f32 v248, v248, v240
  v_add_f32 v249, v249, v241
  v_mfma_f32_16x16x32_bf16 v[44:47], v[132:135], v[100:103], v[44:47]
  v_add_f32 v250, v250, v242
  v_add_f32 v251, v251, v243
  v_mfma_f32_16x16x32_bf16 v[44:47], v[136:139], v[104:107], v[44:47]
  v_cvt_pk_bf16_f32 v248, v248, v249
  v_cvt_pk_bf16_f32 v250, v250, v251
  v_mfma_f32_16x16x32_bf16 v[44:47], v[140:143], v[108:111], v[44:47]
  v_and_b32 v249, 0xffff0000, v248
  v_and_b32 v251, 0xffff0000, v250
  ds_write_b128 v8, v[40:43] offset:0
  s_nop 4
  ds_write_b128 v8, v[44:47] offset:4352
  ds_read_u16_d16_hi v224, v10 offset:3072
  ds_read_u16_d16_hi v225, v10 offset:3104
  ds_read_u16_d16_hi v226, v10 offset:7680
  ds_read_u16_d16_hi v227, v10 offset:7712
  ds_read_u16_d16_hi v228, v10 offset:12288
  ds_read_u16_d16_hi v229, v10 offset:12320
  ds_read_u16_d16_hi v230, v10 offset:16896
  ds_read_u16_d16_hi v231, v10 offset:16928
  v_lshlrev_b32 v248, 16, v248
  v_lshlrev_b32 v250, 16, v250
  s_waitcnt lgkmcnt(10)
  v_add_f32 v248, v248, v244
  v_add_f32 v249, v249, v245
  v_add_f32 v250, v250, v246
  v_add_f32 v251, v251, v247
  v_cvt_pk_bf16_f32 v252, v248, v250
  v_cvt_pk_bf16_f32 v253, v249, v251
  v_min_u32 v252, -2, v252
  buffer_store_dwordx2 v[252:253], v13, s[44:47], s68 offen sc1
  s_add_u32 s68, s68, 0x81000
  s_waitcnt vmcnt(5)
  s_waitcnt lgkmcnt(0)
  s_barrier
  ds_read2_b32 v[232:233], v14 offset0:0 offset1:68
  ds_read2_b32 v[236:237], v14 offset0:16 offset1:84
  ds_read2_b32 v[234:235], v14 offset0:32 offset1:100
  ds_read2_b32 v[238:239], v14 offset0:48 offset1:116
  v_mul_f32 v224, s24, v224
  v_mul_f32 v225, s24, v225
  v_mul_f32 v226, s25, v226
  v_mul_f32 v227, s25, v227
  v_cvt_pk_bf16_f32 v224, v224, v225
  v_cvt_pk_bf16_f32 v226, v226, v227
  v_and_b32 v225, 0xffff0000, v224
  v_and_b32 v227, 0xffff0000, v226
  v_lshlrev_b32 v224, 16, v224
  v_lshlrev_b32 v226, 16, v226
  s_waitcnt lgkmcnt(0)
  v_pk_add_f32 v[232:233], v[232:233], v[236:237]
  v_pk_add_f32 v[234:235], v[234:235], v[238:239]
  v_cvt_pk_bf16_f32 v232, v232, v233
  v_cvt_pk_bf16_f32 v234, v234, v235
  v_and_b32 v233, 0xffff0000, v232
  v_and_b32 v235, 0xffff0000, v234
  v_lshlrev_b32 v232, 16, v232
  v_lshlrev_b32 v234, 16, v234
  v_pk_add_f32 v[232:233], v[232:233], v[224:225]
  v_pk_add_f32 v[234:235], v[234:235], v[226:227]
  v_cvt_pk_bf16_f32 v232, v232, v233
  v_cvt_pk_bf16_f32 v234, v234, v235
  v_and_b32 v233, 0xffff0000, v232
  v_and_b32 v235, 0xffff0000, v234
  v_lshlrev_b32 v232, 16, v232
  v_lshlrev_b32 v234, 16, v234
  v_pk_add_f32 v[232:233], v[232:233], v[228:229]
  v_pk_add_f32 v[234:235], v[234:235], v[230:231]
  v_cvt_pk_bf16_f32 v236, v232, v234
  v_cvt_pk_bf16_f32 v237, v233, v235
  v_min_u32 v236, -2, v236
  buffer_store_dwordx2 v[236:237], v13, s[44:47], s68 offen sc1
  s_waitcnt vmcnt(5)
  v_cmp_ne_u64 vcc, s[10:11], v[116:117]
  v_cmp_ne_u64 s[20:21], s[10:11], v[118:119]
  s_nop 0
  s_or_b64 vcc, vcc, s[20:21]
  s_cbranch_vccnz Rfw
Bfw:
  s_mov_b32 s12, s69
  s_mov_b32 s13, s11
  v_cmp_ne_u64 vcc, s[12:13], v[112:113]
  s_cbranch_vccnz SLOW
  s_mul_i32 s12, s8, 229376
  s_add_u32 s12, s12, 0xea0000
  v_lshl_add_u32 v248, v2, 4, s12
  v_add_u32 v249, 0xe000, v248
  v_add_u32 v250, 0x1c000, v248
  v_add_u32 v251, 0x2a000, v248
  buffer_load_dwordx4 a[0:3], v248, s[44:47], s52 offen sc1
  buffer_load_dwordx4 a[4:7], v249, s[44:47], s52 offen sc1
  s_and_b32 s13, s6, 3
  s_lshl_b32 s13, s13, 11
  v_lshl_add_u32 v3, v2, 4, s13
  s_lshl_b32 s12, s5, 2
  s_add_u32 s12, s12, s3
  s_mul_i32 s13, s12, 33024
  s_add_u32 s13, s13, 0x0
  s_lshr_b32 s14, s6, 2
  s_xor_b32 s14, s14, s3
  s_lshl_b32 s14, s14, 13
  s_add_u32 s16, s13, s14
  v_xor_b32 v4, 2048, v3
  v_xor_b32 v5, 4096, v3
  v_xor_b32 v6, 6144, v3
  s_xor_b32 s15, s14, 8192
  s_add_u32 s17, s13, s15
  s_xor_b32 s15, s14, 16384
  s_add_u32 s18, s13, s15
  s_xor_b32 s15, s14, 24576
  s_add_u32 s19, s13, s15
  v_lshrrev_b32 v13, 2, v2
  v_and_b32 v12, 3, v2
  v_mul_u32_u24 v13, 224, v13
  v_lshl_add_u32 v13, v12, 3, v13
  s_and_b32 s13, s6, 1
  s_lshl_b32 s14, s13, 5
  v_add_u32 v13, s14, v13
  s_mul_i32 s30, s13, -224
  s_add_u32 s30, s30, 192
  s_xor_b32 s13, s3, 0
  s_mul_i32 s13, s13, 28672
  v_add_u32 v100, s13, v13
  v_add_u32 v101, s30, v100
  s_xor_b32 s13, s3, 1
  s_mul_i32 s13, s13, 28672
  v_add_u32 v102, s13, v13
  v_add_u32 v103, s30, v102
  s_xor_b32 s13, s3, 2
  s_mul_i32 s13, s13, 28672
  v_add_u32 v104, s13, v13
  v_add_u32 v105, s30, v104
  s_xor_b32 s13, s3, 3
  s_mul_i32 s13, s13, 28672
  v_add_u32 v106, s13, v13
  v_add_u32 v107, s30, v106
  v_mov_b32 v244, 0x3f803f80
  v_mov_b32 v245, 0x3f803f80
  v_mov_b32 v246, 0x3f803f80
  v_mov_b32 v247, 0x3f803f80
  ds_read_b64_tr_b16 v[72:73], v100 offset:21504
  ds_read_b64_tr_b16 v[74:75], v100 offset:25088
  ds_read_b64_tr_b16 v[76:77], v100 offset:21536
  ds_read_b64_tr_b16 v[78:79], v100 offset:25120
  ds_read_b64_tr_b16 v[80:81], v100 offset:21568
  ds_read_b64_tr_b16 v[82:83], v100 offset:25152
  ds_read_b64_tr_b16 v[84:85], v100 offset:21600
  ds_read_b64_tr_b16 v[86:87], v100 offset:25184
  ds_read_b64_tr_b16 v[88:89], v100 offset:21632
  ds_read_b64_tr_b16 v[90:91], v100 offset:25216
  ds_read_b64_tr_b16 v[92:93], v100 offset:21664
  ds_read_b64_tr_b16 v[94:95], v100 offset:25248
  ds_read_b64_tr_b16 v[96:97], v101 offset:21504
  ds_read_b64_tr_b16 v[98:99], v101 offset:25088
  s_waitcnt lgkmcnt(12)
  v_mfma_f32_16x16x32_bf16 v[16:19], v[244:247], v[72:75], 0
  buffer_load_dwordx4 a[8:11], v250, s[44:47], s52 offen sc1
  s_lshl_b32 s30, s12, 4
  ds_read_b64_tr_b16 v[72:73], v100 offset:14336
  ds_read_b64_tr_b16 v[74:75], v100 offset:17920
  s_waitcnt lgkmcnt(12)
  v_mfma_f32_16x16x32_bf16 v[20:23], v[244:247], v[76:79], 0
  s_add_u32 s30, s30, s6
  s_lshl_b32 s30, s30, 5
  ds_read_b64_tr_b16 v[76:77], v100 offset:14368
  ds_read_b64_tr_b16 v[78:79], v100 offset:17952
  s_waitcnt lgkmcnt(12)
  v_mfma_f32_16x16x32_bf16 v[24:27], v[244:247], v[80:83], 0
  buffer_load_dwordx4 a[12:15], v251, s[44:47], s52 offen sc1
  s_add_u32 s30, s30, 0x18a0000
  ds_read_b64_tr_b16 v[80:81], v100 offset:14400
  ds_read_b64_tr_b16 v[82:83], v100 offset:17984
  s_waitcnt lgkmcnt(12)
  v_mfma_f32_16x16x32_bf16 v[28:31], v[244:247], v[84:87], 0
  s_lshl_b32 s31, s7, 3
  s_add_u32 s31, s31, s3
  ds_read_b64_tr_b16 v[84:85], v100 offset:14432
  ds_read_b64_tr_b16 v[86:87], v100 offset:18016
  s_waitcnt lgkmcnt(12)
  v_mfma_f32_16x16x32_bf16 v[32:35], v[244:247], v[88:91], 0
  buffer_load_dwordx4 a[16:19], v248, s[44:47], s53 offen sc1
  s_lshl_b32 s31, s31, 7
  ds_read_b64_tr_b16 v[88:89], v100 offset:14464
  ds_read_b64_tr_b16 v[90:91], v100 offset:18048
  s_waitcnt lgkmcnt(12)
  v_mfma_f32_16x16x32_bf16 v[36:39], v[244:247], v[92:95], 0
  s_add_u32 s31, s31, 0x18a0000
  s_lshl_b32 s29, s12, 13
  ds_read_b64_tr_b16 v[92:93], v100 offset:14496
  ds_read_b64_tr_b16 v[94:95], v100 offset:18080
  s_waitcnt lgkmcnt(12)
  v_mfma_f32_16x16x32_bf16 v[40:43], v[244:247], v[96:99], 0
  buffer_load_dwordx4 a[20:23], v249, s[44:47], s53 offen sc1
  s_add_u32 s29, s29, 0x1060000
  ds_read_b64_tr_b16 v[96:97], v101 offset:14336
  ds_read_b64_tr_b16 v[98:99], v101 offset:17920
  s_waitcnt lgkmcnt(12)
  v_mfma_f32_16x16x32_bf16 v[16:19], v[244:247], v[72:75], v[16:19]
  s_lshl_b32 s13, s6, 9
  s_add_u32 s28, s29, s13
  ds_read_b64_tr_b16 v[72:73], v100 offset:7168
  ds_read_b64_tr_b16 v[74:75], v100 offset:10752
  s_waitcnt lgkmcnt(12)
  v_mfma_f32_16x16x32_bf16 v[20:23], v[244:247], v[76:79], v[20:23]
  buffer_load_dwordx4 a[24:27], v250, s[44:47], s53 offen sc1
  v_and_b32 v7, 15, v2
  ds_read_b64_tr_b16 v[76:77], v100 offset:7200
  ds_read_b64_tr_b16 v[78:79], v100 offset:10784
  s_waitcnt lgkmcnt(12)
  v_mfma_f32_16x16x32_bf16 v[24:27], v[244:247], v[80:83], v[24:27]
  v_lshlrev_b32 v7, 4, v7
  s_mov_b32 s20, 0x22222222
  ds_read_b64_tr_b16 v[80:81], v100 offset:7232
  ds_read_b64_tr_b16 v[82:83], v100 offset:10816
  s_waitcnt lgkmcnt(12)
  v_mfma_f32_16x16x32_bf16 v[28:31], v[244:247], v[84:87], v[28:31]
  buffer_load_dwordx4 a[28:31], v251, s[44:47], s53 offen sc1
  s_mov_b32 s21, 0x22222222
  ds_read_b64_tr_b16 v[84:85], v100 offset:7264
  ds_read_b64_tr_b16 v[86:87], v100 offset:10848
  s_waitcnt lgkmcnt(12)
  v_mfma_f32_16x16x32_bf16 v[32:35], v[244:247], v[88:91], v[32:35]
  s_mov_b32 s22, 0x44444444
  s_mov_b32 s23, 0x44444444
  ds_read_b64_tr_b16 v[88:89], v100 offset:7296
  ds_read_b64_tr_b16 v[90:91], v100 offset:10880
  s_waitcnt lgkmcnt(12)
  v_mfma_f32_16x16x32_bf16 v[36:39], v[244:247], v[92:95], v[36:39]
  buffer_load_dwordx4 a[32:35], v248, s[44:47], s54 offen sc1
  s_mov_b32 s24, 0x88888888
  ds_read_b64_tr_b16 v[92:93], v100 offset:7328
  ds_read_b64_tr_b16 v[94:95], v100 offset:10912
  s_waitcnt lgkmcnt(12)
  v_mfma_f32_16x16x32_bf16 v[40:43], v[244:247], v[96:99], v[40:43]
  s_mov_b32 s25, 0x88888888
  s_mov_b32 s26, 0x00f0000f
  ds_read_b64_tr_b16 v[96:97], v101 offset:7168
  ds_read_b64_tr_b16 v[98:99], v101 offset:10752
  s_waitcnt lgkmcnt(12)
  v_mfma_f32_16x16x32_bf16 v[16:19], v[244:247], v[72:75], v[16:19]
  buffer_load_dwordx4 a[36:39], v249, s[44:47], s54 offen sc1
  s_mov_b32 s27, 0xf0000f00
  ds_read_b64_tr_b16 v[72:73], v100 offset:0
  ds_read_b64_tr_b16 v[74:75], v100 offset:3584
  s_waitcnt lgkmcnt(12)
  v_mfma_f32_16x16x32_bf16 v[20:23], v[244:247], v[76:79], v[20:23]
  s_lshl_b32 s12, s5, 3
  s_lshl_b32 s13, s3, 1
  ds_read_b64_tr_b16 v[76:77], v100 offset:32
  ds_read_b64_tr_b16 v[78:79], v100 offset:3616
  s_waitcnt lgkmcnt(12)
  v_mfma_f32_16x16x32_bf16 v[24:27], v[244:247], v[80:83], v[24:27]
  buffer_load_dwordx4 a[40:43], v250, s[44:47], s54 offen sc1
  s_add_u32 s12, s12, s13
  ds_read_b64_tr_b16 v[80:81], v100 offset:64
  ds_read_b64_tr_b16 v[82:83], v100 offset:3648
  s_waitcnt lgkmcnt(12)
  v_mfma_f32_16x16x32_bf16 v[28:31], v[244:247], v[84:87], v[28:31]
  s_mul_i32 s12, s12, 57344
  s_mul_i32 s13, s6, 3584
  ds_read_b64_tr_b16 v[84:85], v100 offset:96
  ds_read_b64_tr_b16 v[86:87], v100 offset:3680
  s_waitcnt lgkmcnt(12)
  v_mfma_f32_16x16x32_bf16 v[32:35], v[244:247], v[88:91], v[32:35]
  buffer_load_dwordx4 a[44:47], v251, s[44:47], s54 offen sc1
  s_add_u32 s12, s12, s13
  ds_read_b64_tr_b16 v[88:89], v100 offset:128
  ds_read_b64_tr_b16 v[90:91], v100 offset:3712
  s_waitcnt lgkmcnt(12)
  v_mfma_f32_16x16x32_bf16 v[36:39], v[244:247], v[92:95], v[36:39]
  s_add_u32 s12, s12, 0x11a0000
  s_mov_b32 s68, s12
  ds_read_b64_tr_b16 v[92:93], v100 offset:160
  ds_read_b64_tr_b16 v[94:95], v100 offset:3744
  s_waitcnt lgkmcnt(12)
  v_mfma_f32_16x16x32_bf16 v[40:43], v[244:247], v[96:99], v[40:43]
  s_and_b32 s13, s6, 1
  s_lshl_b32 s14, s13, 9
  ds_read_b64_tr_b16 v[96:97], v101 offset:0
  ds_read_b64_tr_b16 v[98:99], v101 offset:3584
  s_waitcnt lgkmcnt(12)
  v_mfma_f32_16x16x32_bf16 v[16:19], v[244:247], v[72:75], v[16:19]
  s_add_u32 s14, s14, s12
  v_lshl_add_u32 v252, v2, 4, s14
  s_waitcnt lgkmcnt(10)
  v_mfma_f32_16x16x32_bf16 v[20:23], v[244:247], v[76:79], v[20:23]
  v_add_u32 v253, 0xe000, v252
  s_cmp_eq_u32 s13, 0
  s_waitcnt lgkmcnt(8)
  v_mfma_f32_16x16x32_bf16 v[24:27], v[244:247], v[80:83], v[24:27]
  s_cselect_b32 s14, 3072, 0
  s_add_u32 s14, s14, s12
  s_waitcnt lgkmcnt(6)
  v_mfma_f32_16x16x32_bf16 v[28:31], v[244:247], v[84:87], v[28:31]
  v_add_u32 v13, s14, v7
  v_bfe_u32 v14, v2, 4, 1
  s_waitcnt lgkmcnt(4)
  v_mfma_f32_16x16x32_bf16 v[32:35], v[244:247], v[88:91], v[32:35]
  v_mul_u32_u24 v14, 0xe000, v14
  v_lshrrev_b32 v15, 5, v2
  s_waitcnt lgkmcnt(2)
  v_mfma_f32_16x16x32_bf16 v[36:39], v[244:247], v[92:95], v[36:39]
  v_lshl_add_u32 v13, v15, 8, v13
  v_add_u32 v254, v13, v14
  s_waitcnt lgkmcnt(0)
  v_mfma_f32_16x16x32_bf16 v[40:43], v[244:247], v[96:99], v[40:43]
  s_add_u32 s12, s3, 0
  s_and_b32 s12, s12, 3
  s_lshl_b32 s13, s7, 2
  s_add_u32 s12, s12, s13
  s_mul_i32 s12, s12, 57344
  s_add_u32 s12, s12, 0x11a0000
  v_lshl_add_u32 v8, v2, 4, s12
  s_add_u32 s12, s3, 1
  s_and_b32 s12, s12, 3
  s_lshl_b32 s13, s7, 2
  s_add_u32 s12, s12, s13
  s_mul_i32 s12, s12, 57344
  s_add_u32 s12, s12, 0x11a0000
  v_lshl_add_u32 v9, v2, 4, s12
  s_add_u32 s12, s3, 2
  s_and_b32 s12, s12, 3
  s_lshl_b32 s13, s7, 2
  s_add_u32 s12, s12, s13
  s_mul_i32 s12, s12, 57344
  s_add_u32 s12, s12, 0x11a0000
  v_lshl_add_u32 v10, v2, 4, s12
  s_add_u32 s12, s3, 3
  s_and_b32 s12, s12, 3
  s_lshl_b32 s13, s7, 2
  s_add_u32 s12, s12, s13
  s_mul_i32 s12, s12, 57344
  s_add_u32 s12, s12, 0x11a0000
  v_lshl_add_u32 v11, v2, 4, s12
  s_mul_i32 s14, s3, 448
  s_add_u32 s14, s14, 149760
  v_and_b32 v12, 15, v2
  v_lshl_add_u32 v12, v12, 2, s14
  ds_write_b32 v12, v16 offset:0
  ds_write_b32 v12, v20 offset:64
  ds_write_b32 v12, v24 offset:128
  ds_write_b32 v12, v28 offset:192
  ds_write_b32 v12, v32 offset:256
  ds_write_b32 v12, v36 offset:320
  ds_write_b32 v12, v40 offset:384
  v_lshlrev_b32 v12, 4, v2
  v_add_u32 v12, 149760, v12
  v_accvgpr_read_b32 v61, a238
  v_accvgpr_read_b32 v63, a239
  v_lshlrev_b32 v60, 16, v61
  v_and_b32 v61, 0xffff0000, v61
  v_lshlrev_b32 v62, 16, v63
  v_and_b32 v63, 0xffff0000, v63
  s_mov_b32 s14, 0x0fffffff
  s_mov_b32 s15, 0
  s_waitcnt lgkmcnt(0)
  s_barrier
  ds_read_b128 v[44:47], v12 offset:0
  ds_read_b128 v[48:51], v12 offset:448
  ds_read_b128 v[52:55], v12 offset:896
  ds_read_b128 v[56:59], v12 offset:1344
  s_waitcnt lgkmcnt(0)
  s_barrier
  v_pk_add_f32 v[44:45], v[44:45], v[48:49]
  v_pk_add_f32 v[46:47], v[46:47], v[50:51]
  v_pk_add_f32 v[52:53], v[52:53], v[56:57]
  v_pk_add_f32 v[54:55], v[54:55], v[58:59]
  v_pk_add_f32 v[44:45], v[44:45], v[52:53]
  v_pk_add_f32 v[46:47], v[46:47], v[54:55]
  v_cndmask_b32 v44, v60, v44, s[14:15]
  v_cndmask_b32 v45, v61, v45, s[14:15]
  v_cndmask_b32 v46, v62, v46, s[14:15]
  v_cndmask_b32 v47, v63, v47, s[14:15]
  v_mul_f32 v44, 0x3fb8aa3b, v44
  v_mul_f32 v45, 0x3fb8aa3b, v45
  v_mul_f32 v46, 0x3fb8aa3b, v46
  v_mul_f32 v47, 0x3fb8aa3b, v47
  s_add_u32 s15, s3, 1
  s_and_b32 s15, s15, 3
  s_mul_i32 s15, s15, 12288
  s_add_u32 s15, s15, 117760
  v_lshl_add_u32 v1, v2, 4, s15
  ds_write_b128 v1, v[44:47]
  v_lshrrev_b32 v1, 4, v2
  v_lshl_add_u32 v1, v1, 4, s15
  v_accvgpr_write_b32 a234, v44
  v_accvgpr_write_b32 a235, v45
  v_accvgpr_write_b32 a236, v46
  v_accvgpr_write_b32 a237, v47
  buffer_load_dwordx4 v[116:119], v3, s[44:47], s16 offen offset:0 sc1
  buffer_load_dwordx4 v[120:123], v3, s[44:47], s16 offen offset:1024 sc1
  buffer_load_dwordx4 v[124:127], v4, s[44:47], s16 offen offset:0 sc1
  buffer_load_dwordx4 v[128:131], v4, s[44:47], s16 offen offset:1024 sc1
  buffer_load_dwordx4 v[132:135], v5, s[44:47], s16 offen offset:0 sc1
  buffer_load_dwordx4 v[136:139], v5, s[44:47], s16 offen offset:1024 sc1
  buffer_load_dwordx4 v[140:143], v6, s[44:47], s16 offen offset:0 sc1
  buffer_load_dwordx4 v[144:147], v6, s[44:47], s16 offen offset:1024 sc1
  buffer_load_dwordx4 v[148:151], v3, s[44:47], s17 offen offset:0 sc1
  buffer_load_dwordx4 v[152:155], v3, s[44:47], s17 offen offset:1024 sc1
  buffer_load_dwordx4 v[156:159], v4, s[44:47], s17 offen offset:0 sc1
  buffer_load_dwordx4 v[160:163], v4, s[44:47], s17 offen offset:1024 sc1
  s_waitcnt vmcnt(8)
  v_max3_u32 v111, v116, v118, v120
  v_max3_u32 v111, v111, v122, v124
  v_max3_u32 v111, v111, v126, v128
  v_max_u32 v111, v111, v130
  v_cmp_eq_u32 vcc, -1, v111
  s_cbranch_vccnz RFg11x0
BFg11x0:
  v_swap_b32 v117, v120
  v_swap_b32 v119, v122
  s_nop 1
  v_mfma_f32_16x16x32_bf16 v[228:231], v[244:247], v[116:119], 0
  v_swap_b32 v125, v128
  v_swap_b32 v127, v130
  v_mfma_f32_16x16x32_bf16 v[232:235], v[116:119], v[116:119], 0
  buffer_load_dwordx4 v[164:167], v5, s[44:47], s17 offen offset:0 sc1
  buffer_load_dwordx4 v[168:171], v5, s[44:47], s17 offen offset:1024 sc1
  v_mfma_f32_16x16x32_bf16 v[236:239], v[244:247], v[120:123], 0
  s_nop 4
  v_cndmask_b32 v232, v232, v233, s[20:21]
  v_mfma_f32_16x16x32_bf16 v[240:243], v[120:123], v[120:123], 0
  v_cndmask_b32 v232, v232, v234, s[22:23]
  v_cndmask_b32 v229, v232, v235, s[24:25]
  v_mfma_f32_16x16x32_bf16 v[16:19], v[72:75], v[116:119], 0
  v_mov_b32 v230, s10
  v_mov_b32 v231, s11
  s_nop 2
  v_cndmask_b32 v240, v240, v241, s[20:21]
  v_mfma_f32_16x16x32_bf16 v[20:23], v[72:75], v[120:123], 0
  v_cndmask_b32 v240, v240, v242, s[22:23]
  v_cndmask_b32 v237, v240, v243, s[24:25]
  v_mov_b32 v238, s10
  v_mfma_f32_16x16x32_bf16 v[24:27], v[76:79], v[116:119], 0
  ds_read_b64_tr_b16 v[72:73], v100 offset:7168
  v_mov_b32 v239, s11
  s_mov_b64 exec, s[26:27]
  buffer_store_dwordx4 v[228:231], v7, s[44:47], s28 offen offset:0
  buffer_store_dwordx4 v[236:239], v7, s[44:47], s28 offen offset:256
  s_mov_b64 exec, -1
  v_mfma_f32_16x16x32_bf16 v[28:31], v[76:79], v[120:123], 0
  ds_read_b64_tr_b16 v[74:75], v100 offset:10752
  v_bfe_u32 v12, v2, 4, 1
  v_mfma_f32_16x16x32_bf16 v[32:35], v[80:83], v[116:119], 0
  ds_read_b64_tr_b16 v[76:77], v100 offset:7200
  v_lshl_add_u32 v7, v12, 12, v7
  v_lshrrev_b32 v12, 5, v2
  v_mfma_f32_16x16x32_bf16 v[36:39], v[80:83], v[120:123], 0
  ds_read_b64_tr_b16 v[78:79], v100 offset:10784
  v_lshl_add_u32 v7, v12, 8, v7
  s_lshl2_add_u32 s12, s7, s3
  v_mfma_f32_16x16x32_bf16 v[40:43], v[84:87], v[116:119], 0
  ds_read_b64_tr_b16 v[80:81], v100 offset:7232
  s_mul_i32 s12, s12, 16896
  s_lshl_b32 s13, s8, 10
  v_mfma_f32_16x16x32_bf16 v[44:47], v[84:87], v[120:123], 0
  ds_read_b64_tr_b16 v[82:83], v100 offset:10816
  v_mfma_f32_16x16x32_bf16 v[48:51], v[88:91], v[116:119], 0
  ds_read_b64_tr_b16 v[84:85], v100 offset:7264
  s_add_u32 s12, s12, s13
  v_lshl_add_u32 v110, v2, 4, s12
  v_mfma_f32_16x16x32_bf16 v[52:55], v[88:91], v[120:123], 0
  ds_read_b64_tr_b16 v[86:87], v100 offset:10848
  v_mov_b64 v[112:113], -1
  v_mfma_f32_16x16x32_bf16 v[56:59], v[92:95], v[116:119], 0
  ds_read_b64_tr_b16 v[88:89], v100 offset:7296
  v_mov_b64 v[114:115], -1
  v_mfma_f32_16x16x32_bf16 v[60:63], v[92:95], v[120:123], 0
  ds_read_b64_tr_b16 v[90:91], v100 offset:10880
  v_mfma_f32_16x16x32_bf16 v[64:67], v[96:99], v[116:119], 0
  ds_read_b64_tr_b16 v[92:93], v100 offset:7328
  s_mov_b32 s12, 0x420000
  buffer_store_dwordx4 v[112:115], v110, s[44:47], s12 offen sc1
  v_mfma_f32_16x16x32_bf16 v[68:71], v[96:99], v[120:123], 0
  ds_read_b64_tr_b16 v[94:95], v100 offset:10912
  s_waitcnt lgkmcnt(8)
  v_mfma_f32_16x16x32_bf16 v[16:19], v[72:75], v[124:127], v[16:19]
  ds_read_b64_tr_b16 v[96:97], v101 offset:7168
  s_waitcnt vmcnt(9)
  v_max3_u32 v111, v132, v134, v136
  v_mfma_f32_16x16x32_bf16 v[20:23], v[72:75], v[128:131], v[20:23]
  ds_read_b64_tr_b16 v[98:99], v101 offset:10752
  v_max3_u32 v111, v111, v138, v140
  v_max3_u32 v111, v111, v142, v144
  v_mfma_f32_16x16x32_bf16 v[24:27], v[76:79], v[124:127], v[24:27]
  ds_read_b64_tr_b16 v[72:73], v100 offset:14336
  v_max_u32 v111, v111, v146
  v_mfma_f32_16x16x32_bf16 v[28:31], v[76:79], v[128:131], v[28:31]
  ds_read_b64_tr_b16 v[74:75], v100 offset:17920
  s_waitcnt lgkmcnt(8)
  v_mfma_f32_16x16x32_bf16 v[32:35], v[80:83], v[124:127], v[32:35]
  ds_read_b64_tr_b16 v[76:77], v100 offset:14368
  v_cmp_eq_u32 vcc, -1, v111
  s_cbranch_vccnz RFg11x1
BFg11x1:
  v_mfma_f32_16x16x32_bf16 v[36:39], v[80:83], v[128:131], v[36:39]
  ds_read_b64_tr_b16 v[78:79], v100 offset:17952
  v_swap_b32 v133, v136
  v_mfma_f32_16x16x32_bf16 v[40:43], v[84:87], v[124:127], v[40:43]
  ds_read_b64_tr_b16 v[80:81], v100 offset:14400
  v_swap_b32 v135, v138
  v_mfma_f32_16x16x32_bf16 v[44:47], v[84:87], v[128:131], v[44:47]
  ds_read_b64_tr_b16 v[82:83], v100 offset:17984
  s_waitcnt lgkmcnt(8)
  v_mfma_f32_16x16x32_bf16 v[48:51], v[88:91], v[124:127], v[48:51]
  ds_read_b64_tr_b16 v[84:85], v100 offset:14432
  buffer_load_dwordx4 v[172:175], v6, s[44:47], s17 offen offset:0 sc1
  v_mfma_f32_16x16x32_bf16 v[52:55], v[88:91], v[128:131], v[52:55]
  ds_read_b64_tr_b16 v[86:87], v100 offset:18016
  buffer_load_dwordx4 v[176:179], v6, s[44:47], s17 offen offset:1024 sc1
  v_mfma_f32_16x16x32_bf16 v[56:59], v[92:95], v[124:127], v[56:59]
  ds_read_b64_tr_b16 v[88:89], v100 offset:14464
  v_mfma_f32_16x16x32_bf16 v[60:63], v[92:95], v[128:131], v[60:63]
  ds_read_b64_tr_b16 v[90:91], v100 offset:18048
  s_waitcnt lgkmcnt(10)
  v_mfma_f32_16x16x32_bf16 v[64:67], v[96:99], v[124:127], v[64:67]
  ds_read_b64_tr_b16 v[92:93], v100 offset:14496
  s_mov_b32 s12, 0x422100
  buffer_store_dwordx4 v[112:115], v110, s[44:47], s12 offen sc1
  v_mfma_f32_16x16x32_bf16 v[68:71], v[96:99], v[128:131], v[68:71]
  ds_read_b64_tr_b16 v[94:95], v100 offset:18080
  s_waitcnt lgkmcnt(8)
  v_mfma_f32_16x16x32_bf16 v[16:19], v[72:75], v[132:135], v[16:19]
  ds_read_b64_tr_b16 v[96:97], v101 offset:14336
  v_swap_b32 v141, v144
  v_mfma_f32_16x16x32_bf16 v[20:23], v[72:75], v[136:139], v[20:23]
  ds_read_b64_tr_b16 v[98:99], v101 offset:17920
  v_swap_b32 v143, v146
  v_mfma_f32_16x16x32_bf16 v[24:27], v[76:79], v[132:135], v[24:27]
  ds_read_b64_tr_b16 v[72:73], v100 offset:21504
  buffer_load_dwordx4 v[180:183], v3, s[44:47], s18 offen offset:0 sc1
  v_mfma_f32_16x16x32_bf16 v[28:31], v[76:79], v[136:139], v[28:31]
  ds_read_b64_tr_b16 v[74:75], v100 offset:25088
  s_waitcnt lgkmcnt(8)
  v_mfma_f32_16x16x32_bf16 v[32:35], v[80:83], v[132:135], v[32:35]
  ds_read_b64_tr_b16 v[76:77], v100 offset:21536
  buffer_load_dwordx4 v[184:187], v3, s[44:47], s18 offen offset:1024 sc1
  v_mfma_f32_16x16x32_bf16 v[36:39], v[80:83], v[136:139], v[36:39]
  ds_read_b64_tr_b16 v[78:79], v100 offset:25120
  v_mfma_f32_16x16x32_bf16 v[40:43], v[84:87], v[132:135], v[40:43]
  ds_read_b64_tr_b16 v[80:81], v100 offset:21568
  s_mov_b32 s12, 0x640000
  buffer_store_dwordx4 v[112:115], v110, s[44:47], s12 offen sc1
  v_mfma_f32_16x16x32_bf16 v[44:47], v[84:87], v[136:139], v[44:47]
  ds_read_b64_tr_b16 v[82:83], v100 offset:25152
  s_waitcnt lgkmcnt(8)
  v_mfma_f32_16x16x32_bf16 v[48:51], v[88:91], v[132:135], v[48:51]
  ds_read_b64_tr_b16 v[84:85], v100 offset:21600
  v_mfma_f32_16x16x32_bf16 v[52:55], v[88:91], v[136:139], v[52:55]
  ds_read_b64_tr_b16 v[86:87], v100 offset:25184
  v_mfma_f32_16x16x32_bf16 v[56:59], v[92:95], v[132:135], v[56:59]
  ds_read_b64_tr_b16 v[88:89], v100 offset:21632
  v_mfma_f32_16x16x32_bf16 v[60:63], v[92:95], v[136:139], v[60:63]
  ds_read_b64_tr_b16 v[90:91], v100 offset:25216
  s_waitcnt lgkmcnt(10)
  v_mfma_f32_16x16x32_bf16 v[64:67], v[96:99], v[132:135], v[64:67]
  ds_read_b64_tr_b16 v[92:93], v100 offset:21664
  v_mfma_f32_16x16x32_bf16 v[68:71], v[96:99], v[136:139], v[68:71]
  ds_read_b64_tr_b16 v[94:95], v100 offset:25248
  s_waitcnt lgkmcnt(8)
  v_mfma_f32_16x16x32_bf16 v[16:19], v[72:75], v[140:143], v[16:19]
  ds_read_b64_tr_b16 v[96:97], v101 offset:21504
  s_waitcnt vmcnt(11)
  v_max3_u32 v111, v148, v150, v152
  v_mfma_f32_16x16x32_bf16 v[20:23], v[72:75], v[144:147], v[20:23]
  ds_read_b64_tr_b16 v[98:99], v101 offset:25088
  v_max3_u32 v111, v111, v154, v156
  v_max3_u32 v111, v111, v158, v160
  v_mfma_f32_16x16x32_bf16 v[24:27], v[76:79], v[140:143], v[24:27]
  ds_read_b64_tr_b16 v[72:73], v102 offset:0
  v_max_u32 v111, v111, v162
  v_mfma_f32_16x16x32_bf16 v[28:31], v[76:79], v[144:147], v[28:31]
  ds_read_b64_tr_b16 v[74:75], v102 offset:3584
  s_waitcnt lgkmcnt(8)
  v_mfma_f32_16x16x32_bf16 v[32:35], v[80:83], v[140:143], v[32:35]
  ds_read_b64_tr_b16 v[76:77], v102 offset:32
  v_cmp_eq_u32 vcc, -1, v111
  s_cbranch_vccnz RFg11x2
BFg11x2:
  v_mfma_f32_16x16x32_bf16 v[36:39], v[80:83], v[144:147], v[36:39]
  ds_read_b64_tr_b16 v[78:79], v102 offset:3616
  v_swap_b32 v149, v152
  v_mfma_f32_16x16x32_bf16 v[40:43], v[84:87], v[140:143], v[40:43]
  ds_read_b64_tr_b16 v[80:81], v102 offset:64
  v_swap_b32 v151, v154
  v_mfma_f32_16x16x32_bf16 v[44:47], v[84:87], v[144:147], v[44:47]
  ds_read_b64_tr_b16 v[82:83], v102 offset:3648
  s_waitcnt lgkmcnt(8)
  v_mfma_f32_16x16x32_bf16 v[48:51], v[88:91], v[140:143], v[48:51]
  ds_read_b64_tr_b16 v[84:85], v102 offset:96
  buffer_load_dwordx4 v[188:191], v4, s[44:47], s18 offen offset:0 sc1
  v_mfma_f32_16x16x32_bf16 v[52:55], v[88:91], v[144:147], v[52:55]
  ds_read_b64_tr_b16 v[86:87], v102 offset:3680
  buffer_load_dwordx4 v[192:195], v4, s[44:47], s18 offen offset:1024 sc1
  v_mfma_f32_16x16x32_bf16 v[56:59], v[92:95], v[140:143], v[56:59]
  ds_read_b64_tr_b16 v[88:89], v102 offset:128
  v_mfma_f32_16x16x32_bf16 v[60:63], v[92:95], v[144:147], v[60:63]
  ds_read_b64_tr_b16 v[90:91], v102 offset:3712
  s_waitcnt lgkmcnt(10)
  v_mfma_f32_16x16x32_bf16 v[64:67], v[96:99], v[140:143], v[64:67]
  ds_read_b64_tr_b16 v[92:93], v102 offset:160
  s_mov_b32 s12, 0x642100
  buffer_store_dwordx4 v[112:115], v110, s[44:47], s12 offen sc1
  v_mfma_f32_16x16x32_bf16 v[68:71], v[96:99], v[144:147], v[68:71]
  ds_read_b64_tr_b16 v[94:95], v102 offset:3744
  s_waitcnt lgkmcnt(8)
  v_mfma_f32_16x16x32_bf16 v[16:19], v[72:75], v[148:151], v[16:19]
  ds_read_b64_tr_b16 v[96:97], v103 offset:0
  v_swap_b32 v157, v160
  v_mfma_f32_16x16x32_bf16 v[20:23], v[72:75], v[152:155], v[20:23]
  ds_read_b64_tr_b16 v[98:99], v103 offset:3584
  v_swap_b32 v159, v162
  v_mfma_f32_16x16x32_bf16 v[24:27], v[76:79], v[148:151], v[24:27]
  ds_read_b64_tr_b16 v[72:73], v102 offset:7168
  buffer_load_dwordx4 v[196:199], v5, s[44:47], s18 offen offset:0 sc1
  v_mfma_f32_16x16x32_bf16 v[28:31], v[76:79], v[152:155], v[28:31]
  ds_read_b64_tr_b16 v[74:75], v102 offset:10752
  s_waitcnt lgkmcnt(8)
  v_mfma_f32_16x16x32_bf16 v[32:35], v[80:83], v[148:151], v[32:35]
  ds_read_b64_tr_b16 v[76:77], v102 offset:7200
  buffer_load_dwordx4 v[200:203], v5, s[44:47], s18 offen offset:1024 sc1
  v_mfma_f32_16x16x32_bf16 v[36:39], v[80:83], v[152:155], v[36:39]
  ds_read_b64_tr_b16 v[78:79], v102 offset:10784
  v_mfma_f32_16x16x32_bf16 v[40:43], v[84:87], v[148:151], v[40:43]
  ds_read_b64_tr_b16 v[80:81], v102 offset:7232
  v_mfma_f32_16x16x32_bf16 v[44:47], v[84:87], v[152:155], v[44:47]
  ds_read_b64_tr_b16 v[82:83], v102 offset:10816
  s_waitcnt lgkmcnt(8)
  v_mfma_f32_16x16x32_bf16 v[48:51], v[88:91], v[148:151], v[48:51]
  ds_read_b64_tr_b16 v[84:85], v102 offset:7264
  v_mfma_f32_16x16x32_bf16 v[52:55], v[88:91], v[152:155], v[52:55]
  ds_read_b64_tr_b16 v[86:87], v102 offset:10848
  v_mfma_f32_16x16x32_bf16 v[56:59], v[92:95], v[148:151], v[56:59]
  ds_read_b64_tr_b16 v[88:89], v102 offset:7296
  v_mfma_f32_16x16x32_bf16 v[60:63], v[92:95], v[152:155], v[60:63]
  ds_read_b64_tr_b16 v[90:91], v102 offset:10880
  s_waitcnt lgkmcnt(10)
  v_mfma_f32_16x16x32_bf16 v[64:67], v[96:99], v[148:151], v[64:67]
  ds_read_b64_tr_b16 v[92:93], v102 offset:7328
  v_mfma_f32_16x16x32_bf16 v[68:71], v[96:99], v[152:155], v[68:71]
  ds_read_b64_tr_b16 v[94:95], v102 offset:10912
  s_waitcnt lgkmcnt(8)
  v_mfma_f32_16x16x32_bf16 v[16:19], v[72:75], v[156:159], v[16:19]
  ds_read_b64_tr_b16 v[96:97], v103 offset:7168
  s_waitcnt vmcnt(9)
  v_max3_u32 v111, v164, v166, v168
  v_mfma_f32_16x16x32_bf16 v[20:23], v[72:75], v[160:163], v[20:23]
  ds_read_b64_tr_b16 v[98:99], v103 offset:10752
  v_max3_u32 v111, v111, v170, v172
  v_max3_u32 v111, v111, v174, v176
  v_mfma_f32_16x16x32_bf16 v[24:27], v[76:79], v[156:159], v[24:27]
  ds_read_b64_tr_b16 v[72:73], v102 offset:14336
  v_max_u32 v111, v111, v178
  v_mfma_f32_16x16x32_bf16 v[28:31], v[76:79], v[160:163], v[28:31]
  ds_read_b64_tr_b16 v[74:75], v102 offset:17920
  s_waitcnt lgkmcnt(8)
  v_mfma_f32_16x16x32_bf16 v[32:35], v[80:83], v[156:159], v[32:35]
  ds_read_b64_tr_b16 v[76:77], v102 offset:14368
  v_cmp_eq_u32 vcc, -1, v111
  v_mfma_f32_16x16x32_bf16 v[36:39], v[80:83], v[160:163], v[36:39]
  ds_read_b64_tr_b16 v[78:79], v102 offset:17952
  s_cbranch_vccnz RFg11x3
BFg11x3:
  v_mfma_f32_16x16x32_bf16 v[40:43], v[84:87], v[156:159], v[40:43]
  ds_read_b64_tr_b16 v[80:81], v102 offset:14400
  v_swap_b32 v165, v168
  v_mfma_f32_16x16x32_bf16 v[44:47], v[84:87], v[160:163], v[44:47]
  ds_read_b64_tr_b16 v[82:83], v102 offset:17984
  s_waitcnt lgkmcnt(8)
  v_mfma_f32_16x16x32_bf16 v[48:51], v[88:91], v[156:159], v[48:51]
  ds_read_b64_tr_b16 v[84:85], v102 offset:14432
  v_swap_b32 v167, v170
  v_mfma_f32_16x16x32_bf16 v[52:55], v[88:91], v[160:163], v[52:55]
  ds_read_b64_tr_b16 v[86:87], v102 offset:18016
  buffer_load_dwordx4 v[204:207], v6, s[44:47], s18 offen offset:0 sc1
  v_mfma_f32_16x16x32_bf16 v[56:59], v[92:95], v[156:159], v[56:59]
  ds_read_b64_tr_b16 v[88:89], v102 offset:14464
  buffer_load_dwordx4 v[208:211], v6, s[44:47], s18 offen offset:1024 sc1
  v_mfma_f32_16x16x32_bf16 v[60:63], v[92:95], v[160:163], v[60:63]
  ds_read_b64_tr_b16 v[90:91], v102 offset:18048
  s_waitcnt lgkmcnt(10)
  v_mfma_f32_16x16x32_bf16 v[64:67], v[96:99], v[156:159], v[64:67]
  ds_read_b64_tr_b16 v[92:93], v102 offset:14496
  v_mfma_f32_16x16x32_bf16 v[68:71], v[96:99], v[160:163], v[68:71]
  ds_read_b64_tr_b16 v[94:95], v102 offset:18080
  s_waitcnt lgkmcnt(8)
  v_mfma_f32_16x16x32_bf16 v[16:19], v[72:75], v[164:167], v[16:19]
  ds_read_b64_tr_b16 v[96:97], v103 offset:14336
  v_swap_b32 v173, v176
  v_mfma_f32_16x16x32_bf16 v[20:23], v[72:75], v[168:171], v[20:23]
  ds_read_b64_tr_b16 v[98:99], v103 offset:17920
  v_swap_b32 v175, v178
  v_mfma_f32_16x16x32_bf16 v[24:27], v[76:79], v[164:167], v[24:27]
  ds_read_b64_tr_b16 v[72:73], v102 offset:21504
  buffer_load_dwordx4 v[212:215], v3, s[44:47], s19 offen offset:0 sc1
  v_mfma_f32_16x16x32_bf16 v[28:31], v[76:79], v[168:171], v[28:31]
  ds_read_b64_tr_b16 v[74:75], v102 offset:25088
  s_waitcnt lgkmcnt(8)
  v_mfma_f32_16x16x32_bf16 v[32:35], v[80:83], v[164:167], v[32:35]
  ds_read_b64_tr_b16 v[76:77], v102 offset:21536
  buffer_load_dwordx4 v[216:219], v3, s[44:47], s19 offen offset:1024 sc1
  v_mfma_f32_16x16x32_bf16 v[36:39], v[80:83], v[168:171], v[36:39]
  ds_read_b64_tr_b16 v[78:79], v102 offset:25120
  v_mfma_f32_16x16x32_bf16 v[40:43], v[84:87], v[164:167], v[40:43]
  ds_read_b64_tr_b16 v[80:81], v102 offset:21568
  v_mfma_f32_16x16x32_bf16 v[44:47], v[84:87], v[168:171], v[44:47]
  ds_read_b64_tr_b16 v[82:83], v102 offset:25152
  s_waitcnt lgkmcnt(8)
  v_mfma_f32_16x16x32_bf16 v[48:51], v[88:91], v[164:167], v[48:51]
  ds_read_b64_tr_b16 v[84:85], v102 offset:21600
  v_mfma_f32_16x16x32_bf16 v[52:55], v[88:91], v[168:171], v[52:55]
  ds_read_b64_tr_b16 v[86:87], v102 offset:25184
  v_mfma_f32_16x16x32_bf16 v[56:59], v[92:95], v[164:167], v[56:59]
  ds_read_b64_tr_b16 v[88:89], v102 offset:21632
  v_mfma_f32_16x16x32_bf16 v[60:63], v[92:95], v[168:171], v[60:63]
  ds_read_b64_tr_b16 v[90:91], v102 offset:25216
  s_waitcnt lgkmcnt(10)
  v_mfma_f32_16x16x32_bf16 v[64:67], v[96:99], v[164:167], v[64:67]
  ds_read_b64_tr_b16 v[92:93], v102 offset:21664
  v_mfma_f32_16x16x32_bf16 v[68:71], v[96:99], v[168:171], v[68:71]
  ds_read_b64_tr_b16 v[94:95], v102 offset:25248
  s_waitcnt lgkmcnt(8)
  v_mfma_f32_16x16x32_bf16 v[16:19], v[72:75], v[172:175], v[16:19]
  ds_read_b64_tr_b16 v[96:97], v103 offset:21504
  s_waitcnt vmcnt(7)
  v_max3_u32 v111, v180, v182, v184
  v_mfma_f32_16x16x32_bf16 v[20:23], v[72:75], v[176:179], v[20:23]
  ds_read_b64_tr_b16 v[98:99], v103 offset:25088
  v_max3_u32 v111, v111, v186, v188
  v_max3_u32 v111, v111, v190, v192
  v_mfma_f32_16x16x32_bf16 v[24:27], v[76:79], v[172:175], v[24:27]
  ds_read_b64_tr_b16 v[72:73], v104 offset:0
  v_max_u32 v111, v111, v194
  v_mfma_f32_16x16x32_bf16 v[28:31], v[76:79], v[176:179], v[28:31]
  ds_read_b64_tr_b16 v[74:75], v104 offset:3584
  s_waitcnt lgkmcnt(8)
  v_mfma_f32_16x16x32_bf16 v[32:35], v[80:83], v[172:175], v[32:35]
  ds_read_b64_tr_b16 v[76:77], v104 offset:32
  v_cmp_eq_u32 vcc, -1, v111
  v_mfma_f32_16x16x32_bf16 v[36:39], v[80:83], v[176:179], v[36:39]
  ds_read_b64_tr_b16 v[78:79], v104 offset:3616
  s_cbranch_vccnz RFg11x4
BFg11x4:
  v_mfma_f32_16x16x32_bf16 v[40:43], v[84:87], v[172:175], v[40:43]
  ds_read_b64_tr_b16 v[80:81], v104 offset:64
  v_swap_b32 v181, v184
  v_mfma_f32_16x16x32_bf16 v[44:47], v[84:87], v[176:179], v[44:47]
  ds_read_b64_tr_b16 v[82:83], v104 offset:3648
  s_waitcnt lgkmcnt(8)
  v_mfma_f32_16x16x32_bf16 v[48:51], v[88:91], v[172:175], v[48:51]
  ds_read_b64_tr_b16 v[84:85], v104 offset:96
  v_swap_b32 v183, v186
  v_mfma_f32_16x16x32_bf16 v[52:55], v[88:91], v[176:179], v[52:55]
  ds_read_b64_tr_b16 v[86:87], v104 offset:3680
  buffer_load_dwordx4 v[220:223], v4, s[44:47], s19 offen offset:0 sc1
  v_mfma_f32_16x16x32_bf16 v[56:59], v[92:95], v[172:175], v[56:59]
  ds_read_b64_tr_b16 v[88:89], v104 offset:128
  buffer_load_dwordx4 v[224:227], v4, s[44:47], s19 offen offset:1024 sc1
  v_mfma_f32_16x16x32_bf16 v[60:63], v[92:95], v[176:179], v[60:63]
  ds_read_b64_tr_b16 v[90:91], v104 offset:3712
  s_waitcnt lgkmcnt(10)
  v_mfma_f32_16x16x32_bf16 v[64:67], v[96:99], v[172:175], v[64:67]
  ds_read_b64_tr_b16 v[92:93], v104 offset:160
  v_mfma_f32_16x16x32_bf16 v[68:71], v[96:99], v[176:179], v[68:71]
  ds_read_b64_tr_b16 v[94:95], v104 offset:3744
  s_waitcnt lgkmcnt(8)
  v_mfma_f32_16x16x32_bf16 v[16:19], v[72:75], v[180:183], v[16:19]
  ds_read_b64_tr_b16 v[96:97], v105 offset:0
  v_swap_b32 v189, v192
  v_mfma_f32_16x16x32_bf16 v[20:23], v[72:75], v[184:187], v[20:23]
  ds_read_b64_tr_b16 v[98:99], v105 offset:3584
  v_swap_b32 v191, v194
  v_mfma_f32_16x16x32_bf16 v[24:27], v[76:79], v[180:183], v[24:27]
  ds_read_b64_tr_b16 v[72:73], v104 offset:7168
  buffer_load_dwordx4 v[228:231], v5, s[44:47], s19 offen offset:0 sc1
  v_mfma_f32_16x16x32_bf16 v[28:31], v[76:79], v[184:187], v[28:31]
  ds_read_b64_tr_b16 v[74:75], v104 offset:10752
  s_waitcnt lgkmcnt(8)
  v_mfma_f32_16x16x32_bf16 v[32:35], v[80:83], v[180:183], v[32:35]
  ds_read_b64_tr_b16 v[76:77], v104 offset:7200
  buffer_load_dwordx4 v[232:235], v5, s[44:47], s19 offen offset:1024 sc1
  v_mfma_f32_16x16x32_bf16 v[36:39], v[80:83], v[184:187], v[36:39]
  ds_read_b64_tr_b16 v[78:79], v104 offset:10784
  v_mfma_f32_16x16x32_bf16 v[40:43], v[84:87], v[180:183], v[40:43]
  ds_read_b64_tr_b16 v[80:81], v104 offset:7232
  v_mfma_f32_16x16x32_bf16 v[44:47], v[84:87], v[184:187], v[44:47]
  ds_read_b64_tr_b16 v[82:83], v104 offset:10816
  s_waitcnt lgkmcnt(8)
  v_mfma_f32_16x16x32_bf16 v[48:51], v[88:91], v[180:183], v[48:51]
  ds_read_b64_tr_b16 v[84:85], v104 offset:7264
  v_mfma_f32_16x16x32_bf16 v[52:55], v[88:91], v[184:187], v[52:55]
  ds_read_b64_tr_b16 v[86:87], v104 offset:10848
  v_mfma_f32_16x16x32_bf16 v[56:59], v[92:95], v[180:183], v[56:59]
  ds_read_b64_tr_b16 v[88:89], v104 offset:7296
  v_mfma_f32_16x16x32_bf16 v[60:63], v[92:95], v[184:187], v[60:63]
  ds_read_b64_tr_b16 v[90:91], v104 offset:10880
  s_waitcnt lgkmcnt(10)
  v_mfma_f32_16x16x32_bf16 v[64:67], v[96:99], v[180:183], v[64:67]
  ds_read_b64_tr_b16 v[92:93], v104 offset:7328
  v_mfma_f32_16x16x32_bf16 v[68:71], v[96:99], v[184:187], v[68:71]
  ds_read_b64_tr_b16 v[94:95], v104 offset:10912
  s_waitcnt lgkmcnt(8)
  v_mfma_f32_16x16x32_bf16 v[16:19], v[72:75], v[188:191], v[16:19]
  ds_read_b64_tr_b16 v[96:97], v105 offset:7168
  s_waitcnt vmcnt(6)
  v_max3_u32 v111, v196, v198, v200
  v_mfma_f32_16x16x32_bf16 v[20:23], v[72:75], v[192:195], v[20:23]
  ds_read_b64_tr_b16 v[98:99], v105 offset:10752
  v_max3_u32 v111, v111, v202, v204
  v_max3_u32 v111, v111, v206, v208
  v_mfma_f32_16x16x32_bf16 v[24:27], v[76:79], v[188:191], v[24:27]
  ds_read_b64_tr_b16 v[72:73], v104 offset:14336
  v_max_u32 v111, v111, v210
  v_mfma_f32_16x16x32_bf16 v[28:31], v[76:79], v[192:195], v[28:31]
  ds_read_b64_tr_b16 v[74:75], v104 offset:17920
  s_waitcnt lgkmcnt(8)
  v_mfma_f32_16x16x32_bf16 v[32:35], v[80:83], v[188:191], v[32:35]
  ds_read_b64_tr_b16 v[76:77], v104 offset:14368
  v_cmp_eq_u32 vcc, -1, v111
  v_mfma_f32_16x16x32_bf16 v[36:39], v[80:83], v[192:195], v[36:39]
  ds_read_b64_tr_b16 v[78:79], v104 offset:17952
  s_cbranch_vccnz RFg11x5
BFg11x5:
  v_mfma_f32_16x16x32_bf16 v[40:43], v[84:87], v[188:191], v[40:43]
  ds_read_b64_tr_b16 v[80:81], v104 offset:14400
  v_swap_b32 v197, v200
  v_mfma_f32_16x16x32_bf16 v[44:47], v[84:87], v[192:195], v[44:47]
  ds_read_b64_tr_b16 v[82:83], v104 offset:17984
  s_waitcnt lgkmcnt(8)
  v_mfma_f32_16x16x32_bf16 v[48:51], v[88:91], v[188:191], v[48:51]
  ds_read_b64_tr_b16 v[84:85], v104 offset:14432
  v_swap_b32 v199, v202
  v_mfma_f32_16x16x32_bf16 v[52:55], v[88:91], v[192:195], v[52:55]
  ds_read_b64_tr_b16 v[86:87], v104 offset:18016
  buffer_load_dwordx4 v[236:239], v6, s[44:47], s19 offen offset:0 sc1
  v_mfma_f32_16x16x32_bf16 v[56:59], v[92:95], v[188:191], v[56:59]
  ds_read_b64_tr_b16 v[88:89], v104 offset:14464
  buffer_load_dwordx4 v[240:243], v6, s[44:47], s19 offen offset:1024 sc1
  v_mfma_f32_16x16x32_bf16 v[60:63], v[92:95], v[192:195], v[60:63]
  ds_read_b64_tr_b16 v[90:91], v104 offset:18048
  s_waitcnt lgkmcnt(10)
  v_mfma_f32_16x16x32_bf16 v[64:67], v[96:99], v[188:191], v[64:67]
  ds_read_b64_tr_b16 v[92:93], v104 offset:14496
  v_mfma_f32_16x16x32_bf16 v[68:71], v[96:99], v[192:195], v[68:71]
  ds_read_b64_tr_b16 v[94:95], v104 offset:18080
  s_waitcnt lgkmcnt(8)
  v_mfma_f32_16x16x32_bf16 v[16:19], v[72:75], v[196:199], v[16:19]
  ds_read_b64_tr_b16 v[96:97], v105 offset:14336
  v_swap_b32 v205, v208
  v_swap_b32 v207, v210
  v_mfma_f32_16x16x32_bf16 v[20:23], v[72:75], v[200:203], v[20:23]
  ds_read_b64_tr_b16 v[98:99], v105 offset:17920
  buffer_load_dwordx4 v[116:119], v7, s[44:47], s29 offen offset:0 sc1
  buffer_load_dwordx4 v[120:123], v7, s[44:47], s29 offen offset:512 sc1
  v_mfma_f32_16x16x32_bf16 v[24:27], v[76:79], v[196:199], v[24:27]
  ds_read_b64_tr_b16 v[72:73], v104 offset:21504
  buffer_load_dwordx4 a[48:51], v248, s[44:47], s55 offen sc1
  v_mfma_f32_16x16x32_bf16 v[28:31], v[76:79], v[200:203], v[28:31]
  ds_read_b64_tr_b16 v[74:75], v104 offset:25088
  s_waitcnt lgkmcnt(8)
  v_mfma_f32_16x16x32_bf16 v[32:35], v[80:83], v[196:199], v[32:35]
  ds_read_b64_tr_b16 v[76:77], v104 offset:21536
  buffer_load_dwordx4 v[124:127], v7, s[44:47], s29 offen offset:1024 sc1
  buffer_load_dwordx4 v[128:131], v7, s[44:47], s29 offen offset:1536 sc1
  v_mfma_f32_16x16x32_bf16 v[36:39], v[80:83], v[200:203], v[36:39]
  ds_read_b64_tr_b16 v[78:79], v104 offset:25120
  buffer_load_dwordx4 v[132:135], v7, s[44:47], s29 offen offset:2048 sc1
  v_mfma_f32_16x16x32_bf16 v[40:43], v[84:87], v[196:199], v[40:43]
  ds_read_b64_tr_b16 v[80:81], v104 offset:21568
  buffer_load_dwordx4 a[52:55], v249, s[44:47], s55 offen sc1
  v_mfma_f32_16x16x32_bf16 v[44:47], v[84:87], v[200:203], v[44:47]
  ds_read_b64_tr_b16 v[82:83], v104 offset:25152
  s_waitcnt lgkmcnt(8)
  v_mfma_f32_16x16x32_bf16 v[48:51], v[88:91], v[196:199], v[48:51]
  ds_read_b64_tr_b16 v[84:85], v104 offset:21600
  buffer_load_dwordx4 v[136:139], v7, s[44:47], s29 offen offset:2560 sc1
  v_mfma_f32_16x16x32_bf16 v[52:55], v[88:91], v[200:203], v[52:55]
  ds_read_b64_tr_b16 v[86:87], v104 offset:25184
  buffer_load_dwordx4 v[140:143], v7, s[44:47], s29 offen offset:3072 sc1
  v_mfma_f32_16x16x32_bf16 v[56:59], v[92:95], v[196:199], v[56:59]
  ds_read_b64_tr_b16 v[88:89], v104 offset:21632
  buffer_load_dwordx4 v[144:147], v7, s[44:47], s29 offen offset:3584 sc1
  v_mfma_f32_16x16x32_bf16 v[60:63], v[92:95], v[200:203], v[60:63]
  ds_read_b64_tr_b16 v[90:91], v104 offset:25216
  buffer_load_dwordx4 a[56:59], v250, s[44:47], s55 offen sc1
  s_waitcnt lgkmcnt(10)
  v_mfma_f32_16x16x32_bf16 v[64:67], v[96:99], v[196:199], v[64:67]
  ds_read_b64_tr_b16 v[92:93], v104 offset:21664
  v_mfma_f32_16x16x32_bf16 v[68:71], v[96:99], v[200:203], v[68:71]
  ds_read_b64_tr_b16 v[94:95], v104 offset:25248
  s_waitcnt lgkmcnt(8)
  v_mfma_f32_16x16x32_bf16 v[16:19], v[72:75], v[204:207], v[16:19]
  ds_read_b64_tr_b16 v[96:97], v105 offset:21504
  s_waitcnt vmcnt(15)
  v_max3_u32 v111, v212, v214, v216
  v_mfma_f32_16x16x32_bf16 v[20:23], v[72:75], v[208:211], v[20:23]
  ds_read_b64_tr_b16 v[98:99], v105 offset:25088
  buffer_load_dwordx4 a[60:63], v251, s[44:47], s55 offen sc1
  v_max3_u32 v111, v111, v218, v220
  v_mfma_f32_16x16x32_bf16 v[24:27], v[76:79], v[204:207], v[24:27]
  ds_read_b64_tr_b16 v[72:73], v106 offset:0
  v_max3_u32 v111, v111, v222, v224
  v_mfma_f32_16x16x32_bf16 v[28:31], v[76:79], v[208:211], v[28:31]
  ds_read_b64_tr_b16 v[74:75], v106 offset:3584
  s_waitcnt lgkmcnt(8)
  v_mfma_f32_16x16x32_bf16 v[32:35], v[80:83], v[204:207], v[32:35]
  ds_read_b64_tr_b16 v[76:77], v106 offset:32
  v_max_u32 v111, v111, v226
  v_cmp_eq_u32 vcc, -1, v111
  v_mfma_f32_16x16x32_bf16 v[36:39], v[80:83], v[208:211], v[36:39]
  ds_read_b64_tr_b16 v[78:79], v106 offset:3616
  buffer_load_dwordx4 a[64:67], v248, s[44:47], s56 offen sc1
  v_mfma_f32_16x16x32_bf16 v[40:43], v[84:87], v[204:207], v[40:43]
  ds_read_b64_tr_b16 v[80:81], v106 offset:64
  s_cbranch_vccnz RFg11x6
BFg11x6:
  v_mfma_f32_16x16x32_bf16 v[44:47], v[84:87], v[208:211], v[44:47]
  ds_read_b64_tr_b16 v[82:83], v106 offset:3648
  s_waitcnt lgkmcnt(8)
  v_mfma_f32_16x16x32_bf16 v[48:51], v[88:91], v[204:207], v[48:51]
  ds_read_b64_tr_b16 v[84:85], v106 offset:96
  buffer_load_dwordx4 a[68:71], v249, s[44:47], s56 offen sc1
  v_mfma_f32_16x16x32_bf16 v[52:55], v[88:91], v[208:211], v[52:55]
  ds_read_b64_tr_b16 v[86:87], v106 offset:3680
  v_swap_b32 v213, v216
  v_mfma_f32_16x16x32_bf16 v[56:59], v[92:95], v[204:207], v[56:59]
  ds_read_b64_tr_b16 v[88:89], v106 offset:128
  v_swap_b32 v215, v218
  v_mfma_f32_16x16x32_bf16 v[60:63], v[92:95], v[208:211], v[60:63]
  ds_read_b64_tr_b16 v[90:91], v106 offset:3712
  s_waitcnt lgkmcnt(10)
  v_mfma_f32_16x16x32_bf16 v[64:67], v[96:99], v[204:207], v[64:67]
  ds_read_b64_tr_b16 v[92:93], v106 offset:160
  buffer_load_dwordx4 a[72:75], v250, s[44:47], s56 offen sc1
  v_mfma_f32_16x16x32_bf16 v[68:71], v[96:99], v[208:211], v[68:71]
  ds_read_b64_tr_b16 v[94:95], v106 offset:3744
  s_waitcnt lgkmcnt(8)
  v_mfma_f32_16x16x32_bf16 v[16:19], v[72:75], v[212:215], v[16:19]
  ds_read_b64_tr_b16 v[96:97], v107 offset:0
  v_swap_b32 v221, v224
  v_mfma_f32_16x16x32_bf16 v[20:23], v[72:75], v[216:219], v[20:23]
  ds_read_b64_tr_b16 v[98:99], v107 offset:3584
  buffer_load_dwordx4 a[76:79], v251, s[44:47], s56 offen sc1
  v_mfma_f32_16x16x32_bf16 v[24:27], v[76:79], v[212:215], v[24:27]
  ds_read_b64_tr_b16 v[72:73], v106 offset:7168
  v_swap_b32 v223, v226
  v_mfma_f32_16x16x32_bf16 v[28:31], v[76:79], v[216:219], v[28:31]
  ds_read_b64_tr_b16 v[74:75], v106 offset:10752
  s_waitcnt lgkmcnt(8)
  v_mfma_f32_16x16x32_bf16 v[32:35], v[80:83], v[212:215], v[32:35]
  ds_read_b64_tr_b16 v[76:77], v106 offset:7200
  v_mfma_f32_16x16x32_bf16 v[36:39], v[80:83], v[216:219], v[36:39]
  ds_read_b64_tr_b16 v[78:79], v106 offset:10784
  buffer_load_dwordx4 a[80:83], v248, s[44:47], s57 offen sc1
  v_mfma_f32_16x16x32_bf16 v[40:43], v[84:87], v[212:215], v[40:43]
  ds_read_b64_tr_b16 v[80:81], v106 offset:7232
  v_mfma_f32_16x16x32_bf16 v[44:47], v[84:87], v[216:219], v[44:47]
  ds_read_b64_tr_b16 v[82:83], v106 offset:10816
  s_waitcnt lgkmcnt(8)
  v_mfma_f32_16x16x32_bf16 v[48:51], v[88:91], v[212:215], v[48:51]
  ds_read_b64_tr_b16 v[84:85], v106 offset:7264
  buffer_load_dwordx4 a[84:87], v249, s[44:47], s57 offen sc1
  v_mfma_f32_16x16x32_bf16 v[52:55], v[88:91], v[216:219], v[52:55]
  ds_read_b64_tr_b16 v[86:87], v106 offset:10848
  v_mfma_f32_16x16x32_bf16 v[56:59], v[92:95], v[212:215], v[56:59]
  ds_read_b64_tr_b16 v[88:89], v106 offset:7296
  v_mfma_f32_16x16x32_bf16 v[60:63], v[92:95], v[216:219], v[60:63]
  ds_read_b64_tr_b16 v[90:91], v106 offset:10880
  s_waitcnt lgkmcnt(10)
  v_mfma_f32_16x16x32_bf16 v[64:67], v[96:99], v[212:215], v[64:67]
  ds_read_b64_tr_b16 v[92:93], v106 offset:7328
  buffer_load_dwordx4 a[88:91], v250, s[44:47], s57 offen sc1
  v_mfma_f32_16x16x32_bf16 v[68:71], v[96:99], v[216:219], v[68:71]
  ds_read_b64_tr_b16 v[94:95], v106 offset:10912
  s_waitcnt lgkmcnt(8)
  v_mfma_f32_16x16x32_bf16 v[16:19], v[72:75], v[220:223], v[16:19]
  ds_read_b64_tr_b16 v[96:97], v107 offset:7168
  s_waitcnt vmcnt(19)
  v_max3_u32 v111, v228, v230, v232
  v_mfma_f32_16x16x32_bf16 v[20:23], v[72:75], v[224:227], v[20:23]
  ds_read_b64_tr_b16 v[98:99], v107 offset:10752
  buffer_load_dwordx4 a[92:95], v251, s[44:47], s57 offen sc1
  v_max3_u32 v111, v111, v234, v236
  v_mfma_f32_16x16x32_bf16 v[24:27], v[76:79], v[220:223], v[24:27]
  ds_read_b64_tr_b16 v[72:73], v106 offset:14336
  v_max3_u32 v111, v111, v238, v240
  v_mfma_f32_16x16x32_bf16 v[28:31], v[76:79], v[224:227], v[28:31]
  ds_read_b64_tr_b16 v[74:75], v106 offset:17920
  s_waitcnt lgkmcnt(8)
  v_mfma_f32_16x16x32_bf16 v[32:35], v[80:83], v[220:223], v[32:35]
  ds_read_b64_tr_b16 v[76:77], v106 offset:14368
  v_max_u32 v111, v111, v242
  v_cmp_eq_u32 vcc, -1, v111
  v_mfma_f32_16x16x32_bf16 v[36:39], v[80:83], v[224:227], v[36:39]
  ds_read_b64_tr_b16 v[78:79], v106 offset:17952
  buffer_load_dwordx4 a[96:99], v248, s[44:47], s58 offen sc1
  v_mfma_f32_16x16x32_bf16 v[40:43], v[84:87], v[220:223], v[40:43]
  ds_read_b64_tr_b16 v[80:81], v106 offset:14400
  s_cbranch_vccnz RFg11x7
BFg11x7:
  v_mfma_f32_16x16x32_bf16 v[44:47], v[84:87], v[224:227], v[44:47]
  ds_read_b64_tr_b16 v[82:83], v106 offset:17984
  s_waitcnt lgkmcnt(8)
  v_mfma_f32_16x16x32_bf16 v[48:51], v[88:91], v[220:223], v[48:51]
  ds_read_b64_tr_b16 v[84:85], v106 offset:14432
  buffer_load_dwordx4 a[100:103], v249, s[44:47], s58 offen sc1
  v_mfma_f32_16x16x32_bf16 v[52:55], v[88:91], v[224:227], v[52:55]
  ds_read_b64_tr_b16 v[86:87], v106 offset:18016
  v_swap_b32 v229, v232
  v_mfma_f32_16x16x32_bf16 v[56:59], v[92:95], v[220:223], v[56:59]
  ds_read_b64_tr_b16 v[88:89], v106 offset:14464
  v_swap_b32 v231, v234
  v_mfma_f32_16x16x32_bf16 v[60:63], v[92:95], v[224:227], v[60:63]
  ds_read_b64_tr_b16 v[90:91], v106 offset:18048
  s_waitcnt lgkmcnt(10)
  v_mfma_f32_16x16x32_bf16 v[64:67], v[96:99], v[220:223], v[64:67]
  ds_read_b64_tr_b16 v[92:93], v106 offset:14496
  buffer_load_dwordx4 a[104:107], v250, s[44:47], s58 offen sc1
  v_mfma_f32_16x16x32_bf16 v[68:71], v[96:99], v[224:227], v[68:71]
  ds_read_b64_tr_b16 v[94:95], v106 offset:18080
  s_waitcnt lgkmcnt(8)
  v_mfma_f32_16x16x32_bf16 v[16:19], v[72:75], v[228:231], v[16:19]
  ds_read_b64_tr_b16 v[96:97], v107 offset:14336
  v_swap_b32 v237, v240
  v_swap_b32 v239, v242
  v_mfma_f32_16x16x32_bf16 v[20:23], v[72:75], v[232:235], v[20:23]
  ds_read_b64_tr_b16 v[98:99], v107 offset:17920
  buffer_load_dwordx4 a[108:111], v251, s[44:47], s58 offen sc1
  v_mov_b32 v4, s10
  v_mfma_f32_16x16x32_bf16 v[24:27], v[76:79], v[228:231], v[24:27]
  ds_read_b64_tr_b16 v[72:73], v106 offset:21504
  v_mov_b32 v5, s11
  v_lshlrev_b32 v6, 26, v2
  v_mfma_f32_16x16x32_bf16 v[28:31], v[76:79], v[232:235], v[28:31]
  ds_read_b64_tr_b16 v[74:75], v106 offset:25088
  s_waitcnt lgkmcnt(8)
  v_mfma_f32_16x16x32_bf16 v[32:35], v[80:83], v[228:231], v[32:35]
  ds_read_b64_tr_b16 v[76:77], v106 offset:21536
  v_and_b32 v3, 15, v2
  v_bfe_u32 v111, v2, 4, 1
  v_mfma_f32_16x16x32_bf16 v[36:39], v[80:83], v[232:235], v[36:39]
  ds_read_b64_tr_b16 v[78:79], v106 offset:25120
  buffer_load_dwordx4 a[112:115], v248, s[44:47], s59 offen sc1
  v_mfma_f32_16x16x32_bf16 v[40:43], v[84:87], v[228:231], v[40:43]
  ds_read_b64_tr_b16 v[80:81], v106 offset:21568
  v_lshlrev_b32 v3, 3, v3
  v_mfma_f32_16x16x32_bf16 v[44:47], v[84:87], v[232:235], v[44:47]
  ds_read_b64_tr_b16 v[82:83], v106 offset:25152
  s_waitcnt lgkmcnt(8)
  v_mfma_f32_16x16x32_bf16 v[48:51], v[88:91], v[228:231], v[48:51]
  ds_read_b64_tr_b16 v[84:85], v106 offset:21600
  buffer_load_dwordx4 a[116:119], v249, s[44:47], s59 offen sc1
  v_mfma_f32_16x16x32_bf16 v[52:55], v[88:91], v[232:235], v[52:55]
  ds_read_b64_tr_b16 v[86:87], v106 offset:25184
  v_lshl_add_u32 v3, v111, 9, v3
  v_mfma_f32_16x16x32_bf16 v[56:59], v[92:95], v[228:231], v[56:59]
  ds_read_b64_tr_b16 v[88:89], v106 offset:21632
  buffer_load_dwordx2 v[108:109], v3, s[44:47], s31 offen sc1
  v_mfma_f32_16x16x32_bf16 v[60:63], v[92:95], v[232:235], v[60:63]
  ds_read_b64_tr_b16 v[90:91], v106 offset:25216
  s_waitcnt lgkmcnt(10)
  v_mfma_f32_16x16x32_bf16 v[64:67], v[96:99], v[228:231], v[64:67]
  ds_read_b64_tr_b16 v[92:93], v106 offset:21664
  buffer_load_dwordx4 a[120:123], v250, s[44:47], s59 offen sc1
  v_mfma_f32_16x16x32_bf16 v[68:71], v[96:99], v[232:235], v[68:71]
  ds_read_b64_tr_b16 v[94:95], v106 offset:25248
  s_waitcnt lgkmcnt(8)
  v_mfma_f32_16x16x32_bf16 v[16:19], v[72:75], v[236:239], v[16:19]
  ds_read_b64_tr_b16 v[96:97], v107 offset:21504
  s_waitcnt vmcnt(18)
  v_cmp_ne_u64 s[24:25], s[10:11], v[118:119]
  v_mfma_f32_16x16x32_bf16 v[20:23], v[72:75], v[240:243], v[20:23]
  ds_read_b64_tr_b16 v[98:99], v107 offset:25088
  buffer_load_dwordx4 a[124:127], v251, s[44:47], s59 offen sc1
  v_mfma_f32_16x16x32_bf16 v[24:27], v[76:79], v[236:239], v[24:27]
  ds_read_b128 v[148:151], v1 offset:0
  v_cmp_ne_u64 s[22:23], s[10:11], v[122:123]
  v_mfma_f32_16x16x32_bf16 v[28:31], v[76:79], v[240:243], v[28:31]
  ds_read_b128 v[176:179], v1 offset:448
  s_waitcnt lgkmcnt(8)
  v_mfma_f32_16x16x32_bf16 v[32:35], v[80:83], v[236:239], v[32:35]
  ds_read_b128 v[152:155], v1 offset:64
  v_cmp_ne_u64 s[20:21], s[10:11], v[126:127]
  v_mfma_f32_16x16x32_bf16 v[36:39], v[80:83], v[240:243], v[36:39]
  ds_read_b128 v[180:183], v1 offset:512
  buffer_load_dwordx4 a[128:131], v248, s[44:47], s60 offen sc1
  v_mfma_f32_16x16x32_bf16 v[40:43], v[84:87], v[236:239], v[40:43]
  ds_read_b128 v[156:159], v1 offset:128
  s_or_b64 s[24:25], s[24:25], s[22:23]
  v_mfma_f32_16x16x32_bf16 v[44:47], v[84:87], v[240:243], v[44:47]
  ds_read_b128 v[184:187], v1 offset:576
  s_waitcnt lgkmcnt(8)
  v_mfma_f32_16x16x32_bf16 v[48:51], v[88:91], v[236:239], v[48:51]
  ds_read_b128 v[160:163], v1 offset:192
  buffer_load_dwordx4 a[132:135], v249, s[44:47], s60 offen sc1
  v_mfma_f32_16x16x32_bf16 v[52:55], v[88:91], v[240:243], v[52:55]
  ds_read_b128 v[188:191], v1 offset:640
  v_cmp_ne_u64 s[22:23], s[10:11], v[130:131]
  v_mfma_f32_16x16x32_bf16 v[56:59], v[92:95], v[236:239], v[56:59]
  ds_read_b128 v[164:167], v1 offset:256
  s_or_b64 s[24:25], s[24:25], s[20:21]
  v_mfma_f32_16x16x32_bf16 v[60:63], v[92:95], v[240:243], v[60:63]
  ds_read_b128 v[192:195], v1 offset:704
  s_waitcnt lgkmcnt(10)
  v_mfma_f32_16x16x32_bf16 v[64:67], v[96:99], v[236:239], v[64:67]
  ds_read_b128 v[168:171], v1 offset:320
  buffer_load_dwordx4 a[136:139], v250, s[44:47], s60 offen sc1
  v_mfma_f32_16x16x32_bf16 v[68:71], v[96:99], v[240:243], v[68:71]
  ds_read_b128 v[196:199], v1 offset:768
  ds_read_b128 v[172:175], v1 offset:384
  ds_read_b128 v[200:203], v1 offset:832
  v_cmp_ne_u64 s[20:21], s[10:11], v[134:135]
  s_or_b64 s[24:25], s[24:25], s[22:23]
  v_cmp_ne_u64 s[22:23], s[10:11], v[138:139]
  s_or_b64 s[24:25], s[24:25], s[20:21]
  v_cmp_ne_u64 s[20:21], s[10:11], v[142:143]
  s_or_b64 s[24:25], s[24:25], s[22:23]
  v_cmp_ne_u64 s[22:23], s[10:11], v[146:147]
  s_or_b64 s[24:25], s[24:25], s[20:21]
  s_or_b64 vcc, s[24:25], s[22:23]
  s_cbranch_vccnz RFg11p
BFg11p:
  v_add_f32 v116, v116, v120
  v_add_f32 v117, v117, v121
  v_add_f32 v124, v124, v128
  v_add_f32 v125, v125, v129
  v_add_f32 v132, v132, v136
  v_add_f32 v133, v133, v137
  v_add_f32 v140, v140, v144
  v_add_f32 v141, v141, v145
  v_add_f32 v116, v116, v124
  v_add_f32 v117, v117, v125
  v_add_f32 v132, v132, v140
  v_add_f32 v133, v133, v141
  v_add_f32 v116, v116, v132
  v_add_f32 v117, v117, v133
  v_mov_b32 v120, v116
  v_mov_b32 v121, v117
  s_nop 0
  v_permlane16_swap_b32 v116, v120
  v_permlane16_swap_b32 v117, v121
  v_add_f32 v116, v116, v120
  v_add_f32 v117, v117, v121
  v_mul_f32 v116, 0x3b000000, v116
  v_mul_f32 v117, 0x3b000000, v117
  v_fma_f32 v117, -v116, v116, v117
  v_max_f32 v117, 0, v117
  v_cvt_pk_bf16_f32 v119, 0, v117
  v_add_f32 v119, 0x3727c5ac, v119
  v_cvt_pk_bf16_f32 v119, 0, v119
  v_sqrt_f32 v119, v119
  s_nop 0
  v_cvt_pk_bf16_f32 v118, v116, v119
  v_and_b32 v13, 0xffff0000, v118
  v_rcp_f32 v13, v13
  v_lshlrev_b32 v12, 16, v118
  v_mul_f32 v12, v12, v13
  v_mul_f32 v13, 0x3fb8aa3b, v13
  v_mov_b32 v14, v12
  v_mov_b32 v15, v13
  s_nop 0
  v_permlane32_swap_b32 v12, v14
  v_permlane32_swap_b32 v13, v15
  s_mov_b32 s20, 1.0
  s_mov_b32 s21, 1.0
  s_mov_b32 s22, 0x3f317218
  s_mov_b32 s23, 0xbfb17218
  s_lshl2_add_u32 s12, s2, s3
  s_lshl_b32 s12, s12, 3
  s_add_u32 s12, s12, 0x18b2000
  buffer_store_dwordx2 v[4:5], v6, s[44:47], s12 offen sc1
  s_waitcnt lgkmcnt(0)
  v_pk_fma_f32 v[204:205], v[148:149], v[12:13], v[176:177] op_sel:[0,0,0] op_sel_hi:[1,0,1] neg_lo:[0,1,0] neg_hi:[0,1,0]
  v_pk_fma_f32 v[206:207], v[150:151], v[12:13], v[178:179] op_sel:[0,0,0] op_sel_hi:[1,0,1] neg_lo:[0,1,0] neg_hi:[0,1,0]
  v_pk_fma_f32 v[212:213], v[152:153], v[12:13], v[180:181] op_sel:[0,0,0] op_sel_hi:[1,0,1] neg_lo:[0,1,0] neg_hi:[0,1,0]
  v_pk_fma_f32 v[214:215], v[154:155], v[12:13], v[182:183] op_sel:[0,0,0] op_sel_hi:[1,0,1] neg_lo:[0,1,0] neg_hi:[0,1,0]
  v_pk_fma_f32 v[204:205], v[16:17], v[12:13], v[204:205] op_sel:[0,1,0] op_sel_hi:[1,1,1]
  v_pk_fma_f32 v[206:207], v[18:19], v[12:13], v[206:207] op_sel:[0,1,0] op_sel_hi:[1,1,1]
  v_pk_fma_f32 v[212:213], v[24:25], v[12:13], v[212:213] op_sel:[0,1,0] op_sel_hi:[1,1,1]
  v_pk_fma_f32 v[214:215], v[26:27], v[12:13], v[214:215] op_sel:[0,1,0] op_sel_hi:[1,1,1]
  v_exp_f32 v208, v204
  v_exp_f32 v209, v205
  v_exp_f32 v216, v212
  v_exp_f32 v217, v213
  v_exp_f32 v210, v206
  v_exp_f32 v211, v207
  v_exp_f32 v218, v214
  v_exp_f32 v219, v215
  v_pk_add_f32 v[208:209], v[208:209], s[20:21]
  v_pk_add_f32 v[210:211], v[210:211], s[20:21]
  v_pk_add_f32 v[216:217], v[216:217], s[20:21]
  v_pk_add_f32 v[218:219], v[218:219], s[20:21]
  v_pk_fma_f32 v[208:209], v[208:209], v[208:209], s[20:21]
  v_pk_fma_f32 v[210:211], v[210:211], v[210:211], s[20:21]
  v_pk_fma_f32 v[216:217], v[216:217], v[216:217], s[20:21]
  v_pk_fma_f32 v[218:219], v[218:219], v[218:219], s[20:21]
  v_rcp_f32 v208, v208
  v_rcp_f32 v209, v209
  v_rcp_f32 v216, v216
  v_rcp_f32 v217, v217
  v_rcp_f32 v210, v210
  v_rcp_f32 v211, v211
  v_rcp_f32 v218, v218
  v_rcp_f32 v219, v219
  v_pk_fma_f32 v[208:209], v[208:209], s[22:23], s[22:23] op_sel:[0,1,0] op_sel_hi:[1,1,0]
  v_pk_fma_f32 v[210:211], v[210:211], s[22:23], s[22:23] op_sel:[0,1,0] op_sel_hi:[1,1,0]
  v_pk_fma_f32 v[216:217], v[216:217], s[22:23], s[22:23] op_sel:[0,1,0] op_sel_hi:[1,1,0]
  v_pk_fma_f32 v[218:219], v[218:219], s[22:23], s[22:23] op_sel:[0,1,0] op_sel_hi:[1,1,0]
  v_pk_mul_f32 v[208:209], v[208:209], v[204:205]
  v_pk_mul_f32 v[210:211], v[210:211], v[206:207]
  v_pk_mul_f32 v[216:217], v[216:217], v[212:213]
  v_pk_mul_f32 v[218:219], v[218:219], v[214:215]
  v_cvt_pk_bf16_f32 v236, v208, v209
  v_cvt_pk_bf16_f32 v237, v210, v211
  v_cvt_pk_bf16_f32 v238, v216, v217
  v_cvt_pk_bf16_f32 v239, v218, v219
  buffer_store_dwordx4 v[236:239], v252, s[44:47], 0 offen offset:0
  buffer_load_dwordx4 a[140:143], v251, s[44:47], s60 offen sc1
  buffer_load_dwordx4 a[144:147], v248, s[44:47], s61 offen sc1
  buffer_load_dwordx4 a[148:151], v249, s[44:47], s61 offen sc1
  buffer_load_dwordx4 a[152:155], v250, s[44:47], s61 offen sc1
  v_pk_fma_f32 v[220:221], v[148:149], v[14:15], v[176:177] op_sel:[0,0,0] op_sel_hi:[1,0,1] neg_lo:[0,1,0] neg_hi:[0,1,0]
  v_pk_fma_f32 v[222:223], v[150:151], v[14:15], v[178:179] op_sel:[0,0,0] op_sel_hi:[1,0,1] neg_lo:[0,1,0] neg_hi:[0,1,0]
  v_pk_fma_f32 v[228:229], v[152:153], v[14:15], v[180:181] op_sel:[0,0,0] op_sel_hi:[1,0,1] neg_lo:[0,1,0] neg_hi:[0,1,0]
  v_pk_fma_f32 v[230:231], v[154:155], v[14:15], v[182:183] op_sel:[0,0,0] op_sel_hi:[1,0,1] neg_lo:[0,1,0] neg_hi:[0,1,0]
  v_pk_fma_f32 v[220:221], v[20:21], v[14:15], v[220:221] op_sel:[0,1,0] op_sel_hi:[1,1,1]
  v_pk_fma_f32 v[222:223], v[22:23], v[14:15], v[222:223] op_sel:[0,1,0] op_sel_hi:[1,1,1]
  v_pk_fma_f32 v[228:229], v[28:29], v[14:15], v[228:229] op_sel:[0,1,0] op_sel_hi:[1,1,1]
  v_pk_fma_f32 v[230:231], v[30:31], v[14:15], v[230:231] op_sel:[0,1,0] op_sel_hi:[1,1,1]
  v_exp_f32 v224, v220
  v_exp_f32 v225, v221
  v_exp_f32 v232, v228
  v_exp_f32 v233, v229
  v_exp_f32 v226, v222
  v_exp_f32 v227, v223
  v_exp_f32 v234, v230
  v_exp_f32 v235, v231
  v_pk_add_f32 v[224:225], v[224:225], s[20:21]
  v_pk_add_f32 v[226:227], v[226:227], s[20:21]
  v_pk_add_f32 v[232:233], v[232:233], s[20:21]
  v_pk_add_f32 v[234:235], v[234:235], s[20:21]
  v_pk_fma_f32 v[224:225], v[224:225], v[224:225], s[20:21]
  v_pk_fma_f32 v[226:227], v[226:227], v[226:227], s[20:21]
  v_pk_fma_f32 v[232:233], v[232:233], v[232:233], s[20:21]
  v_pk_fma_f32 v[234:235], v[234:235], v[234:235], s[20:21]
  v_rcp_f32 v224, v224
  v_rcp_f32 v225, v225
  v_rcp_f32 v232, v232
  v_rcp_f32 v233, v233
  v_rcp_f32 v226, v226
  v_rcp_f32 v227, v227
  v_rcp_f32 v234, v234
  v_rcp_f32 v235, v235
  v_pk_fma_f32 v[224:225], v[224:225], s[22:23], s[22:23] op_sel:[0,1,0] op_sel_hi:[1,1,0]
  v_pk_fma_f32 v[226:227], v[226:227], s[22:23], s[22:23] op_sel:[0,1,0] op_sel_hi:[1,1,0]
  v_pk_fma_f32 v[232:233], v[232:233], s[22:23], s[22:23] op_sel:[0,1,0] op_sel_hi:[1,1,0]
  v_pk_fma_f32 v[234:235], v[234:235], s[22:23], s[22:23] op_sel:[0,1,0] op_sel_hi:[1,1,0]
  v_pk_mul_f32 v[224:225], v[224:225], v[220:221]
  v_pk_mul_f32 v[226:227], v[226:227], v[222:223]
  v_pk_mul_f32 v[232:233], v[232:233], v[228:229]
  v_pk_mul_f32 v[234:235], v[234:235], v[230:231]
  v_cvt_pk_bf16_f32 v240, v224, v225
  v_cvt_pk_bf16_f32 v241, v226, v227
  v_cvt_pk_bf16_f32 v242, v232, v233
  v_cvt_pk_bf16_f32 v243, v234, v235
  buffer_store_dwordx4 v[240:243], v253, s[44:47], 0 offen offset:0
  buffer_load_dwordx4 a[156:159], v251, s[44:47], s61 offen sc1
  buffer_load_dwordx4 a[160:163], v248, s[44:47], s62 offen sc1
  buffer_load_dwordx4 a[164:167], v249, s[44:47], s62 offen sc1
  buffer_load_dwordx4 a[168:171], v250, s[44:47], s62 offen sc1
  v_pk_fma_f32 v[204:205], v[156:157], v[12:13], v[184:185] op_sel:[0,0,0] op_sel_hi:[1,0,1] neg_lo:[0,1,0] neg_hi:[0,1,0]
  v_pk_fma_f32 v[206:207], v[158:159], v[12:13], v[186:187] op_sel:[0,0,0] op_sel_hi:[1,0,1] neg_lo:[0,1,0] neg_hi:[0,1,0]
  v_pk_fma_f32 v[212:213], v[160:161], v[12:13], v[188:189] op_sel:[0,0,0] op_sel_hi:[1,0,1] neg_lo:[0,1,0] neg_hi:[0,1,0]
  v_pk_fma_f32 v[214:215], v[162:163], v[12:13], v[190:191] op_sel:[0,0,0] op_sel_hi:[1,0,1] neg_lo:[0,1,0] neg_hi:[0,1,0]
  v_pk_fma_f32 v[204:205], v[32:33], v[12:13], v[204:205] op_sel:[0,1,0] op_sel_hi:[1,1,1]
  v_pk_fma_f32 v[206:207], v[34:35], v[12:13], v[206:207] op_sel:[0,1,0] op_sel_hi:[1,1,1]
  v_pk_fma_f32 v[212:213], v[40:41], v[12:13], v[212:213] op_sel:[0,1,0] op_sel_hi:[1,1,1]
  v_pk_fma_f32 v[214:215], v[42:43], v[12:13], v[214:215] op_sel:[0,1,0] op_sel_hi:[1,1,1]
  v_exp_f32 v208, v204
  v_exp_f32 v209, v205
  v_exp_f32 v216, v212
  v_exp_f32 v217, v213
  v_exp_f32 v210, v206
  v_exp_f32 v211, v207
  v_exp_f32 v218, v214
  v_exp_f32 v219, v215
  v_pk_add_f32 v[208:209], v[208:209], s[20:21]
  v_pk_add_f32 v[210:211], v[210:211], s[20:21]
  v_pk_add_f32 v[216:217], v[216:217], s[20:21]
  v_pk_add_f32 v[218:219], v[218:219], s[20:21]
  v_pk_fma_f32 v[208:209], v[208:209], v[208:209], s[20:21]
  v_pk_fma_f32 v[210:211], v[210:211], v[210:211], s[20:21]
  v_pk_fma_f32 v[216:217], v[216:217], v[216:217], s[20:21]
  v_pk_fma_f32 v[218:219], v[218:219], v[218:219], s[20:21]
  v_rcp_f32 v208, v208
  v_rcp_f32 v209, v209
  v_rcp_f32 v216, v216
  v_rcp_f32 v217, v217
  v_rcp_f32 v210, v210
  v_rcp_f32 v211, v211
  v_rcp_f32 v218, v218
  v_rcp_f32 v219, v219
  v_pk_fma_f32 v[208:209], v[208:209], s[22:23], s[22:23] op_sel:[0,1,0] op_sel_hi:[1,1,0]
  v_pk_fma_f32 v[210:211], v[210:211], s[22:23], s[22:23] op_sel:[0,1,0] op_sel_hi:[1,1,0]
  v_pk_fma_f32 v[216:217], v[216:217], s[22:23], s[22:23] op_sel:[0,1,0] op_sel_hi:[1,1,0]
  v_pk_fma_f32 v[218:219], v[218:219], s[22:23], s[22:23] op_sel:[0,1,0] op_sel_hi:[1,1,0]
  v_pk_mul_f32 v[208:209], v[208:209], v[204:205]
  v_pk_mul_f32 v[210:211], v[210:211], v[206:207]
  v_pk_mul_f32 v[216:217], v[216:217], v[212:213]
  v_pk_mul_f32 v[218:219], v[218:219], v[214:215]
  v_cvt_pk_bf16_f32 v236, v208, v209
  v_cvt_pk_bf16_f32 v237, v210, v211
  v_cvt_pk_bf16_f32 v238, v216, v217
  v_cvt_pk_bf16_f32 v239, v218, v219
  buffer_store_dwordx4 v[236:239], v252, s[44:47], 0 offen offset:1024
  s_waitcnt vmcnt(5)
  buffer_store_dwordx2 v[4:5], v6, s[44:47], s30 offen offset:0
  buffer_load_dwordx4 a[172:175], v251, s[44:47], s62 offen sc1
  buffer_load_dwordx4 a[176:179], v248, s[44:47], s63 offen sc1
  buffer_load_dwordx4 a[180:183], v249, s[44:47], s63 offen sc1
  buffer_load_dwordx4 a[184:187], v250, s[44:47], s63 offen sc1
  v_pk_fma_f32 v[220:221], v[156:157], v[14:15], v[184:185] op_sel:[0,0,0] op_sel_hi:[1,0,1] neg_lo:[0,1,0] neg_hi:[0,1,0]
  v_pk_fma_f32 v[222:223], v[158:159], v[14:15], v[186:187] op_sel:[0,0,0] op_sel_hi:[1,0,1] neg_lo:[0,1,0] neg_hi:[0,1,0]
  v_pk_fma_f32 v[228:229], v[160:161], v[14:15], v[188:189] op_sel:[0,0,0] op_sel_hi:[1,0,1] neg_lo:[0,1,0] neg_hi:[0,1,0]
  v_pk_fma_f32 v[230:231], v[162:163], v[14:15], v[190:191] op_sel:[0,0,0] op_sel_hi:[1,0,1] neg_lo:[0,1,0] neg_hi:[0,1,0]
  v_pk_fma_f32 v[220:221], v[36:37], v[14:15], v[220:221] op_sel:[0,1,0] op_sel_hi:[1,1,1]
  v_pk_fma_f32 v[222:223], v[38:39], v[14:15], v[222:223] op_sel:[0,1,0] op_sel_hi:[1,1,1]
  v_pk_fma_f32 v[228:229], v[44:45], v[14:15], v[228:229] op_sel:[0,1,0] op_sel_hi:[1,1,1]
  v_pk_fma_f32 v[230:231], v[46:47], v[14:15], v[230:231] op_sel:[0,1,0] op_sel_hi:[1,1,1]
  v_exp_f32 v224, v220
  v_exp_f32 v225, v221
  v_exp_f32 v232, v228
  v_exp_f32 v233, v229
  v_exp_f32 v226, v222
  v_exp_f32 v227, v223
  v_exp_f32 v234, v230
  v_exp_f32 v235, v231
  v_pk_add_f32 v[224:225], v[224:225], s[20:21]
  v_pk_add_f32 v[226:227], v[226:227], s[20:21]
  v_pk_add_f32 v[232:233], v[232:233], s[20:21]
  v_pk_add_f32 v[234:235], v[234:235], s[20:21]
  v_pk_fma_f32 v[224:225], v[224:225], v[224:225], s[20:21]
  v_pk_fma_f32 v[226:227], v[226:227], v[226:227], s[20:21]
  v_pk_fma_f32 v[232:233], v[232:233], v[232:233], s[20:21]
  v_pk_fma_f32 v[234:235], v[234:235], v[234:235], s[20:21]
  v_rcp_f32 v224, v224
  v_rcp_f32 v225, v225
  v_rcp_f32 v232, v232
  v_rcp_f32 v233, v233
  v_rcp_f32 v226, v226
  v_rcp_f32 v227, v227
  v_rcp_f32 v234, v234
  v_rcp_f32 v235, v235
  v_pk_fma_f32 v[224:225], v[224:225], s[22:23], s[22:23] op_sel:[0,1,0] op_sel_hi:[1,1,0]
  v_pk_fma_f32 v[226:227], v[226:227], s[22:23], s[22:23] op_sel:[0,1,0] op_sel_hi:[1,1,0]
  v_pk_fma_f32 v[232:233], v[232:233], s[22:23], s[22:23] op_sel:[0,1,0] op_sel_hi:[1,1,0]
  v_pk_fma_f32 v[234:235], v[234:235], s[22:23], s[22:23] op_sel:[0,1,0] op_sel_hi:[1,1,0]
  v_pk_mul_f32 v[224:225], v[224:225], v[220:221]
  v_pk_mul_f32 v[226:227], v[226:227], v[222:223]
  v_pk_mul_f32 v[232:233], v[232:233], v[228:229]
  v_pk_mul_f32 v[234:235], v[234:235], v[230:231]
  v_cvt_pk_bf16_f32 v240, v224, v225
  v_cvt_pk_bf16_f32 v241, v226, v227
  v_cvt_pk_bf16_f32 v242, v232, v233
  v_cvt_pk_bf16_f32 v243, v234, v235
  buffer_store_dwordx4 v[240:243], v253, s[44:47], 0 offen offset:1024
  buffer_load_dwordx4 a[188:191], v251, s[44:47], s63 offen sc1
  buffer_load_dwordx4 a[192:195], v248, s[44:47], s64 offen sc1
  buffer_load_dwordx4 a[196:199], v249, s[44:47], s64 offen sc1
  buffer_load_dwordx4 a[200:203], v250, s[44:47], s64 offen sc1
  v_pk_fma_f32 v[204:205], v[164:165], v[12:13], v[192:193] op_sel:[0,0,0] op_sel_hi:[1,0,1] neg_lo:[0,1,0] neg_hi:[0,1,0]
  v_pk_fma_f32 v[206:207], v[166:167], v[12:13], v[194:195] op_sel:[0,0,0] op_sel_hi:[1,0,1] neg_lo:[0,1,0] neg_hi:[0,1,0]
  v_pk_fma_f32 v[212:213], v[168:169], v[12:13], v[196:197] op_sel:[0,0,0] op_sel_hi:[1,0,1] neg_lo:[0,1,0] neg_hi:[0,1,0]
  v_pk_fma_f32 v[214:215], v[170:171], v[12:13], v[198:199] op_sel:[0,0,0] op_sel_hi:[1,0,1] neg_lo:[0,1,0] neg_hi:[0,1,0]
  v_pk_fma_f32 v[204:205], v[48:49], v[12:13], v[204:205] op_sel:[0,1,0] op_sel_hi:[1,1,1]
  v_pk_fma_f32 v[206:207], v[50:51], v[12:13], v[206:207] op_sel:[0,1,0] op_sel_hi:[1,1,1]
  v_pk_fma_f32 v[212:213], v[56:57], v[12:13], v[212:213] op_sel:[0,1,0] op_sel_hi:[1,1,1]
  v_pk_fma_f32 v[214:215], v[58:59], v[12:13], v[214:215] op_sel:[0,1,0] op_sel_hi:[1,1,1]
  v_exp_f32 v208, v204
  v_exp_f32 v209, v205
  v_exp_f32 v216, v212
  v_exp_f32 v217, v213
  v_exp_f32 v210, v206
  v_exp_f32 v211, v207
  v_exp_f32 v218, v214
  v_exp_f32 v219, v215
  v_pk_add_f32 v[208:209], v[208:209], s[20:21]
  v_pk_add_f32 v[210:211], v[210:211], s[20:21]
  v_pk_add_f32 v[216:217], v[216:217], s[20:21]
  v_pk_add_f32 v[218:219], v[218:219], s[20:21]
  v_pk_fma_f32 v[208:209], v[208:209], v[208:209], s[20:21]
  v_pk_fma_f32 v[210:211], v[210:211], v[210:211], s[20:21]
  v_pk_fma_f32 v[216:217], v[216:217], v[216:217], s[20:21]
  v_pk_fma_f32 v[218:219], v[218:219], v[218:219], s[20:21]
  v_rcp_f32 v208, v208
  v_rcp_f32 v209, v209
  v_rcp_f32 v216, v216
  v_rcp_f32 v217, v217
  v_rcp_f32 v210, v210
  v_rcp_f32 v211, v211
  v_rcp_f32 v218, v218
  v_rcp_f32 v219, v219
  v_pk_fma_f32 v[208:209], v[208:209], s[22:23], s[22:23] op_sel:[0,1,0] op_sel_hi:[1,1,0]
  v_pk_fma_f32 v[210:211], v[210:211], s[22:23], s[22:23] op_sel:[0,1,0] op_sel_hi:[1,1,0]
  v_pk_fma_f32 v[216:217], v[216:217], s[22:23], s[22:23] op_sel:[0,1,0] op_sel_hi:[1,1,0]
  v_pk_fma_f32 v[218:219], v[218:219], s[22:23], s[22:23] op_sel:[0,1,0] op_sel_hi:[1,1,0]
  v_pk_mul_f32 v[208:209], v[208:209], v[204:205]
  v_pk_mul_f32 v[210:211], v[210:211], v[206:207]
  v_pk_mul_f32 v[216:217], v[216:217], v[212:213]
  v_pk_mul_f32 v[218:219], v[218:219], v[214:215]
  v_cvt_pk_bf16_f32 v236, v208, v209
  v_cvt_pk_bf16_f32 v237, v210, v211
  v_cvt_pk_bf16_f32 v238, v216, v217
  v_cvt_pk_bf16_f32 v239, v218, v219
  buffer_store_dwordx4 v[236:239], v252, s[44:47], 0 offen offset:2048
  s_waitcnt vmcnt(5)
  buffer_store_dwordx2 v[4:5], v6, s[44:47], s30 offen offset:8
  buffer_load_dwordx4 a[204:207], v251, s[44:47], s64 offen sc1
  buffer_load_dwordx4 a[208:211], v248, s[44:47], s65 offen sc1
  buffer_load_dwordx4 a[212:215], v249, s[44:47], s65 offen sc1
  buffer_load_dwordx4 a[216:219], v250, s[44:47], s65 offen sc1
  buffer_load_dwordx4 a[220:223], v251, s[44:47], s65 offen sc1
  v_pk_fma_f32 v[220:221], v[164:165], v[14:15], v[192:193] op_sel:[0,0,0] op_sel_hi:[1,0,1] neg_lo:[0,1,0] neg_hi:[0,1,0]
  v_pk_fma_f32 v[222:223], v[166:167], v[14:15], v[194:195] op_sel:[0,0,0] op_sel_hi:[1,0,1] neg_lo:[0,1,0] neg_hi:[0,1,0]
  v_pk_fma_f32 v[228:229], v[168:169], v[14:15], v[196:197] op_sel:[0,0,0] op_sel_hi:[1,0,1] neg_lo:[0,1,0] neg_hi:[0,1,0]
  v_pk_fma_f32 v[230:231], v[170:171], v[14:15], v[198:199] op_sel:[0,0,0] op_sel_hi:[1,0,1] neg_lo:[0,1,0] neg_hi:[0,1,0]
  v_pk_fma_f32 v[220:221], v[52:53], v[14:15], v[220:221] op_sel:[0,1,0] op_sel_hi:[1,1,1]
  v_pk_fma_f32 v[222:223], v[54:55], v[14:15], v[222:223] op_sel:[0,1,0] op_sel_hi:[1,1,1]
  v_pk_fma_f32 v[228:229], v[60:61], v[14:15], v[228:229] op_sel:[0,1,0] op_sel_hi:[1,1,1]
  v_pk_fma_f32 v[230:231], v[62:63], v[14:15], v[230:231] op_sel:[0,1,0] op_sel_hi:[1,1,1]
  v_exp_f32 v224, v220
  v_exp_f32 v225, v221
  v_exp_f32 v232, v228
  v_exp_f32 v233, v229
  v_exp_f32 v226, v222
  v_exp_f32 v227, v223
  v_exp_f32 v234, v230
  v_exp_f32 v235, v231
  v_pk_add_f32 v[224:225], v[224:225], s[20:21]
  v_pk_add_f32 v[226:227], v[226:227], s[20:21]
  v_pk_add_f32 v[232:233], v[232:233], s[20:21]
  v_pk_add_f32 v[234:235], v[234:235], s[20:21]
  v_pk_fma_f32 v[224:225], v[224:225], v[224:225], s[20:21]
  v_pk_fma_f32 v[226:227], v[226:227], v[226:227], s[20:21]
  v_pk_fma_f32 v[232:233], v[232:233], v[232:233], s[20:21]
  v_pk_fma_f32 v[234:235], v[234:235], v[234:235], s[20:21]
  v_rcp_f32 v224, v224
  v_rcp_f32 v225, v225
  v_rcp_f32 v232, v232
  v_rcp_f32 v233, v233
  v_rcp_f32 v226, v226
  v_rcp_f32 v227, v227
  v_rcp_f32 v234, v234
  v_rcp_f32 v235, v235
  v_pk_fma_f32 v[224:225], v[224:225], s[22:23], s[22:23] op_sel:[0,1,0] op_sel_hi:[1,1,0]
  v_pk_fma_f32 v[226:227], v[226:227], s[22:23], s[22:23] op_sel:[0,1,0] op_sel_hi:[1,1,0]
  v_pk_fma_f32 v[232:233], v[232:233], s[22:23], s[22:23] op_sel:[0,1,0] op_sel_hi:[1,1,0]
  v_pk_fma_f32 v[234:235], v[234:235], s[22:23], s[22:23] op_sel:[0,1,0] op_sel_hi:[1,1,0]
  v_pk_mul_f32 v[224:225], v[224:225], v[220:221]
  v_pk_mul_f32 v[226:227], v[226:227], v[222:223]
  v_pk_mul_f32 v[232:233], v[232:233], v[228:229]
  v_pk_mul_f32 v[234:235], v[234:235], v[230:231]
  v_cvt_pk_bf16_f32 v240, v224, v225
  v_cvt_pk_bf16_f32 v241, v226, v227
  v_cvt_pk_bf16_f32 v242, v232, v233
  v_cvt_pk_bf16_f32 v243, v234, v235
  buffer_store_dwordx4 v[240:243], v253, s[44:47], 0 offen offset:2048
  buffer_load_dwordx2 v[72:73], v3, s[44:47], s31 offen sc1
  v_pk_fma_f32 v[204:205], v[172:173], v[12:13], v[200:201] op_sel:[0,0,0] op_sel_hi:[1,0,1] neg_lo:[0,1,0] neg_hi:[0,1,0]
  v_pk_fma_f32 v[206:207], v[174:175], v[12:13], v[202:203] op_sel:[0,0,0] op_sel_hi:[1,0,1] neg_lo:[0,1,0] neg_hi:[0,1,0]
  v_pk_fma_f32 v[212:213], v[172:173], v[14:15], v[200:201] op_sel:[0,0,0] op_sel_hi:[1,0,1] neg_lo:[0,1,0] neg_hi:[0,1,0]
  v_pk_fma_f32 v[214:215], v[174:175], v[14:15], v[202:203] op_sel:[0,0,0] op_sel_hi:[1,0,1] neg_lo:[0,1,0] neg_hi:[0,1,0]
  v_pk_fma_f32 v[204:205], v[64:65], v[12:13], v[204:205] op_sel:[0,1,0] op_sel_hi:[1,1,1]
  v_pk_fma_f32 v[206:207], v[66:67], v[12:13], v[206:207] op_sel:[0,1,0] op_sel_hi:[1,1,1]
  v_pk_fma_f32 v[212:213], v[68:69], v[14:15], v[212:213] op_sel:[0,1,0] op_sel_hi:[1,1,1]
  v_pk_fma_f32 v[214:215], v[70:71], v[14:15], v[214:215] op_sel:[0,1,0] op_sel_hi:[1,1,1]
  v_exp_f32 v208, v204
  v_exp_f32 v209, v205
  v_exp_f32 v216, v212
  v_exp_f32 v217, v213
  v_exp_f32 v210, v206
  v_exp_f32 v211, v207
  v_exp_f32 v218, v214
  v_exp_f32 v219, v215
  v_pk_add_f32 v[208:209], v[208:209], s[20:21]
  v_pk_add_f32 v[210:211], v[210:211], s[20:21]
  v_pk_add_f32 v[216:217], v[216:217], s[20:21]
  v_pk_add_f32 v[218:219], v[218:219], s[20:21]
  v_pk_fma_f32 v[208:209], v[208:209], v[208:209], s[20:21]
  v_pk_fma_f32 v[210:211], v[210:211], v[210:211], s[20:21]
  v_pk_fma_f32 v[216:217], v[216:217], v[216:217], s[20:21]
  v_pk_fma_f32 v[218:219], v[218:219], v[218:219], s[20:21]
  v_rcp_f32 v208, v208
  v_rcp_f32 v209, v209
  v_rcp_f32 v216, v216
  v_rcp_f32 v217, v217
  v_rcp_f32 v210, v210
  v_rcp_f32 v211, v211
  v_rcp_f32 v218, v218
  v_rcp_f32 v219, v219
  v_pk_fma_f32 v[208:209], v[208:209], s[22:23], s[22:23] op_sel:[0,1,0] op_sel_hi:[1,1,0]
  v_pk_fma_f32 v[210:211], v[210:211], s[22:23], s[22:23] op_sel:[0,1,0] op_sel_hi:[1,1,0]
  v_pk_fma_f32 v[216:217], v[216:217], s[22:23], s[22:23] op_sel:[0,1,0] op_sel_hi:[1,1,0]
  v_pk_fma_f32 v[218:219], v[218:219], s[22:23], s[22:23] op_sel:[0,1,0] op_sel_hi:[1,1,0]
  v_pk_mul_f32 v[208:209], v[208:209], v[204:205]
  v_pk_mul_f32 v[210:211], v[210:211], v[206:207]
  v_pk_mul_f32 v[216:217], v[216:217], v[212:213]
  v_pk_mul_f32 v[218:219], v[218:219], v[214:215]
  v_cvt_pk_bf16_f32 v236, v208, v209
  v_cvt_pk_bf16_f32 v237, v210, v211
  v_cvt_pk_bf16_f32 v238, v216, v217
  v_cvt_pk_bf16_f32 v239, v218, v219
  s_nop 0
  v_permlane16_swap_b32 v236, v238
  v_permlane16_swap_b32 v237, v239
  buffer_store_dwordx4 v[236:239], v254, s[44:47], 0 offen
  s_waitcnt vmcnt(2)
  buffer_store_dwordx2 v[4:5], v6, s[44:47], s30 offen offset:16
  s_lshl_b32 s12, s7, 1
  s_lshr_b32 s13, s3, 1
  s_add_u32 s12, s12, s13
  s_mul_i32 s12, s12, 33024
  s_lshl_b32 s13, s8, 12
  s_add_u32 s12, s12, s13
  s_and_b32 s13, s3, 1
  s_lshl_b32 s14, s13, 11
  s_add_u32 s14, s14, s12
  s_add_u32 s19, s14, 0x210000
  s_lshl_b32 s13, s13, 2
  s_add_u32 s12, s12, s13
  s_add_u32 s17, s12, 0x0
  v_lshlrev_b32 v7, 4, v2
  s_lshl2_add_u32 s15, s7, s3
  s_lshl_b32 s15, s15, 14
  s_load_dword s15, s[38:39], s15
  s_waitcnt vmcnt(2)
  v_cmp_ne_u64 vcc, s[10:11], v[72:73]
  s_nop 0
  s_and_b32 s12, vcc_lo, 0x11111111
  s_cbranch_scc1 RFg21f0
BFg21f0:
  buffer_load_dwordx4 v[80:83], v8, s[44:47], s52 offen sc1
  buffer_load_dwordx4 v[84:87], v9, s[44:47], s52 offen sc1
  buffer_load_dwordx4 v[88:91], v10, s[44:47], s52 offen sc1
  buffer_load_dwordx4 v[92:95], v11, s[44:47], s52 offen sc1
  buffer_load_dwordx2 v[12:13], v3, s[44:47], s31 offen sc1
  buffer_load_dwordx4 v[96:99], v8, s[44:47], s53 offen sc1
  buffer_load_dwordx4 v[100:103], v9, s[44:47], s53 offen sc1
  buffer_load_dwordx4 v[104:107], v10, s[44:47], s53 offen sc1
  buffer_load_dwordx4 v[108:111], v11, s[44:47], s53 offen sc1
  buffer_load_dwordx4 v[112:115], v8, s[44:47], s54 offen sc1
  buffer_load_dwordx4 v[116:119], v9, s[44:47], s54 offen sc1
  buffer_load_dwordx4 v[120:123], v10, s[44:47], s54 offen sc1
  buffer_load_dwordx4 v[124:127], v11, s[44:47], s54 offen sc1
  buffer_load_dwordx4 v[128:131], v8, s[44:47], s55 offen sc1
  buffer_load_dwordx4 v[132:135], v9, s[44:47], s55 offen sc1
  buffer_load_dwordx4 v[136:139], v10, s[44:47], s55 offen sc1
  buffer_load_dwordx4 v[140:143], v11, s[44:47], s55 offen sc1
  s_waitcnt vmcnt(18)
  buffer_store_dwordx2 v[4:5], v6, s[44:47], s30 offen offset:24
  s_waitcnt vmcnt(13)
  v_cmp_ne_u64 vcc, s[10:11], v[12:13]
  s_nop 0
  s_and_b32 s12, vcc_lo, 0x22222222
  s_cbranch_scc1 RFg21f1
BFg21f1:
  v_mfma_f32_16x16x32_bf16 v[16:19], v[80:83], a[0:3], 0
  buffer_load_dwordx4 v[144:147], v8, s[44:47], s56 offen sc1
  v_mfma_f32_16x16x32_bf16 v[20:23], v[80:83], a[4:7], 0
  v_mfma_f32_16x16x32_bf16 v[24:27], v[80:83], a[8:11], 0
  v_mfma_f32_16x16x32_bf16 v[28:31], v[80:83], a[12:15], 0
  v_mfma_f32_16x16x32_bf16 v[32:35], v[84:87], a[0:3], 0
  buffer_load_dwordx4 v[148:151], v9, s[44:47], s56 offen sc1
  v_mfma_f32_16x16x32_bf16 v[36:39], v[84:87], a[4:7], 0
  v_mfma_f32_16x16x32_bf16 v[40:43], v[84:87], a[8:11], 0
  v_mfma_f32_16x16x32_bf16 v[44:47], v[84:87], a[12:15], 0
  buffer_load_dwordx4 v[152:155], v10, s[44:47], s56 offen sc1
  v_mfma_f32_16x16x32_bf16 v[48:51], v[88:91], a[0:3], 0
  v_mfma_f32_16x16x32_bf16 v[52:55], v[88:91], a[4:7], 0
  v_mfma_f32_16x16x32_bf16 v[56:59], v[88:91], a[8:11], 0
  buffer_load_dwordx4 v[156:159], v11, s[44:47], s56 offen sc1
  v_mfma_f32_16x16x32_bf16 v[60:63], v[88:91], a[12:15], 0
  v_mfma_f32_16x16x32_bf16 v[64:67], v[92:95], a[0:3], 0
  v_mfma_f32_16x16x32_bf16 v[68:71], v[92:95], a[4:7], 0
  buffer_load_dwordx2 v[12:13], v3, s[44:47], s31 offen sc1
  v_mfma_f32_16x16x32_bf16 v[72:75], v[92:95], a[8:11], 0
  v_mfma_f32_16x16x32_bf16 v[76:79], v[92:95], a[12:15], 0
  s_waitcnt vmcnt(14)
  v_mfma_f32_16x16x32_bf16 v[16:19], v[96:99], a[16:19], v[16:19]
  buffer_load_dwordx4 v[160:163], v8, s[44:47], s57 offen sc1
  v_mfma_f32_16x16x32_bf16 v[20:23], v[96:99], a[20:23], v[20:23]
  v_mfma_f32_16x16x32_bf16 v[24:27], v[96:99], a[24:27], v[24:27]
  v_mfma_f32_16x16x32_bf16 v[28:31], v[96:99], a[28:31], v[28:31]
  v_mfma_f32_16x16x32_bf16 v[32:35], v[100:103], a[16:19], v[32:35]
  buffer_load_dwordx4 v[164:167], v9, s[44:47], s57 offen sc1
  v_mfma_f32_16x16x32_bf16 v[36:39], v[100:103], a[20:23], v[36:39]
  v_mfma_f32_16x16x32_bf16 v[40:43], v[100:103], a[24:27], v[40:43]
  v_mfma_f32_16x16x32_bf16 v[44:47], v[100:103], a[28:31], v[44:47]
  buffer_load_dwordx4 v[168:171], v10, s[44:47], s57 offen sc1
  v_mfma_f32_16x16x32_bf16 v[48:51], v[104:107], a[16:19], v[48:51]
  v_mfma_f32_16x16x32_bf16 v[52:55], v[104:107], a[20:23], v[52:55]
  v_mfma_f32_16x16x32_bf16 v[56:59], v[104:107], a[24:27], v[56:59]
  buffer_load_dwordx4 v[172:175], v11, s[44:47], s57 offen sc1
  v_mfma_f32_16x16x32_bf16 v[60:63], v[104:107], a[28:31], v[60:63]
  v_mfma_f32_16x16x32_bf16 v[64:67], v[108:111], a[16:19], v[64:67]
  v_mfma_f32_16x16x32_bf16 v[68:71], v[108:111], a[20:23], v[68:71]
  buffer_load_dwordx4 v[176:179], v8, s[44:47], s58 offen sc1
  v_mfma_f32_16x16x32_bf16 v[72:75], v[108:111], a[24:27], v[72:75]
  v_mfma_f32_16x16x32_bf16 v[76:79], v[108:111], a[28:31], v[76:79]
  s_waitcnt vmcnt(15)
  v_mfma_f32_16x16x32_bf16 v[16:19], v[112:115], a[32:35], v[16:19]
  buffer_load_dwordx4 v[180:183], v9, s[44:47], s58 offen sc1
  v_mfma_f32_16x16x32_bf16 v[20:23], v[112:115], a[36:39], v[20:23]
  v_mfma_f32_16x16x32_bf16 v[24:27], v[112:115], a[40:43], v[24:27]
  v_mfma_f32_16x16x32_bf16 v[28:31], v[112:115], a[44:47], v[28:31]
  v_mfma_f32_16x16x32_bf16 v[32:35], v[116:119], a[32:35], v[32:35]
  buffer_load_dwordx4 v[184:187], v10, s[44:47], s58 offen sc1
  v_mfma_f32_16x16x32_bf16 v[36:39], v[116:119], a[36:39], v[36:39]
  v_mfma_f32_16x16x32_bf16 v[40:43], v[116:119], a[40:43], v[40:43]
  v_mfma_f32_16x16x32_bf16 v[44:47], v[116:119], a[44:47], v[44:47]
  buffer_load_dwordx4 v[188:191], v11, s[44:47], s58 offen sc1
  v_mfma_f32_16x16x32_bf16 v[48:51], v[120:123], a[32:35], v[48:51]
  v_mfma_f32_16x16x32_bf16 v[52:55], v[120:123], a[36:39], v[52:55]
  v_mfma_f32_16x16x32_bf16 v[56:59], v[120:123], a[40:43], v[56:59]
  buffer_load_dwordx4 v[192:195], v8, s[44:47], s59 offen sc1
  v_mfma_f32_16x16x32_bf16 v[60:63], v[120:123], a[44:47], v[60:63]
  v_mfma_f32_16x16x32_bf16 v[64:67], v[124:127], a[32:35], v[64:67]
  v_mfma_f32_16x16x32_bf16 v[68:71], v[124:127], a[36:39], v[68:71]
  buffer_load_dwordx4 v[196:199], v9, s[44:47], s59 offen sc1
  v_mfma_f32_16x16x32_bf16 v[72:75], v[124:127], a[40:43], v[72:75]
  v_mfma_f32_16x16x32_bf16 v[76:79], v[124:127], a[44:47], v[76:79]
  s_waitcnt vmcnt(16)
  v_mfma_f32_16x16x32_bf16 v[16:19], v[128:131], a[48:51], v[16:19]
  buffer_load_dwordx4 v[200:203], v10, s[44:47], s59 offen sc1
  v_mfma_f32_16x16x32_bf16 v[20:23], v[128:131], a[52:55], v[20:23]
  v_mfma_f32_16x16x32_bf16 v[24:27], v[128:131], a[56:59], v[24:27]
  v_mfma_f32_16x16x32_bf16 v[28:31], v[128:131], a[60:63], v[28:31]
  v_mfma_f32_16x16x32_bf16 v[32:35], v[132:135], a[48:51], v[32:35]
  buffer_load_dwordx4 v[204:207], v11, s[44:47], s59 offen sc1
  v_mfma_f32_16x16x32_bf16 v[36:39], v[132:135], a[52:55], v[36:39]
  v_mfma_f32_16x16x32_bf16 v[40:43], v[132:135], a[56:59], v[40:43]
  v_mfma_f32_16x16x32_bf16 v[44:47], v[132:135], a[60:63], v[44:47]
  s_waitcnt vmcnt(12)
  v_cmp_ne_u64 vcc, s[10:11], v[12:13]
  s_nop 0
  s_and_b32 s12, vcc_lo, 0x44444444
  s_cbranch_scc1 RFg21f2
BFg21f2:
  v_mfma_f32_16x16x32_bf16 v[48:51], v[136:139], a[48:51], v[48:51]
  v_mfma_f32_16x16x32_bf16 v[52:55], v[136:139], a[52:55], v[52:55]
  v_mfma_f32_16x16x32_bf16 v[56:59], v[136:139], a[56:59], v[56:59]
  buffer_load_dwordx4 v[208:211], v8, s[44:47], s60 offen sc1
  v_mfma_f32_16x16x32_bf16 v[60:63], v[136:139], a[60:63], v[60:63]
  v_mfma_f32_16x16x32_bf16 v[64:67], v[140:143], a[48:51], v[64:67]
  v_mfma_f32_16x16x32_bf16 v[68:71], v[140:143], a[52:55], v[68:71]
  buffer_load_dwordx4 v[212:215], v9, s[44:47], s60 offen sc1
  v_mfma_f32_16x16x32_bf16 v[72:75], v[140:143], a[56:59], v[72:75]
  v_mfma_f32_16x16x32_bf16 v[76:79], v[140:143], a[60:63], v[76:79]
  v_mfma_f32_16x16x32_bf16 v[16:19], v[144:147], a[64:67], v[16:19]
  buffer_load_dwordx4 v[216:219], v10, s[44:47], s60 offen sc1
  v_mfma_f32_16x16x32_bf16 v[20:23], v[144:147], a[68:71], v[20:23]
  v_mfma_f32_16x16x32_bf16 v[24:27], v[144:147], a[72:75], v[24:27]
  v_mfma_f32_16x16x32_bf16 v[28:31], v[144:147], a[76:79], v[28:31]
  v_mfma_f32_16x16x32_bf16 v[32:35], v[148:151], a[64:67], v[32:35]
  buffer_load_dwordx4 v[220:223], v11, s[44:47], s60 offen sc1
  v_mfma_f32_16x16x32_bf16 v[36:39], v[148:151], a[68:71], v[36:39]
  v_mfma_f32_16x16x32_bf16 v[40:43], v[148:151], a[72:75], v[40:43]
  v_mfma_f32_16x16x32_bf16 v[44:47], v[148:151], a[76:79], v[44:47]
  buffer_load_dwordx2 v[12:13], v3, s[44:47], s31 offen sc1
  v_mfma_f32_16x16x32_bf16 v[48:51], v[152:155], a[64:67], v[48:51]
  v_mfma_f32_16x16x32_bf16 v[52:55], v[152:155], a[68:71], v[52:55]
  v_mfma_f32_16x16x32_bf16 v[56:59], v[152:155], a[72:75], v[56:59]
  buffer_load_dwordx4 v[224:227], v8, s[44:47], s61 offen sc1
  v_mfma_f32_16x16x32_bf16 v[60:63], v[152:155], a[76:79], v[60:63]
  v_mfma_f32_16x16x32_bf16 v[64:67], v[156:159], a[64:67], v[64:67]
  v_mfma_f32_16x16x32_bf16 v[68:71], v[156:159], a[68:71], v[68:71]
  buffer_load_dwordx4 v[228:231], v9, s[44:47], s61 offen sc1
  v_mfma_f32_16x16x32_bf16 v[72:75], v[156:159], a[72:75], v[72:75]
  v_mfma_f32_16x16x32_bf16 v[76:79], v[156:159], a[76:79], v[76:79]
  s_waitcnt vmcnt(15)
  v_mfma_f32_16x16x32_bf16 v[16:19], v[160:163], a[80:83], v[16:19]
  buffer_load_dwordx4 v[232:235], v10, s[44:47], s61 offen sc1
  v_mov_b32 v144, -1
  v_mfma_f32_16x16x32_bf16 v[20:23], v[160:163], a[84:87], v[20:23]
  v_mov_b32 v145, -1
  v_mov_b32 v146, -1
  v_mfma_f32_16x16x32_bf16 v[24:27], v[160:163], a[88:91], v[24:27]
  v_mov_b32 v147, -1
  v_mfma_f32_16x16x32_bf16 v[28:31], v[160:163], a[92:95], v[28:31]
  v_mfma_f32_16x16x32_bf16 v[32:35], v[164:167], a[80:83], v[32:35]
  buffer_load_dwordx4 v[236:239], v11, s[44:47], s61 offen sc1
  v_mfma_f32_16x16x32_bf16 v[36:39], v[164:167], a[84:87], v[36:39]
  v_mfma_f32_16x16x32_bf16 v[40:43], v[164:167], a[88:91], v[40:43]
  v_mfma_f32_16x16x32_bf16 v[44:47], v[164:167], a[92:95], v[44:47]
  buffer_load_dwordx4 v[240:243], v8, s[44:47], s62 offen sc1
  v_mfma_f32_16x16x32_bf16 v[48:51], v[168:171], a[80:83], v[48:51]
  v_mfma_f32_16x16x32_bf16 v[52:55], v[168:171], a[84:87], v[52:55]
  v_mfma_f32_16x16x32_bf16 v[56:59], v[168:171], a[88:91], v[56:59]
  buffer_load_dwordx4 v[244:247], v9, s[44:47], s62 offen sc1
  v_mfma_f32_16x16x32_bf16 v[60:63], v[168:171], a[92:95], v[60:63]
  v_mfma_f32_16x16x32_bf16 v[64:67], v[172:175], a[80:83], v[64:67]
  v_mfma_f32_16x16x32_bf16 v[68:71], v[172:175], a[84:87], v[68:71]
  buffer_load_dwordx4 v[248:251], v10, s[44:47], s62 offen sc1
  v_mfma_f32_16x16x32_bf16 v[72:75], v[172:175], a[88:91], v[72:75]
  v_mfma_f32_16x16x32_bf16 v[76:79], v[172:175], a[92:95], v[76:79]
  s_waitcnt vmcnt(16)
  v_mfma_f32_16x16x32_bf16 v[16:19], v[176:179], a[96:99], v[16:19]
  buffer_load_dwordx4 v[252:255], v11, s[44:47], s62 offen sc1
  v_mfma_f32_16x16x32_bf16 v[20:23], v[176:179], a[100:103], v[20:23]
  v_mfma_f32_16x16x32_bf16 v[24:27], v[176:179], a[104:107], v[24:27]
  v_mfma_f32_16x16x32_bf16 v[28:31], v[176:179], a[108:111], v[28:31]
  v_mfma_f32_16x16x32_bf16 v[32:35], v[180:183], a[96:99], v[32:35]
  buffer_load_dwordx4 v[80:83], v8, s[44:47], s63 offen sc1
  v_mfma_f32_16x16x32_bf16 v[36:39], v[180:183], a[100:103], v[36:39]
  v_mfma_f32_16x16x32_bf16 v[40:43], v[180:183], a[104:107], v[40:43]
  v_mfma_f32_16x16x32_bf16 v[44:47], v[180:183], a[108:111], v[44:47]
  buffer_load_dwordx4 v[84:87], v9, s[44:47], s63 offen sc1
  v_mfma_f32_16x16x32_bf16 v[48:51], v[184:187], a[96:99], v[48:51]
  v_mfma_f32_16x16x32_bf16 v[52:55], v[184:187], a[100:103], v[52:55]
  v_mfma_f32_16x16x32_bf16 v[56:59], v[184:187], a[104:107], v[56:59]
  buffer_load_dwordx4 v[88:91], v10, s[44:47], s63 offen sc1
  v_mfma_f32_16x16x32_bf16 v[60:63], v[184:187], a[108:111], v[60:63]
  v_mfma_f32_16x16x32_bf16 v[64:67], v[188:191], a[96:99], v[64:67]
  v_mfma_f32_16x16x32_bf16 v[68:71], v[188:191], a[100:103], v[68:71]
  buffer_load_dwordx4 v[92:95], v11, s[44:47], s63 offen sc1
  v_mfma_f32_16x16x32_bf16 v[72:75], v[188:191], a[104:107], v[72:75]
  v_mfma_f32_16x16x32_bf16 v[76:79], v[188:191], a[108:111], v[76:79]
  s_waitcnt vmcnt(17)
  v_mfma_f32_16x16x32_bf16 v[16:19], v[192:195], a[112:115], v[16:19]
  s_waitcnt vmcnt(12)
  v_cmp_ne_u64 vcc, s[10:11], v[12:13]
  s_nop 0
  s_and_b32 s12, vcc_lo, 0x88888888
  s_cbranch_scc1 RFg21f3
BFg21f3:
  v_mfma_f32_16x16x32_bf16 v[20:23], v[192:195], a[116:119], v[20:23]
  v_mfma_f32_16x16x32_bf16 v[24:27], v[192:195], a[120:123], v[24:27]
  v_mfma_f32_16x16x32_bf16 v[28:31], v[192:195], a[124:127], v[28:31]
  v_mfma_f32_16x16x32_bf16 v[32:35], v[196:199], a[112:115], v[32:35]
  s_add_u32 s12, s3, 0
  v_mfma_f32_16x16x32_bf16 v[36:39], v[196:199], a[116:119], v[36:39]
  s_and_b32 s12, s12, 3
  s_mul_i32 s13, s12, 12288
  v_mfma_f32_16x16x32_bf16 v[40:43], v[196:199], a[120:123], v[40:43]
  s_add_u32 s13, s13, 114688
  v_lshl_add_u32 v3, v2, 4, s13
  v_mfma_f32_16x16x32_bf16 v[44:47], v[196:199], a[124:127], v[44:47]
  buffer_load_dwordx4 v[96:99], v8, s[44:47], s64 offen sc1
  s_add_u32 s12, s3, 1
  v_mfma_f32_16x16x32_bf16 v[48:51], v[200:203], a[112:115], v[48:51]
  s_and_b32 s12, s12, 3
  s_mul_i32 s13, s12, 12288
  v_mfma_f32_16x16x32_bf16 v[52:55], v[200:203], a[116:119], v[52:55]
  s_add_u32 s18, s13, 114688
  v_lshl_add_u32 v4, v2, 4, s18
  v_mfma_f32_16x16x32_bf16 v[56:59], v[200:203], a[120:123], v[56:59]
  buffer_load_dwordx4 v[100:103], v9, s[44:47], s64 offen sc1
  s_add_u32 s12, s3, 2
  v_mfma_f32_16x16x32_bf16 v[60:63], v[200:203], a[124:127], v[60:63]
  s_and_b32 s12, s12, 3
  s_mul_i32 s13, s12, 12288
  v_mfma_f32_16x16x32_bf16 v[64:67], v[204:207], a[112:115], v[64:67]
  s_add_u32 s13, s13, 114688
  v_lshl_add_u32 v5, v2, 4, s13
  v_mfma_f32_16x16x32_bf16 v[68:71], v[204:207], a[116:119], v[68:71]
  buffer_load_dwordx4 v[104:107], v10, s[44:47], s64 offen sc1
  s_add_u32 s12, s3, 3
  v_mfma_f32_16x16x32_bf16 v[72:75], v[204:207], a[120:123], v[72:75]
  s_and_b32 s12, s12, 3
  s_mul_i32 s13, s12, 12288
  v_mfma_f32_16x16x32_bf16 v[76:79], v[204:207], a[124:127], v[76:79]
  s_add_u32 s13, s13, 114688
  v_lshl_add_u32 v6, v2, 4, s13
  v_mfma_f32_16x16x32_bf16 v[16:19], v[208:211], a[128:131], v[16:19]
  buffer_load_dwordx4 v[108:111], v11, s[44:47], s64 offen sc1
  v_and_b32 v14, 15, v2
  v_mfma_f32_16x16x32_bf16 v[20:23], v[208:211], a[132:135], v[20:23]
  v_lshrrev_b32 v15, 4, v2
  v_mul_u32_u24 v14, 136, v14
  v_mfma_f32_16x16x32_bf16 v[24:27], v[208:211], a[136:139], v[24:27]
  v_lshl_add_u32 v14, v15, 3, v14
  v_add_u32 v14, s18, v14
  v_mfma_f32_16x16x32_bf16 v[28:31], v[208:211], a[140:143], v[28:31]
  v_lshrrev_b32 v13, 2, v2
  v_mul_u32_u24 v13, 136, v13
  v_mfma_f32_16x16x32_bf16 v[32:35], v[212:215], a[128:131], v[32:35]
  buffer_load_dwordx4 v[112:115], v8, s[44:47], s65 offen sc1
  v_and_b32 v12, 3, v2
  v_mfma_f32_16x16x32_bf16 v[36:39], v[212:215], a[132:135], v[36:39]
  v_lshl_add_u32 v13, v12, 3, v13
  v_add_u32 v13, s18, v13
  v_mfma_f32_16x16x32_bf16 v[40:43], v[212:215], a[136:139], v[40:43]
  v_mfma_f32_16x16x32_bf16 v[44:47], v[212:215], a[140:143], v[44:47]
  buffer_load_dwordx4 v[116:119], v9, s[44:47], s65 offen sc1
  v_mfma_f32_16x16x32_bf16 v[48:51], v[216:219], a[128:131], v[48:51]
  v_mfma_f32_16x16x32_bf16 v[52:55], v[216:219], a[132:135], v[52:55]
  v_mfma_f32_16x16x32_bf16 v[56:59], v[216:219], a[136:139], v[56:59]
  buffer_load_dwordx4 v[120:123], v10, s[44:47], s65 offen sc1
  v_mfma_f32_16x16x32_bf16 v[60:63], v[216:219], a[140:143], v[60:63]
  v_mfma_f32_16x16x32_bf16 v[64:67], v[220:223], a[128:131], v[64:67]
  v_mfma_f32_16x16x32_bf16 v[68:71], v[220:223], a[132:135], v[68:71]
  buffer_load_dwordx4 v[124:127], v11, s[44:47], s65 offen sc1
  v_mfma_f32_16x16x32_bf16 v[72:75], v[220:223], a[136:139], v[72:75]
  v_mfma_f32_16x16x32_bf16 v[76:79], v[220:223], a[140:143], v[76:79]
  s_waitcnt vmcnt(16)
  v_mfma_f32_16x16x32_bf16 v[16:19], v[224:227], a[144:147], v[16:19]
  buffer_load_dwordx3 v[128:130], v7, s[44:47], s17 offen offset:0 sc1
  v_mfma_f32_16x16x32_bf16 v[20:23], v[224:227], a[148:151], v[20:23]
  v_mfma_f32_16x16x32_bf16 v[24:27], v[224:227], a[152:155], v[24:27]
  v_mfma_f32_16x16x32_bf16 v[28:31], v[224:227], a[156:159], v[28:31]
  v_mfma_f32_16x16x32_bf16 v[32:35], v[228:231], a[144:147], v[32:35]
  buffer_load_dwordx3 v[132:134], v7, s[44:47], s17 offen offset:1024 sc1
  v_mfma_f32_16x16x32_bf16 v[36:39], v[228:231], a[148:151], v[36:39]
  v_mfma_f32_16x16x32_bf16 v[40:43], v[228:231], a[152:155], v[40:43]
  v_mfma_f32_16x16x32_bf16 v[44:47], v[228:231], a[156:159], v[44:47]
  buffer_load_dwordx3 v[136:138], v7, s[44:47], s17 offen offset:2048 sc1
  v_mfma_f32_16x16x32_bf16 v[48:51], v[232:235], a[144:147], v[48:51]
  v_mfma_f32_16x16x32_bf16 v[52:55], v[232:235], a[148:151], v[52:55]
  v_mfma_f32_16x16x32_bf16 v[56:59], v[232:235], a[152:155], v[56:59]
  buffer_load_dwordx3 v[140:142], v7, s[44:47], s17 offen offset:3072 sc1
  v_mfma_f32_16x16x32_bf16 v[60:63], v[232:235], a[156:159], v[60:63]
  v_mfma_f32_16x16x32_bf16 v[64:67], v[236:239], a[144:147], v[64:67]
  v_mfma_f32_16x16x32_bf16 v[68:71], v[236:239], a[148:151], v[68:71]
  buffer_store_dwordx4 v[144:147], v7, s[44:47], s19 offen offset:0 sc1
  v_mfma_f32_16x16x32_bf16 v[72:75], v[236:239], a[152:155], v[72:75]
  v_mfma_f32_16x16x32_bf16 v[76:79], v[236:239], a[156:159], v[76:79]
  s_waitcnt vmcnt(17)
  v_mfma_f32_16x16x32_bf16 v[16:19], v[240:243], a[160:163], v[16:19]
  buffer_store_dwordx4 v[144:147], v7, s[44:47], s19 offen offset:1024 sc1
  v_mfma_f32_16x16x32_bf16 v[20:23], v[240:243], a[164:167], v[20:23]
  v_mfma_f32_16x16x32_bf16 v[24:27], v[240:243], a[168:171], v[24:27]
  v_mfma_f32_16x16x32_bf16 v[28:31], v[240:243], a[172:175], v[28:31]
  v_mfma_f32_16x16x32_bf16 v[32:35], v[244:247], a[160:163], v[32:35]
  v_mfma_f32_16x16x32_bf16 v[36:39], v[244:247], a[164:167], v[36:39]
  v_mfma_f32_16x16x32_bf16 v[40:43], v[244:247], a[168:171], v[40:43]
  v_mfma_f32_16x16x32_bf16 v[44:47], v[244:247], a[172:175], v[44:47]
  v_mfma_f32_16x16x32_bf16 v[48:51], v[248:251], a[160:163], v[48:51]
  v_mfma_f32_16x16x32_bf16 v[52:55], v[248:251], a[164:167], v[52:55]
  v_mfma_f32_16x16x32_bf16 v[56:59], v[248:251], a[168:171], v[56:59]
  v_mfma_f32_16x16x32_bf16 v[60:63], v[248:251], a[172:175], v[60:63]
  v_mfma_f32_16x16x32_bf16 v[64:67], v[252:255], a[160:163], v[64:67]
  v_mfma_f32_16x16x32_bf16 v[68:71], v[252:255], a[164:167], v[68:71]
  v_mfma_f32_16x16x32_bf16 v[72:75], v[252:255], a[168:171], v[72:75]
  v_mfma_f32_16x16x32_bf16 v[76:79], v[252:255], a[172:175], v[76:79]
  s_waitcnt vmcnt(14)
  v_mfma_f32_16x16x32_bf16 v[16:19], v[80:83], a[176:179], v[16:19]
  v_mfma_f32_16x16x32_bf16 v[20:23], v[80:83], a[180:183], v[20:23]
  v_mfma_f32_16x16x32_bf16 v[24:27], v[80:83], a[184:187], v[24:27]
  v_mfma_f32_16x16x32_bf16 v[28:31], v[80:83], a[188:191], v[28:31]
  v_mfma_f32_16x16x32_bf16 v[32:35], v[84:87], a[176:179], v[32:35]
  v_mfma_f32_16x16x32_bf16 v[36:39], v[84:87], a[180:183], v[36:39]
  v_mfma_f32_16x16x32_bf16 v[40:43], v[84:87], a[184:187], v[40:43]
  v_mfma_f32_16x16x32_bf16 v[44:47], v[84:87], a[188:191], v[44:47]
  v_mfma_f32_16x16x32_bf16 v[48:51], v[88:91], a[176:179], v[48:51]
  v_mfma_f32_16x16x32_bf16 v[52:55], v[88:91], a[180:183], v[52:55]
  v_mfma_f32_16x16x32_bf16 v[56:59], v[88:91], a[184:187], v[56:59]
  v_mfma_f32_16x16x32_bf16 v[60:63], v[88:91], a[188:191], v[60:63]
  v_mfma_f32_16x16x32_bf16 v[64:67], v[92:95], a[176:179], v[64:67]
  v_mfma_f32_16x16x32_bf16 v[68:71], v[92:95], a[180:183], v[68:71]
  v_mfma_f32_16x16x32_bf16 v[72:75], v[92:95], a[184:187], v[72:75]
  v_mfma_f32_16x16x32_bf16 v[76:79], v[92:95], a[188:191], v[76:79]
  s_waitcnt vmcnt(10)
  v_mfma_f32_16x16x32_bf16 v[32:35], v[100:103], a[192:195], v[32:35]
  s_waitcnt vmcnt(2)
  v_mfma_f32_16x16x32_bf16 v[36:39], v[100:103], a[196:199], v[36:39]
  ds_write2_b32 v14, v128, v132 offset0:0 offset1:1
  v_mfma_f32_16x16x32_bf16 v[40:43], v[100:103], a[200:203], v[40:43]
  ds_write2_b32 v14, v130, v134 offset0:8 offset1:9
  v_mfma_f32_16x16x32_bf16 v[44:47], v[100:103], a[204:207], v[44:47]
  ds_write2_b32 v14, v136, v140 offset0:16 offset1:17
  v_mfma_f32_16x16x32_bf16 v[32:35], v[116:119], a[208:211], v[32:35]
  ds_write2_b32 v14, v138, v142 offset0:24 offset1:25
  v_mfma_f32_16x16x32_bf16 v[36:39], v[116:119], a[212:215], v[36:39]
  ds_read_b64_tr_b16 v[208:209], v13 offset:0
  v_mfma_f32_16x16x32_bf16 v[40:43], v[116:119], a[216:219], v[40:43]
  ds_read_b64_tr_b16 v[210:211], v13 offset:32
  v_mfma_f32_16x16x32_bf16 v[44:47], v[116:119], a[220:223], v[44:47]
  ds_read_b64_tr_b16 v[212:213], v13 offset:64
  ds_read_b64_tr_b16 v[214:215], v13 offset:96
  v_mfma_f32_16x16x32_bf16 v[48:51], v[104:107], a[192:195], v[48:51]
  v_mfma_f32_16x16x32_bf16 v[52:55], v[104:107], a[196:199], v[52:55]
  ds_write_b128 v4, v[32:35] offset:0
  v_mfma_f32_16x16x32_bf16 v[56:59], v[104:107], a[200:203], v[56:59]
  v_mfma_f32_16x16x32_bf16 v[60:63], v[104:107], a[204:207], v[60:63]
  v_mfma_f32_16x16x32_bf16 v[48:51], v[120:123], a[208:211], v[48:51]
  ds_write_b128 v4, v[36:39] offset:1024
  v_mfma_f32_16x16x32_bf16 v[52:55], v[120:123], a[212:215], v[52:55]
  v_mfma_f32_16x16x32_bf16 v[56:59], v[120:123], a[216:219], v[56:59]
  v_mfma_f32_16x16x32_bf16 v[60:63], v[120:123], a[220:223], v[60:63]
  ds_write_b128 v4, v[40:43] offset:2048
  ds_write_b128 v4, v[44:47] offset:3072
  v_mfma_f32_16x16x32_bf16 v[64:67], v[108:111], a[192:195], v[64:67]
  s_waitcnt lgkmcnt(4)
  v_lshlrev_b32 v144, 16, v208
  v_and_b32 v145, 0xffff0000, v208
  v_mfma_f32_16x16x32_bf16 v[68:71], v[108:111], a[196:199], v[68:71]
  ds_write_b128 v5, v[48:51] offset:4096
  v_mfma_f32_16x16x32_bf16 v[72:75], v[108:111], a[200:203], v[72:75]
  v_lshlrev_b32 v146, 16, v209
  v_and_b32 v147, 0xffff0000, v209
  v_mfma_f32_16x16x32_bf16 v[76:79], v[108:111], a[204:207], v[76:79]
  v_lshlrev_b32 v148, 16, v210
  v_and_b32 v149, 0xffff0000, v210
  v_mfma_f32_16x16x32_bf16 v[64:67], v[124:127], a[208:211], v[64:67]
  ds_write_b128 v5, v[52:55] offset:5120
  v_mfma_f32_16x16x32_bf16 v[68:71], v[124:127], a[212:215], v[68:71]
  v_lshlrev_b32 v150, 16, v211
  v_and_b32 v151, 0xffff0000, v211
  v_mfma_f32_16x16x32_bf16 v[72:75], v[124:127], a[216:219], v[72:75]
  v_lshlrev_b32 v152, 16, v212
  v_and_b32 v153, 0xffff0000, v212
  v_mfma_f32_16x16x32_bf16 v[76:79], v[124:127], a[220:223], v[76:79]
  ds_write_b128 v5, v[56:59] offset:6144
  ds_write_b128 v5, v[60:63] offset:7168
  v_mfma_f32_16x16x32_bf16 v[16:19], v[96:99], a[192:195], v[16:19]
  v_lshlrev_b32 v154, 16, v213
  v_and_b32 v155, 0xffff0000, v213
  v_mfma_f32_16x16x32_bf16 v[20:23], v[96:99], a[196:199], v[20:23]
  ds_write_b128 v6, v[64:67] offset:8192
  v_mfma_f32_16x16x32_bf16 v[24:27], v[96:99], a[200:203], v[24:27]
  v_lshlrev_b32 v156, 16, v214
  v_and_b32 v157, 0xffff0000, v214
  v_mfma_f32_16x16x32_bf16 v[28:31], v[96:99], a[204:207], v[28:31]
  v_lshlrev_b32 v158, 16, v215
  v_and_b32 v159, 0xffff0000, v215
  v_mfma_f32_16x16x32_bf16 v[16:19], v[112:115], a[208:211], v[16:19]
  ds_write_b128 v6, v[68:71] offset:9216
  v_mfma_f32_16x16x32_bf16 v[20:23], v[112:115], a[212:215], v[20:23]
  v_mfma_f32_16x16x32_bf16 v[24:27], v[112:115], a[216:219], v[24:27]
  v_mfma_f32_16x16x32_bf16 v[28:31], v[112:115], a[220:223], v[28:31]
  ds_write_b128 v6, v[72:75] offset:10240
  ds_write_b128 v6, v[76:79] offset:11264
  s_waitcnt lgkmcnt(0)
  s_barrier
  ds_read_b128 v[160:163], v3 offset:0
  ds_read_b128 v[164:167], v3 offset:1024
  ds_read_b128 v[168:171], v3 offset:2048
  ds_read_b128 v[172:175], v3 offset:3072
  ds_read_b128 v[176:179], v3 offset:4096
  ds_read_b128 v[180:183], v3 offset:5120
  ds_read_b128 v[184:187], v3 offset:6144
  ds_read_b128 v[188:191], v3 offset:7168
  ds_read_b128 v[192:195], v3 offset:8192
  ds_read_b128 v[196:199], v3 offset:9216
  ds_read_b128 v[200:203], v3 offset:10240
  ds_read_b128 v[204:207], v3 offset:11264
  v_lshlrev_b32 v120, 5, v0
  v_add_u32 v120, 0x18b2000, v120
  buffer_load_dwordx4 v[112:115], v120, s[44:47], 0 offen offset:0 sc1
  buffer_load_dwordx4 v[116:119], v120, s[44:47], 0 offen offset:16 sc1
  s_lshl_b32 s12, s7, 2
  s_add_u32 s12, s12, s3
  s_lshl_b32 s19, s12, 11
  s_add_u32 s19, s19, 0x1160000
  s_lshl_b32 s13, s8, 8
  s_add_u32 s18, s19, s13
  s_mul_i32 s12, s12, 16896
  s_lshl_b32 s13, s8, 10
  s_add_u32 s12, s12, s13
  v_lshrrev_b32 v7, 1, v15
  v_mul_u32_u24 v95, 0x2100, v7
  v_and_b32 v7, 31, v2
  v_lshl_add_u32 v95, v7, 4, v95
  v_add_u32 v95, s12, v95
  v_lshlrev_b32 v7, 2, v2
  s_mov_b32 s20, 0x11111111
  s_mov_b32 s21, 0x11111111
  s_mov_b32 s22, 0x420000
  s_mov_b32 s23, 0x640000
  s_waitcnt lgkmcnt(8)
  v_pk_add_f32 v[16:17], v[16:17], v[160:161]
  v_pk_add_f32 v[18:19], v[18:19], v[162:163]
  v_pk_add_f32 v[20:21], v[20:21], v[164:165]
  v_pk_add_f32 v[22:23], v[22:23], v[166:167]
  v_pk_add_f32 v[24:25], v[24:25], v[168:169]
  v_pk_add_f32 v[26:27], v[26:27], v[170:171]
  v_pk_add_f32 v[28:29], v[28:29], v[172:173]
  v_pk_add_f32 v[30:31], v[30:31], v[174:175]
  s_waitcnt lgkmcnt(4)
  v_pk_add_f32 v[16:17], v[16:17], v[176:177]
  v_pk_add_f32 v[18:19], v[18:19], v[178:179]
  v_pk_add_f32 v[20:21], v[20:21], v[180:181]
  v_pk_add_f32 v[22:23], v[22:23], v[182:183]
  v_pk_add_f32 v[24:25], v[24:25], v[184:185]
  v_pk_add_f32 v[26:27], v[26:27], v[186:187]
  v_pk_add_f32 v[28:29], v[28:29], v[188:189]
  v_pk_add_f32 v[30:31], v[30:31], v[190:191]
  s_waitcnt lgkmcnt(0)
  v_pk_add_f32 v[16:17], v[16:17], v[192:193]
  v_pk_add_f32 v[18:19], v[18:19], v[194:195]
  v_pk_add_f32 v[20:21], v[20:21], v[196:197]
  v_pk_add_f32 v[22:23], v[22:23], v[198:199]
  v_pk_add_f32 v[24:25], v[24:25], v[200:201]
  v_pk_add_f32 v[26:27], v[26:27], v[202:203]
  v_pk_add_f32 v[28:29], v[28:29], v[204:205]
  v_pk_add_f32 v[30:31], v[30:31], v[206:207]
  v_cvt_pk_bf16_f32 v16, v16, v17
  v_cvt_pk_bf16_f32 v18, v18, v19
  v_cvt_pk_bf16_f32 v20, v20, v21
  v_cvt_pk_bf16_f32 v22, v22, v23
  v_cvt_pk_bf16_f32 v24, v24, v25
  v_cvt_pk_bf16_f32 v26, v26, v27
  v_cvt_pk_bf16_f32 v28, v28, v29
  v_cvt_pk_bf16_f32 v30, v30, v31
  v_and_b32 v17, 0xffff0000, v16
  v_lshlrev_b32 v16, 16, v16
  v_and_b32 v19, 0xffff0000, v18
  v_lshlrev_b32 v18, 16, v18
  v_and_b32 v21, 0xffff0000, v20
  v_lshlrev_b32 v20, 16, v20
  v_and_b32 v23, 0xffff0000, v22
  v_lshlrev_b32 v22, 16, v22
  v_and_b32 v25, 0xffff0000, v24
  v_lshlrev_b32 v24, 16, v24
  v_and_b32 v27, 0xffff0000, v26
  v_lshlrev_b32 v26, 16, v26
  v_and_b32 v29, 0xffff0000, v28
  v_lshlrev_b32 v28, 16, v28
  v_and_b32 v31, 0xffff0000, v30
  v_lshlrev_b32 v30, 16, v30
  v_pk_add_f32 v[16:17], v[16:17], v[144:145]
  v_pk_add_f32 v[18:19], v[18:19], v[146:147]
  v_pk_add_f32 v[20:21], v[20:21], v[148:149]
  v_pk_add_f32 v[22:23], v[22:23], v[150:151]
  v_pk_add_f32 v[24:25], v[24:25], v[152:153]
  v_pk_add_f32 v[26:27], v[26:27], v[154:155]
  v_pk_add_f32 v[28:29], v[28:29], v[156:157]
  v_pk_add_f32 v[30:31], v[30:31], v[158:159]
  v_cvt_pk_bf16_f32 v32, v16, v17
  v_cvt_pk_bf16_f32 v33, v18, v19
  v_cvt_pk_bf16_f32 v34, v20, v21
  v_cvt_pk_bf16_f32 v35, v22, v23
  v_cvt_pk_bf16_f32 v36, v24, v25
  v_cvt_pk_bf16_f32 v37, v26, v27
  v_cvt_pk_bf16_f32 v38, v28, v29
  v_cvt_pk_bf16_f32 v39, v30, v31
  v_lshlrev_b32 v96, 16, v32
  v_and_b32 v97, 0xffff0000, v32
  v_lshlrev_b32 v98, 16, v33
  v_and_b32 v99, 0xffff0000, v33
  v_lshlrev_b32 v100, 16, v34
  v_and_b32 v101, 0xffff0000, v34
  v_lshlrev_b32 v102, 16, v35
  v_and_b32 v103, 0xffff0000, v35
  v_lshlrev_b32 v104, 16, v36
  v_and_b32 v105, 0xffff0000, v36
  v_lshlrev_b32 v106, 16, v37
  v_and_b32 v107, 0xffff0000, v37
  v_lshlrev_b32 v108, 16, v38
  v_and_b32 v109, 0xffff0000, v38
  v_lshlrev_b32 v110, 16, v39
  v_and_b32 v111, 0xffff0000, v39
  v_pk_add_f32 v[16:17], v[96:97], v[100:101]
  v_pk_add_f32 v[18:19], v[98:99], v[102:103]
  v_pk_add_f32 v[24:25], v[104:105], v[108:109]
  v_pk_add_f32 v[26:27], v[106:107], v[110:111]
  v_pk_mul_f32 v[20:21], v[96:97], v[96:97]
  v_pk_mul_f32 v[22:23], v[98:99], v[98:99]
  v_pk_mul_f32 v[28:29], v[104:105], v[104:105]
  v_pk_mul_f32 v[30:31], v[106:107], v[106:107]
  v_pk_fma_f32 v[20:21], v[100:101], v[100:101], v[20:21]
  v_pk_fma_f32 v[22:23], v[102:103], v[102:103], v[22:23]
  v_pk_fma_f32 v[28:29], v[108:109], v[108:109], v[28:29]
  v_pk_fma_f32 v[30:31], v[110:111], v[110:111], v[30:31]
  v_pk_add_f32 v[16:17], v[16:17], v[24:25]
  v_pk_add_f32 v[18:19], v[18:19], v[26:27]
  v_pk_add_f32 v[20:21], v[20:21], v[28:29]
  v_pk_add_f32 v[22:23], v[22:23], v[30:31]
  v_add_f32_dpp v16, v16, v16 row_ror:8 row_mask:0xf bank_mask:0x3
  v_add_f32_dpp v17, v17, v17 row_ror:8 row_mask:0xf bank_mask:0x3
  v_add_f32_dpp v20, v20, v20 row_ror:8 row_mask:0xf bank_mask:0x3
  v_add_f32_dpp v21, v21, v21 row_ror:8 row_mask:0xf bank_mask:0x3
  v_add_f32_dpp v16, v18, v18 row_ror:8 row_mask:0xf bank_mask:0xc
  v_add_f32_dpp v17, v19, v19 row_ror:8 row_mask:0xf bank_mask:0xc
  v_add_f32_dpp v20, v22, v22 row_ror:8 row_mask:0xf bank_mask:0xc
  v_add_f32_dpp v21, v23, v23 row_ror:8 row_mask:0xf bank_mask:0xc
  v_mov_b32 v26, s10
  v_mov_b32 v27, s11
  v_add_f32_dpp v24, v16, v16 row_ror:12 row_mask:0xf bank_mask:0x5
  v_add_f32_dpp v25, v20, v20 row_ror:12 row_mask:0xf bank_mask:0x5
  s_nop 0
  v_add_f32_dpp v24, v17, v17 row_ror:4 row_mask:0xf bank_mask:0xa
  v_add_f32_dpp v25, v21, v21 row_ror:4 row_mask:0xf bank_mask:0xa
  s_nop 0
  v_add_f32_dpp v24, v24, v24 quad_perm:[1,0,3,2] row_mask:0xf bank_mask:0xf
  v_add_f32_dpp v25, v25, v25 quad_perm:[1,0,3,2] row_mask:0xf bank_mask:0xf
  s_nop 0
  v_add_f32_dpp v24, v24, v24 quad_perm:[2,3,0,1] row_mask:0xf bank_mask:0xf
  v_add_f32_dpp v25, v25, v25 quad_perm:[2,3,0,1] row_mask:0xf bank_mask:0xf
  s_waitcnt vmcnt(2)
  s_mov_b64 exec, s[20:21]
  buffer_store_dwordx4 v[24:27], v7, s[44:47], s18 offen
  s_mov_b64 exec, -1
  v_permlane16_swap_b32 v32, v34
  v_permlane16_swap_b32 v33, v35
  v_permlane16_swap_b32 v36, v38
  v_permlane16_swap_b32 v37, v39
  v_min_u32 v32, -2, v32
  buffer_store_dwordx4 v[32:35], v95, s[44:47], s22 offen offset:0 sc1
  v_min_u32 v36, -2, v36
  buffer_store_dwordx4 v[36:39], v95, s[44:47], s22 offen offset:512 sc1
  v_accvgpr_read_b32 v48, a224
  v_accvgpr_read_b32 v49, a225
  v_accvgpr_read_b32 v50, a226
  v_accvgpr_read_b32 v51, a227
  v_accvgpr_read_b32 v52, a228
  v_accvgpr_read_b32 v56, a229
  v_accvgpr_read_b32 v57, a230
  v_accvgpr_read_b32 v58, a231
  v_accvgpr_read_b32 v59, a232
  v_accvgpr_read_b32 v60, a233
  s_lshr_b32 s12, s3, 1
  s_mul_i32 s12, s12, 8320
  s_add_u32 s12, s12, 133120
  v_and_b32 v78, 127, v0
  v_lshl_add_u32 v76, v78, 4, s12
  v_sub_u32 v78, 127, v78
  v_and_b32 v79, 1, v78
  v_lshl_add_u32 v77, v79, 4, s12
  v_bfe_u32 v79, v78, 1, 1
  v_mul_u32_u24 v79, 0x1040, v79
  v_add3_u32 v77, v77, v79, 64
  v_add_u32 v77, 4032, v77
  v_and_b32 v1, 3, v2
  v_lshlrev_b32 v94, 9, v1
  v_lshrrev_b32 v1, 2, v2
  v_lshl_add_u32 v94, v1, 4, v94
  s_waitcnt lgkmcnt(0)
  s_barrier
  ds_write_b128 v76, v[48:51] offset:0
  v_alignbit_b32 v64, v49, v48, 16
  v_alignbit_b32 v65, v50, v49, 16
  v_alignbit_b32 v66, v51, v50, 16
  v_alignbit_b32 v67, v52, v51, 16
  ds_write_b128 v76, v[64:67] offset:4160
  ds_write_b128 v76, v[56:59] offset:2048
  v_alignbit_b32 v68, v57, v56, 16
  v_alignbit_b32 v69, v58, v57, 16
  v_alignbit_b32 v70, v59, v58, 16
  v_alignbit_b32 v71, v60, v59, 16
  ds_write_b128 v76, v[68:71] offset:6208
  v_mov_b32 v73, 0
  v_mov_b32 v74, 0
  v_mov_b32 v75, 0
  v_mov_b32 v72, 0
  v_lshrrev_b32 v64, 5, v2
  v_mul_u32_u24 v64, 0x1000, v64
  v_lshl_add_u32 v64, v2, 4, v64
  v_add_u32 v64, 0x1c000, v64
  ds_write_b128 v64, v[72:75]
  v_and_b32 v65, 127, v0
  v_and_b32 v66, 0xffff, v60
  v_cmp_eq_u32 vcc, 127, v65
  s_nop 1
  v_cndmask_b32 v72, 0, v66, vcc
  s_bitcmp0_b32 s3, 0
  s_cbranch_scc1 KTF2
  s_mov_b32 exec_lo, 0
  s_mov_b32 exec_hi, 0xf0000000
  ds_write_b128 v77, v[72:75]
  s_mov_b64 exec, -1
KTF2:
  v_and_b32 v8, 15, v2
  v_lshrrev_b32 v9, 4, v2
  v_and_b32 v10, 1, v2
  v_add_u32 v11, v8, v10
  v_mul_u32_u24 v10, 0x1040, v10
  v_lshl_add_u32 v10, v9, 4, v10
  v_lshlrev_b32 v11, 1, v11
  v_sub_u32 v10, v10, v11
  s_lshr_b32 s12, s3, 1
  s_mul_i32 s13, s12, 8320
  s_and_b32 s14, s3, 1
  s_lshl_b32 s14, s14, 8
  s_sub_u32 s13, s13, s14
  s_add_u32 s13, s13, 136480
  v_add_u32 v3, s13, v10
  v_add_u32 v4, 4294966272, v3
  v_add_u32 v5, 4294965248, v3
  v_add_u32 v6, 4294964224, v3
  s_mul_i32 s13, s12, 4608
  s_sub_u32 s13, s13, s14
  s_add_u32 s13, s13, 114976
  v_lshlrev_b32 v7, 5, v8
  v_lshl_add_u32 v7, v9, 4, v7
  v_add_u32 v7, s13, v7
  v_bfe_u32 v1, v0, 1, 6
  v_mul_u32_u24 v12, 0x2100, v1
  v_and_b32 v1, 1, v0
  v_lshl_add_u32 v12, v1, 4, v12
  s_cmp_lt_u32 s3, 2
  s_mov_b32 s12, 0x420000
  s_cselect_b32 s12, 0x640000, s12
  s_lshl_b32 s13, s4, 5
  s_add_u32 s28, s12, s13
  s_add_u32 s29, s28, 0x84000
  s_add_u32 s30, s28, 0x108000
  s_add_u32 s31, s28, 0x18c000
  s_waitcnt vmcnt(3)
  v_cmp_ne_u64 vcc, s[10:11], v[112:113]
  v_cmp_ne_u64 s[26:27], s[10:11], v[114:115]
  v_cmp_ne_u64 s[24:25], s[10:11], v[116:117]
  s_or_b64 vcc, vcc, s[26:27]
  v_cmp_ne_u64 s[26:27], s[10:11], v[118:119]
  s_or_b64 vcc, vcc, s[24:25]
  s_or_b64 vcc, vcc, s[26:27]
  s_cbranch_vccnz RFmidfb
BFmidfb:
  s_waitcnt lgkmcnt(0)
  s_barrier
  buffer_load_dwordx4 v[80:83], v94, s[44:47], s19 offen offset:0 sc1
  buffer_load_dwordx4 v[84:87], v94, s[44:47], s19 offen offset:256 sc1
  s_lshr_b32 s12, s3, 1
  v_and_b32 v1, 15, v2
  v_lshrrev_b32 v15, 4, v2
  s_lshl_b32 s14, s3, 6
  s_add_u32 s14, s14, 133120
  v_mul_u32_u24 v8, 272, v1
  v_lshl_add_u32 v8, v15, 4, v8
  v_add_u32 v8, s14, v8
  v_bfrev_b32 v13, v15
  v_lshrrev_b32 v13, 30, v13
  s_mul_i32 s14, s3, 2176
  s_add_u32 s14, s14, 133120
  v_mul_u32_u24 v14, 544, v13
  v_lshl_add_u32 v14, v1, 2, v14
  v_add_u32 v14, s14, v14
  v_add_u32 v9, 16640, v14
  s_lshl_b32 s14, s3, 8
  s_add_u32 s14, s14, 115200
  v_lshl_add_u32 v10, v13, 6, s14
  v_lshl_add_u32 v10, v1, 1, v10
  v_mul_u32_u24 v13, 0x8100, v13
  v_lshl_add_u32 v13, v1, 4, v13
  s_lshr_b32 s14, s4, 4
  s_lshl_b32 s14, s14, 11
  s_and_b32 s15, s4, 1
  s_lshl_b32 s15, s15, 10
  s_add_u32 s14, s14, s15
  s_and_b32 s15, s4, 6
  s_lshl_b32 s15, s15, 7
  s_add_u32 s14, s14, s15
  s_and_b32 s15, s4, 8
  s_add_u32 s14, s14, s15
  s_mul_i32 s15, s3, 132096
  s_add_u32 s14, s14, s15
  s_add_u32 s68, s14, 0x210000
  v_and_b32 v1, 1, v2
  v_mul_u32_u24 v11, 0x1200, v1
  v_bfe_u32 v15, v0, 1, 6
  v_lshl_add_u32 v11, v15, 4, v11
  s_mul_i32 s14, s12, 9216
  s_add_u32 s14, s14, 115200
  v_add_u32 v11, s14, v11
  s_waitcnt vmcnt(0)
  v_cmp_ne_u64 vcc, s[10:11], v[82:83]
  v_cmp_ne_u64 s[20:21], s[10:11], v[86:87]
  s_nop 0
  s_or_b64 vcc, vcc, s[20:21]
  s_cbranch_vccnz RFmid
BFmid:
  v_pk_add_f32 v[80:81], v[80:81], v[84:85]
  s_nop 1
  v_add_f32_dpp v80, v80, v80 quad_perm:[1,0,3,2] row_mask:0xf bank_mask:0xf
  v_add_f32_dpp v81, v81, v81 quad_perm:[1,0,3,2] row_mask:0xf bank_mask:0xf
  s_nop 0
  v_add_f32_dpp v80, v80, v80 quad_perm:[2,3,0,1] row_mask:0xf bank_mask:0xf
  v_add_f32_dpp v81, v81, v81 quad_perm:[2,3,0,1] row_mask:0xf bank_mask:0xf
  v_mul_f32 v80, 0x3b000000, v80
  v_mul_f32 v81, 0x3b000000, v81
  v_fma_f32 v81, -v80, v80, v81
  v_max_f32 v81, 0, v81
  v_cvt_pk_bf16_f32 v83, 0, v81
  v_add_f32 v83, 0x3727c5ac, v83
  v_cvt_pk_bf16_f32 v83, 0, v83
  v_sqrt_f32 v83, v83
  s_nop 0
  v_cvt_pk_bf16_f32 v82, v80, v83
  v_and_b32 v83, 0xffff0000, v82
  v_rcp_f32 v83, v83
  v_lshlrev_b32 v82, 16, v82
  s_nop 1
  v_mov_b32_dpp v48, v82 row_newbcast:0 row_mask:0xf bank_mask:0xf
  v_mov_b32_dpp v49, v82 row_newbcast:4 row_mask:0xf bank_mask:0xf
  v_mov_b32_dpp v50, v82 row_newbcast:8 row_mask:0xf bank_mask:0xf
  v_mov_b32_dpp v51, v82 row_newbcast:12 row_mask:0xf bank_mask:0xf
  v_mov_b32_dpp v52, v83 row_newbcast:0 row_mask:0xf bank_mask:0xf
  v_mov_b32_dpp v53, v83 row_newbcast:4 row_mask:0xf bank_mask:0xf
  v_mov_b32_dpp v54, v83 row_newbcast:8 row_mask:0xf bank_mask:0xf
  v_mov_b32_dpp v55, v83 row_newbcast:12 row_mask:0xf bank_mask:0xf
  v_pk_add_f32 v[96:97], v[96:97], v[48:49] neg_lo:[0,1] neg_hi:[0,1]
  v_pk_add_f32 v[98:99], v[98:99], v[50:51] neg_lo:[0,1] neg_hi:[0,1]
  v_pk_add_f32 v[100:101], v[100:101], v[48:49] neg_lo:[0,1] neg_hi:[0,1]
  v_pk_add_f32 v[102:103], v[102:103], v[50:51] neg_lo:[0,1] neg_hi:[0,1]
  v_cvt_pk_bf16_f32 v96, v96, v97
  v_cvt_pk_bf16_f32 v98, v98, v99
  v_cvt_pk_bf16_f32 v100, v100, v101
  v_cvt_pk_bf16_f32 v102, v102, v103
  v_and_b32 v97, 0xffff0000, v96
  v_lshlrev_b32 v96, 16, v96
  v_and_b32 v99, 0xffff0000, v98
  v_lshlrev_b32 v98, 16, v98
  v_and_b32 v101, 0xffff0000, v100
  v_lshlrev_b32 v100, 16, v100
  v_and_b32 v103, 0xffff0000, v102
  v_lshlrev_b32 v102, 16, v102
  v_pk_mul_f32 v[96:97], v[96:97], v[52:53]
  v_pk_mul_f32 v[98:99], v[98:99], v[54:55]
  v_pk_mul_f32 v[100:101], v[100:101], v[52:53]
  v_pk_mul_f32 v[102:103], v[102:103], v[54:55]
  v_cvt_pk_bf16_f32 v56, v96, v97
  v_cvt_pk_bf16_f32 v57, v98, v99
  v_cvt_pk_bf16_f32 v58, v100, v101
  v_cvt_pk_bf16_f32 v59, v102, v103
  s_nop 0
  v_permlane16_swap_b32 v56, v58
  v_permlane16_swap_b32 v57, v59
  v_min_u32 v56, -2, v56
  buffer_store_dwordx4 v[56:59], v95, s[44:47], s23 offen offset:0 sc1
  v_pk_add_f32 v[104:105], v[104:105], v[48:49] neg_lo:[0,1] neg_hi:[0,1]
  v_pk_add_f32 v[106:107], v[106:107], v[50:51] neg_lo:[0,1] neg_hi:[0,1]
  v_pk_add_f32 v[108:109], v[108:109], v[48:49] neg_lo:[0,1] neg_hi:[0,1]
  v_pk_add_f32 v[110:111], v[110:111], v[50:51] neg_lo:[0,1] neg_hi:[0,1]
  v_cvt_pk_bf16_f32 v104, v104, v105
  v_cvt_pk_bf16_f32 v106, v106, v107
  v_cvt_pk_bf16_f32 v108, v108, v109
  v_cvt_pk_bf16_f32 v110, v110, v111
  v_and_b32 v105, 0xffff0000, v104
  v_lshlrev_b32 v104, 16, v104
  v_and_b32 v107, 0xffff0000, v106
  v_lshlrev_b32 v106, 16, v106
  v_and_b32 v109, 0xffff0000, v108
  v_lshlrev_b32 v108, 16, v108
  v_and_b32 v111, 0xffff0000, v110
  v_lshlrev_b32 v110, 16, v110
  v_pk_mul_f32 v[104:105], v[104:105], v[52:53]
  v_pk_mul_f32 v[106:107], v[106:107], v[54:55]
  v_pk_mul_f32 v[108:109], v[108:109], v[52:53]
  v_pk_mul_f32 v[110:111], v[110:111], v[54:55]
  v_cvt_pk_bf16_f32 v60, v104, v105
  v_cvt_pk_bf16_f32 v61, v106, v107
  v_cvt_pk_bf16_f32 v62, v108, v109
  v_cvt_pk_bf16_f32 v63, v110, v111
  s_nop 0
  v_permlane16_swap_b32 v60, v62
  v_permlane16_swap_b32 v61, v63
  v_min_u32 v60, -2, v60
  buffer_store_dwordx4 v[60:63], v95, s[44:47], s23 offen offset:512 sc1
  ds_read2_b32 v[128:129], v3 offset0:176 offset1:177
  ds_read2_b32 v[130:131], v3 offset0:178 offset1:179
  ds_read2_b32 v[132:133], v3 offset0:160 offset1:161
  ds_read2_b32 v[134:135], v3 offset0:162 offset1:163
  ds_read2_b32 v[136:137], v3 offset0:144 offset1:145
  ds_read2_b32 v[138:139], v3 offset0:146 offset1:147
  ds_read2_b32 v[140:141], v3 offset0:128 offset1:129
  ds_read2_b32 v[142:143], v3 offset0:130 offset1:131
  ds_read2_b32 v[144:145], v3 offset0:48 offset1:49
  ds_read2_b32 v[146:147], v3 offset0:50 offset1:51
  ds_read2_b32 v[148:149], v3 offset0:32 offset1:33
  ds_read2_b32 v[150:151], v3 offset0:34 offset1:35
  ds_read2_b32 v[152:153], v3 offset0:16 offset1:17
  ds_read2_b32 v[154:155], v3 offset0:18 offset1:19
  ds_read2_b32 v[156:157], v3 offset0:0 offset1:1
  ds_read2_b32 v[158:159], v3 offset0:2 offset1:3
  ds_read2_b32 v[240:241], v6 offset0:48 offset1:49
  ds_read2_b32 v[242:243], v6 offset0:50 offset1:51
  ds_read2_b32 v[244:245], v6 offset0:32 offset1:33
  ds_read2_b32 v[246:247], v6 offset0:34 offset1:35
  ds_read2_b32 v[248:249], v6 offset0:16 offset1:17
  ds_read2_b32 v[250:251], v6 offset0:18 offset1:19
  ds_read2_b32 v[252:253], v6 offset0:0 offset1:1
  ds_read2_b32 v[254:255], v6 offset0:2 offset1:3
  ds_read2_b32 v[224:225], v6 offset0:176 offset1:177
  ds_read2_b32 v[226:227], v6 offset0:178 offset1:179
  ds_read2_b32 v[228:229], v6 offset0:160 offset1:161
  ds_read2_b32 v[230:231], v6 offset0:162 offset1:163
  ds_read2_b32 v[232:233], v6 offset0:144 offset1:145
  ds_read2_b32 v[234:235], v6 offset0:146 offset1:147
  ds_read2_b32 v[236:237], v6 offset0:128 offset1:129
  ds_read2_b32 v[238:239], v6 offset0:130 offset1:131
  ds_read2_b32 v[208:209], v5 offset0:48 offset1:49
  ds_read2_b32 v[210:211], v5 offset0:50 offset1:51
  ds_read2_b32 v[212:213], v5 offset0:32 offset1:33
  ds_read2_b32 v[214:215], v5 offset0:34 offset1:35
  ds_read2_b32 v[216:217], v5 offset0:16 offset1:17
  ds_read2_b32 v[218:219], v5 offset0:18 offset1:19
  ds_read2_b32 v[220:221], v5 offset0:0 offset1:1
  ds_read2_b32 v[222:223], v5 offset0:2 offset1:3
  ds_read2_b32 v[192:193], v5 offset0:176 offset1:177
  ds_read2_b32 v[194:195], v5 offset0:178 offset1:179
  ds_read2_b32 v[196:197], v5 offset0:160 offset1:161
  ds_read2_b32 v[198:199], v5 offset0:162 offset1:163
  ds_read2_b32 v[200:201], v5 offset0:144 offset1:145
  ds_read2_b32 v[202:203], v5 offset0:146 offset1:147
  ds_read2_b32 v[204:205], v5 offset0:128 offset1:129
  ds_read2_b32 v[206:207], v5 offset0:130 offset1:131
  ds_read2_b32 v[176:177], v4 offset0:48 offset1:49
  ds_read2_b32 v[178:179], v4 offset0:50 offset1:51
  ds_read2_b32 v[180:181], v4 offset0:32 offset1:33
  ds_read2_b32 v[182:183], v4 offset0:34 offset1:35
  ds_read2_b32 v[184:185], v4 offset0:16 offset1:17
  ds_read2_b32 v[186:187], v4 offset0:18 offset1:19
  ds_read2_b32 v[188:189], v4 offset0:0 offset1:1
  ds_read2_b32 v[190:191], v4 offset0:2 offset1:3
  ds_read2_b32 v[160:161], v4 offset0:176 offset1:177
  ds_read2_b32 v[162:163], v4 offset0:178 offset1:179
  ds_read2_b32 v[164:165], v4 offset0:160 offset1:161
  ds_read2_b32 v[166:167], v4 offset0:162 offset1:163
  ds_read2_b32 v[168:169], v4 offset0:144 offset1:145
  ds_read2_b32 v[170:171], v4 offset0:146 offset1:147
  ds_read2_b32 v[172:173], v4 offset0:128 offset1:129
  ds_read2_b32 v[174:175], v4 offset0:130 offset1:131
  buffer_load_dwordx4 v[112:115], v12, s[44:47], s28 offen sc1
  s_waitcnt vmcnt(0)
  v_cmp_eq_u32 vcc, -1, v112
  s_cbranch_vccnz RFc2s0
BFc2s0:
  ds_write_b128 v11, v[112:115] offset:0
  s_waitcnt lgkmcnt(0)
  s_barrier
  ds_read_b128 v[48:51], v7 offset:192
  ds_read_b128 v[52:55], v7 offset:128
  ds_read_b128 v[56:59], v7 offset:64
  ds_read_b128 v[60:63], v7 offset:0
  ds_read_b128 v[64:67], v7 offset:704
  ds_read_b128 v[68:71], v7 offset:640
  ds_read_b128 v[72:75], v7 offset:576
  ds_read_b128 v[76:79], v7 offset:512
  s_lshl_b32 s24, s66, 16
  s_and_b32 s25, s66, 0xffff0000
  s_waitcnt lgkmcnt(7)
  v_mfma_f32_16x16x32_bf16 v[16:19], v[128:131], v[48:51], 0
  buffer_load_dwordx4 v[116:119], v12, s[44:47], s29 offen sc1
  s_waitcnt lgkmcnt(6)
  v_mfma_f32_16x16x32_bf16 v[16:19], v[132:135], v[52:55], v[16:19]
  s_waitcnt lgkmcnt(5)
  v_mfma_f32_16x16x32_bf16 v[16:19], v[136:139], v[56:59], v[16:19]
  s_waitcnt lgkmcnt(4)
  v_mfma_f32_16x16x32_bf16 v[16:19], v[140:143], v[60:63], v[16:19]
  v_mfma_f32_16x16x32_bf16 v[20:23], v[144:147], v[48:51], 0
  v_mfma_f32_16x16x32_bf16 v[20:23], v[148:151], v[52:55], v[20:23]
  v_mfma_f32_16x16x32_bf16 v[20:23], v[152:155], v[56:59], v[20:23]
  v_mfma_f32_16x16x32_bf16 v[20:23], v[156:159], v[60:63], v[20:23]
  s_waitcnt lgkmcnt(3)
  v_mfma_f32_16x16x32_bf16 v[20:23], v[128:131], v[64:67], v[20:23]
  s_waitcnt lgkmcnt(2)
  v_mfma_f32_16x16x32_bf16 v[20:23], v[132:135], v[68:71], v[20:23]
  s_waitcnt lgkmcnt(1)
  v_mfma_f32_16x16x32_bf16 v[20:23], v[136:139], v[72:75], v[20:23]
  buffer_load_dwordx4 v[120:123], v12, s[44:47], s30 offen sc1
  s_waitcnt lgkmcnt(0)
  v_mfma_f32_16x16x32_bf16 v[20:23], v[140:143], v[76:79], v[20:23]
  v_mfma_f32_16x16x32_bf16 v[44:47], v[240:243], v[48:51], 0
  v_mfma_f32_16x16x32_bf16 v[44:47], v[244:247], v[52:55], v[44:47]
  v_mfma_f32_16x16x32_bf16 v[44:47], v[248:251], v[56:59], v[44:47]
  v_mfma_f32_16x16x32_bf16 v[44:47], v[252:255], v[60:63], v[44:47]
  ds_write_b128 v8, v[16:19] offset:16640
  s_nop 2
  ds_write_b128 v8, v[20:23] offset:20992
  v_mfma_f32_16x16x32_bf16 v[40:43], v[224:227], v[48:51], 0
  v_mfma_f32_16x16x32_bf16 v[40:43], v[228:231], v[52:55], v[40:43]
  v_mov_b32 v240, 0
  v_mov_b32 v241, 0
  v_mfma_f32_16x16x32_bf16 v[40:43], v[232:235], v[56:59], v[40:43]
  v_mov_b32 v242, 0
  v_mov_b32 v243, 0
  v_mfma_f32_16x16x32_bf16 v[40:43], v[236:239], v[60:63], v[40:43]
  s_waitcnt lgkmcnt(0)
  s_barrier
  ds_read2_b32 v[248:249], v9 offset0:0 offset1:68
  v_mfma_f32_16x16x32_bf16 v[36:39], v[208:211], v[48:51], 0
  ds_read2_b32 v[252:253], v9 offset0:16 offset1:84
  ds_read2_b32 v[250:251], v9 offset0:32 offset1:100
  v_mfma_f32_16x16x32_bf16 v[36:39], v[212:215], v[52:55], v[36:39]
  ds_read2_b32 v[254:255], v9 offset0:48 offset1:116
  v_mov_b32 v244, 0
  v_mfma_f32_16x16x32_bf16 v[36:39], v[216:219], v[56:59], v[36:39]
  v_mov_b32 v245, 0
  v_mov_b32 v246, 0
  v_mfma_f32_16x16x32_bf16 v[36:39], v[220:223], v[60:63], v[36:39]
  v_mov_b32 v247, 0
  ds_read_u16_d16_hi v240, v10 offset:0
  v_mfma_f32_16x16x32_bf16 v[32:35], v[192:195], v[48:51], 0
  ds_read_u16_d16_hi v241, v10 offset:32
  ds_read_u16_d16_hi v242, v10 offset:4608
  v_mfma_f32_16x16x32_bf16 v[32:35], v[196:199], v[52:55], v[32:35]
  ds_read_u16_d16_hi v243, v10 offset:4640
  ds_read_u16_d16_hi v244, v10 offset:9216
  v_mfma_f32_16x16x32_bf16 v[32:35], v[200:203], v[56:59], v[32:35]
  ds_read_u16_d16_hi v245, v10 offset:9248
  ds_read_u16_d16_hi v246, v10 offset:13824
  v_mfma_f32_16x16x32_bf16 v[32:35], v[204:207], v[60:63], v[32:35]
  s_waitcnt lgkmcnt(7)
  v_add_f32 v248, v248, v252
  v_add_f32 v249, v249, v253
  v_mfma_f32_16x16x32_bf16 v[28:31], v[176:179], v[48:51], 0
  v_add_f32 v250, v250, v254
  v_add_f32 v251, v251, v255
  v_mfma_f32_16x16x32_bf16 v[28:31], v[180:183], v[52:55], v[28:31]
  v_cvt_pk_bf16_f32 v248, v248, v249
  v_cvt_pk_bf16_f32 v250, v250, v251
  v_mfma_f32_16x16x32_bf16 v[28:31], v[184:187], v[56:59], v[28:31]
  v_and_b32 v249, 0xffff0000, v248
  v_and_b32 v251, 0xffff0000, v250
  v_mfma_f32_16x16x32_bf16 v[28:31], v[188:191], v[60:63], v[28:31]
  v_lshlrev_b32 v248, 16, v248
  v_lshlrev_b32 v250, 16, v250
  v_mfma_f32_16x16x32_bf16 v[24:27], v[160:163], v[48:51], 0
  ds_read_u16_d16_hi v247, v10 offset:13856
  v_mfma_f32_16x16x32_bf16 v[24:27], v[164:167], v[52:55], v[24:27]
  v_mfma_f32_16x16x32_bf16 v[24:27], v[168:171], v[56:59], v[24:27]
  v_mfma_f32_16x16x32_bf16 v[24:27], v[172:175], v[60:63], v[24:27]
  v_mfma_f32_16x16x32_bf16 v[44:47], v[224:227], v[64:67], v[44:47]
  s_waitcnt lgkmcnt(4)
  v_mul_f32 v240, s24, v240
  v_mul_f32 v241, s24, v241
  v_mfma_f32_16x16x32_bf16 v[44:47], v[228:231], v[68:71], v[44:47]
  v_mul_f32 v242, s25, v242
  v_mul_f32 v243, s25, v243
  v_mfma_f32_16x16x32_bf16 v[44:47], v[232:235], v[72:75], v[44:47]
  v_cvt_pk_bf16_f32 v240, v240, v241
  v_cvt_pk_bf16_f32 v242, v242, v243
  v_mfma_f32_16x16x32_bf16 v[44:47], v[236:239], v[76:79], v[44:47]
  v_and_b32 v241, 0xffff0000, v240
  v_and_b32 v243, 0xffff0000, v242
  v_mfma_f32_16x16x32_bf16 v[40:43], v[208:211], v[64:67], v[40:43]
  buffer_load_dwordx4 v[124:127], v12, s[44:47], s31 offen sc1
  v_lshlrev_b32 v240, 16, v240
  v_mfma_f32_16x16x32_bf16 v[40:43], v[212:215], v[68:71], v[40:43]
  v_lshlrev_b32 v242, 16, v242
  v_add_f32 v248, v248, v240
  v_mfma_f32_16x16x32_bf16 v[40:43], v[216:219], v[72:75], v[40:43]
  v_add_f32 v249, v249, v241
  v_add_f32 v250, v250, v242
  v_mfma_f32_16x16x32_bf16 v[40:43], v[220:223], v[76:79], v[40:43]
  s_waitcnt vmcnt(2)
  v_cmp_eq_u32 vcc, -1, v116
  s_cbranch_vccnz RFc2s1
BFc2s1:
  v_mfma_f32_16x16x32_bf16 v[36:39], v[192:195], v[64:67], v[36:39]
  ds_write_b128 v11, v[116:119] offset:1024
  v_add_f32 v251, v251, v243
  v_mfma_f32_16x16x32_bf16 v[36:39], v[196:199], v[68:71], v[36:39]
  v_cvt_pk_bf16_f32 v248, v248, v249
  v_cvt_pk_bf16_f32 v250, v250, v251
  v_mfma_f32_16x16x32_bf16 v[36:39], v[200:203], v[72:75], v[36:39]
  v_and_b32 v249, 0xffff0000, v248
  v_and_b32 v251, 0xffff0000, v250
  v_mfma_f32_16x16x32_bf16 v[36:39], v[204:207], v[76:79], v[36:39]
  v_lshlrev_b32 v248, 16, v248
  v_lshlrev_b32 v250, 16, v250
  v_mfma_f32_16x16x32_bf16 v[32:35], v[176:179], v[64:67], v[32:35]
  s_waitcnt lgkmcnt(0)
  s_barrier
  ds_read_b128 v[80:83], v7 offset:1216
  v_mfma_f32_16x16x32_bf16 v[32:35], v[180:183], v[68:71], v[32:35]
  ds_read_b128 v[84:87], v7 offset:1152
  ds_read_b128 v[88:91], v7 offset:1088
  v_mfma_f32_16x16x32_bf16 v[32:35], v[184:187], v[72:75], v[32:35]
  ds_read_b128 v[92:95], v7 offset:1024
  ds_read_b128 v[96:99], v7 offset:1728
  v_mfma_f32_16x16x32_bf16 v[32:35], v[188:191], v[76:79], v[32:35]
  ds_read_b128 v[100:103], v7 offset:1664
  ds_read_b128 v[104:107], v7 offset:1600
  v_mfma_f32_16x16x32_bf16 v[28:31], v[160:163], v[64:67], v[28:31]
  ds_read_b128 v[108:111], v7 offset:1536
  v_add_f32 v248, v248, v244
  v_mfma_f32_16x16x32_bf16 v[28:31], v[164:167], v[68:71], v[28:31]
  v_add_f32 v249, v249, v245
  v_add_f32 v250, v250, v246
  v_mfma_f32_16x16x32_bf16 v[28:31], v[168:171], v[72:75], v[28:31]
  v_add_f32 v251, v251, v247
  v_cvt_pk_bf16_f32 v252, v248, v250
  v_mfma_f32_16x16x32_bf16 v[28:31], v[172:175], v[76:79], v[28:31]
  v_cvt_pk_bf16_f32 v253, v249, v251
  v_min_u32 v252, -2, v252
  v_mfma_f32_16x16x32_bf16 v[24:27], v[144:147], v[64:67], v[24:27]
  buffer_store_dwordx2 v[252:253], v13, s[44:47], s68 offen sc1
  s_add_u32 s68, s68, 0x81000
  v_mov_b32 v224, 0
  v_mfma_f32_16x16x32_bf16 v[24:27], v[148:151], v[68:71], v[24:27]
  v_mov_b32 v225, 0
  v_mov_b32 v226, 0
  v_mfma_f32_16x16x32_bf16 v[24:27], v[152:155], v[72:75], v[24:27]
  v_mov_b32 v227, 0
  v_mov_b32 v228, 0
  v_mfma_f32_16x16x32_bf16 v[24:27], v[156:159], v[76:79], v[24:27]
  v_mov_b32 v229, 0
  v_mov_b32 v230, 0
  s_waitcnt lgkmcnt(7)
  v_mfma_f32_16x16x32_bf16 v[24:27], v[128:131], v[80:83], v[24:27]
  v_mov_b32 v231, 0
  ds_read_u16_d16_hi v224, v10 offset:1024
  s_waitcnt lgkmcnt(7)
  v_mfma_f32_16x16x32_bf16 v[24:27], v[132:135], v[84:87], v[24:27]
  ds_read_u16_d16_hi v225, v10 offset:1056
  ds_read_u16_d16_hi v226, v10 offset:5632
  s_waitcnt lgkmcnt(8)
  v_mfma_f32_16x16x32_bf16 v[24:27], v[136:139], v[88:91], v[24:27]
  ds_read_u16_d16_hi v227, v10 offset:5664
  ds_read_u16_d16_hi v228, v10 offset:10240
  s_waitcnt lgkmcnt(9)
  v_mfma_f32_16x16x32_bf16 v[24:27], v[140:143], v[92:95], v[24:27]
  ds_read_u16_d16_hi v229, v10 offset:10272
  ds_read_u16_d16_hi v230, v10 offset:14848
  v_mfma_f32_16x16x32_bf16 v[28:31], v[144:147], v[80:83], v[28:31]
  ds_read_u16_d16_hi v231, v10 offset:14880
  v_mfma_f32_16x16x32_bf16 v[28:31], v[148:151], v[84:87], v[28:31]
  v_mfma_f32_16x16x32_bf16 v[28:31], v[152:155], v[88:91], v[28:31]
  v_mfma_f32_16x16x32_bf16 v[28:31], v[156:159], v[92:95], v[28:31]
  s_waitcnt lgkmcnt(11)
  v_mfma_f32_16x16x32_bf16 v[28:31], v[128:131], v[96:99], v[28:31]
  s_waitcnt lgkmcnt(4)
  v_mul_f32 v224, s24, v224
  v_mul_f32 v225, s24, v225
  v_mfma_f32_16x16x32_bf16 v[28:31], v[132:135], v[100:103], v[28:31]
  v_mul_f32 v226, s25, v226
  v_mul_f32 v227, s25, v227
  v_mfma_f32_16x16x32_bf16 v[28:31], v[136:139], v[104:107], v[28:31]
  v_cvt_pk_bf16_f32 v224, v224, v225
  v_cvt_pk_bf16_f32 v226, v226, v227
  v_mfma_f32_16x16x32_bf16 v[28:31], v[140:143], v[108:111], v[28:31]
  v_and_b32 v225, 0xffff0000, v224
  v_and_b32 v227, 0xffff0000, v226
  v_mfma_f32_16x16x32_bf16 v[44:47], v[208:211], v[80:83], v[44:47]
  v_lshlrev_b32 v224, 16, v224
  v_lshlrev_b32 v226, 16, v226
  v_mfma_f32_16x16x32_bf16 v[44:47], v[212:215], v[84:87], v[44:47]
  v_mfma_f32_16x16x32_bf16 v[44:47], v[216:219], v[88:91], v[44:47]
  v_mfma_f32_16x16x32_bf16 v[44:47], v[220:223], v[92:95], v[44:47]
  ds_write_b128 v8, v[24:27] offset:0
  ds_write_b128 v8, v[28:31] offset:4352
  v_mfma_f32_16x16x32_bf16 v[40:43], v[192:195], v[80:83], v[40:43]
  v_mfma_f32_16x16x32_bf16 v[40:43], v[196:199], v[84:87], v[40:43]
  v_mfma_f32_16x16x32_bf16 v[40:43], v[200:203], v[88:91], v[40:43]
  v_mfma_f32_16x16x32_bf16 v[40:43], v[204:207], v[92:95], v[40:43]
  s_waitcnt lgkmcnt(0)
  s_barrier
  ds_read2_b32 v[232:233], v14 offset0:0 offset1:68
  v_mfma_f32_16x16x32_bf16 v[36:39], v[176:179], v[80:83], v[36:39]
  ds_read2_b32 v[236:237], v14 offset0:16 offset1:84
  ds_read2_b32 v[234:235], v14 offset0:32 offset1:100
  v_mfma_f32_16x16x32_bf16 v[36:39], v[180:183], v[84:87], v[36:39]
  ds_read2_b32 v[238:239], v14 offset0:48 offset1:116
  v_mfma_f32_16x16x32_bf16 v[36:39], v[184:187], v[88:91], v[36:39]
  v_mfma_f32_16x16x32_bf16 v[36:39], v[188:191], v[92:95], v[36:39]
  v_mfma_f32_16x16x32_bf16 v[32:35], v[160:163], v[80:83], v[32:35]
  v_mfma_f32_16x16x32_bf16 v[32:35], v[164:167], v[84:87], v[32:35]
  v_mfma_f32_16x16x32_bf16 v[32:35], v[168:171], v[88:91], v[32:35]
  v_mfma_f32_16x16x32_bf16 v[32:35], v[172:175], v[92:95], v[32:35]
  s_waitcnt vmcnt(2)
  v_cmp_eq_u32 vcc, -1, v120
  s_cbranch_vccnz RFc2s2
BFc2s2:
  v_mfma_f32_16x16x32_bf16 v[44:47], v[192:195], v[96:99], v[44:47]
  ds_write_b128 v11, v[120:123] offset:2048
  s_waitcnt lgkmcnt(1)
  v_add_f32 v232, v232, v236
  v_mfma_f32_16x16x32_bf16 v[44:47], v[196:199], v[100:103], v[44:47]
  v_add_f32 v233, v233, v237
  v_add_f32 v234, v234, v238
  v_mfma_f32_16x16x32_bf16 v[44:47], v[200:203], v[104:107], v[44:47]
  v_add_f32 v235, v235, v239
  v_cvt_pk_bf16_f32 v232, v232, v233
  v_mfma_f32_16x16x32_bf16 v[44:47], v[204:207], v[108:111], v[44:47]
  v_cvt_pk_bf16_f32 v234, v234, v235
  v_and_b32 v233, 0xffff0000, v232
  v_mfma_f32_16x16x32_bf16 v[40:43], v[176:179], v[96:99], v[40:43]
  s_waitcnt lgkmcnt(0)
  s_barrier
  ds_read_b128 v[48:51], v7 offset:2240
  v_mfma_f32_16x16x32_bf16 v[40:43], v[180:183], v[100:103], v[40:43]
  ds_read_b128 v[52:55], v7 offset:2176
  ds_read_b128 v[56:59], v7 offset:2112
  v_mfma_f32_16x16x32_bf16 v[40:43], v[184:187], v[104:107], v[40:43]
  ds_read_b128 v[60:63], v7 offset:2048
  ds_read_b128 v[64:67], v7 offset:2752
  v_mfma_f32_16x16x32_bf16 v[40:43], v[188:191], v[108:111], v[40:43]
  ds_read_b128 v[68:71], v7 offset:2688
  ds_read_b128 v[72:75], v7 offset:2624
  v_mfma_f32_16x16x32_bf16 v[36:39], v[160:163], v[96:99], v[36:39]
  ds_read_b128 v[76:79], v7 offset:2560
  v_and_b32 v235, 0xffff0000, v234
  v_mfma_f32_16x16x32_bf16 v[36:39], v[164:167], v[100:103], v[36:39]
  v_lshlrev_b32 v232, 16, v232
  v_lshlrev_b32 v234, 16, v234
  v_mfma_f32_16x16x32_bf16 v[36:39], v[168:171], v[104:107], v[36:39]
  v_add_f32 v232, v232, v224
  v_add_f32 v233, v233, v225
  v_mfma_f32_16x16x32_bf16 v[36:39], v[172:175], v[108:111], v[36:39]
  v_add_f32 v234, v234, v226
  v_add_f32 v235, v235, v227
  v_mfma_f32_16x16x32_bf16 v[32:35], v[144:147], v[96:99], v[32:35]
  v_cvt_pk_bf16_f32 v232, v232, v233
  v_cvt_pk_bf16_f32 v234, v234, v235
  v_mfma_f32_16x16x32_bf16 v[32:35], v[148:151], v[100:103], v[32:35]
  v_and_b32 v233, 0xffff0000, v232
  v_and_b32 v235, 0xffff0000, v234
  v_mfma_f32_16x16x32_bf16 v[32:35], v[152:155], v[104:107], v[32:35]
  v_lshlrev_b32 v232, 16, v232
  v_lshlrev_b32 v234, 16, v234
  v_mfma_f32_16x16x32_bf16 v[32:35], v[156:159], v[108:111], v[32:35]
  v_add_f32 v232, v232, v228
  v_add_f32 v233, v233, v229
  s_waitcnt lgkmcnt(7)
  v_mfma_f32_16x16x32_bf16 v[32:35], v[128:131], v[48:51], v[32:35]
  v_add_f32 v234, v234, v230
  v_add_f32 v235, v235, v231
  s_waitcnt lgkmcnt(6)
  v_mfma_f32_16x16x32_bf16 v[32:35], v[132:135], v[52:55], v[32:35]
  v_cvt_pk_bf16_f32 v236, v232, v234
  v_cvt_pk_bf16_f32 v237, v233, v235
  s_waitcnt lgkmcnt(5)
  v_mfma_f32_16x16x32_bf16 v[32:35], v[136:139], v[56:59], v[32:35]
  v_min_u32 v236, -2, v236
  buffer_store_dwordx2 v[236:237], v13, s[44:47], s68 offen sc1
  s_add_u32 s68, s68, 0x81000
  s_waitcnt lgkmcnt(4)
  v_mfma_f32_16x16x32_bf16 v[32:35], v[140:143], v[60:63], v[32:35]
  ds_read_u16_d16_hi v240, v10 offset:2048
  ds_read_u16_d16_hi v241, v10 offset:2080
  v_mfma_f32_16x16x32_bf16 v[36:39], v[144:147], v[48:51], v[36:39]
  ds_read_u16_d16_hi v242, v10 offset:6656
  ds_read_u16_d16_hi v243, v10 offset:6688
  v_mfma_f32_16x16x32_bf16 v[36:39], v[148:151], v[52:55], v[36:39]
  ds_read_u16_d16_hi v244, v10 offset:11264
  ds_read_u16_d16_hi v245, v10 offset:11296
  v_mfma_f32_16x16x32_bf16 v[36:39], v[152:155], v[56:59], v[36:39]
  ds_read_u16_d16_hi v246, v10 offset:15872
  ds_read_u16_d16_hi v247, v10 offset:15904
  v_mfma_f32_16x16x32_bf16 v[36:39], v[156:159], v[60:63], v[36:39]
  s_waitcnt lgkmcnt(11)
  v_mfma_f32_16x16x32_bf16 v[36:39], v[128:131], v[64:67], v[36:39]
  s_waitcnt lgkmcnt(10)
  v_mfma_f32_16x16x32_bf16 v[36:39], v[132:135], v[68:71], v[36:39]
  s_waitcnt lgkmcnt(9)
  v_mfma_f32_16x16x32_bf16 v[36:39], v[136:139], v[72:75], v[36:39]
  s_waitcnt lgkmcnt(4)
  v_mul_f32 v240, s24, v240
  v_mul_f32 v241, s24, v241
  v_mfma_f32_16x16x32_bf16 v[36:39], v[140:143], v[76:79], v[36:39]
  v_mul_f32 v242, s25, v242
  v_mul_f32 v243, s25, v243
  v_mfma_f32_16x16x32_bf16 v[44:47], v[176:179], v[48:51], v[44:47]
  v_cvt_pk_bf16_f32 v240, v240, v241
  v_cvt_pk_bf16_f32 v242, v242, v243
  v_mfma_f32_16x16x32_bf16 v[44:47], v[180:183], v[52:55], v[44:47]
  v_and_b32 v241, 0xffff0000, v240
  v_and_b32 v243, 0xffff0000, v242
  v_mfma_f32_16x16x32_bf16 v[44:47], v[184:187], v[56:59], v[44:47]
  s_waitcnt vmcnt(2)
  v_cmp_eq_u32 vcc, -1, v124
  s_cbranch_vccnz RFc2s3
BFc2s3:
  v_mfma_f32_16x16x32_bf16 v[44:47], v[188:191], v[60:63], v[44:47]
  ds_write_b128 v11, v[124:127] offset:3072
  ds_write_b128 v8, v[32:35] offset:16640
  v_mfma_f32_16x16x32_bf16 v[40:43], v[160:163], v[48:51], v[40:43]
  ds_write_b128 v8, v[36:39] offset:20992
  v_lshlrev_b32 v240, 16, v240
  v_mfma_f32_16x16x32_bf16 v[40:43], v[164:167], v[52:55], v[40:43]
  v_lshlrev_b32 v242, 16, v242
  v_mfma_f32_16x16x32_bf16 v[40:43], v[168:171], v[56:59], v[40:43]
  v_mfma_f32_16x16x32_bf16 v[40:43], v[172:175], v[60:63], v[40:43]
  v_mfma_f32_16x16x32_bf16 v[44:47], v[160:163], v[64:67], v[44:47]
  s_waitcnt lgkmcnt(0)
  s_barrier
  ds_read_b128 v[80:83], v7 offset:3264
  v_mfma_f32_16x16x32_bf16 v[44:47], v[164:167], v[68:71], v[44:47]
  ds_read_b128 v[84:87], v7 offset:3200
  ds_read_b128 v[88:91], v7 offset:3136
  v_mfma_f32_16x16x32_bf16 v[44:47], v[168:171], v[72:75], v[44:47]
  ds_read_b128 v[92:95], v7 offset:3072
  ds_read_b128 v[96:99], v7 offset:3776
  v_mfma_f32_16x16x32_bf16 v[44:47], v[172:175], v[76:79], v[44:47]
  ds_read_b128 v[100:103], v7 offset:3712
  ds_read_b128 v[104:107], v7 offset:3648
  v_mfma_f32_16x16x32_bf16 v[40:43], v[144:147], v[64:67], v[40:43]
  ds_read_b128 v[108:111], v7 offset:3584
  ds_read2_b32 v[248:249], v9 offset0:0 offset1:68
  v_mfma_f32_16x16x32_bf16 v[40:43], v[148:151], v[68:71], v[40:43]
  ds_read2_b32 v[252:253], v9 offset0:16 offset1:84
  ds_read2_b32 v[250:251], v9 offset0:32 offset1:100
  v_mfma_f32_16x16x32_bf16 v[40:43], v[152:155], v[72:75], v[40:43]
  ds_read2_b32 v[254:255], v9 offset0:48 offset1:116
  ds_read_u16_d16_hi v224, v10 offset:3072
  v_mfma_f32_16x16x32_bf16 v[40:43], v[156:159], v[76:79], v[40:43]
  ds_read_u16_d16_hi v225, v10 offset:3104
  ds_read_u16_d16_hi v226, v10 offset:7680
  s_waitcnt lgkmcnt(14)
  v_mfma_f32_16x16x32_bf16 v[40:43], v[128:131], v[80:83], v[40:43]
  ds_read_u16_d16_hi v227, v10 offset:7712
  ds_read_u16_d16_hi v228, v10 offset:12288
  s_waitcnt lgkmcnt(15)
  v_mfma_f32_16x16x32_bf16 v[40:43], v[132:135], v[84:87], v[40:43]
  ds_read_u16_d16_hi v229, v10 offset:12320
  ds_read_u16_d16_hi v230, v10 offset:16896
  s_waitcnt lgkmcnt(15)
  v_mfma_f32_16x16x32_bf16 v[40:43], v[136:139], v[88:91], v[40:43]
  ds_read_u16_d16_hi v231, v10 offset:16928
  v_mfma_f32_16x16x32_bf16 v[40:43], v[140:143], v[92:95], v[40:43]
  v_mfma_f32_16x16x32_bf16 v[44:47], v[144:147], v[80:83], v[44:47]
  s_waitcnt lgkmcnt(8)
  v_add_f32 v248, v248, v252
  v_add_f32 v249, v249, v253
  v_mfma_f32_16x16x32_bf16 v[44:47], v[148:151], v[84:87], v[44:47]
  v_add_f32 v250, v250, v254
  v_add_f32 v251, v251, v255
  v_mfma_f32_16x16x32_bf16 v[44:47], v[152:155], v[88:91], v[44:47]
  v_cvt_pk_bf16_f32 v248, v248, v249
  v_cvt_pk_bf16_f32 v250, v250, v251
  v_mfma_f32_16x16x32_bf16 v[44:47], v[156:159], v[92:95], v[44:47]
  v_and_b32 v249, 0xffff0000, v248
  v_and_b32 v251, 0xffff0000, v250
  v_mfma_f32_16x16x32_bf16 v[44:47], v[128:131], v[96:99], v[44:47]
  v_lshlrev_b32 v248, 16, v248
  v_lshlrev_b32 v250, 16, v250
  v_mfma_f32_16x16x32_bf16 v[44:47], v[132:135], v[100:103], v[44:47]
  v_add_f32 v248, v248, v240
  v_add_f32 v249, v249, v241
  v_mfma_f32_16x16x32_bf16 v[44:47], v[136:139], v[104:107], v[44:47]
  v_add_f32 v250, v250, v242
  v_add_f32 v251, v251, v243
  v_mfma_f32_16x16x32_bf16 v[44:47], v[140:143], v[108:111], v[44:47]
  v_cvt_pk_bf16_f32 v248, v248, v249
  v_cvt_pk_bf16_f32 v250, v250, v251
  ds_write_b128 v8, v[40:43] offset:0
  s_nop 4
  ds_write_b128 v8, v[44:47] offset:4352
  v_and_b32 v249, 0xffff0000, v248
  v_and_b32 v251, 0xffff0000, v250
  v_lshlrev_b32 v248, 16, v248
  v_lshlrev_b32 v250, 16, v250
  v_add_f32 v248, v248, v244
  v_add_f32 v249, v249, v245
  v_add_f32 v250, v250, v246
  v_add_f32 v251, v251, v247
  v_cvt_pk_bf16_f32 v252, v248, v250
  v_cvt_pk_bf16_f32 v253, v249, v251
  v_min_u32 v252, -2, v252
  buffer_store_dwordx2 v[252:253], v13, s[44:47], s68 offen sc1
  s_add_u32 s68, s68, 0x81000
  s_waitcnt lgkmcnt(0)
  s_barrier
  ds_read2_b32 v[232:233], v14 offset0:0 offset1:68
  ds_read2_b32 v[236:237], v14 offset0:16 offset1:84
  ds_read2_b32 v[234:235], v14 offset0:32 offset1:100
  ds_read2_b32 v[238:239], v14 offset0:48 offset1:116
  v_mul_f32 v224, s24, v224
  v_mul_f32 v225, s24, v225
  v_mul_f32 v226, s25, v226
  v_mul_f32 v227, s25, v227
  v_cvt_pk_bf16_f32 v224, v224, v225
  v_cvt_pk_bf16_f32 v226, v226, v227
  v_and_b32 v225, 0xffff0000, v224
  v_and_b32 v227, 0xffff0000, v226
  v_lshlrev_b32 v224, 16, v224
  v_lshlrev_b32 v226, 16, v226
  s_waitcnt lgkmcnt(0)
  v_pk_add_f32 v[232:233], v[232:233], v[236:237]
  v_pk_add_f32 v[234:235], v[234:235], v[238:239]
  v_cvt_pk_bf16_f32 v232, v232, v233
  v_cvt_pk_bf16_f32 v234, v234, v235
  v_and_b32 v233, 0xffff0000, v232
  v_and_b32 v235, 0xffff0000, v234
  v_lshlrev_b32 v232, 16, v232
  v_lshlrev_b32 v234, 16, v234
  v_pk_add_f32 v[232:233], v[232:233], v[224:225]
  v_pk_add_f32 v[234:235], v[234:235], v[226:227]
  v_cvt_pk_bf16_f32 v232, v232, v233
  v_cvt_pk_bf16_f32 v234, v234, v235
  v_and_b32 v233, 0xffff0000, v232
  v_and_b32 v235, 0xffff0000, v234
  v_lshlrev_b32 v232, 16, v232
  v_lshlrev_b32 v234, 16, v234
  v_pk_add_f32 v[232:233], v[232:233], v[228:229]
  v_pk_add_f32 v[234:235], v[234:235], v[230:231]
  v_cvt_pk_bf16_f32 v236, v232, v234
  v_cvt_pk_bf16_f32 v237, v233, v235
  v_min_u32 v236, -2, v236
  buffer_store_dwordx2 v[236:237], v13, s[44:47], s68 offen sc1
  s_and_b32 s13, s6, 3
  s_lshl_b32 s13, s13, 11
  v_lshl_add_u32 v3, v2, 4, s13
  s_lshl_b32 s12, s5, 2
  s_add_u32 s12, s12, s3
  s_mul_i32 s13, s12, 33024
  s_add_u32 s13, s13, 0x210000
  s_lshr_b32 s14, s6, 2
  s_xor_b32 s14, s14, s3
  s_lshl_b32 s14, s14, 13
  s_add_u32 s16, s13, s14
  v_xor_b32 v4, 2048, v3
  v_xor_b32 v5, 4096, v3
  v_xor_b32 v6, 6144, v3
  s_xor_b32 s15, s14, 8192
  s_add_u32 s17, s13, s15
  s_xor_b32 s15, s14, 16384
  s_add_u32 s18, s13, s15
  s_xor_b32 s15, s14, 24576
  s_add_u32 s19, s13, s15
  v_lshrrev_b32 v13, 2, v2
  v_and_b32 v12, 3, v2
  v_mul_u32_u24 v13, 224, v13
  v_lshl_add_u32 v13, v12, 3, v13
  s_and_b32 s13, s6, 1
  s_lshl_b32 s14, s13, 5
  v_add_u32 v13, s14, v13
  s_mul_i32 s30, s13, -224
  s_add_u32 s30, s30, 192
  s_xor_b32 s13, s3, 0
  s_mul_i32 s13, s13, 28672
  v_add_u32 v100, s13, v13
  v_add_u32 v101, s30, v100
  s_xor_b32 s13, s3, 1
  s_mul_i32 s13, s13, 28672
  v_add_u32 v102, s13, v13
  v_add_u32 v103, s30, v102
  s_xor_b32 s13, s3, 2
  s_mul_i32 s13, s13, 28672
  v_add_u32 v104, s13, v13
  v_add_u32 v105, s30, v104
  s_xor_b32 s13, s3, 3
  s_mul_i32 s13, s13, 28672
  v_add_u32 v106, s13, v13
  v_add_u32 v107, s30, v106
  v_mov_b32 v244, 0x3f803f80
  v_mov_b32 v245, 0x3f803f80
  v_mov_b32 v246, 0x3f803f80
  v_mov_b32 v247, 0x3f803f80
  ds_read_b64_tr_b16 v[72:73], v100 offset:0
  ds_read_b64_tr_b16 v[74:75], v100 offset:3584
  ds_read_b64_tr_b16 v[76:77], v100 offset:32
  ds_read_b64_tr_b16 v[78:79], v100 offset:3616
  ds_read_b64_tr_b16 v[80:81], v100 offset:64
  ds_read_b64_tr_b16 v[82:83], v100 offset:3648
  ds_read_b64_tr_b16 v[84:85], v100 offset:96
  ds_read_b64_tr_b16 v[86:87], v100 offset:3680
  ds_read_b64_tr_b16 v[88:89], v100 offset:128
  ds_read_b64_tr_b16 v[90:91], v100 offset:3712
  ds_read_b64_tr_b16 v[92:93], v100 offset:160
  ds_read_b64_tr_b16 v[94:95], v100 offset:3744
  ds_read_b64_tr_b16 v[96:97], v101 offset:0
  ds_read_b64_tr_b16 v[98:99], v101 offset:3584
  v_accvgpr_read_b32 v44, a234
  v_accvgpr_read_b32 v45, a235
  v_accvgpr_read_b32 v46, a236
  v_accvgpr_read_b32 v47, a237
  s_add_u32 s15, s3, 1
  s_and_b32 s15, s15, 3
  s_mul_i32 s15, s15, 12288
  s_add_u32 s15, s15, 117760
  v_lshl_add_u32 v1, v2, 4, s15
  ds_write_b128 v1, v[44:47]
  v_lshrrev_b32 v1, 4, v2
  v_lshl_add_u32 v1, v1, 4, s15
  s_lshl_b32 s30, s12, 4
  s_add_u32 s30, s30, s6
  s_lshl_b32 s30, s30, 5
  s_add_u32 s30, s30, 0x18a8000
  s_lshl_b32 s31, s7, 3
  s_add_u32 s31, s31, s3
  s_lshl_b32 s31, s31, 7
  s_add_u32 s31, s31, 0x18a8000
  s_lshl_b32 s29, s12, 13
  s_add_u32 s29, s29, 0x10e0000
  s_lshl_b32 s13, s6, 9
  s_add_u32 s28, s29, s13
  v_and_b32 v7, 15, v2
  v_lshlrev_b32 v7, 4, v7
  s_mov_b32 s20, 0x22222222
  s_mov_b32 s21, 0x22222222
  s_mov_b32 s22, 0x44444444
  s_mov_b32 s23, 0x44444444
  s_mov_b32 s24, 0x88888888
  s_mov_b32 s25, 0x88888888
  s_mov_b32 s26, 0x00f0000f
  s_mov_b32 s27, 0xf0000f00
  s_lshl_b32 s12, s5, 3
  s_lshl_b32 s13, s3, 1
  s_add_u32 s12, s12, s13
  s_mul_i32 s12, s12, 57344
  s_mul_i32 s13, s6, 3584
  s_add_u32 s12, s12, s13
  s_add_u32 s12, s12, 0x11a0000
  s_mov_b32 s68, s12
  s_and_b32 s13, s6, 1
  s_lshl_b32 s14, s13, 9
  s_add_u32 s14, s14, s12
  v_lshl_add_u32 v252, v2, 4, s14
  v_add_u32 v253, 0xe000, v252
  s_cmp_eq_u32 s13, 0
  s_cselect_b32 s14, 3072, 0
  s_add_u32 s14, s14, s12
  v_add_u32 v13, s14, v7
  v_bfe_u32 v14, v2, 4, 1
  v_mul_u32_u24 v14, 0xe000, v14
  v_lshrrev_b32 v15, 5, v2
  v_lshl_add_u32 v13, v15, 8, v13
  v_add_u32 v254, v13, v14
  s_add_u32 s12, s3, 0
  s_and_b32 s12, s12, 3
  s_lshl_b32 s13, s7, 2
  s_add_u32 s12, s12, s13
  s_mul_i32 s12, s12, 57344
  s_add_u32 s12, s12, 0x11a0000
  v_lshl_add_u32 v8, v2, 4, s12
  s_add_u32 s12, s3, 1
  s_and_b32 s12, s12, 3
  s_lshl_b32 s13, s7, 2
  s_add_u32 s12, s12, s13
  s_mul_i32 s12, s12, 57344
  s_add_u32 s12, s12, 0x11a0000
  v_lshl_add_u32 v9, v2, 4, s12
  s_add_u32 s12, s3, 2
  s_and_b32 s12, s12, 3
  s_lshl_b32 s13, s7, 2
  s_add_u32 s12, s12, s13
  s_mul_i32 s12, s12, 57344
  s_add_u32 s12, s12, 0x11a0000
  v_lshl_add_u32 v10, v2, 4, s12
  s_add_u32 s12, s3, 3
  s_and_b32 s12, s12, 3
  s_lshl_b32 s13, s7, 2
  s_add_u32 s12, s12, s13
  s_mul_i32 s12, s12, 57344
  s_add_u32 s12, s12, 0x11a0000
  v_lshl_add_u32 v11, v2, 4, s12
  buffer_load_dwordx4 v[116:119], v3, s[44:47], s16 offen offset:0 sc1
  buffer_load_dwordx4 v[120:123], v3, s[44:47], s16 offen offset:1024 sc1
  buffer_load_dwordx4 v[124:127], v4, s[44:47], s16 offen offset:0 sc1
  buffer_load_dwordx4 v[128:131], v4, s[44:47], s16 offen offset:1024 sc1
  buffer_load_dwordx4 v[132:135], v5, s[44:47], s16 offen offset:0 sc1
  buffer_load_dwordx4 v[136:139], v5, s[44:47], s16 offen offset:1024 sc1
  buffer_load_dwordx4 v[140:143], v6, s[44:47], s16 offen offset:0 sc1
  buffer_load_dwordx4 v[144:147], v6, s[44:47], s16 offen offset:1024 sc1
  buffer_load_dwordx4 v[148:151], v3, s[44:47], s17 offen offset:0 sc1
  buffer_load_dwordx4 v[152:155], v3, s[44:47], s17 offen offset:1024 sc1
  buffer_load_dwordx4 v[156:159], v4, s[44:47], s17 offen offset:0 sc1
  buffer_load_dwordx4 v[160:163], v4, s[44:47], s17 offen offset:1024 sc1
  s_waitcnt vmcnt(8)
  v_max3_u32 v111, v116, v118, v120
  v_max3_u32 v111, v111, v122, v124
  v_max3_u32 v111, v111, v126, v128
  v_max_u32 v111, v111, v130
  v_cmp_eq_u32 vcc, -1, v111
  s_cbranch_vccnz RFg12x0
BFg12x0:
  v_swap_b32 v117, v120
  v_swap_b32 v119, v122
  s_nop 1
  v_mfma_f32_16x16x32_bf16 v[228:231], v[244:247], v[116:119], 0
  v_swap_b32 v125, v128
  v_swap_b32 v127, v130
  v_mfma_f32_16x16x32_bf16 v[232:235], v[116:119], v[116:119], 0
  buffer_load_dwordx4 v[164:167], v5, s[44:47], s17 offen offset:0 sc1
  buffer_load_dwordx4 v[168:171], v5, s[44:47], s17 offen offset:1024 sc1
  v_mfma_f32_16x16x32_bf16 v[236:239], v[244:247], v[120:123], 0
  s_nop 4
  v_cndmask_b32 v232, v232, v233, s[20:21]
  v_mfma_f32_16x16x32_bf16 v[240:243], v[120:123], v[120:123], 0
  v_cndmask_b32 v232, v232, v234, s[22:23]
  v_cndmask_b32 v229, v232, v235, s[24:25]
  s_waitcnt lgkmcnt(11)
  v_mfma_f32_16x16x32_bf16 v[16:19], v[72:75], v[116:119], 0
  v_mov_b32 v230, s10
  v_mov_b32 v231, s11
  s_nop 1
  v_cndmask_b32 v240, v240, v241, s[20:21]
  v_mfma_f32_16x16x32_bf16 v[20:23], v[72:75], v[120:123], 0
  v_cndmask_b32 v240, v240, v242, s[22:23]
  v_cndmask_b32 v237, v240, v243, s[24:25]
  v_mfma_f32_16x16x32_bf16 v[24:27], v[76:79], v[116:119], 0
  ds_read_b64_tr_b16 v[72:73], v100 offset:7168
  v_mov_b32 v238, s10
  v_mfma_f32_16x16x32_bf16 v[28:31], v[76:79], v[120:123], 0
  ds_read_b64_tr_b16 v[74:75], v100 offset:10752
  s_waitcnt lgkmcnt(9)
  v_mfma_f32_16x16x32_bf16 v[32:35], v[80:83], v[116:119], 0
  ds_read_b64_tr_b16 v[76:77], v100 offset:7200
  v_mov_b32 v239, s11
  v_mfma_f32_16x16x32_bf16 v[36:39], v[80:83], v[120:123], 0
  ds_read_b64_tr_b16 v[78:79], v100 offset:10784
  s_mov_b64 exec, s[26:27]
  buffer_store_dwordx4 v[228:231], v7, s[44:47], s28 offen offset:0
  buffer_store_dwordx4 v[236:239], v7, s[44:47], s28 offen offset:256
  s_mov_b64 exec, -1
  v_mfma_f32_16x16x32_bf16 v[40:43], v[84:87], v[116:119], 0
  ds_read_b64_tr_b16 v[80:81], v100 offset:7232
  v_bfe_u32 v12, v2, 4, 1
  v_mfma_f32_16x16x32_bf16 v[44:47], v[84:87], v[120:123], 0
  ds_read_b64_tr_b16 v[82:83], v100 offset:10816
  s_waitcnt lgkmcnt(9)
  v_mfma_f32_16x16x32_bf16 v[48:51], v[88:91], v[116:119], 0
  ds_read_b64_tr_b16 v[84:85], v100 offset:7264
  v_lshl_add_u32 v7, v12, 12, v7
  v_mfma_f32_16x16x32_bf16 v[52:55], v[88:91], v[120:123], 0
  ds_read_b64_tr_b16 v[86:87], v100 offset:10848
  v_lshrrev_b32 v12, 5, v2
  v_mfma_f32_16x16x32_bf16 v[56:59], v[92:95], v[116:119], 0
  ds_read_b64_tr_b16 v[88:89], v100 offset:7296
  v_lshl_add_u32 v7, v12, 8, v7
  v_mfma_f32_16x16x32_bf16 v[60:63], v[92:95], v[120:123], 0
  ds_read_b64_tr_b16 v[90:91], v100 offset:10880
  s_waitcnt lgkmcnt(11)
  v_mfma_f32_16x16x32_bf16 v[64:67], v[96:99], v[116:119], 0
  ds_read_b64_tr_b16 v[92:93], v100 offset:7328
  v_mfma_f32_16x16x32_bf16 v[68:71], v[96:99], v[120:123], 0
  ds_read_b64_tr_b16 v[94:95], v100 offset:10912
  s_waitcnt lgkmcnt(8)
  v_mfma_f32_16x16x32_bf16 v[16:19], v[72:75], v[124:127], v[16:19]
  ds_read_b64_tr_b16 v[96:97], v101 offset:7168
  s_waitcnt vmcnt(8)
  v_max3_u32 v111, v132, v134, v136
  v_mfma_f32_16x16x32_bf16 v[20:23], v[72:75], v[128:131], v[20:23]
  ds_read_b64_tr_b16 v[98:99], v101 offset:10752
  v_max3_u32 v111, v111, v138, v140
  v_max3_u32 v111, v111, v142, v144
  v_mfma_f32_16x16x32_bf16 v[24:27], v[76:79], v[124:127], v[24:27]
  ds_read_b64_tr_b16 v[72:73], v100 offset:14336
  v_max_u32 v111, v111, v146
  v_mfma_f32_16x16x32_bf16 v[28:31], v[76:79], v[128:131], v[28:31]
  ds_read_b64_tr_b16 v[74:75], v100 offset:17920
  s_waitcnt lgkmcnt(8)
  v_mfma_f32_16x16x32_bf16 v[32:35], v[80:83], v[124:127], v[32:35]
  ds_read_b64_tr_b16 v[76:77], v100 offset:14368
  v_cmp_eq_u32 vcc, -1, v111
  v_mfma_f32_16x16x32_bf16 v[36:39], v[80:83], v[128:131], v[36:39]
  ds_read_b64_tr_b16 v[78:79], v100 offset:17952
  s_cbranch_vccnz RFg12x1
BFg12x1:
  v_mfma_f32_16x16x32_bf16 v[40:43], v[84:87], v[124:127], v[40:43]
  ds_read_b64_tr_b16 v[80:81], v100 offset:14400
  v_swap_b32 v133, v136
  v_mfma_f32_16x16x32_bf16 v[44:47], v[84:87], v[128:131], v[44:47]
  ds_read_b64_tr_b16 v[82:83], v100 offset:17984
  s_waitcnt lgkmcnt(8)
  v_mfma_f32_16x16x32_bf16 v[48:51], v[88:91], v[124:127], v[48:51]
  ds_read_b64_tr_b16 v[84:85], v100 offset:14432
  v_swap_b32 v135, v138
  v_mfma_f32_16x16x32_bf16 v[52:55], v[88:91], v[128:131], v[52:55]
  ds_read_b64_tr_b16 v[86:87], v100 offset:18016
  buffer_load_dwordx4 v[172:175], v6, s[44:47], s17 offen offset:0 sc1
  v_mfma_f32_16x16x32_bf16 v[56:59], v[92:95], v[124:127], v[56:59]
  ds_read_b64_tr_b16 v[88:89], v100 offset:14464
  buffer_load_dwordx4 v[176:179], v6, s[44:47], s17 offen offset:1024 sc1
  v_mfma_f32_16x16x32_bf16 v[60:63], v[92:95], v[128:131], v[60:63]
  ds_read_b64_tr_b16 v[90:91], v100 offset:18048
  s_waitcnt lgkmcnt(10)
  v_mfma_f32_16x16x32_bf16 v[64:67], v[96:99], v[124:127], v[64:67]
  ds_read_b64_tr_b16 v[92:93], v100 offset:14496
  v_mfma_f32_16x16x32_bf16 v[68:71], v[96:99], v[128:131], v[68:71]
  ds_read_b64_tr_b16 v[94:95], v100 offset:18080
  s_waitcnt lgkmcnt(8)
  v_mfma_f32_16x16x32_bf16 v[16:19], v[72:75], v[132:135], v[16:19]
  ds_read_b64_tr_b16 v[96:97], v101 offset:14336
  v_swap_b32 v141, v144
  v_mfma_f32_16x16x32_bf16 v[20:23], v[72:75], v[136:139], v[20:23]
  ds_read_b64_tr_b16 v[98:99], v101 offset:17920
  v_swap_b32 v143, v146
  v_mfma_f32_16x16x32_bf16 v[24:27], v[76:79], v[132:135], v[24:27]
  ds_read_b64_tr_b16 v[72:73], v100 offset:21504
  buffer_load_dwordx4 v[180:183], v3, s[44:47], s18 offen offset:0 sc1
  v_mfma_f32_16x16x32_bf16 v[28:31], v[76:79], v[136:139], v[28:31]
  ds_read_b64_tr_b16 v[74:75], v100 offset:25088
  s_waitcnt lgkmcnt(8)
  v_mfma_f32_16x16x32_bf16 v[32:35], v[80:83], v[132:135], v[32:35]
  ds_read_b64_tr_b16 v[76:77], v100 offset:21536
  buffer_load_dwordx4 v[184:187], v3, s[44:47], s18 offen offset:1024 sc1
  v_mfma_f32_16x16x32_bf16 v[36:39], v[80:83], v[136:139], v[36:39]
  ds_read_b64_tr_b16 v[78:79], v100 offset:25120
  v_mfma_f32_16x16x32_bf16 v[40:43], v[84:87], v[132:135], v[40:43]
  ds_read_b64_tr_b16 v[80:81], v100 offset:21568
  v_mfma_f32_16x16x32_bf16 v[44:47], v[84:87], v[136:139], v[44:47]
  ds_read_b64_tr_b16 v[82:83], v100 offset:25152
  s_waitcnt lgkmcnt(8)
  v_mfma_f32_16x16x32_bf16 v[48:51], v[88:91], v[132:135], v[48:51]
  ds_read_b64_tr_b16 v[84:85], v100 offset:21600
  v_mfma_f32_16x16x32_bf16 v[52:55], v[88:91], v[136:139], v[52:55]
  ds_read_b64_tr_b16 v[86:87], v100 offset:25184
  v_mfma_f32_16x16x32_bf16 v[56:59], v[92:95], v[132:135], v[56:59]
  ds_read_b64_tr_b16 v[88:89], v100 offset:21632
  v_mfma_f32_16x16x32_bf16 v[60:63], v[92:95], v[136:139], v[60:63]
  ds_read_b64_tr_b16 v[90:91], v100 offset:25216
  s_waitcnt lgkmcnt(10)
  v_mfma_f32_16x16x32_bf16 v[64:67], v[96:99], v[132:135], v[64:67]
  ds_read_b64_tr_b16 v[92:93], v100 offset:21664
  v_mfma_f32_16x16x32_bf16 v[68:71], v[96:99], v[136:139], v[68:71]
  ds_read_b64_tr_b16 v[94:95], v100 offset:25248
  s_waitcnt lgkmcnt(8)
  v_mfma_f32_16x16x32_bf16 v[16:19], v[72:75], v[140:143], v[16:19]
  ds_read_b64_tr_b16 v[96:97], v101 offset:21504
  s_waitcnt vmcnt(8)
  v_max3_u32 v111, v148, v150, v152
  v_mfma_f32_16x16x32_bf16 v[20:23], v[72:75], v[144:147], v[20:23]
  ds_read_b64_tr_b16 v[98:99], v101 offset:25088
  v_max3_u32 v111, v111, v154, v156
  v_max3_u32 v111, v111, v158, v160
  v_mfma_f32_16x16x32_bf16 v[24:27], v[76:79], v[140:143], v[24:27]
  ds_read_b64_tr_b16 v[72:73], v102 offset:0
  v_max_u32 v111, v111, v162
  v_mfma_f32_16x16x32_bf16 v[28:31], v[76:79], v[144:147], v[28:31]
  ds_read_b64_tr_b16 v[74:75], v102 offset:3584
  s_waitcnt lgkmcnt(8)
  v_mfma_f32_16x16x32_bf16 v[32:35], v[80:83], v[140:143], v[32:35]
  ds_read_b64_tr_b16 v[76:77], v102 offset:32
  v_cmp_eq_u32 vcc, -1, v111
  v_mfma_f32_16x16x32_bf16 v[36:39], v[80:83], v[144:147], v[36:39]
  ds_read_b64_tr_b16 v[78:79], v102 offset:3616
  s_cbranch_vccnz RFg12x2
BFg12x2:
  v_mfma_f32_16x16x32_bf16 v[40:43], v[84:87], v[140:143], v[40:43]
  ds_read_b64_tr_b16 v[80:81], v102 offset:64
  v_swap_b32 v149, v152
  v_mfma_f32_16x16x32_bf16 v[44:47], v[84:87], v[144:147], v[44:47]
  ds_read_b64_tr_b16 v[82:83], v102 offset:3648
  s_waitcnt lgkmcnt(8)
  v_mfma_f32_16x16x32_bf16 v[48:51], v[88:91], v[140:143], v[48:51]
  ds_read_b64_tr_b16 v[84:85], v102 offset:96
  v_swap_b32 v151, v154
  v_mfma_f32_16x16x32_bf16 v[52:55], v[88:91], v[144:147], v[52:55]
  ds_read_b64_tr_b16 v[86:87], v102 offset:3680
  buffer_load_dwordx4 v[188:191], v4, s[44:47], s18 offen offset:0 sc1
  v_mfma_f32_16x16x32_bf16 v[56:59], v[92:95], v[140:143], v[56:59]
  ds_read_b64_tr_b16 v[88:89], v102 offset:128
  buffer_load_dwordx4 v[192:195], v4, s[44:47], s18 offen offset:1024 sc1
  v_mfma_f32_16x16x32_bf16 v[60:63], v[92:95], v[144:147], v[60:63]
  ds_read_b64_tr_b16 v[90:91], v102 offset:3712
  s_waitcnt lgkmcnt(10)
  v_mfma_f32_16x16x32_bf16 v[64:67], v[96:99], v[140:143], v[64:67]
  ds_read_b64_tr_b16 v[92:93], v102 offset:160
  v_mfma_f32_16x16x32_bf16 v[68:71], v[96:99], v[144:147], v[68:71]
  ds_read_b64_tr_b16 v[94:95], v102 offset:3744
  s_waitcnt lgkmcnt(8)
  v_mfma_f32_16x16x32_bf16 v[16:19], v[72:75], v[148:151], v[16:19]
  ds_read_b64_tr_b16 v[96:97], v103 offset:0
  v_swap_b32 v157, v160
  v_mfma_f32_16x16x32_bf16 v[20:23], v[72:75], v[152:155], v[20:23]
  ds_read_b64_tr_b16 v[98:99], v103 offset:3584
  v_swap_b32 v159, v162
  v_mfma_f32_16x16x32_bf16 v[24:27], v[76:79], v[148:151], v[24:27]
  ds_read_b64_tr_b16 v[72:73], v102 offset:7168
  buffer_load_dwordx4 v[196:199], v5, s[44:47], s18 offen offset:0 sc1
  v_mfma_f32_16x16x32_bf16 v[28:31], v[76:79], v[152:155], v[28:31]
  ds_read_b64_tr_b16 v[74:75], v102 offset:10752
  s_waitcnt lgkmcnt(8)
  v_mfma_f32_16x16x32_bf16 v[32:35], v[80:83], v[148:151], v[32:35]
  ds_read_b64_tr_b16 v[76:77], v102 offset:7200
  buffer_load_dwordx4 v[200:203], v5, s[44:47], s18 offen offset:1024 sc1
  v_mfma_f32_16x16x32_bf16 v[36:39], v[80:83], v[152:155], v[36:39]
  ds_read_b64_tr_b16 v[78:79], v102 offset:10784
  v_mfma_f32_16x16x32_bf16 v[40:43], v[84:87], v[148:151], v[40:43]
  ds_read_b64_tr_b16 v[80:81], v102 offset:7232
  v_mfma_f32_16x16x32_bf16 v[44:47], v[84:87], v[152:155], v[44:47]
  ds_read_b64_tr_b16 v[82:83], v102 offset:10816
  s_waitcnt lgkmcnt(8)
  v_mfma_f32_16x16x32_bf16 v[48:51], v[88:91], v[148:151], v[48:51]
  ds_read_b64_tr_b16 v[84:85], v102 offset:7264
  v_mfma_f32_16x16x32_bf16 v[52:55], v[88:91], v[152:155], v[52:55]
  ds_read_b64_tr_b16 v[86:87], v102 offset:10848
  v_mfma_f32_16x16x32_bf16 v[56:59], v[92:95], v[148:151], v[56:59]
  ds_read_b64_tr_b16 v[88:89], v102 offset:7296
  v_mfma_f32_16x16x32_bf16 v[60:63], v[92:95], v[152:155], v[60:63]
  ds_read_b64_tr_b16 v[90:91], v102 offset:10880
  s_waitcnt lgkmcnt(10)
  v_mfma_f32_16x16x32_bf16 v[64:67], v[96:99], v[148:151], v[64:67]
  ds_read_b64_tr_b16 v[92:93], v102 offset:7328
  v_mfma_f32_16x16x32_bf16 v[68:71], v[96:99], v[152:155], v[68:71]
  ds_read_b64_tr_b16 v[94:95], v102 offset:10912
  s_waitcnt lgkmcnt(8)
  v_mfma_f32_16x16x32_bf16 v[16:19], v[72:75], v[156:159], v[16:19]
  ds_read_b64_tr_b16 v[96:97], v103 offset:7168
  s_waitcnt vmcnt(6)
  v_max3_u32 v111, v164, v166, v168
  v_mfma_f32_16x16x32_bf16 v[20:23], v[72:75], v[160:163], v[20:23]
  ds_read_b64_tr_b16 v[98:99], v103 offset:10752
  v_max3_u32 v111, v111, v170, v172
  v_max3_u32 v111, v111, v174, v176
  v_mfma_f32_16x16x32_bf16 v[24:27], v[76:79], v[156:159], v[24:27]
  ds_read_b64_tr_b16 v[72:73], v102 offset:14336
  v_max_u32 v111, v111, v178
  v_mfma_f32_16x16x32_bf16 v[28:31], v[76:79], v[160:163], v[28:31]
  ds_read_b64_tr_b16 v[74:75], v102 offset:17920
  s_waitcnt lgkmcnt(8)
  v_mfma_f32_16x16x32_bf16 v[32:35], v[80:83], v[156:159], v[32:35]
  ds_read_b64_tr_b16 v[76:77], v102 offset:14368
  v_cmp_eq_u32 vcc, -1, v111
  v_mfma_f32_16x16x32_bf16 v[36:39], v[80:83], v[160:163], v[36:39]
  ds_read_b64_tr_b16 v[78:79], v102 offset:17952
  s_cbranch_vccnz RFg12x3
BFg12x3:
  v_mfma_f32_16x16x32_bf16 v[40:43], v[84:87], v[156:159], v[40:43]
  ds_read_b64_tr_b16 v[80:81], v102 offset:14400
  v_swap_b32 v165, v168
  v_mfma_f32_16x16x32_bf16 v[44:47], v[84:87], v[160:163], v[44:47]
  ds_read_b64_tr_b16 v[82:83], v102 offset:17984
  s_waitcnt lgkmcnt(8)
  v_mfma_f32_16x16x32_bf16 v[48:51], v[88:91], v[156:159], v[48:51]
  ds_read_b64_tr_b16 v[84:85], v102 offset:14432
  v_swap_b32 v167, v170
  v_mfma_f32_16x16x32_bf16 v[52:55], v[88:91], v[160:163], v[52:55]
  ds_read_b64_tr_b16 v[86:87], v102 offset:18016
  buffer_load_dwordx4 v[204:207], v6, s[44:47], s18 offen offset:0 sc1
  v_mfma_f32_16x16x32_bf16 v[56:59], v[92:95], v[156:159], v[56:59]
  ds_read_b64_tr_b16 v[88:89], v102 offset:14464
  buffer_load_dwordx4 v[208:211], v6, s[44:47], s18 offen offset:1024 sc1
  v_mfma_f32_16x16x32_bf16 v[60:63], v[92:95], v[160:163], v[60:63]
  ds_read_b64_tr_b16 v[90:91], v102 offset:18048
  s_waitcnt lgkmcnt(10)
  v_mfma_f32_16x16x32_bf16 v[64:67], v[96:99], v[156:159], v[64:67]
  ds_read_b64_tr_b16 v[92:93], v102 offset:14496
  v_mfma_f32_16x16x32_bf16 v[68:71], v[96:99], v[160:163], v[68:71]
  ds_read_b64_tr_b16 v[94:95], v102 offset:18080
  s_waitcnt lgkmcnt(8)
  v_mfma_f32_16x16x32_bf16 v[16:19], v[72:75], v[164:167], v[16:19]
  ds_read_b64_tr_b16 v[96:97], v103 offset:14336
  v_swap_b32 v173, v176
  v_mfma_f32_16x16x32_bf16 v[20:23], v[72:75], v[168:171], v[20:23]
  ds_read_b64_tr_b16 v[98:99], v103 offset:17920
  v_swap_b32 v175, v178
  v_mfma_f32_16x16x32_bf16 v[24:27], v[76:79], v[164:167], v[24:27]
  ds_read_b64_tr_b16 v[72:73], v102 offset:21504
  buffer_load_dwordx4 v[212:215], v3, s[44:47], s19 offen offset:0 sc1
  v_mfma_f32_16x16x32_bf16 v[28:31], v[76:79], v[168:171], v[28:31]
  ds_read_b64_tr_b16 v[74:75], v102 offset:25088
  s_waitcnt lgkmcnt(8)
  v_mfma_f32_16x16x32_bf16 v[32:35], v[80:83], v[164:167], v[32:35]
  ds_read_b64_tr_b16 v[76:77], v102 offset:21536
  buffer_load_dwordx4 v[216:219], v3, s[44:47], s19 offen offset:1024 sc1
  v_mfma_f32_16x16x32_bf16 v[36:39], v[80:83], v[168:171], v[36:39]
  ds_read_b64_tr_b16 v[78:79], v102 offset:25120
  v_mfma_f32_16x16x32_bf16 v[40:43], v[84:87], v[164:167], v[40:43]
  ds_read_b64_tr_b16 v[80:81], v102 offset:21568
  v_mfma_f32_16x16x32_bf16 v[44:47], v[84:87], v[168:171], v[44:47]
  ds_read_b64_tr_b16 v[82:83], v102 offset:25152
  s_waitcnt lgkmcnt(8)
  v_mfma_f32_16x16x32_bf16 v[48:51], v[88:91], v[164:167], v[48:51]
  ds_read_b64_tr_b16 v[84:85], v102 offset:21600
  v_mfma_f32_16x16x32_bf16 v[52:55], v[88:91], v[168:171], v[52:55]
  ds_read_b64_tr_b16 v[86:87], v102 offset:25184
  v_mfma_f32_16x16x32_bf16 v[56:59], v[92:95], v[164:167], v[56:59]
  ds_read_b64_tr_b16 v[88:89], v102 offset:21632
  v_mfma_f32_16x16x32_bf16 v[60:63], v[92:95], v[168:171], v[60:63]
  ds_read_b64_tr_b16 v[90:91], v102 offset:25216
  s_waitcnt lgkmcnt(10)
  v_mfma_f32_16x16x32_bf16 v[64:67], v[96:99], v[164:167], v[64:67]
  ds_read_b64_tr_b16 v[92:93], v102 offset:21664
  v_mfma_f32_16x16x32_bf16 v[68:71], v[96:99], v[168:171], v[68:71]
  ds_read_b64_tr_b16 v[94:95], v102 offset:25248
  s_waitcnt lgkmcnt(8)
  v_mfma_f32_16x16x32_bf16 v[16:19], v[72:75], v[172:175], v[16:19]
  ds_read_b64_tr_b16 v[96:97], v103 offset:21504
  s_waitcnt vmcnt(6)
  v_max3_u32 v111, v180, v182, v184
  v_mfma_f32_16x16x32_bf16 v[20:23], v[72:75], v[176:179], v[20:23]
  ds_read_b64_tr_b16 v[98:99], v103 offset:25088
  v_max3_u32 v111, v111, v186, v188
  v_max3_u32 v111, v111, v190, v192
  v_mfma_f32_16x16x32_bf16 v[24:27], v[76:79], v[172:175], v[24:27]
  ds_read_b64_tr_b16 v[72:73], v104 offset:0
  v_max_u32 v111, v111, v194
  v_mfma_f32_16x16x32_bf16 v[28:31], v[76:79], v[176:179], v[28:31]
  ds_read_b64_tr_b16 v[74:75], v104 offset:3584
  s_waitcnt lgkmcnt(8)
  v_mfma_f32_16x16x32_bf16 v[32:35], v[80:83], v[172:175], v[32:35]
  ds_read_b64_tr_b16 v[76:77], v104 offset:32
  v_cmp_eq_u32 vcc, -1, v111
  v_mfma_f32_16x16x32_bf16 v[36:39], v[80:83], v[176:179], v[36:39]
  ds_read_b64_tr_b16 v[78:79], v104 offset:3616
  s_cbranch_vccnz RFg12x4
BFg12x4:
  v_mfma_f32_16x16x32_bf16 v[40:43], v[84:87], v[172:175], v[40:43]
  ds_read_b64_tr_b16 v[80:81], v104 offset:64
  v_swap_b32 v181, v184
  v_mfma_f32_16x16x32_bf16 v[44:47], v[84:87], v[176:179], v[44:47]
  ds_read_b64_tr_b16 v[82:83], v104 offset:3648
  s_waitcnt lgkmcnt(8)
  v_mfma_f32_16x16x32_bf16 v[48:51], v[88:91], v[172:175], v[48:51]
  ds_read_b64_tr_b16 v[84:85], v104 offset:96
  v_swap_b32 v183, v186
  v_mfma_f32_16x16x32_bf16 v[52:55], v[88:91], v[176:179], v[52:55]
  ds_read_b64_tr_b16 v[86:87], v104 offset:3680
  buffer_load_dwordx4 v[220:223], v4, s[44:47], s19 offen offset:0 sc1
  v_mfma_f32_16x16x32_bf16 v[56:59], v[92:95], v[172:175], v[56:59]
  ds_read_b64_tr_b16 v[88:89], v104 offset:128
  buffer_load_dwordx4 v[224:227], v4, s[44:47], s19 offen offset:1024 sc1
  v_mfma_f32_16x16x32_bf16 v[60:63], v[92:95], v[176:179], v[60:63]
  ds_read_b64_tr_b16 v[90:91], v104 offset:3712
  s_waitcnt lgkmcnt(10)
  v_mfma_f32_16x16x32_bf16 v[64:67], v[96:99], v[172:175], v[64:67]
  ds_read_b64_tr_b16 v[92:93], v104 offset:160
  v_mfma_f32_16x16x32_bf16 v[68:71], v[96:99], v[176:179], v[68:71]
  ds_read_b64_tr_b16 v[94:95], v104 offset:3744
  s_waitcnt lgkmcnt(8)
  v_mfma_f32_16x16x32_bf16 v[16:19], v[72:75], v[180:183], v[16:19]
  ds_read_b64_tr_b16 v[96:97], v105 offset:0
  v_swap_b32 v189, v192
  v_mfma_f32_16x16x32_bf16 v[20:23], v[72:75], v[184:187], v[20:23]
  ds_read_b64_tr_b16 v[98:99], v105 offset:3584
  v_swap_b32 v191, v194
  v_mfma_f32_16x16x32_bf16 v[24:27], v[76:79], v[180:183], v[24:27]
  ds_read_b64_tr_b16 v[72:73], v104 offset:7168
  buffer_load_dwordx4 v[228:231], v5, s[44:47], s19 offen offset:0 sc1
  v_mfma_f32_16x16x32_bf16 v[28:31], v[76:79], v[184:187], v[28:31]
  ds_read_b64_tr_b16 v[74:75], v104 offset:10752
  s_waitcnt lgkmcnt(8)
  v_mfma_f32_16x16x32_bf16 v[32:35], v[80:83], v[180:183], v[32:35]
  ds_read_b64_tr_b16 v[76:77], v104 offset:7200
  buffer_load_dwordx4 v[232:235], v5, s[44:47], s19 offen offset:1024 sc1
  v_mfma_f32_16x16x32_bf16 v[36:39], v[80:83], v[184:187], v[36:39]
  ds_read_b64_tr_b16 v[78:79], v104 offset:10784
  v_mfma_f32_16x16x32_bf16 v[40:43], v[84:87], v[180:183], v[40:43]
  ds_read_b64_tr_b16 v[80:81], v104 offset:7232
  v_mfma_f32_16x16x32_bf16 v[44:47], v[84:87], v[184:187], v[44:47]
  ds_read_b64_tr_b16 v[82:83], v104 offset:10816
  s_waitcnt lgkmcnt(8)
  v_mfma_f32_16x16x32_bf16 v[48:51], v[88:91], v[180:183], v[48:51]
  ds_read_b64_tr_b16 v[84:85], v104 offset:7264
  v_mfma_f32_16x16x32_bf16 v[52:55], v[88:91], v[184:187], v[52:55]
  ds_read_b64_tr_b16 v[86:87], v104 offset:10848
  v_mfma_f32_16x16x32_bf16 v[56:59], v[92:95], v[180:183], v[56:59]
  ds_read_b64_tr_b16 v[88:89], v104 offset:7296
  v_mfma_f32_16x16x32_bf16 v[60:63], v[92:95], v[184:187], v[60:63]
  ds_read_b64_tr_b16 v[90:91], v104 offset:10880
  s_waitcnt lgkmcnt(10)
  v_mfma_f32_16x16x32_bf16 v[64:67], v[96:99], v[180:183], v[64:67]
  ds_read_b64_tr_b16 v[92:93], v104 offset:7328
  v_mfma_f32_16x16x32_bf16 v[68:71], v[96:99], v[184:187], v[68:71]
  ds_read_b64_tr_b16 v[94:95], v104 offset:10912
  s_waitcnt lgkmcnt(8)
  v_mfma_f32_16x16x32_bf16 v[16:19], v[72:75], v[188:191], v[16:19]
  ds_read_b64_tr_b16 v[96:97], v105 offset:7168
  s_waitcnt vmcnt(6)
  v_max3_u32 v111, v196, v198, v200
  v_mfma_f32_16x16x32_bf16 v[20:23], v[72:75], v[192:195], v[20:23]
  ds_read_b64_tr_b16 v[98:99], v105 offset:10752
  v_max3_u32 v111, v111, v202, v204
  v_max3_u32 v111, v111, v206, v208
  v_mfma_f32_16x16x32_bf16 v[24:27], v[76:79], v[188:191], v[24:27]
  ds_read_b64_tr_b16 v[72:73], v104 offset:14336
  v_max_u32 v111, v111, v210
  v_mfma_f32_16x16x32_bf16 v[28:31], v[76:79], v[192:195], v[28:31]
  ds_read_b64_tr_b16 v[74:75], v104 offset:17920
  s_waitcnt lgkmcnt(8)
  v_mfma_f32_16x16x32_bf16 v[32:35], v[80:83], v[188:191], v[32:35]
  ds_read_b64_tr_b16 v[76:77], v104 offset:14368
  v_cmp_eq_u32 vcc, -1, v111
  v_mfma_f32_16x16x32_bf16 v[36:39], v[80:83], v[192:195], v[36:39]
  ds_read_b64_tr_b16 v[78:79], v104 offset:17952
  s_cbranch_vccnz RFg12x5
BFg12x5:
  v_mfma_f32_16x16x32_bf16 v[40:43], v[84:87], v[188:191], v[40:43]
  ds_read_b64_tr_b16 v[80:81], v104 offset:14400
  v_swap_b32 v197, v200
  v_mfma_f32_16x16x32_bf16 v[44:47], v[84:87], v[192:195], v[44:47]
  ds_read_b64_tr_b16 v[82:83], v104 offset:17984
  s_waitcnt lgkmcnt(8)
  v_mfma_f32_16x16x32_bf16 v[48:51], v[88:91], v[188:191], v[48:51]
  ds_read_b64_tr_b16 v[84:85], v104 offset:14432
  v_swap_b32 v199, v202
  v_mfma_f32_16x16x32_bf16 v[52:55], v[88:91], v[192:195], v[52:55]
  ds_read_b64_tr_b16 v[86:87], v104 offset:18016
  buffer_load_dwordx4 v[236:239], v6, s[44:47], s19 offen offset:0 sc1
  v_mfma_f32_16x16x32_bf16 v[56:59], v[92:95], v[188:191], v[56:59]
  ds_read_b64_tr_b16 v[88:89], v104 offset:14464
  buffer_load_dwordx4 v[240:243], v6, s[44:47], s19 offen offset:1024 sc1
  v_mfma_f32_16x16x32_bf16 v[60:63], v[92:95], v[192:195], v[60:63]
  ds_read_b64_tr_b16 v[90:91], v104 offset:18048
  s_waitcnt lgkmcnt(10)
  v_mfma_f32_16x16x32_bf16 v[64:67], v[96:99], v[188:191], v[64:67]
  ds_read_b64_tr_b16 v[92:93], v104 offset:14496
  v_mfma_f32_16x16x32_bf16 v[68:71], v[96:99], v[192:195], v[68:71]
  ds_read_b64_tr_b16 v[94:95], v104 offset:18080
  s_waitcnt lgkmcnt(8)
  v_mfma_f32_16x16x32_bf16 v[16:19], v[72:75], v[196:199], v[16:19]
  ds_read_b64_tr_b16 v[96:97], v105 offset:14336
  v_swap_b32 v205, v208
  v_mfma_f32_16x16x32_bf16 v[20:23], v[72:75], v[200:203], v[20:23]
  ds_read_b64_tr_b16 v[98:99], v105 offset:17920
  v_swap_b32 v207, v210
  v_mfma_f32_16x16x32_bf16 v[24:27], v[76:79], v[196:199], v[24:27]
  ds_read_b64_tr_b16 v[72:73], v104 offset:21504
  buffer_load_dwordx4 v[116:119], v7, s[44:47], s29 offen offset:0 sc1
  v_mfma_f32_16x16x32_bf16 v[28:31], v[76:79], v[200:203], v[28:31]
  ds_read_b64_tr_b16 v[74:75], v104 offset:25088
  s_waitcnt lgkmcnt(8)
  v_mfma_f32_16x16x32_bf16 v[32:35], v[80:83], v[196:199], v[32:35]
  ds_read_b64_tr_b16 v[76:77], v104 offset:21536
  buffer_load_dwordx4 v[120:123], v7, s[44:47], s29 offen offset:512 sc1
  v_mfma_f32_16x16x32_bf16 v[36:39], v[80:83], v[200:203], v[36:39]
  ds_read_b64_tr_b16 v[78:79], v104 offset:25120
  buffer_load_dwordx4 v[124:127], v7, s[44:47], s29 offen offset:1024 sc1
  v_mfma_f32_16x16x32_bf16 v[40:43], v[84:87], v[196:199], v[40:43]
  ds_read_b64_tr_b16 v[80:81], v104 offset:21568
  buffer_load_dwordx4 v[128:131], v7, s[44:47], s29 offen offset:1536 sc1
  v_mfma_f32_16x16x32_bf16 v[44:47], v[84:87], v[200:203], v[44:47]
  ds_read_b64_tr_b16 v[82:83], v104 offset:25152
  s_waitcnt lgkmcnt(8)
  v_mfma_f32_16x16x32_bf16 v[48:51], v[88:91], v[196:199], v[48:51]
  ds_read_b64_tr_b16 v[84:85], v104 offset:21600
  buffer_load_dwordx4 v[132:135], v7, s[44:47], s29 offen offset:2048 sc1
  v_mfma_f32_16x16x32_bf16 v[52:55], v[88:91], v[200:203], v[52:55]
  ds_read_b64_tr_b16 v[86:87], v104 offset:25184
  buffer_load_dwordx4 v[136:139], v7, s[44:47], s29 offen offset:2560 sc1
  v_mfma_f32_16x16x32_bf16 v[56:59], v[92:95], v[196:199], v[56:59]
  ds_read_b64_tr_b16 v[88:89], v104 offset:21632
  buffer_load_dwordx4 v[140:143], v7, s[44:47], s29 offen offset:3072 sc1
  v_mfma_f32_16x16x32_bf16 v[60:63], v[92:95], v[200:203], v[60:63]
  ds_read_b64_tr_b16 v[90:91], v104 offset:25216
  s_waitcnt lgkmcnt(10)
  v_mfma_f32_16x16x32_bf16 v[64:67], v[96:99], v[196:199], v[64:67]
  ds_read_b64_tr_b16 v[92:93], v104 offset:21664
  buffer_load_dwordx4 v[144:147], v7, s[44:47], s29 offen offset:3584 sc1
  v_mfma_f32_16x16x32_bf16 v[68:71], v[96:99], v[200:203], v[68:71]
  ds_read_b64_tr_b16 v[94:95], v104 offset:25248
  s_waitcnt lgkmcnt(8)
  v_mfma_f32_16x16x32_bf16 v[16:19], v[72:75], v[204:207], v[16:19]
  ds_read_b64_tr_b16 v[96:97], v105 offset:21504
  s_waitcnt vmcnt(12)
  v_max3_u32 v111, v212, v214, v216
  v_mfma_f32_16x16x32_bf16 v[20:23], v[72:75], v[208:211], v[20:23]
  ds_read_b64_tr_b16 v[98:99], v105 offset:25088
  v_max3_u32 v111, v111, v218, v220
  v_mfma_f32_16x16x32_bf16 v[24:27], v[76:79], v[204:207], v[24:27]
  ds_read_b64_tr_b16 v[72:73], v106 offset:0
  v_max3_u32 v111, v111, v222, v224
  v_mfma_f32_16x16x32_bf16 v[28:31], v[76:79], v[208:211], v[28:31]
  ds_read_b64_tr_b16 v[74:75], v106 offset:3584
  s_waitcnt lgkmcnt(8)
  v_mfma_f32_16x16x32_bf16 v[32:35], v[80:83], v[204:207], v[32:35]
  ds_read_b64_tr_b16 v[76:77], v106 offset:32
  v_max_u32 v111, v111, v226
  v_mfma_f32_16x16x32_bf16 v[36:39], v[80:83], v[208:211], v[36:39]
  ds_read_b64_tr_b16 v[78:79], v106 offset:3616
  v_cmp_eq_u32 vcc, -1, v111
  v_mfma_f32_16x16x32_bf16 v[40:43], v[84:87], v[204:207], v[40:43]
  ds_read_b64_tr_b16 v[80:81], v106 offset:64
  s_cbranch_vccnz RFg12x6
BFg12x6:
  v_mfma_f32_16x16x32_bf16 v[44:47], v[84:87], v[208:211], v[44:47]
  ds_read_b64_tr_b16 v[82:83], v106 offset:3648
  s_waitcnt lgkmcnt(8)
  v_mfma_f32_16x16x32_bf16 v[48:51], v[88:91], v[204:207], v[48:51]
  ds_read_b64_tr_b16 v[84:85], v106 offset:96
  v_swap_b32 v213, v216
  v_mfma_f32_16x16x32_bf16 v[52:55], v[88:91], v[208:211], v[52:55]
  ds_read_b64_tr_b16 v[86:87], v106 offset:3680
  v_swap_b32 v215, v218
  v_mfma_f32_16x16x32_bf16 v[56:59], v[92:95], v[204:207], v[56:59]
  ds_read_b64_tr_b16 v[88:89], v106 offset:128
  v_mfma_f32_16x16x32_bf16 v[60:63], v[92:95], v[208:211], v[60:63]
  ds_read_b64_tr_b16 v[90:91], v106 offset:3712
  s_waitcnt lgkmcnt(10)
  v_mfma_f32_16x16x32_bf16 v[64:67], v[96:99], v[204:207], v[64:67]
  ds_read_b64_tr_b16 v[92:93], v106 offset:160
  v_mfma_f32_16x16x32_bf16 v[68:71], v[96:99], v[208:211], v[68:71]
  ds_read_b64_tr_b16 v[94:95], v106 offset:3744
  s_waitcnt lgkmcnt(8)
  v_mfma_f32_16x16x32_bf16 v[16:19], v[72:75], v[212:215], v[16:19]
  ds_read_b64_tr_b16 v[96:97], v107 offset:0
  v_swap_b32 v221, v224
  v_mfma_f32_16x16x32_bf16 v[20:23], v[72:75], v[216:219], v[20:23]
  ds_read_b64_tr_b16 v[98:99], v107 offset:3584
  v_swap_b32 v223, v226
  v_mfma_f32_16x16x32_bf16 v[24:27], v[76:79], v[212:215], v[24:27]
  ds_read_b64_tr_b16 v[72:73], v106 offset:7168
  v_mfma_f32_16x16x32_bf16 v[28:31], v[76:79], v[216:219], v[28:31]
  ds_read_b64_tr_b16 v[74:75], v106 offset:10752
  s_waitcnt lgkmcnt(8)
  v_mfma_f32_16x16x32_bf16 v[32:35], v[80:83], v[212:215], v[32:35]
  ds_read_b64_tr_b16 v[76:77], v106 offset:7200
  v_mfma_f32_16x16x32_bf16 v[36:39], v[80:83], v[216:219], v[36:39]
  ds_read_b64_tr_b16 v[78:79], v106 offset:10784
  v_mfma_f32_16x16x32_bf16 v[40:43], v[84:87], v[212:215], v[40:43]
  ds_read_b64_tr_b16 v[80:81], v106 offset:7232
  v_mfma_f32_16x16x32_bf16 v[44:47], v[84:87], v[216:219], v[44:47]
  ds_read_b64_tr_b16 v[82:83], v106 offset:10816
  s_waitcnt lgkmcnt(8)
  v_mfma_f32_16x16x32_bf16 v[48:51], v[88:91], v[212:215], v[48:51]
  ds_read_b64_tr_b16 v[84:85], v106 offset:7264
  v_mfma_f32_16x16x32_bf16 v[52:55], v[88:91], v[216:219], v[52:55]
  ds_read_b64_tr_b16 v[86:87], v106 offset:10848
  v_mfma_f32_16x16x32_bf16 v[56:59], v[92:95], v[212:215], v[56:59]
  ds_read_b64_tr_b16 v[88:89], v106 offset:7296
  v_mfma_f32_16x16x32_bf16 v[60:63], v[92:95], v[216:219], v[60:63]
  ds_read_b64_tr_b16 v[90:91], v106 offset:10880
  s_waitcnt lgkmcnt(10)
  v_mfma_f32_16x16x32_bf16 v[64:67], v[96:99], v[212:215], v[64:67]
  ds_read_b64_tr_b16 v[92:93], v106 offset:7328
  v_mfma_f32_16x16x32_bf16 v[68:71], v[96:99], v[216:219], v[68:71]
  ds_read_b64_tr_b16 v[94:95], v106 offset:10912
  s_waitcnt lgkmcnt(8)
  v_mfma_f32_16x16x32_bf16 v[16:19], v[72:75], v[220:223], v[16:19]
  ds_read_b64_tr_b16 v[96:97], v107 offset:7168
  s_waitcnt vmcnt(8)
  v_max3_u32 v111, v228, v230, v232
  v_mfma_f32_16x16x32_bf16 v[20:23], v[72:75], v[224:227], v[20:23]
  ds_read_b64_tr_b16 v[98:99], v107 offset:10752
  v_max3_u32 v111, v111, v234, v236
  v_mfma_f32_16x16x32_bf16 v[24:27], v[76:79], v[220:223], v[24:27]
  ds_read_b64_tr_b16 v[72:73], v106 offset:14336
  v_max3_u32 v111, v111, v238, v240
  v_mfma_f32_16x16x32_bf16 v[28:31], v[76:79], v[224:227], v[28:31]
  ds_read_b64_tr_b16 v[74:75], v106 offset:17920
  s_waitcnt lgkmcnt(8)
  v_mfma_f32_16x16x32_bf16 v[32:35], v[80:83], v[220:223], v[32:35]
  ds_read_b64_tr_b16 v[76:77], v106 offset:14368
  v_max_u32 v111, v111, v242
  v_mfma_f32_16x16x32_bf16 v[36:39], v[80:83], v[224:227], v[36:39]
  ds_read_b64_tr_b16 v[78:79], v106 offset:17952
  v_cmp_eq_u32 vcc, -1, v111
  v_mfma_f32_16x16x32_bf16 v[40:43], v[84:87], v[220:223], v[40:43]
  ds_read_b64_tr_b16 v[80:81], v106 offset:14400
  s_cbranch_vccnz RFg12x7
BFg12x7:
  v_mfma_f32_16x16x32_bf16 v[44:47], v[84:87], v[224:227], v[44:47]
  ds_read_b64_tr_b16 v[82:83], v106 offset:17984
  s_waitcnt lgkmcnt(8)
  v_mfma_f32_16x16x32_bf16 v[48:51], v[88:91], v[220:223], v[48:51]
  ds_read_b64_tr_b16 v[84:85], v106 offset:14432
  v_swap_b32 v229, v232
  v_mfma_f32_16x16x32_bf16 v[52:55], v[88:91], v[224:227], v[52:55]
  ds_read_b64_tr_b16 v[86:87], v106 offset:18016
  v_swap_b32 v231, v234
  v_mfma_f32_16x16x32_bf16 v[56:59], v[92:95], v[220:223], v[56:59]
  ds_read_b64_tr_b16 v[88:89], v106 offset:14464
  v_mfma_f32_16x16x32_bf16 v[60:63], v[92:95], v[224:227], v[60:63]
  ds_read_b64_tr_b16 v[90:91], v106 offset:18048
  s_waitcnt lgkmcnt(10)
  v_mfma_f32_16x16x32_bf16 v[64:67], v[96:99], v[220:223], v[64:67]
  ds_read_b64_tr_b16 v[92:93], v106 offset:14496
  v_mfma_f32_16x16x32_bf16 v[68:71], v[96:99], v[224:227], v[68:71]
  ds_read_b64_tr_b16 v[94:95], v106 offset:18080
  s_waitcnt lgkmcnt(8)
  v_mfma_f32_16x16x32_bf16 v[16:19], v[72:75], v[228:231], v[16:19]
  ds_read_b64_tr_b16 v[96:97], v107 offset:14336
  v_swap_b32 v237, v240
  v_mfma_f32_16x16x32_bf16 v[20:23], v[72:75], v[232:235], v[20:23]
  ds_read_b64_tr_b16 v[98:99], v107 offset:17920
  v_swap_b32 v239, v242
  v_mfma_f32_16x16x32_bf16 v[24:27], v[76:79], v[228:231], v[24:27]
  ds_read_b64_tr_b16 v[72:73], v106 offset:21504
  v_mov_b32 v4, s10
  v_mfma_f32_16x16x32_bf16 v[28:31], v[76:79], v[232:235], v[28:31]
  ds_read_b64_tr_b16 v[74:75], v106 offset:25088
  s_waitcnt lgkmcnt(8)
  v_mfma_f32_16x16x32_bf16 v[32:35], v[80:83], v[228:231], v[32:35]
  ds_read_b64_tr_b16 v[76:77], v106 offset:21536
  v_mov_b32 v5, s11
  v_mfma_f32_16x16x32_bf16 v[36:39], v[80:83], v[232:235], v[36:39]
  ds_read_b64_tr_b16 v[78:79], v106 offset:25120
  v_lshlrev_b32 v6, 26, v2
  v_mfma_f32_16x16x32_bf16 v[40:43], v[84:87], v[228:231], v[40:43]
  ds_read_b64_tr_b16 v[80:81], v106 offset:21568
  v_and_b32 v3, 15, v2
  v_mfma_f32_16x16x32_bf16 v[44:47], v[84:87], v[232:235], v[44:47]
  ds_read_b64_tr_b16 v[82:83], v106 offset:25152
  s_waitcnt lgkmcnt(8)
  v_mfma_f32_16x16x32_bf16 v[48:51], v[88:91], v[228:231], v[48:51]
  ds_read_b64_tr_b16 v[84:85], v106 offset:21600
  v_bfe_u32 v111, v2, 4, 1
  v_mfma_f32_16x16x32_bf16 v[52:55], v[88:91], v[232:235], v[52:55]
  ds_read_b64_tr_b16 v[86:87], v106 offset:25184
  v_lshlrev_b32 v3, 3, v3
  v_mfma_f32_16x16x32_bf16 v[56:59], v[92:95], v[228:231], v[56:59]
  ds_read_b64_tr_b16 v[88:89], v106 offset:21632
  v_lshl_add_u32 v3, v111, 9, v3
  v_mfma_f32_16x16x32_bf16 v[60:63], v[92:95], v[232:235], v[60:63]
  ds_read_b64_tr_b16 v[90:91], v106 offset:25216
  s_waitcnt lgkmcnt(10)
  v_mfma_f32_16x16x32_bf16 v[64:67], v[96:99], v[228:231], v[64:67]
  ds_read_b64_tr_b16 v[92:93], v106 offset:21664
  buffer_load_dwordx2 v[108:109], v3, s[44:47], s31 offen sc1
  v_mfma_f32_16x16x32_bf16 v[68:71], v[96:99], v[232:235], v[68:71]
  ds_read_b64_tr_b16 v[94:95], v106 offset:25248
  s_waitcnt lgkmcnt(8)
  v_mfma_f32_16x16x32_bf16 v[16:19], v[72:75], v[236:239], v[16:19]
  ds_read_b64_tr_b16 v[96:97], v107 offset:21504
  s_waitcnt vmcnt(1)
  v_cmp_ne_u64 s[24:25], s[10:11], v[118:119]
  v_mfma_f32_16x16x32_bf16 v[20:23], v[72:75], v[240:243], v[20:23]
  ds_read_b64_tr_b16 v[98:99], v107 offset:25088
  v_cmp_ne_u64 s[22:23], s[10:11], v[122:123]
  v_mfma_f32_16x16x32_bf16 v[24:27], v[76:79], v[236:239], v[24:27]
  ds_read_b128 v[148:151], v1 offset:0
  v_cmp_ne_u64 s[20:21], s[10:11], v[126:127]
  v_mfma_f32_16x16x32_bf16 v[28:31], v[76:79], v[240:243], v[28:31]
  ds_read_b128 v[176:179], v1 offset:448
  s_waitcnt lgkmcnt(8)
  v_mfma_f32_16x16x32_bf16 v[32:35], v[80:83], v[236:239], v[32:35]
  ds_read_b128 v[152:155], v1 offset:64
  s_or_b64 s[24:25], s[24:25], s[22:23]
  v_mfma_f32_16x16x32_bf16 v[36:39], v[80:83], v[240:243], v[36:39]
  ds_read_b128 v[180:183], v1 offset:512
  v_cmp_ne_u64 s[22:23], s[10:11], v[130:131]
  v_mfma_f32_16x16x32_bf16 v[40:43], v[84:87], v[236:239], v[40:43]
  ds_read_b128 v[156:159], v1 offset:128
  s_or_b64 s[24:25], s[24:25], s[20:21]
  v_mfma_f32_16x16x32_bf16 v[44:47], v[84:87], v[240:243], v[44:47]
  ds_read_b128 v[184:187], v1 offset:576
  s_waitcnt lgkmcnt(8)
  v_mfma_f32_16x16x32_bf16 v[48:51], v[88:91], v[236:239], v[48:51]
  ds_read_b128 v[160:163], v1 offset:192
  v_cmp_ne_u64 s[20:21], s[10:11], v[134:135]
  v_mfma_f32_16x16x32_bf16 v[52:55], v[88:91], v[240:243], v[52:55]
  ds_read_b128 v[188:191], v1 offset:640
  s_or_b64 s[24:25], s[24:25], s[22:23]
  v_mfma_f32_16x16x32_bf16 v[56:59], v[92:95], v[236:239], v[56:59]
  ds_read_b128 v[164:167], v1 offset:256
  v_cmp_ne_u64 s[22:23], s[10:11], v[138:139]
  v_mfma_f32_16x16x32_bf16 v[60:63], v[92:95], v[240:243], v[60:63]
  ds_read_b128 v[192:195], v1 offset:704
  s_waitcnt lgkmcnt(10)
  v_mfma_f32_16x16x32_bf16 v[64:67], v[96:99], v[236:239], v[64:67]
  ds_read_b128 v[168:171], v1 offset:320
  s_or_b64 s[24:25], s[24:25], s[20:21]
  v_mfma_f32_16x16x32_bf16 v[68:71], v[96:99], v[240:243], v[68:71]
  ds_read_b128 v[196:199], v1 offset:768
  ds_read_b128 v[172:175], v1 offset:384
  ds_read_b128 v[200:203], v1 offset:832
  v_cmp_ne_u64 s[20:21], s[10:11], v[142:143]
  s_or_b64 s[24:25], s[24:25], s[22:23]
  v_cmp_ne_u64 s[22:23], s[10:11], v[146:147]
  s_or_b64 s[24:25], s[24:25], s[20:21]
  s_or_b64 vcc, s[24:25], s[22:23]
  s_cbranch_vccnz RFg12p
BFg12p:
  v_add_f32 v116, v116, v120
  v_add_f32 v117, v117, v121
  v_add_f32 v124, v124, v128
  v_add_f32 v125, v125, v129
  v_add_f32 v132, v132, v136
  v_add_f32 v133, v133, v137
  v_add_f32 v140, v140, v144
  v_add_f32 v141, v141, v145
  v_add_f32 v116, v116, v124
  v_add_f32 v117, v117, v125
  v_add_f32 v132, v132, v140
  v_add_f32 v133, v133, v141
  v_add_f32 v116, v116, v132
  v_add_f32 v117, v117, v133
  v_mov_b32 v120, v116
  v_mov_b32 v121, v117
  s_nop 0
  v_permlane16_swap_b32 v116, v120
  v_permlane16_swap_b32 v117, v121
  v_add_f32 v116, v116, v120
  v_add_f32 v117, v117, v121
  v_mul_f32 v116, 0x3b000000, v116
  v_mul_f32 v117, 0x3b000000, v117
  v_fma_f32 v117, -v116, v116, v117
  v_max_f32 v117, 0, v117
  v_cvt_pk_bf16_f32 v119, 0, v117
  v_add_f32 v119, 0x3727c5ac, v119
  v_cvt_pk_bf16_f32 v119, 0, v119
  v_sqrt_f32 v119, v119
  s_nop 0
  v_cvt_pk_bf16_f32 v118, v116, v119
  v_and_b32 v13, 0xffff0000, v118
  v_rcp_f32 v13, v13
  v_lshlrev_b32 v12, 16, v118
  v_mul_f32 v12, v12, v13
  v_mul_f32 v13, 0x3fb8aa3b, v13
  v_mov_b32 v14, v12
  v_mov_b32 v15, v13
  s_nop 0
  v_permlane32_swap_b32 v12, v14
  v_permlane32_swap_b32 v13, v15
  s_mov_b32 s20, 1.0
  s_mov_b32 s21, 1.0
  s_mov_b32 s22, 0x3f317218
  s_mov_b32 s23, 0xbfb17218
  s_waitcnt lgkmcnt(0)
  v_pk_fma_f32 v[204:205], v[148:149], v[12:13], v[176:177] op_sel:[0,0,0] op_sel_hi:[1,0,1] neg_lo:[0,1,0] neg_hi:[0,1,0]
  v_pk_fma_f32 v[206:207], v[150:151], v[12:13], v[178:179] op_sel:[0,0,0] op_sel_hi:[1,0,1] neg_lo:[0,1,0] neg_hi:[0,1,0]
  v_pk_fma_f32 v[212:213], v[152:153], v[12:13], v[180:181] op_sel:[0,0,0] op_sel_hi:[1,0,1] neg_lo:[0,1,0] neg_hi:[0,1,0]
  v_pk_fma_f32 v[214:215], v[154:155], v[12:13], v[182:183] op_sel:[0,0,0] op_sel_hi:[1,0,1] neg_lo:[0,1,0] neg_hi:[0,1,0]
  v_pk_fma_f32 v[204:205], v[16:17], v[12:13], v[204:205] op_sel:[0,1,0] op_sel_hi:[1,1,1]
  v_pk_fma_f32 v[206:207], v[18:19], v[12:13], v[206:207] op_sel:[0,1,0] op_sel_hi:[1,1,1]
  v_pk_fma_f32 v[212:213], v[24:25], v[12:13], v[212:213] op_sel:[0,1,0] op_sel_hi:[1,1,1]
  v_pk_fma_f32 v[214:215], v[26:27], v[12:13], v[214:215] op_sel:[0,1,0] op_sel_hi:[1,1,1]
  v_exp_f32 v208, v204
  v_exp_f32 v209, v205
  v_exp_f32 v216, v212
  v_exp_f32 v217, v213
  v_exp_f32 v210, v206
  v_exp_f32 v211, v207
  v_exp_f32 v218, v214
  v_exp_f32 v219, v215
  v_pk_add_f32 v[208:209], v[208:209], s[20:21]
  v_pk_add_f32 v[210:211], v[210:211], s[20:21]
  v_pk_add_f32 v[216:217], v[216:217], s[20:21]
  v_pk_add_f32 v[218:219], v[218:219], s[20:21]
  v_pk_fma_f32 v[208:209], v[208:209], v[208:209], s[20:21]
  v_pk_fma_f32 v[210:211], v[210:211], v[210:211], s[20:21]
  v_pk_fma_f32 v[216:217], v[216:217], v[216:217], s[20:21]
  v_pk_fma_f32 v[218:219], v[218:219], v[218:219], s[20:21]
  v_rcp_f32 v208, v208
  v_rcp_f32 v209, v209
  v_rcp_f32 v216, v216
  v_rcp_f32 v217, v217
  v_rcp_f32 v210, v210
  v_rcp_f32 v211, v211
  v_rcp_f32 v218, v218
  v_rcp_f32 v219, v219
  v_pk_fma_f32 v[208:209], v[208:209], s[22:23], s[22:23] op_sel:[0,1,0] op_sel_hi:[1,1,0]
  v_pk_fma_f32 v[210:211], v[210:211], s[22:23], s[22:23] op_sel:[0,1,0] op_sel_hi:[1,1,0]
  v_pk_fma_f32 v[216:217], v[216:217], s[22:23], s[22:23] op_sel:[0,1,0] op_sel_hi:[1,1,0]
  v_pk_fma_f32 v[218:219], v[218:219], s[22:23], s[22:23] op_sel:[0,1,0] op_sel_hi:[1,1,0]
  v_pk_mul_f32 v[208:209], v[208:209], v[204:205]
  v_pk_mul_f32 v[210:211], v[210:211], v[206:207]
  v_pk_mul_f32 v[216:217], v[216:217], v[212:213]
  v_pk_mul_f32 v[218:219], v[218:219], v[214:215]
  v_cvt_pk_bf16_f32 v236, v208, v209
  v_cvt_pk_bf16_f32 v237, v210, v211
  v_cvt_pk_bf16_f32 v238, v216, v217
  v_cvt_pk_bf16_f32 v239, v218, v219
  buffer_store_dwordx4 v[236:239], v252, s[44:47], 0 offen offset:0 nt
  v_pk_fma_f32 v[220:221], v[148:149], v[14:15], v[176:177] op_sel:[0,0,0] op_sel_hi:[1,0,1] neg_lo:[0,1,0] neg_hi:[0,1,0]
  v_pk_fma_f32 v[222:223], v[150:151], v[14:15], v[178:179] op_sel:[0,0,0] op_sel_hi:[1,0,1] neg_lo:[0,1,0] neg_hi:[0,1,0]
  v_pk_fma_f32 v[228:229], v[152:153], v[14:15], v[180:181] op_sel:[0,0,0] op_sel_hi:[1,0,1] neg_lo:[0,1,0] neg_hi:[0,1,0]
  v_pk_fma_f32 v[230:231], v[154:155], v[14:15], v[182:183] op_sel:[0,0,0] op_sel_hi:[1,0,1] neg_lo:[0,1,0] neg_hi:[0,1,0]
  v_pk_fma_f32 v[220:221], v[20:21], v[14:15], v[220:221] op_sel:[0,1,0] op_sel_hi:[1,1,1]
  v_pk_fma_f32 v[222:223], v[22:23], v[14:15], v[222:223] op_sel:[0,1,0] op_sel_hi:[1,1,1]
  v_pk_fma_f32 v[228:229], v[28:29], v[14:15], v[228:229] op_sel:[0,1,0] op_sel_hi:[1,1,1]
  v_pk_fma_f32 v[230:231], v[30:31], v[14:15], v[230:231] op_sel:[0,1,0] op_sel_hi:[1,1,1]
  v_exp_f32 v224, v220
  v_exp_f32 v225, v221
  v_exp_f32 v232, v228
  v_exp_f32 v233, v229
  v_exp_f32 v226, v222
  v_exp_f32 v227, v223
  v_exp_f32 v234, v230
  v_exp_f32 v235, v231
  v_pk_add_f32 v[224:225], v[224:225], s[20:21]
  v_pk_add_f32 v[226:227], v[226:227], s[20:21]
  v_pk_add_f32 v[232:233], v[232:233], s[20:21]
  v_pk_add_f32 v[234:235], v[234:235], s[20:21]
  v_pk_fma_f32 v[224:225], v[224:225], v[224:225], s[20:21]
  v_pk_fma_f32 v[226:227], v[226:227], v[226:227], s[20:21]
  v_pk_fma_f32 v[232:233], v[232:233], v[232:233], s[20:21]
  v_pk_fma_f32 v[234:235], v[234:235], v[234:235], s[20:21]
  v_rcp_f32 v224, v224
  v_rcp_f32 v225, v225
  v_rcp_f32 v232, v232
  v_rcp_f32 v233, v233
  v_rcp_f32 v226, v226
  v_rcp_f32 v227, v227
  v_rcp_f32 v234, v234
  v_rcp_f32 v235, v235
  v_pk_fma_f32 v[224:225], v[224:225], s[22:23], s[22:23] op_sel:[0,1,0] op_sel_hi:[1,1,0]
  v_pk_fma_f32 v[226:227], v[226:227], s[22:23], s[22:23] op_sel:[0,1,0] op_sel_hi:[1,1,0]
  v_pk_fma_f32 v[232:233], v[232:233], s[22:23], s[22:23] op_sel:[0,1,0] op_sel_hi:[1,1,0]
  v_pk_fma_f32 v[234:235], v[234:235], s[22:23], s[22:23] op_sel:[0,1,0] op_sel_hi:[1,1,0]
  v_pk_mul_f32 v[224:225], v[224:225], v[220:221]
  v_pk_mul_f32 v[226:227], v[226:227], v[222:223]
  v_pk_mul_f32 v[232:233], v[232:233], v[228:229]
  v_pk_mul_f32 v[234:235], v[234:235], v[230:231]
  v_cvt_pk_bf16_f32 v240, v224, v225
  v_cvt_pk_bf16_f32 v241, v226, v227
  v_cvt_pk_bf16_f32 v242, v232, v233
  v_cvt_pk_bf16_f32 v243, v234, v235
  buffer_store_dwordx4 v[240:243], v253, s[44:47], 0 offen offset:0 nt
  v_pk_fma_f32 v[204:205], v[156:157], v[12:13], v[184:185] op_sel:[0,0,0] op_sel_hi:[1,0,1] neg_lo:[0,1,0] neg_hi:[0,1,0]
  v_pk_fma_f32 v[206:207], v[158:159], v[12:13], v[186:187] op_sel:[0,0,0] op_sel_hi:[1,0,1] neg_lo:[0,1,0] neg_hi:[0,1,0]
  v_pk_fma_f32 v[212:213], v[160:161], v[12:13], v[188:189] op_sel:[0,0,0] op_sel_hi:[1,0,1] neg_lo:[0,1,0] neg_hi:[0,1,0]
  v_pk_fma_f32 v[214:215], v[162:163], v[12:13], v[190:191] op_sel:[0,0,0] op_sel_hi:[1,0,1] neg_lo:[0,1,0] neg_hi:[0,1,0]
  v_pk_fma_f32 v[204:205], v[32:33], v[12:13], v[204:205] op_sel:[0,1,0] op_sel_hi:[1,1,1]
  v_pk_fma_f32 v[206:207], v[34:35], v[12:13], v[206:207] op_sel:[0,1,0] op_sel_hi:[1,1,1]
  v_pk_fma_f32 v[212:213], v[40:41], v[12:13], v[212:213] op_sel:[0,1,0] op_sel_hi:[1,1,1]
  v_pk_fma_f32 v[214:215], v[42:43], v[12:13], v[214:215] op_sel:[0,1,0] op_sel_hi:[1,1,1]
  v_exp_f32 v208, v204
  v_exp_f32 v209, v205
  v_exp_f32 v216, v212
  v_exp_f32 v217, v213
  v_exp_f32 v210, v206
  v_exp_f32 v211, v207
  v_exp_f32 v218, v214
  v_exp_f32 v219, v215
  v_pk_add_f32 v[208:209], v[208:209], s[20:21]
  v_pk_add_f32 v[210:211], v[210:211], s[20:21]
  v_pk_add_f32 v[216:217], v[216:217], s[20:21]
  v_pk_add_f32 v[218:219], v[218:219], s[20:21]
  v_pk_fma_f32 v[208:209], v[208:209], v[208:209], s[20:21]
  v_pk_fma_f32 v[210:211], v[210:211], v[210:211], s[20:21]
  v_pk_fma_f32 v[216:217], v[216:217], v[216:217], s[20:21]
  v_pk_fma_f32 v[218:219], v[218:219], v[218:219], s[20:21]
  v_rcp_f32 v208, v208
  v_rcp_f32 v209, v209
  v_rcp_f32 v216, v216
  v_rcp_f32 v217, v217
  v_rcp_f32 v210, v210
  v_rcp_f32 v211, v211
  v_rcp_f32 v218, v218
  v_rcp_f32 v219, v219
  v_pk_fma_f32 v[208:209], v[208:209], s[22:23], s[22:23] op_sel:[0,1,0] op_sel_hi:[1,1,0]
  v_pk_fma_f32 v[210:211], v[210:211], s[22:23], s[22:23] op_sel:[0,1,0] op_sel_hi:[1,1,0]
  v_pk_fma_f32 v[216:217], v[216:217], s[22:23], s[22:23] op_sel:[0,1,0] op_sel_hi:[1,1,0]
  v_pk_fma_f32 v[218:219], v[218:219], s[22:23], s[22:23] op_sel:[0,1,0] op_sel_hi:[1,1,0]
  v_pk_mul_f32 v[208:209], v[208:209], v[204:205]
  v_pk_mul_f32 v[210:211], v[210:211], v[206:207]
  v_pk_mul_f32 v[216:217], v[216:217], v[212:213]
  v_pk_mul_f32 v[218:219], v[218:219], v[214:215]
  v_cvt_pk_bf16_f32 v236, v208, v209
  v_cvt_pk_bf16_f32 v237, v210, v211
  v_cvt_pk_bf16_f32 v238, v216, v217
  v_cvt_pk_bf16_f32 v239, v218, v219
  buffer_store_dwordx4 v[236:239], v252, s[44:47], 0 offen offset:1024 nt
  s_waitcnt vmcnt(1)
  buffer_store_dwordx2 v[4:5], v6, s[44:47], s30 offen offset:0
  v_pk_fma_f32 v[220:221], v[156:157], v[14:15], v[184:185] op_sel:[0,0,0] op_sel_hi:[1,0,1] neg_lo:[0,1,0] neg_hi:[0,1,0]
  v_pk_fma_f32 v[222:223], v[158:159], v[14:15], v[186:187] op_sel:[0,0,0] op_sel_hi:[1,0,1] neg_lo:[0,1,0] neg_hi:[0,1,0]
  v_pk_fma_f32 v[228:229], v[160:161], v[14:15], v[188:189] op_sel:[0,0,0] op_sel_hi:[1,0,1] neg_lo:[0,1,0] neg_hi:[0,1,0]
  v_pk_fma_f32 v[230:231], v[162:163], v[14:15], v[190:191] op_sel:[0,0,0] op_sel_hi:[1,0,1] neg_lo:[0,1,0] neg_hi:[0,1,0]
  v_pk_fma_f32 v[220:221], v[36:37], v[14:15], v[220:221] op_sel:[0,1,0] op_sel_hi:[1,1,1]
  v_pk_fma_f32 v[222:223], v[38:39], v[14:15], v[222:223] op_sel:[0,1,0] op_sel_hi:[1,1,1]
  v_pk_fma_f32 v[228:229], v[44:45], v[14:15], v[228:229] op_sel:[0,1,0] op_sel_hi:[1,1,1]
  v_pk_fma_f32 v[230:231], v[46:47], v[14:15], v[230:231] op_sel:[0,1,0] op_sel_hi:[1,1,1]
  v_exp_f32 v224, v220
  v_exp_f32 v225, v221
  v_exp_f32 v232, v228
  v_exp_f32 v233, v229
  v_exp_f32 v226, v222
  v_exp_f32 v227, v223
  v_exp_f32 v234, v230
  v_exp_f32 v235, v231
  v_pk_add_f32 v[224:225], v[224:225], s[20:21]
  v_pk_add_f32 v[226:227], v[226:227], s[20:21]
  v_pk_add_f32 v[232:233], v[232:233], s[20:21]
  v_pk_add_f32 v[234:235], v[234:235], s[20:21]
  v_pk_fma_f32 v[224:225], v[224:225], v[224:225], s[20:21]
  v_pk_fma_f32 v[226:227], v[226:227], v[226:227], s[20:21]
  v_pk_fma_f32 v[232:233], v[232:233], v[232:233], s[20:21]
  v_pk_fma_f32 v[234:235], v[234:235], v[234:235], s[20:21]
  v_rcp_f32 v224, v224
  v_rcp_f32 v225, v225
  v_rcp_f32 v232, v232
  v_rcp_f32 v233, v233
  v_rcp_f32 v226, v226
  v_rcp_f32 v227, v227
  v_rcp_f32 v234, v234
  v_rcp_f32 v235, v235
  v_pk_fma_f32 v[224:225], v[224:225], s[22:23], s[22:23] op_sel:[0,1,0] op_sel_hi:[1,1,0]
  v_pk_fma_f32 v[226:227], v[226:227], s[22:23], s[22:23] op_sel:[0,1,0] op_sel_hi:[1,1,0]
  v_pk_fma_f32 v[232:233], v[232:233], s[22:23], s[22:23] op_sel:[0,1,0] op_sel_hi:[1,1,0]
  v_pk_fma_f32 v[234:235], v[234:235], s[22:23], s[22:23] op_sel:[0,1,0] op_sel_hi:[1,1,0]
  v_pk_mul_f32 v[224:225], v[224:225], v[220:221]
  v_pk_mul_f32 v[226:227], v[226:227], v[222:223]
  v_pk_mul_f32 v[232:233], v[232:233], v[228:229]
  v_pk_mul_f32 v[234:235], v[234:235], v[230:231]
  v_cvt_pk_bf16_f32 v240, v224, v225
  v_cvt_pk_bf16_f32 v241, v226, v227
  v_cvt_pk_bf16_f32 v242, v232, v233
  v_cvt_pk_bf16_f32 v243, v234, v235
  buffer_store_dwordx4 v[240:243], v253, s[44:47], 0 offen offset:1024 nt
  buffer_load_dwordx2 v[72:73], v3, s[44:47], s31 offen sc1
  v_pk_fma_f32 v[204:205], v[164:165], v[12:13], v[192:193] op_sel:[0,0,0] op_sel_hi:[1,0,1] neg_lo:[0,1,0] neg_hi:[0,1,0]
  v_pk_fma_f32 v[206:207], v[166:167], v[12:13], v[194:195] op_sel:[0,0,0] op_sel_hi:[1,0,1] neg_lo:[0,1,0] neg_hi:[0,1,0]
  v_pk_fma_f32 v[212:213], v[168:169], v[12:13], v[196:197] op_sel:[0,0,0] op_sel_hi:[1,0,1] neg_lo:[0,1,0] neg_hi:[0,1,0]
  v_pk_fma_f32 v[214:215], v[170:171], v[12:13], v[198:199] op_sel:[0,0,0] op_sel_hi:[1,0,1] neg_lo:[0,1,0] neg_hi:[0,1,0]
  v_pk_fma_f32 v[204:205], v[48:49], v[12:13], v[204:205] op_sel:[0,1,0] op_sel_hi:[1,1,1]
  v_pk_fma_f32 v[206:207], v[50:51], v[12:13], v[206:207] op_sel:[0,1,0] op_sel_hi:[1,1,1]
  v_pk_fma_f32 v[212:213], v[56:57], v[12:13], v[212:213] op_sel:[0,1,0] op_sel_hi:[1,1,1]
  v_pk_fma_f32 v[214:215], v[58:59], v[12:13], v[214:215] op_sel:[0,1,0] op_sel_hi:[1,1,1]
  v_exp_f32 v208, v204
  v_exp_f32 v209, v205
  v_exp_f32 v216, v212
  v_exp_f32 v217, v213
  v_exp_f32 v210, v206
  v_exp_f32 v211, v207
  v_exp_f32 v218, v214
  v_exp_f32 v219, v215
  v_pk_add_f32 v[208:209], v[208:209], s[20:21]
  v_pk_add_f32 v[210:211], v[210:211], s[20:21]
  v_pk_add_f32 v[216:217], v[216:217], s[20:21]
  v_pk_add_f32 v[218:219], v[218:219], s[20:21]
  v_pk_fma_f32 v[208:209], v[208:209], v[208:209], s[20:21]
  v_pk_fma_f32 v[210:211], v[210:211], v[210:211], s[20:21]
  v_pk_fma_f32 v[216:217], v[216:217], v[216:217], s[20:21]
  v_pk_fma_f32 v[218:219], v[218:219], v[218:219], s[20:21]
  v_rcp_f32 v208, v208
  v_rcp_f32 v209, v209
  v_rcp_f32 v216, v216
  v_rcp_f32 v217, v217
  v_rcp_f32 v210, v210
  v_rcp_f32 v211, v211
  v_rcp_f32 v218, v218
  v_rcp_f32 v219, v219
  v_pk_fma_f32 v[208:209], v[208:209], s[22:23], s[22:23] op_sel:[0,1,0] op_sel_hi:[1,1,0]
  v_pk_fma_f32 v[210:211], v[210:211], s[22:23], s[22:23] op_sel:[0,1,0] op_sel_hi:[1,1,0]
  v_pk_fma_f32 v[216:217], v[216:217], s[22:23], s[22:23] op_sel:[0,1,0] op_sel_hi:[1,1,0]
  v_pk_fma_f32 v[218:219], v[218:219], s[22:23], s[22:23] op_sel:[0,1,0] op_sel_hi:[1,1,0]
  v_pk_mul_f32 v[208:209], v[208:209], v[204:205]
  v_pk_mul_f32 v[210:211], v[210:211], v[206:207]
  v_pk_mul_f32 v[216:217], v[216:217], v[212:213]
  v_pk_mul_f32 v[218:219], v[218:219], v[214:215]
  v_cvt_pk_bf16_f32 v236, v208, v209
  v_cvt_pk_bf16_f32 v237, v210, v211
  v_cvt_pk_bf16_f32 v238, v216, v217
  v_cvt_pk_bf16_f32 v239, v218, v219
  buffer_store_dwordx4 v[236:239], v252, s[44:47], 0 offen offset:2048 nt
  s_waitcnt vmcnt(2)
  buffer_store_dwordx2 v[4:5], v6, s[44:47], s30 offen offset:8
  s_waitcnt vmcnt(2)
  v_cmp_ne_u64 vcc, s[10:11], v[72:73]
  s_nop 0
  s_and_b32 s12, vcc_lo, 0x11111111
  s_cbranch_scc1 RFg22f0
BFg22f0:
  v_pk_fma_f32 v[220:221], v[164:165], v[14:15], v[192:193] op_sel:[0,0,0] op_sel_hi:[1,0,1] neg_lo:[0,1,0] neg_hi:[0,1,0]
  v_pk_fma_f32 v[222:223], v[166:167], v[14:15], v[194:195] op_sel:[0,0,0] op_sel_hi:[1,0,1] neg_lo:[0,1,0] neg_hi:[0,1,0]
  v_pk_fma_f32 v[228:229], v[168:169], v[14:15], v[196:197] op_sel:[0,0,0] op_sel_hi:[1,0,1] neg_lo:[0,1,0] neg_hi:[0,1,0]
  v_pk_fma_f32 v[230:231], v[170:171], v[14:15], v[198:199] op_sel:[0,0,0] op_sel_hi:[1,0,1] neg_lo:[0,1,0] neg_hi:[0,1,0]
  buffer_load_dwordx4 v[80:83], v8, s[44:47], s52 offen sc1
  v_pk_fma_f32 v[220:221], v[52:53], v[14:15], v[220:221] op_sel:[0,1,0] op_sel_hi:[1,1,1]
  v_pk_fma_f32 v[222:223], v[54:55], v[14:15], v[222:223] op_sel:[0,1,0] op_sel_hi:[1,1,1]
  v_pk_fma_f32 v[228:229], v[60:61], v[14:15], v[228:229] op_sel:[0,1,0] op_sel_hi:[1,1,1]
  v_pk_fma_f32 v[230:231], v[62:63], v[14:15], v[230:231] op_sel:[0,1,0] op_sel_hi:[1,1,1]
  buffer_load_dwordx4 v[84:87], v9, s[44:47], s52 offen sc1
  v_exp_f32 v224, v220
  v_exp_f32 v225, v221
  v_exp_f32 v232, v228
  v_exp_f32 v233, v229
  buffer_load_dwordx4 v[88:91], v10, s[44:47], s52 offen sc1
  v_exp_f32 v226, v222
  v_exp_f32 v227, v223
  v_exp_f32 v234, v230
  v_exp_f32 v235, v231
  buffer_load_dwordx4 v[92:95], v11, s[44:47], s52 offen sc1
  v_pk_add_f32 v[224:225], v[224:225], s[20:21]
  v_pk_add_f32 v[226:227], v[226:227], s[20:21]
  v_pk_add_f32 v[232:233], v[232:233], s[20:21]
  v_pk_add_f32 v[234:235], v[234:235], s[20:21]
  buffer_load_dwordx4 v[96:99], v8, s[44:47], s53 offen sc1
  v_pk_fma_f32 v[224:225], v[224:225], v[224:225], s[20:21]
  v_pk_fma_f32 v[226:227], v[226:227], v[226:227], s[20:21]
  v_pk_fma_f32 v[232:233], v[232:233], v[232:233], s[20:21]
  v_pk_fma_f32 v[234:235], v[234:235], v[234:235], s[20:21]
  buffer_load_dwordx4 v[100:103], v9, s[44:47], s53 offen sc1
  v_rcp_f32 v224, v224
  v_rcp_f32 v225, v225
  v_rcp_f32 v232, v232
  v_rcp_f32 v233, v233
  buffer_load_dwordx4 v[104:107], v10, s[44:47], s53 offen sc1
  v_rcp_f32 v226, v226
  v_rcp_f32 v227, v227
  v_rcp_f32 v234, v234
  v_rcp_f32 v235, v235
  buffer_load_dwordx4 v[108:111], v11, s[44:47], s53 offen sc1
  v_pk_fma_f32 v[224:225], v[224:225], s[22:23], s[22:23] op_sel:[0,1,0] op_sel_hi:[1,1,0]
  v_pk_fma_f32 v[226:227], v[226:227], s[22:23], s[22:23] op_sel:[0,1,0] op_sel_hi:[1,1,0]
  v_pk_fma_f32 v[232:233], v[232:233], s[22:23], s[22:23] op_sel:[0,1,0] op_sel_hi:[1,1,0]
  v_pk_fma_f32 v[234:235], v[234:235], s[22:23], s[22:23] op_sel:[0,1,0] op_sel_hi:[1,1,0]
  v_pk_mul_f32 v[224:225], v[224:225], v[220:221]
  v_pk_mul_f32 v[226:227], v[226:227], v[222:223]
  v_pk_mul_f32 v[232:233], v[232:233], v[228:229]
  v_pk_mul_f32 v[234:235], v[234:235], v[230:231]
  v_cvt_pk_bf16_f32 v240, v224, v225
  v_cvt_pk_bf16_f32 v241, v226, v227
  v_cvt_pk_bf16_f32 v242, v232, v233
  v_cvt_pk_bf16_f32 v243, v234, v235
  buffer_store_dwordx4 v[240:243], v253, s[44:47], 0 offen offset:2048 nt
  v_pk_fma_f32 v[204:205], v[172:173], v[12:13], v[200:201] op_sel:[0,0,0] op_sel_hi:[1,0,1] neg_lo:[0,1,0] neg_hi:[0,1,0]
  v_pk_fma_f32 v[206:207], v[174:175], v[12:13], v[202:203] op_sel:[0,0,0] op_sel_hi:[1,0,1] neg_lo:[0,1,0] neg_hi:[0,1,0]
  v_pk_fma_f32 v[212:213], v[172:173], v[14:15], v[200:201] op_sel:[0,0,0] op_sel_hi:[1,0,1] neg_lo:[0,1,0] neg_hi:[0,1,0]
  v_pk_fma_f32 v[214:215], v[174:175], v[14:15], v[202:203] op_sel:[0,0,0] op_sel_hi:[1,0,1] neg_lo:[0,1,0] neg_hi:[0,1,0]
  buffer_load_dwordx2 v[74:75], v3, s[44:47], s31 offen sc1
  v_pk_fma_f32 v[204:205], v[64:65], v[12:13], v[204:205] op_sel:[0,1,0] op_sel_hi:[1,1,1]
  v_pk_fma_f32 v[206:207], v[66:67], v[12:13], v[206:207] op_sel:[0,1,0] op_sel_hi:[1,1,1]
  v_pk_fma_f32 v[212:213], v[68:69], v[14:15], v[212:213] op_sel:[0,1,0] op_sel_hi:[1,1,1]
  v_pk_fma_f32 v[214:215], v[70:71], v[14:15], v[214:215] op_sel:[0,1,0] op_sel_hi:[1,1,1]
  buffer_load_dwordx4 v[112:115], v8, s[44:47], s54 offen sc1
  v_exp_f32 v208, v204
  v_exp_f32 v209, v205
  v_exp_f32 v216, v212
  v_exp_f32 v217, v213
  buffer_load_dwordx4 v[116:119], v9, s[44:47], s54 offen sc1
  v_exp_f32 v210, v206
  v_exp_f32 v211, v207
  v_exp_f32 v218, v214
  v_exp_f32 v219, v215
  buffer_load_dwordx4 v[120:123], v10, s[44:47], s54 offen sc1
  v_pk_add_f32 v[208:209], v[208:209], s[20:21]
  v_pk_add_f32 v[210:211], v[210:211], s[20:21]
  v_pk_add_f32 v[216:217], v[216:217], s[20:21]
  v_pk_add_f32 v[218:219], v[218:219], s[20:21]
  buffer_load_dwordx4 v[124:127], v11, s[44:47], s54 offen sc1
  v_pk_fma_f32 v[208:209], v[208:209], v[208:209], s[20:21]
  v_pk_fma_f32 v[210:211], v[210:211], v[210:211], s[20:21]
  v_pk_fma_f32 v[216:217], v[216:217], v[216:217], s[20:21]
  v_pk_fma_f32 v[218:219], v[218:219], v[218:219], s[20:21]
  buffer_load_dwordx4 v[128:131], v8, s[44:47], s55 offen sc1
  v_rcp_f32 v208, v208
  v_rcp_f32 v209, v209
  v_rcp_f32 v216, v216
  v_rcp_f32 v217, v217
  buffer_load_dwordx4 v[132:135], v9, s[44:47], s55 offen sc1
  v_rcp_f32 v210, v210
  v_rcp_f32 v211, v211
  v_rcp_f32 v218, v218
  v_rcp_f32 v219, v219
  buffer_load_dwordx4 v[136:139], v10, s[44:47], s55 offen sc1
  v_pk_fma_f32 v[208:209], v[208:209], s[22:23], s[22:23] op_sel:[0,1,0] op_sel_hi:[1,1,0]
  v_pk_fma_f32 v[210:211], v[210:211], s[22:23], s[22:23] op_sel:[0,1,0] op_sel_hi:[1,1,0]
  v_pk_fma_f32 v[216:217], v[216:217], s[22:23], s[22:23] op_sel:[0,1,0] op_sel_hi:[1,1,0]
  v_pk_fma_f32 v[218:219], v[218:219], s[22:23], s[22:23] op_sel:[0,1,0] op_sel_hi:[1,1,0]
  buffer_load_dwordx4 v[140:143], v11, s[44:47], s55 offen sc1
  v_pk_mul_f32 v[208:209], v[208:209], v[204:205]
  v_pk_mul_f32 v[210:211], v[210:211], v[206:207]
  v_pk_mul_f32 v[216:217], v[216:217], v[212:213]
  v_pk_mul_f32 v[218:219], v[218:219], v[214:215]
  v_cvt_pk_bf16_f32 v236, v208, v209
  v_cvt_pk_bf16_f32 v237, v210, v211
  v_cvt_pk_bf16_f32 v238, v216, v217
  v_cvt_pk_bf16_f32 v239, v218, v219
  s_nop 0
  v_permlane16_swap_b32 v236, v238
  v_permlane16_swap_b32 v237, v239
  buffer_store_dwordx4 v[236:239], v254, s[44:47], 0 offen nt
  s_lshl_b32 s12, s7, 1
  s_lshr_b32 s13, s3, 1
  s_add_u32 s12, s12, s13
  s_mul_i32 s12, s12, 33024
  s_lshl_b32 s13, s8, 12
  s_add_u32 s12, s12, s13
  s_and_b32 s13, s3, 1
  s_lshl_b32 s13, s13, 2
  s_add_u32 s12, s12, s13
  s_add_u32 s17, s12, 0x210000
  v_lshlrev_b32 v7, 4, v2
  s_waitcnt vmcnt(9)
  v_cmp_ne_u64 vcc, s[10:11], v[74:75]
  s_nop 0
  s_and_b32 s12, vcc_lo, 0x22222222
  s_cbranch_scc1 RFg22f1
BFg22f1:
  v_mfma_f32_16x16x32_bf16 v[16:19], a[0:3], v[80:83], 0
  buffer_load_dwordx4 v[144:147], v8, s[44:47], s56 offen sc1
  v_mfma_f32_16x16x32_bf16 v[20:23], a[4:7], v[80:83], 0
  v_mfma_f32_16x16x32_bf16 v[24:27], a[8:11], v[80:83], 0
  v_mfma_f32_16x16x32_bf16 v[28:31], a[12:15], v[80:83], 0
  v_mfma_f32_16x16x32_bf16 v[32:35], a[0:3], v[84:87], 0
  buffer_store_dwordx2 v[4:5], v6, s[44:47], s30 offen offset:16
  v_mfma_f32_16x16x32_bf16 v[36:39], a[4:7], v[84:87], 0
  v_mfma_f32_16x16x32_bf16 v[40:43], a[8:11], v[84:87], 0
  v_mfma_f32_16x16x32_bf16 v[44:47], a[12:15], v[84:87], 0
  buffer_load_dwordx4 v[148:151], v9, s[44:47], s56 offen sc1
  v_mfma_f32_16x16x32_bf16 v[48:51], a[0:3], v[88:91], 0
  v_mfma_f32_16x16x32_bf16 v[52:55], a[4:7], v[88:91], 0
  v_mfma_f32_16x16x32_bf16 v[56:59], a[8:11], v[88:91], 0
  s_waitcnt vmcnt(3)
  buffer_store_dwordx2 v[4:5], v6, s[44:47], s30 offen offset:24
  v_mfma_f32_16x16x32_bf16 v[60:63], a[12:15], v[88:91], 0
  v_mfma_f32_16x16x32_bf16 v[64:67], a[0:3], v[92:95], 0
  v_mfma_f32_16x16x32_bf16 v[68:71], a[4:7], v[92:95], 0
  buffer_load_dwordx4 v[152:155], v10, s[44:47], s56 offen sc1
  v_mfma_f32_16x16x32_bf16 v[72:75], a[8:11], v[92:95], 0
  v_mfma_f32_16x16x32_bf16 v[76:79], a[12:15], v[92:95], 0
  v_mfma_f32_16x16x32_bf16 v[16:19], a[16:19], v[96:99], v[16:19]
  buffer_load_dwordx4 v[156:159], v11, s[44:47], s56 offen sc1
  v_mfma_f32_16x16x32_bf16 v[20:23], a[20:23], v[96:99], v[20:23]
  v_mfma_f32_16x16x32_bf16 v[24:27], a[24:27], v[96:99], v[24:27]
  v_mfma_f32_16x16x32_bf16 v[28:31], a[28:31], v[96:99], v[28:31]
  v_mfma_f32_16x16x32_bf16 v[32:35], a[16:19], v[100:103], v[32:35]
  buffer_load_dwordx2 v[12:13], v3, s[44:47], s31 offen sc1
  v_mfma_f32_16x16x32_bf16 v[36:39], a[20:23], v[100:103], v[36:39]
  v_mfma_f32_16x16x32_bf16 v[40:43], a[24:27], v[100:103], v[40:43]
  v_mfma_f32_16x16x32_bf16 v[44:47], a[28:31], v[100:103], v[44:47]
  buffer_load_dwordx4 v[160:163], v8, s[44:47], s57 offen sc1
  v_mfma_f32_16x16x32_bf16 v[48:51], a[16:19], v[104:107], v[48:51]
  v_mfma_f32_16x16x32_bf16 v[52:55], a[20:23], v[104:107], v[52:55]
  v_mfma_f32_16x16x32_bf16 v[56:59], a[24:27], v[104:107], v[56:59]
  buffer_load_dwordx4 v[164:167], v9, s[44:47], s57 offen sc1
  v_mfma_f32_16x16x32_bf16 v[60:63], a[28:31], v[104:107], v[60:63]
  v_mfma_f32_16x16x32_bf16 v[64:67], a[16:19], v[108:111], v[64:67]
  v_mfma_f32_16x16x32_bf16 v[68:71], a[20:23], v[108:111], v[68:71]
  buffer_load_dwordx4 v[168:171], v10, s[44:47], s57 offen sc1
  v_mfma_f32_16x16x32_bf16 v[72:75], a[24:27], v[108:111], v[72:75]
  v_mfma_f32_16x16x32_bf16 v[76:79], a[28:31], v[108:111], v[76:79]
  v_mfma_f32_16x16x32_bf16 v[16:19], a[32:35], v[112:115], v[16:19]
  buffer_load_dwordx4 v[172:175], v11, s[44:47], s57 offen sc1
  v_mfma_f32_16x16x32_bf16 v[20:23], a[36:39], v[112:115], v[20:23]
  v_mfma_f32_16x16x32_bf16 v[24:27], a[40:43], v[112:115], v[24:27]
  v_mfma_f32_16x16x32_bf16 v[28:31], a[44:47], v[112:115], v[28:31]
  v_mfma_f32_16x16x32_bf16 v[32:35], a[32:35], v[116:119], v[32:35]
  buffer_load_dwordx4 v[176:179], v8, s[44:47], s58 offen sc1
  v_mfma_f32_16x16x32_bf16 v[36:39], a[36:39], v[116:119], v[36:39]
  v_mfma_f32_16x16x32_bf16 v[40:43], a[40:43], v[116:119], v[40:43]
  v_mfma_f32_16x16x32_bf16 v[44:47], a[44:47], v[116:119], v[44:47]
  buffer_load_dwordx4 v[180:183], v9, s[44:47], s58 offen sc1
  v_mfma_f32_16x16x32_bf16 v[48:51], a[32:35], v[120:123], v[48:51]
  v_mfma_f32_16x16x32_bf16 v[52:55], a[36:39], v[120:123], v[52:55]
  v_mfma_f32_16x16x32_bf16 v[56:59], a[40:43], v[120:123], v[56:59]
  buffer_load_dwordx4 v[184:187], v10, s[44:47], s58 offen sc1
  v_mfma_f32_16x16x32_bf16 v[60:63], a[44:47], v[120:123], v[60:63]
  v_mfma_f32_16x16x32_bf16 v[64:67], a[32:35], v[124:127], v[64:67]
  v_mfma_f32_16x16x32_bf16 v[68:71], a[36:39], v[124:127], v[68:71]
  buffer_load_dwordx4 v[188:191], v11, s[44:47], s58 offen sc1
  v_mfma_f32_16x16x32_bf16 v[72:75], a[40:43], v[124:127], v[72:75]
  v_mfma_f32_16x16x32_bf16 v[76:79], a[44:47], v[124:127], v[76:79]
  v_mfma_f32_16x16x32_bf16 v[16:19], a[48:51], v[128:131], v[16:19]
  buffer_load_dwordx4 v[192:195], v8, s[44:47], s59 offen sc1
  v_mfma_f32_16x16x32_bf16 v[20:23], a[52:55], v[128:131], v[20:23]
  v_mfma_f32_16x16x32_bf16 v[24:27], a[56:59], v[128:131], v[24:27]
  v_mfma_f32_16x16x32_bf16 v[28:31], a[60:63], v[128:131], v[28:31]
  v_mfma_f32_16x16x32_bf16 v[32:35], a[48:51], v[132:135], v[32:35]
  buffer_load_dwordx4 v[196:199], v9, s[44:47], s59 offen sc1
  v_mfma_f32_16x16x32_bf16 v[36:39], a[52:55], v[132:135], v[36:39]
  v_mfma_f32_16x16x32_bf16 v[40:43], a[56:59], v[132:135], v[40:43]
  v_mfma_f32_16x16x32_bf16 v[44:47], a[60:63], v[132:135], v[44:47]
  buffer_load_dwordx4 v[200:203], v10, s[44:47], s59 offen sc1
  v_mfma_f32_16x16x32_bf16 v[48:51], a[48:51], v[136:139], v[48:51]
  v_mfma_f32_16x16x32_bf16 v[52:55], a[52:55], v[136:139], v[52:55]
  v_mfma_f32_16x16x32_bf16 v[56:59], a[56:59], v[136:139], v[56:59]
  buffer_load_dwordx4 v[204:207], v11, s[44:47], s59 offen sc1
  v_mfma_f32_16x16x32_bf16 v[60:63], a[60:63], v[136:139], v[60:63]
  v_mfma_f32_16x16x32_bf16 v[64:67], a[48:51], v[140:143], v[64:67]
  v_mfma_f32_16x16x32_bf16 v[68:71], a[52:55], v[140:143], v[68:71]
  s_waitcnt vmcnt(12)
  v_cmp_ne_u64 vcc, s[10:11], v[12:13]
  s_nop 0
  s_and_b32 s12, vcc_lo, 0x44444444
  s_cbranch_scc1 RFg22f2
BFg22f2:
  v_mfma_f32_16x16x32_bf16 v[72:75], a[56:59], v[140:143], v[72:75]
  v_mfma_f32_16x16x32_bf16 v[76:79], a[60:63], v[140:143], v[76:79]
  v_mfma_f32_16x16x32_bf16 v[16:19], a[64:67], v[144:147], v[16:19]
  buffer_load_dwordx4 v[208:211], v8, s[44:47], s60 offen sc1
  v_mfma_f32_16x16x32_bf16 v[20:23], a[68:71], v[144:147], v[20:23]
  v_mfma_f32_16x16x32_bf16 v[24:27], a[72:75], v[144:147], v[24:27]
  v_mfma_f32_16x16x32_bf16 v[28:31], a[76:79], v[144:147], v[28:31]
  v_mfma_f32_16x16x32_bf16 v[32:35], a[64:67], v[148:151], v[32:35]
  buffer_load_dwordx4 v[212:215], v9, s[44:47], s60 offen sc1
  v_mfma_f32_16x16x32_bf16 v[36:39], a[68:71], v[148:151], v[36:39]
  v_mfma_f32_16x16x32_bf16 v[40:43], a[72:75], v[148:151], v[40:43]
  v_mfma_f32_16x16x32_bf16 v[44:47], a[76:79], v[148:151], v[44:47]
  buffer_load_dwordx4 v[216:219], v10, s[44:47], s60 offen sc1
  v_mfma_f32_16x16x32_bf16 v[48:51], a[64:67], v[152:155], v[48:51]
  v_mfma_f32_16x16x32_bf16 v[52:55], a[68:71], v[152:155], v[52:55]
  v_mfma_f32_16x16x32_bf16 v[56:59], a[72:75], v[152:155], v[56:59]
  buffer_load_dwordx4 v[220:223], v11, s[44:47], s60 offen sc1
  v_mfma_f32_16x16x32_bf16 v[60:63], a[76:79], v[152:155], v[60:63]
  v_mfma_f32_16x16x32_bf16 v[64:67], a[64:67], v[156:159], v[64:67]
  v_mfma_f32_16x16x32_bf16 v[68:71], a[68:71], v[156:159], v[68:71]
  buffer_load_dwordx2 v[12:13], v3, s[44:47], s31 offen sc1
  v_mfma_f32_16x16x32_bf16 v[72:75], a[72:75], v[156:159], v[72:75]
  v_mfma_f32_16x16x32_bf16 v[76:79], a[76:79], v[156:159], v[76:79]
  s_waitcnt vmcnt(13)
  v_mfma_f32_16x16x32_bf16 v[16:19], a[80:83], v[160:163], v[16:19]
  buffer_load_dwordx4 v[224:227], v8, s[44:47], s61 offen sc1
  v_mfma_f32_16x16x32_bf16 v[20:23], a[84:87], v[160:163], v[20:23]
  v_mfma_f32_16x16x32_bf16 v[24:27], a[88:91], v[160:163], v[24:27]
  v_mfma_f32_16x16x32_bf16 v[28:31], a[92:95], v[160:163], v[28:31]
  v_mfma_f32_16x16x32_bf16 v[32:35], a[80:83], v[164:167], v[32:35]
  buffer_load_dwordx4 v[228:231], v9, s[44:47], s61 offen sc1
  v_mfma_f32_16x16x32_bf16 v[36:39], a[84:87], v[164:167], v[36:39]
  v_mfma_f32_16x16x32_bf16 v[40:43], a[88:91], v[164:167], v[40:43]
  v_mfma_f32_16x16x32_bf16 v[44:47], a[92:95], v[164:167], v[44:47]
  buffer_load_dwordx4 v[232:235], v10, s[44:47], s61 offen sc1
  v_mfma_f32_16x16x32_bf16 v[48:51], a[80:83], v[168:171], v[48:51]
  v_mfma_f32_16x16x32_bf16 v[52:55], a[84:87], v[168:171], v[52:55]
  v_mfma_f32_16x16x32_bf16 v[56:59], a[88:91], v[168:171], v[56:59]
  buffer_load_dwordx4 v[236:239], v11, s[44:47], s61 offen sc1
  v_mfma_f32_16x16x32_bf16 v[60:63], a[92:95], v[168:171], v[60:63]
  v_mfma_f32_16x16x32_bf16 v[64:67], a[80:83], v[172:175], v[64:67]
  v_mfma_f32_16x16x32_bf16 v[68:71], a[84:87], v[172:175], v[68:71]
  buffer_load_dwordx4 v[240:243], v8, s[44:47], s62 offen sc1
  v_mfma_f32_16x16x32_bf16 v[72:75], a[88:91], v[172:175], v[72:75]
  v_mfma_f32_16x16x32_bf16 v[76:79], a[92:95], v[172:175], v[76:79]
  s_waitcnt vmcnt(14)
  v_mfma_f32_16x16x32_bf16 v[16:19], a[96:99], v[176:179], v[16:19]
  buffer_load_dwordx4 v[244:247], v9, s[44:47], s62 offen sc1
  v_mfma_f32_16x16x32_bf16 v[20:23], a[100:103], v[176:179], v[20:23]
  v_mfma_f32_16x16x32_bf16 v[24:27], a[104:107], v[176:179], v[24:27]
  v_mfma_f32_16x16x32_bf16 v[28:31], a[108:111], v[176:179], v[28:31]
  v_mfma_f32_16x16x32_bf16 v[32:35], a[96:99], v[180:183], v[32:35]
  buffer_load_dwordx4 v[248:251], v10, s[44:47], s62 offen sc1
  v_mfma_f32_16x16x32_bf16 v[36:39], a[100:103], v[180:183], v[36:39]
  v_mfma_f32_16x16x32_bf16 v[40:43], a[104:107], v[180:183], v[40:43]
  v_mfma_f32_16x16x32_bf16 v[44:47], a[108:111], v[180:183], v[44:47]
  buffer_load_dwordx4 v[252:255], v11, s[44:47], s62 offen sc1
  v_mfma_f32_16x16x32_bf16 v[48:51], a[96:99], v[184:187], v[48:51]
  v_mfma_f32_16x16x32_bf16 v[52:55], a[100:103], v[184:187], v[52:55]
  v_mfma_f32_16x16x32_bf16 v[56:59], a[104:107], v[184:187], v[56:59]
  buffer_load_dwordx4 v[80:83], v8, s[44:47], s63 offen sc1
  v_mfma_f32_16x16x32_bf16 v[60:63], a[108:111], v[184:187], v[60:63]
  v_mfma_f32_16x16x32_bf16 v[64:67], a[96:99], v[188:191], v[64:67]
  v_mfma_f32_16x16x32_bf16 v[68:71], a[100:103], v[188:191], v[68:71]
  buffer_load_dwordx4 v[84:87], v9, s[44:47], s63 offen sc1
  v_mfma_f32_16x16x32_bf16 v[72:75], a[104:107], v[188:191], v[72:75]
  v_mfma_f32_16x16x32_bf16 v[76:79], a[108:111], v[188:191], v[76:79]
  s_waitcnt vmcnt(15)
  v_mfma_f32_16x16x32_bf16 v[16:19], a[112:115], v[192:195], v[16:19]
  buffer_load_dwordx4 v[88:91], v10, s[44:47], s63 offen sc1
  v_mfma_f32_16x16x32_bf16 v[20:23], a[116:119], v[192:195], v[20:23]
  v_mfma_f32_16x16x32_bf16 v[24:27], a[120:123], v[192:195], v[24:27]
  v_mfma_f32_16x16x32_bf16 v[28:31], a[124:127], v[192:195], v[28:31]
  v_mfma_f32_16x16x32_bf16 v[32:35], a[112:115], v[196:199], v[32:35]
  buffer_load_dwordx4 v[92:95], v11, s[44:47], s63 offen sc1
  v_mfma_f32_16x16x32_bf16 v[36:39], a[116:119], v[196:199], v[36:39]
  v_mfma_f32_16x16x32_bf16 v[40:43], a[120:123], v[196:199], v[40:43]
  v_mfma_f32_16x16x32_bf16 v[44:47], a[124:127], v[196:199], v[44:47]
  s_waitcnt vmcnt(12)
  v_cmp_ne_u64 vcc, s[10:11], v[12:13]
  s_nop 0
  s_and_b32 s12, vcc_lo, 0x88888888
  s_cbranch_scc1 RFg22f3
BFg22f3:
  v_mfma_f32_16x16x32_bf16 v[48:51], a[112:115], v[200:203], v[48:51]
  v_mfma_f32_16x16x32_bf16 v[52:55], a[116:119], v[200:203], v[52:55]
  v_mfma_f32_16x16x32_bf16 v[56:59], a[120:123], v[200:203], v[56:59]
  s_add_u32 s12, s3, 0
  v_mfma_f32_16x16x32_bf16 v[60:63], a[124:127], v[200:203], v[60:63]
  s_and_b32 s12, s12, 3
  s_mul_i32 s13, s12, 12288
  v_mfma_f32_16x16x32_bf16 v[64:67], a[112:115], v[204:207], v[64:67]
  s_add_u32 s13, s13, 114688
  v_lshl_add_u32 v3, v2, 4, s13
  v_mfma_f32_16x16x32_bf16 v[68:71], a[116:119], v[204:207], v[68:71]
  buffer_load_dwordx4 v[96:99], v8, s[44:47], s64 offen sc1
  s_add_u32 s12, s3, 1
  v_mfma_f32_16x16x32_bf16 v[72:75], a[120:123], v[204:207], v[72:75]
  s_and_b32 s12, s12, 3
  s_mul_i32 s13, s12, 12288
  v_mfma_f32_16x16x32_bf16 v[76:79], a[124:127], v[204:207], v[76:79]
  s_add_u32 s18, s13, 114688
  v_lshl_add_u32 v4, v2, 4, s18
  v_mfma_f32_16x16x32_bf16 v[16:19], a[128:131], v[208:211], v[16:19]
  buffer_load_dwordx4 v[100:103], v9, s[44:47], s64 offen sc1
  s_add_u32 s12, s3, 2
  v_mfma_f32_16x16x32_bf16 v[20:23], a[132:135], v[208:211], v[20:23]
  s_and_b32 s12, s12, 3
  s_mul_i32 s13, s12, 12288
  v_mfma_f32_16x16x32_bf16 v[24:27], a[136:139], v[208:211], v[24:27]
  s_add_u32 s13, s13, 114688
  v_lshl_add_u32 v5, v2, 4, s13
  v_mfma_f32_16x16x32_bf16 v[28:31], a[140:143], v[208:211], v[28:31]
  s_add_u32 s12, s3, 3
  s_and_b32 s12, s12, 3
  v_mfma_f32_16x16x32_bf16 v[32:35], a[128:131], v[212:215], v[32:35]
  buffer_load_dwordx4 v[104:107], v10, s[44:47], s64 offen sc1
  s_mul_i32 s13, s12, 12288
  v_mfma_f32_16x16x32_bf16 v[36:39], a[132:135], v[212:215], v[36:39]
  s_add_u32 s13, s13, 114688
  v_lshl_add_u32 v6, v2, 4, s13
  v_mfma_f32_16x16x32_bf16 v[40:43], a[136:139], v[212:215], v[40:43]
  v_mfma_f32_16x16x32_bf16 v[44:47], a[140:143], v[212:215], v[44:47]
  buffer_load_dwordx4 v[108:111], v11, s[44:47], s64 offen sc1
  v_mfma_f32_16x16x32_bf16 v[48:51], a[128:131], v[216:219], v[48:51]
  v_mfma_f32_16x16x32_bf16 v[52:55], a[132:135], v[216:219], v[52:55]
  v_mfma_f32_16x16x32_bf16 v[56:59], a[136:139], v[216:219], v[56:59]
  buffer_load_dwordx4 v[112:115], v8, s[44:47], s65 offen sc1
  v_mfma_f32_16x16x32_bf16 v[60:63], a[140:143], v[216:219], v[60:63]
  v_mfma_f32_16x16x32_bf16 v[64:67], a[128:131], v[220:223], v[64:67]
  v_mfma_f32_16x16x32_bf16 v[68:71], a[132:135], v[220:223], v[68:71]
  buffer_load_dwordx4 v[116:119], v9, s[44:47], s65 offen sc1
  v_mfma_f32_16x16x32_bf16 v[72:75], a[136:139], v[220:223], v[72:75]
  v_mfma_f32_16x16x32_bf16 v[76:79], a[140:143], v[220:223], v[76:79]
  s_waitcnt vmcnt(14)
  v_mfma_f32_16x16x32_bf16 v[16:19], a[144:147], v[224:227], v[16:19]
  buffer_load_dwordx4 v[120:123], v10, s[44:47], s65 offen sc1
  v_mfma_f32_16x16x32_bf16 v[20:23], a[148:151], v[224:227], v[20:23]
  v_mfma_f32_16x16x32_bf16 v[24:27], a[152:155], v[224:227], v[24:27]
  v_mfma_f32_16x16x32_bf16 v[28:31], a[156:159], v[224:227], v[28:31]
  v_mfma_f32_16x16x32_bf16 v[32:35], a[144:147], v[228:231], v[32:35]
  buffer_load_dwordx4 v[124:127], v11, s[44:47], s65 offen sc1
  v_mfma_f32_16x16x32_bf16 v[36:39], a[148:151], v[228:231], v[36:39]
  v_mfma_f32_16x16x32_bf16 v[40:43], a[152:155], v[228:231], v[40:43]
  v_mfma_f32_16x16x32_bf16 v[44:47], a[156:159], v[228:231], v[44:47]
  buffer_load_dwordx3 v[128:130], v7, s[44:47], s17 offen offset:0 sc1
  v_mfma_f32_16x16x32_bf16 v[48:51], a[144:147], v[232:235], v[48:51]
  v_mfma_f32_16x16x32_bf16 v[52:55], a[148:151], v[232:235], v[52:55]
  v_mfma_f32_16x16x32_bf16 v[56:59], a[152:155], v[232:235], v[56:59]
  buffer_load_dwordx3 v[132:134], v7, s[44:47], s17 offen offset:1024 sc1
  v_mfma_f32_16x16x32_bf16 v[60:63], a[156:159], v[232:235], v[60:63]
  v_mfma_f32_16x16x32_bf16 v[64:67], a[144:147], v[236:239], v[64:67]
  v_mfma_f32_16x16x32_bf16 v[68:71], a[148:151], v[236:239], v[68:71]
  buffer_load_dwordx3 v[136:138], v7, s[44:47], s17 offen offset:2048 sc1
  v_mfma_f32_16x16x32_bf16 v[72:75], a[152:155], v[236:239], v[72:75]
  v_mfma_f32_16x16x32_bf16 v[76:79], a[156:159], v[236:239], v[76:79]
  s_waitcnt vmcnt(15)
  v_mfma_f32_16x16x32_bf16 v[16:19], a[160:163], v[240:243], v[16:19]
  buffer_load_dwordx3 v[140:142], v7, s[44:47], s17 offen offset:3072 sc1
  v_mfma_f32_16x16x32_bf16 v[20:23], a[164:167], v[240:243], v[20:23]
  v_mfma_f32_16x16x32_bf16 v[24:27], a[168:171], v[240:243], v[24:27]
  v_mfma_f32_16x16x32_bf16 v[28:31], a[172:175], v[240:243], v[28:31]
  v_mfma_f32_16x16x32_bf16 v[32:35], a[160:163], v[244:247], v[32:35]
  v_mfma_f32_16x16x32_bf16 v[36:39], a[164:167], v[244:247], v[36:39]
  v_mfma_f32_16x16x32_bf16 v[40:43], a[168:171], v[244:247], v[40:43]
  v_mfma_f32_16x16x32_bf16 v[44:47], a[172:175], v[244:247], v[44:47]
  v_mfma_f32_16x16x32_bf16 v[48:51], a[160:163], v[248:251], v[48:51]
  v_mfma_f32_16x16x32_bf16 v[52:55], a[164:167], v[248:251], v[52:55]
  v_mfma_f32_16x16x32_bf16 v[56:59], a[168:171], v[248:251], v[56:59]
  v_mfma_f32_16x16x32_bf16 v[60:63], a[172:175], v[248:251], v[60:63]
  v_mfma_f32_16x16x32_bf16 v[64:67], a[160:163], v[252:255], v[64:67]
  v_mfma_f32_16x16x32_bf16 v[68:71], a[164:167], v[252:255], v[68:71]
  v_mfma_f32_16x16x32_bf16 v[72:75], a[168:171], v[252:255], v[72:75]
  v_mfma_f32_16x16x32_bf16 v[76:79], a[172:175], v[252:255], v[76:79]
  s_waitcnt vmcnt(12)
  v_mfma_f32_16x16x32_bf16 v[16:19], a[176:179], v[80:83], v[16:19]
  v_mfma_f32_16x16x32_bf16 v[20:23], a[180:183], v[80:83], v[20:23]
  v_mfma_f32_16x16x32_bf16 v[24:27], a[184:187], v[80:83], v[24:27]
  v_mfma_f32_16x16x32_bf16 v[28:31], a[188:191], v[80:83], v[28:31]
  v_mfma_f32_16x16x32_bf16 v[32:35], a[176:179], v[84:87], v[32:35]
  v_mfma_f32_16x16x32_bf16 v[36:39], a[180:183], v[84:87], v[36:39]
  v_mfma_f32_16x16x32_bf16 v[40:43], a[184:187], v[84:87], v[40:43]
  v_mfma_f32_16x16x32_bf16 v[44:47], a[188:191], v[84:87], v[44:47]
  v_mfma_f32_16x16x32_bf16 v[48:51], a[176:179], v[88:91], v[48:51]
  v_mfma_f32_16x16x32_bf16 v[52:55], a[180:183], v[88:91], v[52:55]
  v_mfma_f32_16x16x32_bf16 v[56:59], a[184:187], v[88:91], v[56:59]
  v_mfma_f32_16x16x32_bf16 v[60:63], a[188:191], v[88:91], v[60:63]
  v_mfma_f32_16x16x32_bf16 v[64:67], a[176:179], v[92:95], v[64:67]
  v_mfma_f32_16x16x32_bf16 v[68:71], a[180:183], v[92:95], v[68:71]
  v_mfma_f32_16x16x32_bf16 v[72:75], a[184:187], v[92:95], v[72:75]
  v_mfma_f32_16x16x32_bf16 v[76:79], a[188:191], v[92:95], v[76:79]
  s_waitcnt vmcnt(8)
  v_mfma_f32_16x16x32_bf16 v[32:35], a[192:195], v[100:103], v[32:35]
  v_mfma_f32_16x16x32_bf16 v[36:39], a[196:199], v[100:103], v[36:39]
  v_mfma_f32_16x16x32_bf16 v[40:43], a[200:203], v[100:103], v[40:43]
  v_mfma_f32_16x16x32_bf16 v[44:47], a[204:207], v[100:103], v[44:47]
  s_waitcnt vmcnt(4)
  v_mfma_f32_16x16x32_bf16 v[32:35], a[208:211], v[116:119], v[32:35]
  v_mfma_f32_16x16x32_bf16 v[36:39], a[212:215], v[116:119], v[36:39]
  v_mfma_f32_16x16x32_bf16 v[40:43], a[216:219], v[116:119], v[40:43]
  v_mfma_f32_16x16x32_bf16 v[44:47], a[220:223], v[116:119], v[44:47]
  v_mfma_f32_16x16x32_bf16 v[48:51], a[192:195], v[104:107], v[48:51]
  v_mfma_f32_16x16x32_bf16 v[52:55], a[196:199], v[104:107], v[52:55]
  s_nop 2
  ds_write_b128 v4, v[32:35] offset:0
  v_mfma_f32_16x16x32_bf16 v[56:59], a[200:203], v[104:107], v[56:59]
  v_mfma_f32_16x16x32_bf16 v[60:63], a[204:207], v[104:107], v[60:63]
  v_mfma_f32_16x16x32_bf16 v[48:51], a[208:211], v[120:123], v[48:51]
  ds_write_b128 v4, v[36:39] offset:1024
  v_mfma_f32_16x16x32_bf16 v[52:55], a[212:215], v[120:123], v[52:55]
  v_mfma_f32_16x16x32_bf16 v[56:59], a[216:219], v[120:123], v[56:59]
  v_mfma_f32_16x16x32_bf16 v[60:63], a[220:223], v[120:123], v[60:63]
  ds_write_b128 v4, v[40:43] offset:2048
  ds_write_b128 v4, v[44:47] offset:3072
  s_lshr_b32 s12, s2, 3
  s_and_b32 s12, s12, 31
  s_add_u32 s12, s12, s3
  s_cmp_eq_u32 s12, 0
  s_cbranch_scc1 FWB
  buffer_load_dword v12, v7, s[44:47], s17 offen sc1
FNWB:
  v_mfma_f32_16x16x32_bf16 v[64:67], a[192:195], v[108:111], v[64:67]
  s_waitcnt vmcnt(1)
  v_lshlrev_b32 v144, 16, v128
  v_and_b32 v145, 0xffff0000, v128
  v_mfma_f32_16x16x32_bf16 v[68:71], a[196:199], v[108:111], v[68:71]
  ds_write_b128 v5, v[48:51] offset:4096
  v_mfma_f32_16x16x32_bf16 v[72:75], a[200:203], v[108:111], v[72:75]
  v_lshlrev_b32 v146, 16, v132
  v_and_b32 v147, 0xffff0000, v132
  v_mfma_f32_16x16x32_bf16 v[76:79], a[204:207], v[108:111], v[76:79]
  v_lshlrev_b32 v148, 16, v130
  v_and_b32 v149, 0xffff0000, v130
  v_mfma_f32_16x16x32_bf16 v[64:67], a[208:211], v[124:127], v[64:67]
  ds_write_b128 v5, v[52:55] offset:5120
  v_mfma_f32_16x16x32_bf16 v[68:71], a[212:215], v[124:127], v[68:71]
  v_lshlrev_b32 v150, 16, v134
  v_and_b32 v151, 0xffff0000, v134
  v_mfma_f32_16x16x32_bf16 v[72:75], a[216:219], v[124:127], v[72:75]
  v_lshlrev_b32 v152, 16, v136
  v_and_b32 v153, 0xffff0000, v136
  v_mfma_f32_16x16x32_bf16 v[76:79], a[220:223], v[124:127], v[76:79]
  ds_write_b128 v5, v[56:59] offset:6144
  ds_write_b128 v5, v[60:63] offset:7168
  v_mfma_f32_16x16x32_bf16 v[16:19], a[192:195], v[96:99], v[16:19]
  v_lshlrev_b32 v154, 16, v140
  v_and_b32 v155, 0xffff0000, v140
  v_mfma_f32_16x16x32_bf16 v[20:23], a[196:199], v[96:99], v[20:23]
  ds_write_b128 v6, v[64:67] offset:8192
  v_mfma_f32_16x16x32_bf16 v[24:27], a[200:203], v[96:99], v[24:27]
  v_lshlrev_b32 v156, 16, v138
  v_and_b32 v157, 0xffff0000, v138
  v_mfma_f32_16x16x32_bf16 v[28:31], a[204:207], v[96:99], v[28:31]
  v_lshlrev_b32 v158, 16, v142
  v_and_b32 v159, 0xffff0000, v142
  v_mfma_f32_16x16x32_bf16 v[16:19], a[208:211], v[112:115], v[16:19]
  ds_write_b128 v6, v[68:71] offset:9216
  v_mfma_f32_16x16x32_bf16 v[20:23], a[212:215], v[112:115], v[20:23]
  v_mfma_f32_16x16x32_bf16 v[24:27], a[216:219], v[112:115], v[24:27]
  v_mfma_f32_16x16x32_bf16 v[28:31], a[220:223], v[112:115], v[28:31]
  ds_write_b128 v6, v[72:75] offset:10240
  ds_write_b128 v6, v[76:79] offset:11264
  s_waitcnt lgkmcnt(0)
  s_barrier
  ds_read_b128 v[160:163], v3 offset:0
  ds_read_b128 v[164:167], v3 offset:1024
  ds_read_b128 v[168:171], v3 offset:2048
  ds_read_b128 v[172:175], v3 offset:3072
  ds_read_b128 v[176:179], v3 offset:4096
  ds_read_b128 v[180:183], v3 offset:5120
  ds_read_b128 v[184:187], v3 offset:6144
  ds_read_b128 v[188:191], v3 offset:7168
  ds_read_b128 v[192:195], v3 offset:8192
  ds_read_b128 v[196:199], v3 offset:9216
  ds_read_b128 v[200:203], v3 offset:10240
  ds_read_b128 v[204:207], v3 offset:11264
  v_and_b32 v4, 15, v2
  v_lshrrev_b32 v5, 4, v2
  s_waitcnt lgkmcnt(8)
  v_pk_add_f32 v[16:17], v[16:17], v[160:161]
  v_pk_add_f32 v[18:19], v[18:19], v[162:163]
  v_pk_add_f32 v[20:21], v[20:21], v[164:165]
  v_pk_add_f32 v[22:23], v[22:23], v[166:167]
  v_pk_add_f32 v[24:25], v[24:25], v[168:169]
  v_pk_add_f32 v[26:27], v[26:27], v[170:171]
  v_pk_add_f32 v[28:29], v[28:29], v[172:173]
  v_pk_add_f32 v[30:31], v[30:31], v[174:175]
  s_waitcnt lgkmcnt(4)
  v_pk_add_f32 v[16:17], v[16:17], v[176:177]
  v_pk_add_f32 v[18:19], v[18:19], v[178:179]
  v_pk_add_f32 v[20:21], v[20:21], v[180:181]
  v_pk_add_f32 v[22:23], v[22:23], v[182:183]
  v_pk_add_f32 v[24:25], v[24:25], v[184:185]
  v_pk_add_f32 v[26:27], v[26:27], v[186:187]
  v_pk_add_f32 v[28:29], v[28:29], v[188:189]
  v_pk_add_f32 v[30:31], v[30:31], v[190:191]
  s_waitcnt lgkmcnt(0)
  v_pk_add_f32 v[16:17], v[16:17], v[192:193]
  v_pk_add_f32 v[18:19], v[18:19], v[194:195]
  v_pk_add_f32 v[20:21], v[20:21], v[196:197]
  v_pk_add_f32 v[22:23], v[22:23], v[198:199]
  v_pk_add_f32 v[24:25], v[24:25], v[200:201]
  v_pk_add_f32 v[26:27], v[26:27], v[202:203]
  v_pk_add_f32 v[28:29], v[28:29], v[204:205]
  v_pk_add_f32 v[30:31], v[30:31], v[206:207]
  v_cvt_pk_bf16_f32 v16, v16, v17
  v_cvt_pk_bf16_f32 v18, v18, v19
  v_cvt_pk_bf16_f32 v20, v20, v21
  v_cvt_pk_bf16_f32 v22, v22, v23
  v_cvt_pk_bf16_f32 v24, v24, v25
  v_cvt_pk_bf16_f32 v26, v26, v27
  v_cvt_pk_bf16_f32 v28, v28, v29
  v_cvt_pk_bf16_f32 v30, v30, v31
  v_and_b32 v17, 0xffff0000, v16
  v_lshlrev_b32 v16, 16, v16
  v_and_b32 v19, 0xffff0000, v18
  v_lshlrev_b32 v18, 16, v18
  v_and_b32 v21, 0xffff0000, v20
  v_lshlrev_b32 v20, 16, v20
  v_and_b32 v23, 0xffff0000, v22
  v_lshlrev_b32 v22, 16, v22
  v_and_b32 v25, 0xffff0000, v24
  v_lshlrev_b32 v24, 16, v24
  v_and_b32 v27, 0xffff0000, v26
  v_lshlrev_b32 v26, 16, v26
  v_and_b32 v29, 0xffff0000, v28
  v_lshlrev_b32 v28, 16, v28
  v_and_b32 v31, 0xffff0000, v30
  v_lshlrev_b32 v30, 16, v30
  v_pk_add_f32 v[16:17], v[16:17], v[144:145]
  v_pk_add_f32 v[18:19], v[18:19], v[146:147]
  v_pk_add_f32 v[20:21], v[20:21], v[148:149]
  v_pk_add_f32 v[22:23], v[22:23], v[150:151]
  v_pk_add_f32 v[24:25], v[24:25], v[152:153]
  v_pk_add_f32 v[26:27], v[26:27], v[154:155]
  v_pk_add_f32 v[28:29], v[28:29], v[156:157]
  v_pk_add_f32 v[30:31], v[30:31], v[158:159]
  v_cvt_pk_bf16_f32 v32, v16, v17
  v_cvt_pk_bf16_f32 v33, v18, v19
  v_cvt_pk_bf16_f32 v34, v20, v21
  v_cvt_pk_bf16_f32 v35, v22, v23
  v_cvt_pk_bf16_f32 v36, v24, v25
  v_cvt_pk_bf16_f32 v37, v26, v27
  v_cvt_pk_bf16_f32 v38, v28, v29
  v_cvt_pk_bf16_f32 v39, v30, v31
  v_permlane16_swap_b32 v32, v34
  v_permlane16_swap_b32 v33, v35
  v_permlane16_swap_b32 v36, v38
  v_permlane16_swap_b32 v37, v39
  s_lshl_b32 s12, s7, 16
  s_lshl_b32 s13, s3, 14
  s_add_u32 s12, s12, s13
  s_lshl_b32 s13, s8, 7
  s_add_u32 s12, s12, s13
  v_lshl_add_u32 v3, v4, 10, s12
  v_and_b32 v8, 1, v5
  v_lshl_add_u32 v3, v8, 5, v3
  v_lshrrev_b32 v6, 1, v5
  v_lshl_add_u32 v3, v6, 4, v3
  global_store_dwordx4 v3, v[32:35], s[38:39] sc1
  global_store_dwordx4 v3, v[36:39], s[38:39] offset:64 sc1
  s_branch ALL_fin
Rc1u:
  s_cmp_eq_u32 s9, 0
  s_cbranch_scc1 Qc1u
  s_sub_u32 s9, s9, 1
  v_lshlrev_b32 v32, 4, v0
  buffer_load_dwordx4 v[112:115], v12, s[44:47], s28 offen sc1
  buffer_load_dwordx4 v[16:19], v32, s[44:47], s16 offen sc1
  buffer_load_dwordx4 v[116:119], v12, s[44:47], s29 offen sc1
  buffer_load_dwordx4 v[20:23], v32, s[44:47], s17 offen sc1
  buffer_load_dwordx4 v[120:123], v12, s[44:47], s30 offen sc1
  buffer_load_dwordx4 v[24:27], v32, s[44:47], s18 offen sc1
  buffer_load_dwordx4 v[124:127], v12, s[44:47], s31 offen sc1
  buffer_load_dwordx4 v[28:31], v32, s[44:47], s19 offen sc1
  s_waitcnt vmcnt(0)
  v_cmp_ne_u64 vcc, s[10:11], v[114:115]
  v_cmp_ne_u64 s[22:23], s[10:11], v[18:19]
  v_cmp_ne_u64 s[20:21], s[10:11], v[118:119]
  s_or_b64 vcc, vcc, s[22:23]
  v_cmp_ne_u64 s[22:23], s[10:11], v[22:23]
  s_or_b64 vcc, vcc, s[20:21]
  v_cmp_ne_u64 s[20:21], s[10:11], v[122:123]
  s_or_b64 vcc, vcc, s[22:23]
  v_cmp_ne_u64 s[22:23], s[10:11], v[26:27]
  s_or_b64 vcc, vcc, s[20:21]
  v_cmp_ne_u64 s[20:21], s[10:11], v[126:127]
  s_or_b64 vcc, vcc, s[22:23]
  v_cmp_ne_u64 s[22:23], s[10:11], v[30:31]
  s_or_b64 vcc, vcc, s[20:21]
  s_or_b64 vcc, vcc, s[22:23]
  s_cbranch_vccnz Rc1u
Qc1u:
  s_nop 4
  s_branch Bc1u
Rfw:
  s_cmp_eq_u32 s9, 0
  s_cbranch_scc1 Qfw
  s_sub_u32 s9, s9, 1
  buffer_load_dwordx4 v[116:119], v127, s[44:47], s17 offen sc1
  s_waitcnt vmcnt(0)
  v_cmp_ne_u64 vcc, s[10:11], v[116:117]
  v_cmp_ne_u64 s[20:21], s[10:11], v[118:119]
  s_nop 0
  s_or_b64 vcc, vcc, s[20:21]
  s_cbranch_vccnz Rfw
Qfw:
  s_nop 4
  s_branch Bfw
RFg11x0:
  s_cmp_eq_u32 s9, 0
  s_cbranch_scc1 QFg11x0
  s_sub_u32 s9, s9, 1
  s_mov_b64 exec, vcc
  buffer_load_dwordx4 v[116:119], v3, s[44:47], s16 offen offset:0 sc1
  buffer_load_dwordx4 v[120:123], v3, s[44:47], s16 offen offset:1024 sc1
  buffer_load_dwordx4 v[124:127], v4, s[44:47], s16 offen offset:0 sc1
  buffer_load_dwordx4 v[128:131], v4, s[44:47], s16 offen offset:1024 sc1
  s_waitcnt vmcnt(0)
  v_max3_u32 v111, v116, v118, v120
  v_max3_u32 v111, v111, v122, v124
  v_max3_u32 v111, v111, v126, v128
  v_max_u32 v111, v111, v130
  v_cmp_eq_u32 vcc, -1, v111
  s_cbranch_vccnz RFg11x0
QFg11x0:
  s_mov_b64 exec, -1
  buffer_load_dwordx4 v[132:135], v5, s[44:47], s16 offen offset:0 sc1
  buffer_load_dwordx4 v[136:139], v5, s[44:47], s16 offen offset:1024 sc1
  buffer_load_dwordx4 v[140:143], v6, s[44:47], s16 offen offset:0 sc1
  buffer_load_dwordx4 v[144:147], v6, s[44:47], s16 offen offset:1024 sc1
  buffer_load_dwordx4 v[148:151], v3, s[44:47], s17 offen offset:0 sc1
  buffer_load_dwordx4 v[152:155], v3, s[44:47], s17 offen offset:1024 sc1
  buffer_load_dwordx4 v[156:159], v4, s[44:47], s17 offen offset:0 sc1
  buffer_load_dwordx4 v[160:163], v4, s[44:47], s17 offen offset:1024 sc1
  s_nop 4
  s_branch BFg11x0
RFg11x1:
  s_cmp_eq_u32 s9, 0
  s_cbranch_scc1 QFg11x1
  s_sub_u32 s9, s9, 1
  s_mov_b64 exec, vcc
  buffer_load_dwordx4 v[132:135], v5, s[44:47], s16 offen offset:0 sc1
  buffer_load_dwordx4 v[136:139], v5, s[44:47], s16 offen offset:1024 sc1
  buffer_load_dwordx4 v[140:143], v6, s[44:47], s16 offen offset:0 sc1
  buffer_load_dwordx4 v[144:147], v6, s[44:47], s16 offen offset:1024 sc1
  s_waitcnt vmcnt(0)
  v_max3_u32 v111, v132, v134, v136
  v_max3_u32 v111, v111, v138, v140
  v_max3_u32 v111, v111, v142, v144
  v_max_u32 v111, v111, v146
  v_cmp_eq_u32 vcc, -1, v111
  s_cbranch_vccnz RFg11x1
QFg11x1:
  s_mov_b64 exec, -1
  buffer_load_dwordx4 v[148:151], v3, s[44:47], s17 offen offset:0 sc1
  buffer_load_dwordx4 v[152:155], v3, s[44:47], s17 offen offset:1024 sc1
  buffer_load_dwordx4 v[156:159], v4, s[44:47], s17 offen offset:0 sc1
  buffer_load_dwordx4 v[160:163], v4, s[44:47], s17 offen offset:1024 sc1
  buffer_load_dwordx4 v[164:167], v5, s[44:47], s17 offen offset:0 sc1
  buffer_load_dwordx4 v[168:171], v5, s[44:47], s17 offen offset:1024 sc1
  s_mov_b64 exec, 1
  buffer_load_dword a255, v3, s[44:47], s16 offen sc1
  buffer_load_dword a255, v3, s[44:47], s16 offen sc1
  buffer_load_dword a255, v3, s[44:47], s16 offen sc1
  s_mov_b64 exec, -1
  s_nop 4
  s_branch BFg11x1
RFg11x2:
  s_cmp_eq_u32 s9, 0
  s_cbranch_scc1 QFg11x2
  s_sub_u32 s9, s9, 1
  s_mov_b64 exec, vcc
  buffer_load_dwordx4 v[148:151], v3, s[44:47], s17 offen offset:0 sc1
  buffer_load_dwordx4 v[152:155], v3, s[44:47], s17 offen offset:1024 sc1
  buffer_load_dwordx4 v[156:159], v4, s[44:47], s17 offen offset:0 sc1
  buffer_load_dwordx4 v[160:163], v4, s[44:47], s17 offen offset:1024 sc1
  s_waitcnt vmcnt(0)
  v_max3_u32 v111, v148, v150, v152
  v_max3_u32 v111, v111, v154, v156
  v_max3_u32 v111, v111, v158, v160
  v_max_u32 v111, v111, v162
  v_cmp_eq_u32 vcc, -1, v111
  s_cbranch_vccnz RFg11x2
QFg11x2:
  s_mov_b64 exec, -1
  buffer_load_dwordx4 v[164:167], v5, s[44:47], s17 offen offset:0 sc1
  buffer_load_dwordx4 v[168:171], v5, s[44:47], s17 offen offset:1024 sc1
  buffer_load_dwordx4 v[172:175], v6, s[44:47], s17 offen offset:0 sc1
  buffer_load_dwordx4 v[176:179], v6, s[44:47], s17 offen offset:1024 sc1
  buffer_load_dwordx4 v[180:183], v3, s[44:47], s18 offen offset:0 sc1
  buffer_load_dwordx4 v[184:187], v3, s[44:47], s18 offen offset:1024 sc1
  s_mov_b64 exec, 1
  buffer_load_dword a255, v3, s[44:47], s16 offen sc1
  buffer_load_dword a255, v3, s[44:47], s16 offen sc1
  buffer_load_dword a255, v3, s[44:47], s16 offen sc1
  buffer_load_dword a255, v3, s[44:47], s16 offen sc1
  buffer_load_dword a255, v3, s[44:47], s16 offen sc1
  s_mov_b64 exec, -1
  s_nop 4
  s_branch BFg11x2
RFg11x3:
  s_cmp_eq_u32 s9, 0
  s_cbranch_scc1 QFg11x3
  s_sub_u32 s9, s9, 1
  s_mov_b64 exec, vcc
  buffer_load_dwordx4 v[164:167], v5, s[44:47], s17 offen offset:0 sc1
  buffer_load_dwordx4 v[168:171], v5, s[44:47], s17 offen offset:1024 sc1
  buffer_load_dwordx4 v[172:175], v6, s[44:47], s17 offen offset:0 sc1
  buffer_load_dwordx4 v[176:179], v6, s[44:47], s17 offen offset:1024 sc1
  s_waitcnt vmcnt(0)
  v_max3_u32 v111, v164, v166, v168
  v_max3_u32 v111, v111, v170, v172
  v_max3_u32 v111, v111, v174, v176
  v_max_u32 v111, v111, v178
  v_cmp_eq_u32 vcc, -1, v111
  s_cbranch_vccnz RFg11x3
QFg11x3:
  s_mov_b64 exec, -1
  buffer_load_dwordx4 v[180:183], v3, s[44:47], s18 offen offset:0 sc1
  buffer_load_dwordx4 v[184:187], v3, s[44:47], s18 offen offset:1024 sc1
  buffer_load_dwordx4 v[188:191], v4, s[44:47], s18 offen offset:0 sc1
  buffer_load_dwordx4 v[192:195], v4, s[44:47], s18 offen offset:1024 sc1
  buffer_load_dwordx4 v[196:199], v5, s[44:47], s18 offen offset:0 sc1
  buffer_load_dwordx4 v[200:203], v5, s[44:47], s18 offen offset:1024 sc1
  s_mov_b64 exec, 1
  buffer_load_dword a255, v3, s[44:47], s16 offen sc1
  buffer_load_dword a255, v3, s[44:47], s16 offen sc1
  s_mov_b64 exec, -1
  s_nop 4
  s_branch BFg11x3
RFg11x4:
  s_cmp_eq_u32 s9, 0
  s_cbranch_scc1 QFg11x4
  s_sub_u32 s9, s9, 1
  s_mov_b64 exec, vcc
  buffer_load_dwordx4 v[180:183], v3, s[44:47], s18 offen offset:0 sc1
  buffer_load_dwordx4 v[184:187], v3, s[44:47], s18 offen offset:1024 sc1
  buffer_load_dwordx4 v[188:191], v4, s[44:47], s18 offen offset:0 sc1
  buffer_load_dwordx4 v[192:195], v4, s[44:47], s18 offen offset:1024 sc1
  s_waitcnt vmcnt(0)
  v_max3_u32 v111, v180, v182, v184
  v_max3_u32 v111, v111, v186, v188
  v_max3_u32 v111, v111, v190, v192
  v_max_u32 v111, v111, v194
  v_cmp_eq_u32 vcc, -1, v111
  s_cbranch_vccnz RFg11x4
QFg11x4:
  s_mov_b64 exec, -1
  buffer_load_dwordx4 v[196:199], v5, s[44:47], s18 offen offset:0 sc1
  buffer_load_dwordx4 v[200:203], v5, s[44:47], s18 offen offset:1024 sc1
  buffer_load_dwordx4 v[204:207], v6, s[44:47], s18 offen offset:0 sc1
  buffer_load_dwordx4 v[208:211], v6, s[44:47], s18 offen offset:1024 sc1
  buffer_load_dwordx4 v[212:215], v3, s[44:47], s19 offen offset:0 sc1
  buffer_load_dwordx4 v[216:219], v3, s[44:47], s19 offen offset:1024 sc1
  s_nop 4
  s_branch BFg11x4
RFg11x5:
  s_cmp_eq_u32 s9, 0
  s_cbranch_scc1 QFg11x5
  s_sub_u32 s9, s9, 1
  s_mov_b64 exec, vcc
  buffer_load_dwordx4 v[196:199], v5, s[44:47], s18 offen offset:0 sc1
  buffer_load_dwordx4 v[200:203], v5, s[44:47], s18 offen offset:1024 sc1
  buffer_load_dwordx4 v[204:207], v6, s[44:47], s18 offen offset:0 sc1
  buffer_load_dwordx4 v[208:211], v6, s[44:47], s18 offen offset:1024 sc1
  s_waitcnt vmcnt(0)
  v_max3_u32 v111, v196, v198, v200
  v_max3_u32 v111, v111, v202, v204
  v_max3_u32 v111, v111, v206, v208
  v_max_u32 v111, v111, v210
  v_cmp_eq_u32 vcc, -1, v111
  s_cbranch_vccnz RFg11x5
QFg11x5:
  s_mov_b64 exec, -1
  buffer_load_dwordx4 v[212:215], v3, s[44:47], s19 offen offset:0 sc1
  buffer_load_dwordx4 v[216:219], v3, s[44:47], s19 offen offset:1024 sc1
  buffer_load_dwordx4 v[220:223], v4, s[44:47], s19 offen offset:0 sc1
  buffer_load_dwordx4 v[224:227], v4, s[44:47], s19 offen offset:1024 sc1
  buffer_load_dwordx4 v[228:231], v5, s[44:47], s19 offen offset:0 sc1
  buffer_load_dwordx4 v[232:235], v5, s[44:47], s19 offen offset:1024 sc1
  s_nop 4
  s_branch BFg11x5
RFg11x6:
  s_cmp_eq_u32 s9, 0
  s_cbranch_scc1 QFg11x6
  s_sub_u32 s9, s9, 1
  s_mov_b64 exec, vcc
  buffer_load_dwordx4 v[212:215], v3, s[44:47], s19 offen offset:0 sc1
  buffer_load_dwordx4 v[216:219], v3, s[44:47], s19 offen offset:1024 sc1
  buffer_load_dwordx4 v[220:223], v4, s[44:47], s19 offen offset:0 sc1
  buffer_load_dwordx4 v[224:227], v4, s[44:47], s19 offen offset:1024 sc1
  s_waitcnt vmcnt(0)
  v_max3_u32 v111, v212, v214, v216
  v_max3_u32 v111, v111, v218, v220
  v_max3_u32 v111, v111, v222, v224
  v_max_u32 v111, v111, v226
  v_cmp_eq_u32 vcc, -1, v111
  s_cbranch_vccnz RFg11x6
QFg11x6:
  s_mov_b64 exec, -1
  buffer_load_dwordx4 v[228:231], v5, s[44:47], s19 offen offset:0 sc1
  buffer_load_dwordx4 v[232:235], v5, s[44:47], s19 offen offset:1024 sc1
  buffer_load_dwordx4 v[236:239], v6, s[44:47], s19 offen offset:0 sc1
  buffer_load_dwordx4 v[240:243], v6, s[44:47], s19 offen offset:1024 sc1
  s_waitcnt vmcnt(0)
  s_nop 4
  s_branch BFg11x6
RFg11x7:
  s_cmp_eq_u32 s9, 0
  s_cbranch_scc1 QFg11x7
  s_sub_u32 s9, s9, 1
  s_mov_b64 exec, vcc
  buffer_load_dwordx4 v[228:231], v5, s[44:47], s19 offen offset:0 sc1
  buffer_load_dwordx4 v[232:235], v5, s[44:47], s19 offen offset:1024 sc1
  buffer_load_dwordx4 v[236:239], v6, s[44:47], s19 offen offset:0 sc1
  buffer_load_dwordx4 v[240:243], v6, s[44:47], s19 offen offset:1024 sc1
  s_waitcnt vmcnt(0)
  v_max3_u32 v111, v228, v230, v232
  v_max3_u32 v111, v111, v234, v236
  v_max3_u32 v111, v111, v238, v240
  v_max_u32 v111, v111, v242
  v_cmp_eq_u32 vcc, -1, v111
  s_cbranch_vccnz RFg11x7
QFg11x7:
  s_mov_b64 exec, -1
  s_nop 4
  s_branch BFg11x7
RFg11p:
  s_cmp_eq_u32 s9, 0
  s_cbranch_scc1 QFg11p
  s_sub_u32 s9, s9, 1
  buffer_load_dwordx4 v[116:119], v7, s[44:47], s29 offen offset:0 sc1
  buffer_load_dwordx4 v[120:123], v7, s[44:47], s29 offen offset:512 sc1
  buffer_load_dwordx4 v[124:127], v7, s[44:47], s29 offen offset:1024 sc1
  buffer_load_dwordx4 v[128:131], v7, s[44:47], s29 offen offset:1536 sc1
  buffer_load_dwordx4 v[132:135], v7, s[44:47], s29 offen offset:2048 sc1
  buffer_load_dwordx4 v[136:139], v7, s[44:47], s29 offen offset:2560 sc1
  buffer_load_dwordx4 v[140:143], v7, s[44:47], s29 offen offset:3072 sc1
  buffer_load_dwordx4 v[144:147], v7, s[44:47], s29 offen offset:3584 sc1
  s_waitcnt vmcnt(0)
  v_cmp_ne_u64 s[24:25], s[10:11], v[118:119]
  v_cmp_ne_u64 s[22:23], s[10:11], v[122:123]
  v_cmp_ne_u64 s[20:21], s[10:11], v[126:127]
  s_or_b64 s[24:25], s[24:25], s[22:23]
  v_cmp_ne_u64 s[22:23], s[10:11], v[130:131]
  s_or_b64 s[24:25], s[24:25], s[20:21]
  v_cmp_ne_u64 s[20:21], s[10:11], v[134:135]
  s_or_b64 s[24:25], s[24:25], s[22:23]
  v_cmp_ne_u64 s[22:23], s[10:11], v[138:139]
  s_or_b64 s[24:25], s[24:25], s[20:21]
  v_cmp_ne_u64 s[20:21], s[10:11], v[142:143]
  s_or_b64 s[24:25], s[24:25], s[22:23]
  v_cmp_ne_u64 s[22:23], s[10:11], v[146:147]
  s_or_b64 s[24:25], s[24:25], s[20:21]
  s_or_b64 vcc, s[24:25], s[22:23]
  s_cbranch_vccnz RFg11p
QFg11p:
  s_nop 4
  s_branch BFg11p
RFg21f0:
  s_cmp_eq_u32 s9, 0
  s_cbranch_scc1 QFg21f0
  s_sub_u32 s9, s9, 1
  buffer_load_dwordx2 v[72:73], v3, s[44:47], s31 offen sc1
  s_waitcnt vmcnt(0)
  v_cmp_ne_u64 vcc, s[10:11], v[72:73]
  s_nop 0
  s_and_b32 s12, vcc_lo, 0x11111111
  s_cbranch_scc1 RFg21f0
QFg21f0:
  s_nop 4
  s_branch BFg21f0
RFg21f1:
  s_cmp_eq_u32 s9, 0
  s_cbranch_scc1 QFg21f1
  s_sub_u32 s9, s9, 1
  buffer_load_dwordx2 v[12:13], v3, s[44:47], s31 offen sc1
  s_waitcnt vmcnt(0)
  v_cmp_ne_u64 vcc, s[10:11], v[12:13]
  s_nop 0
  s_and_b32 s12, vcc_lo, 0x22222222
  s_cbranch_scc1 RFg21f1
QFg21f1:
  s_nop 4
  s_branch BFg21f1
RFg21f2:
  s_cmp_eq_u32 s9, 0
  s_cbranch_scc1 QFg21f2
  s_sub_u32 s9, s9, 1
  buffer_load_dwordx2 v[12:13], v3, s[44:47], s31 offen sc1
  s_waitcnt vmcnt(0)
  v_cmp_ne_u64 vcc, s[10:11], v[12:13]
  s_nop 0
  s_and_b32 s12, vcc_lo, 0x44444444
  s_cbranch_scc1 RFg21f2
QFg21f2:
  s_nop 4
  s_branch BFg21f2
RFg21f3:
  s_cmp_eq_u32 s9, 0
  s_cbranch_scc1 QFg21f3
  s_sub_u32 s9, s9, 1
  buffer_load_dwordx2 v[12:13], v3, s[44:47], s31 offen sc1
  s_waitcnt vmcnt(0)
  v_cmp_ne_u64 vcc, s[10:11], v[12:13]
  s_nop 0
  s_and_b32 s12, vcc_lo, 0x88888888
  s_cbranch_scc1 RFg21f3
QFg21f3:
  s_nop 4
  s_branch BFg21f3
RFmidfb:
  s_cmp_eq_u32 s9, 0
  s_cbranch_scc1 QFmidfb
  s_sub_u32 s9, s9, 1
  buffer_load_dwordx4 v[112:115], v120, s[44:47], 0 offen offset:0 sc1
  buffer_load_dwordx4 v[116:119], v120, s[44:47], 0 offen offset:16 sc1
  s_waitcnt vmcnt(0)
  v_cmp_ne_u64 vcc, s[10:11], v[112:113]
  v_cmp_ne_u64 s[26:27], s[10:11], v[114:115]
  v_cmp_ne_u64 s[24:25], s[10:11], v[116:117]
  s_or_b64 vcc, vcc, s[26:27]
  v_cmp_ne_u64 s[26:27], s[10:11], v[118:119]
  s_or_b64 vcc, vcc, s[24:25]
  s_or_b64 vcc, vcc, s[26:27]
  s_cbranch_vccnz RFmidfb
QFmidfb:
  s_nop 4
  s_branch BFmidfb
RFmid:
  s_cmp_eq_u32 s9, 0
  s_cbranch_scc1 QFmid
  s_sub_u32 s9, s9, 1
  buffer_load_dwordx4 v[80:83], v94, s[44:47], s19 offen offset:0 sc1
  buffer_load_dwordx4 v[84:87], v94, s[44:47], s19 offen offset:256 sc1
  s_waitcnt vmcnt(0)
  v_cmp_ne_u64 vcc, s[10:11], v[82:83]
  v_cmp_ne_u64 s[20:21], s[10:11], v[86:87]
  s_nop 0
  s_or_b64 vcc, vcc, s[20:21]
  s_cbranch_vccnz RFmid
QFmid:
  s_nop 4
  s_branch BFmid
RFc2s0:
  s_cmp_eq_u32 s9, 0
  s_cbranch_scc1 QFc2s0
  s_sub_u32 s9, s9, 1
  buffer_load_dwordx4 v[112:115], v12, s[44:47], s28 offen sc1
  s_waitcnt vmcnt(0)
  v_cmp_eq_u32 vcc, -1, v112
  s_cbranch_vccnz RFc2s0
QFc2s0:
  s_nop 4
  s_branch BFc2s0
RFc2s1:
  s_cmp_eq_u32 s9, 0
  s_cbranch_scc1 QFc2s1
  s_sub_u32 s9, s9, 1
  buffer_load_dwordx4 v[116:119], v12, s[44:47], s29 offen sc1
  s_waitcnt vmcnt(0)
  v_cmp_eq_u32 vcc, -1, v116
  s_cbranch_vccnz RFc2s1
QFc2s1:
  s_nop 4
  s_branch BFc2s1
RFc2s2:
  s_cmp_eq_u32 s9, 0
  s_cbranch_scc1 QFc2s2
  s_sub_u32 s9, s9, 1
  buffer_load_dwordx4 v[120:123], v12, s[44:47], s30 offen sc1
  s_waitcnt vmcnt(0)
  v_cmp_eq_u32 vcc, -1, v120
  s_cbranch_vccnz RFc2s2
QFc2s2:
  s_nop 4
  s_branch BFc2s2
RFc2s3:
  s_cmp_eq_u32 s9, 0
  s_cbranch_scc1 QFc2s3
  s_sub_u32 s9, s9, 1
  buffer_load_dwordx4 v[124:127], v12, s[44:47], s31 offen sc1
  s_waitcnt vmcnt(0)
  v_cmp_eq_u32 vcc, -1, v124
  s_cbranch_vccnz RFc2s3
QFc2s3:
  s_nop 4
  s_branch BFc2s3
RFg12x0:
  s_cmp_eq_u32 s9, 0
  s_cbranch_scc1 QFg12x0
  s_sub_u32 s9, s9, 1
  s_mov_b64 exec, vcc
  buffer_load_dwordx4 v[116:119], v3, s[44:47], s16 offen offset:0 sc1
  buffer_load_dwordx4 v[120:123], v3, s[44:47], s16 offen offset:1024 sc1
  buffer_load_dwordx4 v[124:127], v4, s[44:47], s16 offen offset:0 sc1
  buffer_load_dwordx4 v[128:131], v4, s[44:47], s16 offen offset:1024 sc1
  s_waitcnt vmcnt(0)
  v_max3_u32 v111, v116, v118, v120
  v_max3_u32 v111, v111, v122, v124
  v_max3_u32 v111, v111, v126, v128
  v_max_u32 v111, v111, v130
  v_cmp_eq_u32 vcc, -1, v111
  s_cbranch_vccnz RFg12x0
QFg12x0:
  s_mov_b64 exec, -1
  buffer_load_dwordx4 v[132:135], v5, s[44:47], s16 offen offset:0 sc1
  buffer_load_dwordx4 v[136:139], v5, s[44:47], s16 offen offset:1024 sc1
  buffer_load_dwordx4 v[140:143], v6, s[44:47], s16 offen offset:0 sc1
  buffer_load_dwordx4 v[144:147], v6, s[44:47], s16 offen offset:1024 sc1
  buffer_load_dwordx4 v[148:151], v3, s[44:47], s17 offen offset:0 sc1
  buffer_load_dwordx4 v[152:155], v3, s[44:47], s17 offen offset:1024 sc1
  buffer_load_dwordx4 v[156:159], v4, s[44:47], s17 offen offset:0 sc1
  buffer_load_dwordx4 v[160:163], v4, s[44:47], s17 offen offset:1024 sc1
  s_nop 4
  s_branch BFg12x0
RFg12x1:
  s_cmp_eq_u32 s9, 0
  s_cbranch_scc1 QFg12x1
  s_sub_u32 s9, s9, 1
  s_mov_b64 exec, vcc
  buffer_load_dwordx4 v[132:135], v5, s[44:47], s16 offen offset:0 sc1
  buffer_load_dwordx4 v[136:139], v5, s[44:47], s16 offen offset:1024 sc1
  buffer_load_dwordx4 v[140:143], v6, s[44:47], s16 offen offset:0 sc1
  buffer_load_dwordx4 v[144:147], v6, s[44:47], s16 offen offset:1024 sc1
  s_waitcnt vmcnt(0)
  v_max3_u32 v111, v132, v134, v136
  v_max3_u32 v111, v111, v138, v140
  v_max3_u32 v111, v111, v142, v144
  v_max_u32 v111, v111, v146
  v_cmp_eq_u32 vcc, -1, v111
  s_cbranch_vccnz RFg12x1
QFg12x1:
  s_mov_b64 exec, -1
  buffer_load_dwordx4 v[148:151], v3, s[44:47], s17 offen offset:0 sc1
  buffer_load_dwordx4 v[152:155], v3, s[44:47], s17 offen offset:1024 sc1
  buffer_load_dwordx4 v[156:159], v4, s[44:47], s17 offen offset:0 sc1
  buffer_load_dwordx4 v[160:163], v4, s[44:47], s17 offen offset:1024 sc1
  buffer_load_dwordx4 v[164:167], v5, s[44:47], s17 offen offset:0 sc1
  buffer_load_dwordx4 v[168:171], v5, s[44:47], s17 offen offset:1024 sc1
  s_mov_b64 exec, 1
  buffer_load_dword a255, v3, s[44:47], s16 offen sc1
  buffer_load_dword a255, v3, s[44:47], s16 offen sc1
  s_mov_b64 exec, -1
  s_nop 4
  s_branch BFg12x1
RFg12x2:
  s_cmp_eq_u32 s9, 0
  s_cbranch_scc1 QFg12x2
  s_sub_u32 s9, s9, 1
  s_mov_b64 exec, vcc
  buffer_load_dwordx4 v[148:151], v3, s[44:47], s17 offen offset:0 sc1
  buffer_load_dwordx4 v[152:155], v3, s[44:47], s17 offen offset:1024 sc1
  buffer_load_dwordx4 v[156:159], v4, s[44:47], s17 offen offset:0 sc1
  buffer_load_dwordx4 v[160:163], v4, s[44:47], s17 offen offset:1024 sc1
  s_waitcnt vmcnt(0)
  v_max3_u32 v111, v148, v150, v152
  v_max3_u32 v111, v111, v154, v156
  v_max3_u32 v111, v111, v158, v160
  v_max_u32 v111, v111, v162
  v_cmp_eq_u32 vcc, -1, v111
  s_cbranch_vccnz RFg12x2
QFg12x2:
  s_mov_b64 exec, -1
  buffer_load_dwordx4 v[164:167], v5, s[44:47], s17 offen offset:0 sc1
  buffer_load_dwordx4 v[168:171], v5, s[44:47], s17 offen offset:1024 sc1
  buffer_load_dwordx4 v[172:175], v6, s[44:47], s17 offen offset:0 sc1
  buffer_load_dwordx4 v[176:179], v6, s[44:47], s17 offen offset:1024 sc1
  buffer_load_dwordx4 v[180:183], v3, s[44:47], s18 offen offset:0 sc1
  buffer_load_dwordx4 v[184:187], v3, s[44:47], s18 offen offset:1024 sc1
  s_mov_b64 exec, 1
  buffer_load_dword a255, v3, s[44:47], s16 offen sc1
  buffer_load_dword a255, v3, s[44:47], s16 offen sc1
  s_mov_b64 exec, -1
  s_nop 4
  s_branch BFg12x2
RFg12x3:
  s_cmp_eq_u32 s9, 0
  s_cbranch_scc1 QFg12x3
  s_sub_u32 s9, s9, 1
  s_mov_b64 exec, vcc
  buffer_load_dwordx4 v[164:167], v5, s[44:47], s17 offen offset:0 sc1
  buffer_load_dwordx4 v[168:171], v5, s[44:47], s17 offen offset:1024 sc1
  buffer_load_dwordx4 v[172:175], v6, s[44:47], s17 offen offset:0 sc1
  buffer_load_dwordx4 v[176:179], v6, s[44:47], s17 offen offset:1024 sc1
  s_waitcnt vmcnt(0)
  v_max3_u32 v111, v164, v166, v168
  v_max3_u32 v111, v111, v170, v172
  v_max3_u32 v111, v111, v174, v176
  v_max_u32 v111, v111, v178
  v_cmp_eq_u32 vcc, -1, v111
  s_cbranch_vccnz RFg12x3
QFg12x3:
  s_mov_b64 exec, -1
  buffer_load_dwordx4 v[180:183], v3, s[44:47], s18 offen offset:0 sc1
  buffer_load_dwordx4 v[184:187], v3, s[44:47], s18 offen offset:1024 sc1
  buffer_load_dwordx4 v[188:191], v4, s[44:47], s18 offen offset:0 sc1
  buffer_load_dwordx4 v[192:195], v4, s[44:47], s18 offen offset:1024 sc1
  buffer_load_dwordx4 v[196:199], v5, s[44:47], s18 offen offset:0 sc1
  buffer_load_dwordx4 v[200:203], v5, s[44:47], s18 offen offset:1024 sc1
  s_nop 4
  s_branch BFg12x3
RFg12x4:
  s_cmp_eq_u32 s9, 0
  s_cbranch_scc1 QFg12x4
  s_sub_u32 s9, s9, 1
  s_mov_b64 exec, vcc
  buffer_load_dwordx4 v[180:183], v3, s[44:47], s18 offen offset:0 sc1
  buffer_load_dwordx4 v[184:187], v3, s[44:47], s18 offen offset:1024 sc1
  buffer_load_dwordx4 v[188:191], v4, s[44:47], s18 offen offset:0 sc1
  buffer_load_dwordx4 v[192:195], v4, s[44:47], s18 offen offset:1024 sc1
  s_waitcnt vmcnt(0)
  v_max3_u32 v111, v180, v182, v184
  v_max3_u32 v111, v111, v186, v188
  v_max3_u32 v111, v111, v190, v192
  v_max_u32 v111, v111, v194
  v_cmp_eq_u32 vcc, -1, v111
  s_cbranch_vccnz RFg12x4
QFg12x4:
  s_mov_b64 exec, -1
  buffer_load_dwordx4 v[196:199], v5, s[44:47], s18 offen offset:0 sc1
  buffer_load_dwordx4 v[200:203], v5, s[44:47], s18 offen offset:1024 sc1
  buffer_load_dwordx4 v[204:207], v6, s[44:47], s18 offen offset:0 sc1
  buffer_load_dwordx4 v[208:211], v6, s[44:47], s18 offen offset:1024 sc1
  buffer_load_dwordx4 v[212:215], v3, s[44:47], s19 offen offset:0 sc1
  buffer_load_dwordx4 v[216:219], v3, s[44:47], s19 offen offset:1024 sc1
  s_nop 4
  s_branch BFg12x4
RFg12x5:
  s_cmp_eq_u32 s9, 0
  s_cbranch_scc1 QFg12x5
  s_sub_u32 s9, s9, 1
  s_mov_b64 exec, vcc
  buffer_load_dwordx4 v[196:199], v5, s[44:47], s18 offen offset:0 sc1
  buffer_load_dwordx4 v[200:203], v5, s[44:47], s18 offen offset:1024 sc1
  buffer_load_dwordx4 v[204:207], v6, s[44:47], s18 offen offset:0 sc1
  buffer_load_dwordx4 v[208:211], v6, s[44:47], s18 offen offset:1024 sc1
  s_waitcnt vmcnt(0)
  v_max3_u32 v111, v196, v198, v200
  v_max3_u32 v111, v111, v202, v204
  v_max3_u32 v111, v111, v206, v208
  v_max_u32 v111, v111, v210
  v_cmp_eq_u32 vcc, -1, v111
  s_cbranch_vccnz RFg12x5
QFg12x5:
  s_mov_b64 exec, -1
  buffer_load_dwordx4 v[212:215], v3, s[44:47], s19 offen offset:0 sc1
  buffer_load_dwordx4 v[216:219], v3, s[44:47], s19 offen offset:1024 sc1
  buffer_load_dwordx4 v[220:223], v4, s[44:47], s19 offen offset:0 sc1
  buffer_load_dwordx4 v[224:227], v4, s[44:47], s19 offen offset:1024 sc1
  buffer_load_dwordx4 v[228:231], v5, s[44:47], s19 offen offset:0 sc1
  buffer_load_dwordx4 v[232:235], v5, s[44:47], s19 offen offset:1024 sc1
  s_nop 4
  s_branch BFg12x5
RFg12x6:
  s_cmp_eq_u32 s9, 0
  s_cbranch_scc1 QFg12x6
  s_sub_u32 s9, s9, 1
  s_mov_b64 exec, vcc
  buffer_load_dwordx4 v[212:215], v3, s[44:47], s19 offen offset:0 sc1
  buffer_load_dwordx4 v[216:219], v3, s[44:47], s19 offen offset:1024 sc1
  buffer_load_dwordx4 v[220:223], v4, s[44:47], s19 offen offset:0 sc1
  buffer_load_dwordx4 v[224:227], v4, s[44:47], s19 offen offset:1024 sc1
  s_waitcnt vmcnt(0)
  v_max3_u32 v111, v212, v214, v216
  v_max3_u32 v111, v111, v218, v220
  v_max3_u32 v111, v111, v222, v224
  v_max_u32 v111, v111, v226
  v_cmp_eq_u32 vcc, -1, v111
  s_cbranch_vccnz RFg12x6
QFg12x6:
  s_mov_b64 exec, -1
  buffer_load_dwordx4 v[228:231], v5, s[44:47], s19 offen offset:0 sc1
  buffer_load_dwordx4 v[232:235], v5, s[44:47], s19 offen offset:1024 sc1
  buffer_load_dwordx4 v[236:239], v6, s[44:47], s19 offen offset:0 sc1
  buffer_load_dwordx4 v[240:243], v6, s[44:47], s19 offen offset:1024 sc1
  s_mov_b64 exec, 1
  buffer_load_dword a255, v3, s[44:47], s16 offen sc1
  buffer_load_dword a255, v3, s[44:47], s16 offen sc1
  buffer_load_dword a255, v3, s[44:47], s16 offen sc1
  buffer_load_dword a255, v3, s[44:47], s16 offen sc1
  buffer_load_dword a255, v3, s[44:47], s16 offen sc1
  buffer_load_dword a255, v3, s[44:47], s16 offen sc1
  buffer_load_dword a255, v3, s[44:47], s16 offen sc1
  buffer_load_dword a255, v3, s[44:47], s16 offen sc1
  s_mov_b64 exec, -1
  s_nop 4
  s_branch BFg12x6
RFg12x7:
  s_cmp_eq_u32 s9, 0
  s_cbranch_scc1 QFg12x7
  s_sub_u32 s9, s9, 1
  s_mov_b64 exec, vcc
  buffer_load_dwordx4 v[228:231], v5, s[44:47], s19 offen offset:0 sc1
  buffer_load_dwordx4 v[232:235], v5, s[44:47], s19 offen offset:1024 sc1
  buffer_load_dwordx4 v[236:239], v6, s[44:47], s19 offen offset:0 sc1
  buffer_load_dwordx4 v[240:243], v6, s[44:47], s19 offen offset:1024 sc1
  s_waitcnt vmcnt(0)
  v_max3_u32 v111, v228, v230, v232
  v_max3_u32 v111, v111, v234, v236
  v_max3_u32 v111, v111, v238, v240
  v_max_u32 v111, v111, v242
  v_cmp_eq_u32 vcc, -1, v111
  s_cbranch_vccnz RFg12x7
QFg12x7:
  s_mov_b64 exec, -1
  s_nop 4
  s_branch BFg12x7
RFg12p:
  s_cmp_eq_u32 s9, 0
  s_cbranch_scc1 QFg12p
  s_sub_u32 s9, s9, 1
  buffer_load_dwordx4 v[116:119], v7, s[44:47], s29 offen offset:0 sc1
  buffer_load_dwordx4 v[120:123], v7, s[44:47], s29 offen offset:512 sc1
  buffer_load_dwordx4 v[124:127], v7, s[44:47], s29 offen offset:1024 sc1
  buffer_load_dwordx4 v[128:131], v7, s[44:47], s29 offen offset:1536 sc1
  buffer_load_dwordx4 v[132:135], v7, s[44:47], s29 offen offset:2048 sc1
  buffer_load_dwordx4 v[136:139], v7, s[44:47], s29 offen offset:2560 sc1
  buffer_load_dwordx4 v[140:143], v7, s[44:47], s29 offen offset:3072 sc1
  buffer_load_dwordx4 v[144:147], v7, s[44:47], s29 offen offset:3584 sc1
  s_waitcnt vmcnt(0)
  v_cmp_ne_u64 s[24:25], s[10:11], v[118:119]
  v_cmp_ne_u64 s[22:23], s[10:11], v[122:123]
  v_cmp_ne_u64 s[20:21], s[10:11], v[126:127]
  s_or_b64 s[24:25], s[24:25], s[22:23]
  v_cmp_ne_u64 s[22:23], s[10:11], v[130:131]
  s_or_b64 s[24:25], s[24:25], s[20:21]
  v_cmp_ne_u64 s[20:21], s[10:11], v[134:135]
  s_or_b64 s[24:25], s[24:25], s[22:23]
  v_cmp_ne_u64 s[22:23], s[10:11], v[138:139]
  s_or_b64 s[24:25], s[24:25], s[20:21]
  v_cmp_ne_u64 s[20:21], s[10:11], v[142:143]
  s_or_b64 s[24:25], s[24:25], s[22:23]
  v_cmp_ne_u64 s[22:23], s[10:11], v[146:147]
  s_or_b64 s[24:25], s[24:25], s[20:21]
  s_or_b64 vcc, s[24:25], s[22:23]
  s_cbranch_vccnz RFg12p
QFg12p:
  s_nop 4
  s_branch BFg12p
RFg22f0:
  s_cmp_eq_u32 s9, 0
  s_cbranch_scc1 QFg22f0
  s_sub_u32 s9, s9, 1
  buffer_load_dwordx2 v[72:73], v3, s[44:47], s31 offen sc1
  s_waitcnt vmcnt(0)
  v_cmp_ne_u64 vcc, s[10:11], v[72:73]
  s_nop 0
  s_and_b32 s12, vcc_lo, 0x11111111
  s_cbranch_scc1 RFg22f0
QFg22f0:
  s_nop 4
  s_branch BFg22f0
RFg22f1:
  s_cmp_eq_u32 s9, 0
  s_cbranch_scc1 QFg22f1
  s_sub_u32 s9, s9, 1
  buffer_load_dwordx2 v[74:75], v3, s[44:47], s31 offen sc1
  s_waitcnt vmcnt(0)
  v_cmp_ne_u64 vcc, s[10:11], v[74:75]
  s_nop 0
  s_and_b32 s12, vcc_lo, 0x22222222
  s_cbranch_scc1 RFg22f1
QFg22f1:
  s_nop 4
  s_branch BFg22f1
RFg22f2:
  s_cmp_eq_u32 s9, 0
  s_cbranch_scc1 QFg22f2
  s_sub_u32 s9, s9, 1
  buffer_load_dwordx2 v[12:13], v3, s[44:47], s31 offen sc1
  s_waitcnt vmcnt(0)
  v_cmp_ne_u64 vcc, s[10:11], v[12:13]
  s_nop 0
  s_and_b32 s12, vcc_lo, 0x44444444
  s_cbranch_scc1 RFg22f2
QFg22f2:
  s_nop 4
  s_branch BFg22f2
RFg22f3:
  s_cmp_eq_u32 s9, 0
  s_cbranch_scc1 QFg22f3
  s_sub_u32 s9, s9, 1
  buffer_load_dwordx2 v[12:13], v3, s[44:47], s31 offen sc1
  s_waitcnt vmcnt(0)
  v_cmp_ne_u64 vcc, s[10:11], v[12:13]
  s_nop 0
  s_and_b32 s12, vcc_lo, 0x88888888
  s_cbranch_scc1 RFg22f3
QFg22f3:
  s_nop 4
  s_branch BFg22f3
FWB:
  buffer_wbl2 sc1
  s_branch FNWB
SLOW:
  s_mul_i32 s12, s8, 229376
  s_add_u32 s12, s12, 0xea0000
  v_lshl_add_u32 v248, v2, 4, s12
  v_add_u32 v249, 0xe000, v248
  v_add_u32 v250, 0x1c000, v248
  v_add_u32 v251, 0x2a000, v248
  buffer_load_dwordx4 a[0:3], v248, s[44:47], s52 offen sc1
  buffer_load_dwordx4 a[4:7], v249, s[44:47], s52 offen sc1
  s_and_b32 s13, s6, 3
  s_lshl_b32 s13, s13, 11
  v_lshl_add_u32 v3, v2, 4, s13
  s_lshl_b32 s12, s5, 2
  s_add_u32 s12, s12, s3
  s_mul_i32 s13, s12, 33024
  s_add_u32 s13, s13, 0x0
  s_lshr_b32 s14, s6, 2
  s_xor_b32 s14, s14, s3
  s_lshl_b32 s14, s14, 13
  s_add_u32 s16, s13, s14
  v_xor_b32 v4, 2048, v3
  v_xor_b32 v5, 4096, v3
  v_xor_b32 v6, 6144, v3
  s_xor_b32 s15, s14, 8192
  s_add_u32 s17, s13, s15
  s_xor_b32 s15, s14, 16384
  s_add_u32 s18, s13, s15
  s_xor_b32 s15, s14, 24576
  s_add_u32 s19, s13, s15
  v_lshrrev_b32 v13, 2, v2
  v_and_b32 v12, 3, v2
  v_mul_u32_u24 v13, 224, v13
  v_lshl_add_u32 v13, v12, 3, v13
  s_and_b32 s13, s6, 1
  s_lshl_b32 s14, s13, 5
  v_add_u32 v13, s14, v13
  s_mul_i32 s30, s13, -224
  s_add_u32 s30, s30, 192
  s_xor_b32 s13, s3, 0
  s_mul_i32 s13, s13, 28672
  v_add_u32 v100, s13, v13
  v_add_u32 v101, s30, v100
  s_xor_b32 s13, s3, 1
  s_mul_i32 s13, s13, 28672
  v_add_u32 v102, s13, v13
  v_add_u32 v103, s30, v102
  s_xor_b32 s13, s3, 2
  s_mul_i32 s13, s13, 28672
  v_add_u32 v104, s13, v13
  v_add_u32 v105, s30, v104
  s_xor_b32 s13, s3, 3
  s_mul_i32 s13, s13, 28672
  v_add_u32 v106, s13, v13
  v_add_u32 v107, s30, v106
  v_mov_b32 v244, 0x3f803f80
  v_mov_b32 v245, 0x3f803f80
  v_mov_b32 v246, 0x3f803f80
  v_mov_b32 v247, 0x3f803f80
  ds_read_b64_tr_b16 v[72:73], v100 offset:21504
  ds_read_b64_tr_b16 v[74:75], v100 offset:25088
  ds_read_b64_tr_b16 v[76:77], v100 offset:21536
  ds_read_b64_tr_b16 v[78:79], v100 offset:25120
  ds_read_b64_tr_b16 v[80:81], v100 offset:21568
  ds_read_b64_tr_b16 v[82:83], v100 offset:25152
  ds_read_b64_tr_b16 v[84:85], v100 offset:21600
  ds_read_b64_tr_b16 v[86:87], v100 offset:25184
  ds_read_b64_tr_b16 v[88:89], v100 offset:21632
  ds_read_b64_tr_b16 v[90:91], v100 offset:25216
  ds_read_b64_tr_b16 v[92:93], v100 offset:21664
  ds_read_b64_tr_b16 v[94:95], v100 offset:25248
  ds_read_b64_tr_b16 v[96:97], v101 offset:21504
  ds_read_b64_tr_b16 v[98:99], v101 offset:25088
  s_waitcnt lgkmcnt(12)
  v_mfma_f32_16x16x32_bf16 v[16:19], v[244:247], v[72:75], 0
  buffer_load_dwordx4 a[8:11], v250, s[44:47], s52 offen sc1
  s_lshl_b32 s30, s12, 4
  ds_read_b64_tr_b16 v[72:73], v100 offset:14336
  ds_read_b64_tr_b16 v[74:75], v100 offset:17920
  s_waitcnt lgkmcnt(12)
  v_mfma_f32_16x16x32_bf16 v[20:23], v[244:247], v[76:79], 0
  s_add_u32 s30, s30, s6
  s_lshl_b32 s30, s30, 5
  ds_read_b64_tr_b16 v[76:77], v100 offset:14368
  ds_read_b64_tr_b16 v[78:79], v100 offset:17952
  s_waitcnt lgkmcnt(12)
  v_mfma_f32_16x16x32_bf16 v[24:27], v[244:247], v[80:83], 0
  buffer_load_dwordx4 a[12:15], v251, s[44:47], s52 offen sc1
  s_add_u32 s30, s30, 0x18a0000
  ds_read_b64_tr_b16 v[80:81], v100 offset:14400
  ds_read_b64_tr_b16 v[82:83], v100 offset:17984
  s_waitcnt lgkmcnt(12)
  v_mfma_f32_16x16x32_bf16 v[28:31], v[244:247], v[84:87], 0
  s_lshl_b32 s31, s7, 3
  s_add_u32 s31, s31, s3
  ds_read_b64_tr_b16 v[84:85], v100 offset:14432
  ds_read_b64_tr_b16 v[86:87], v100 offset:18016
  s_waitcnt lgkmcnt(12)
  v_mfma_f32_16x16x32_bf16 v[32:35], v[244:247], v[88:91], 0
  buffer_load_dwordx4 a[16:19], v248, s[44:47], s53 offen sc1
  s_lshl_b32 s31, s31, 7
  ds_read_b64_tr_b16 v[88:89], v100 offset:14464
  ds_read_b64_tr_b16 v[90:91], v100 offset:18048
  s_waitcnt lgkmcnt(12)
  v_mfma_f32_16x16x32_bf16 v[36:39], v[244:247], v[92:95], 0
  s_add_u32 s31, s31, 0x18a0000
  s_lshl_b32 s29, s12, 13
  ds_read_b64_tr_b16 v[92:93], v100 offset:14496
  ds_read_b64_tr_b16 v[94:95], v100 offset:18080
  s_waitcnt lgkmcnt(12)
  v_mfma_f32_16x16x32_bf16 v[40:43], v[244:247], v[96:99], 0
  buffer_load_dwordx4 a[20:23], v249, s[44:47], s53 offen sc1
  s_add_u32 s29, s29, 0x1060000
  ds_read_b64_tr_b16 v[96:97], v101 offset:14336
  ds_read_b64_tr_b16 v[98:99], v101 offset:17920
  s_waitcnt lgkmcnt(12)
  v_mfma_f32_16x16x32_bf16 v[16:19], v[244:247], v[72:75], v[16:19]
  s_lshl_b32 s13, s6, 9
  s_add_u32 s28, s29, s13
  ds_read_b64_tr_b16 v[72:73], v100 offset:7168
  ds_read_b64_tr_b16 v[74:75], v100 offset:10752
  s_waitcnt lgkmcnt(12)
  v_mfma_f32_16x16x32_bf16 v[20:23], v[244:247], v[76:79], v[20:23]
  buffer_load_dwordx4 a[24:27], v250, s[44:47], s53 offen sc1
  v_and_b32 v7, 15, v2
  ds_read_b64_tr_b16 v[76:77], v100 offset:7200
  ds_read_b64_tr_b16 v[78:79], v100 offset:10784
  s_waitcnt lgkmcnt(12)
  v_mfma_f32_16x16x32_bf16 v[24:27], v[244:247], v[80:83], v[24:27]
  v_lshlrev_b32 v7, 4, v7
  s_mov_b32 s20, 0x22222222
  ds_read_b64_tr_b16 v[80:81], v100 offset:7232
  ds_read_b64_tr_b16 v[82:83], v100 offset:10816
  s_waitcnt lgkmcnt(12)
  v_mfma_f32_16x16x32_bf16 v[28:31], v[244:247], v[84:87], v[28:31]
  buffer_load_dwordx4 a[28:31], v251, s[44:47], s53 offen sc1
  s_mov_b32 s21, 0x22222222
  ds_read_b64_tr_b16 v[84:85], v100 offset:7264
  ds_read_b64_tr_b16 v[86:87], v100 offset:10848
  s_waitcnt lgkmcnt(12)
  v_mfma_f32_16x16x32_bf16 v[32:35], v[244:247], v[88:91], v[32:35]
  s_mov_b32 s22, 0x44444444
  s_mov_b32 s23, 0x44444444
  ds_read_b64_tr_b16 v[88:89], v100 offset:7296
  ds_read_b64_tr_b16 v[90:91], v100 offset:10880
  s_waitcnt lgkmcnt(12)
  v_mfma_f32_16x16x32_bf16 v[36:39], v[244:247], v[92:95], v[36:39]
  buffer_load_dwordx4 a[32:35], v248, s[44:47], s54 offen sc1
  s_mov_b32 s24, 0x88888888
  ds_read_b64_tr_b16 v[92:93], v100 offset:7328
  ds_read_b64_tr_b16 v[94:95], v100 offset:10912
  s_waitcnt lgkmcnt(12)
  v_mfma_f32_16x16x32_bf16 v[40:43], v[244:247], v[96:99], v[40:43]
  s_mov_b32 s25, 0x88888888
  s_mov_b32 s26, 0x00f0000f
  ds_read_b64_tr_b16 v[96:97], v101 offset:7168
  ds_read_b64_tr_b16 v[98:99], v101 offset:10752
  s_waitcnt lgkmcnt(12)
  v_mfma_f32_16x16x32_bf16 v[16:19], v[244:247], v[72:75], v[16:19]
  buffer_load_dwordx4 a[36:39], v249, s[44:47], s54 offen sc1
  s_mov_b32 s27, 0xf0000f00
  ds_read_b64_tr_b16 v[72:73], v100 offset:0
  ds_read_b64_tr_b16 v[74:75], v100 offset:3584
  s_waitcnt lgkmcnt(12)
  v_mfma_f32_16x16x32_bf16 v[20:23], v[244:247], v[76:79], v[20:23]
  s_lshl_b32 s12, s5, 3
  s_lshl_b32 s13, s3, 1
  ds_read_b64_tr_b16 v[76:77], v100 offset:32
  ds_read_b64_tr_b16 v[78:79], v100 offset:3616
  s_waitcnt lgkmcnt(12)
  v_mfma_f32_16x16x32_bf16 v[24:27], v[244:247], v[80:83], v[24:27]
  buffer_load_dwordx4 a[40:43], v250, s[44:47], s54 offen sc1
  s_add_u32 s12, s12, s13
  ds_read_b64_tr_b16 v[80:81], v100 offset:64
  ds_read_b64_tr_b16 v[82:83], v100 offset:3648
  s_waitcnt lgkmcnt(12)
  v_mfma_f32_16x16x32_bf16 v[28:31], v[244:247], v[84:87], v[28:31]
  s_mul_i32 s12, s12, 57344
  s_mul_i32 s13, s6, 3584
  ds_read_b64_tr_b16 v[84:85], v100 offset:96
  ds_read_b64_tr_b16 v[86:87], v100 offset:3680
  s_waitcnt lgkmcnt(12)
  v_mfma_f32_16x16x32_bf16 v[32:35], v[244:247], v[88:91], v[32:35]
  buffer_load_dwordx4 a[44:47], v251, s[44:47], s54 offen sc1
  s_add_u32 s12, s12, s13
  ds_read_b64_tr_b16 v[88:89], v100 offset:128
  ds_read_b64_tr_b16 v[90:91], v100 offset:3712
  s_waitcnt lgkmcnt(12)
  v_mfma_f32_16x16x32_bf16 v[36:39], v[244:247], v[92:95], v[36:39]
  s_add_u32 s12, s12, 0x11a0000
  s_mov_b32 s68, s12
  ds_read_b64_tr_b16 v[92:93], v100 offset:160
  ds_read_b64_tr_b16 v[94:95], v100 offset:3744
  s_waitcnt lgkmcnt(12)
  v_mfma_f32_16x16x32_bf16 v[40:43], v[244:247], v[96:99], v[40:43]
  s_and_b32 s13, s6, 1
  s_lshl_b32 s14, s13, 9
  ds_read_b64_tr_b16 v[96:97], v101 offset:0
  ds_read_b64_tr_b16 v[98:99], v101 offset:3584
  s_waitcnt lgkmcnt(12)
  v_mfma_f32_16x16x32_bf16 v[16:19], v[244:247], v[72:75], v[16:19]
  s_add_u32 s14, s14, s12
  v_lshl_add_u32 v252, v2, 4, s14
  s_waitcnt lgkmcnt(10)
  v_mfma_f32_16x16x32_bf16 v[20:23], v[244:247], v[76:79], v[20:23]
  v_add_u32 v253, 0xe000, v252
  s_cmp_eq_u32 s13, 0
  s_waitcnt lgkmcnt(8)
  v_mfma_f32_16x16x32_bf16 v[24:27], v[244:247], v[80:83], v[24:27]
  s_cselect_b32 s14, 3072, 0
  s_add_u32 s14, s14, s12
  s_waitcnt lgkmcnt(6)
  v_mfma_f32_16x16x32_bf16 v[28:31], v[244:247], v[84:87], v[28:31]
  v_add_u32 v13, s14, v7
  v_bfe_u32 v14, v2, 4, 1
  s_waitcnt lgkmcnt(4)
  v_mfma_f32_16x16x32_bf16 v[32:35], v[244:247], v[88:91], v[32:35]
  v_mul_u32_u24 v14, 0xe000, v14
  v_lshrrev_b32 v15, 5, v2
  s_waitcnt lgkmcnt(2)
  v_mfma_f32_16x16x32_bf16 v[36:39], v[244:247], v[92:95], v[36:39]
  v_lshl_add_u32 v13, v15, 8, v13
  v_add_u32 v254, v13, v14
  s_waitcnt lgkmcnt(0)
  v_mfma_f32_16x16x32_bf16 v[40:43], v[244:247], v[96:99], v[40:43]
  s_add_u32 s12, s3, 0
  s_and_b32 s12, s12, 3
  s_lshl_b32 s13, s7, 2
  s_add_u32 s12, s12, s13
  s_mul_i32 s12, s12, 57344
  s_add_u32 s12, s12, 0x11a0000
  v_lshl_add_u32 v8, v2, 4, s12
  s_add_u32 s12, s3, 1
  s_and_b32 s12, s12, 3
  s_lshl_b32 s13, s7, 2
  s_add_u32 s12, s12, s13
  s_mul_i32 s12, s12, 57344
  s_add_u32 s12, s12, 0x11a0000
  v_lshl_add_u32 v9, v2, 4, s12
  s_add_u32 s12, s3, 2
  s_and_b32 s12, s12, 3
  s_lshl_b32 s13, s7, 2
  s_add_u32 s12, s12, s13
  s_mul_i32 s12, s12, 57344
  s_add_u32 s12, s12, 0x11a0000
  v_lshl_add_u32 v10, v2, 4, s12
  s_add_u32 s12, s3, 3
  s_and_b32 s12, s12, 3
  s_lshl_b32 s13, s7, 2
  s_add_u32 s12, s12, s13
  s_mul_i32 s12, s12, 57344
  s_add_u32 s12, s12, 0x11a0000
  v_lshl_add_u32 v11, v2, 4, s12
  s_mul_i32 s14, s3, 448
  s_add_u32 s14, s14, 149760
  v_and_b32 v12, 15, v2
  v_lshl_add_u32 v12, v12, 2, s14
  ds_write_b32 v12, v16 offset:0
  ds_write_b32 v12, v20 offset:64
  ds_write_b32 v12, v24 offset:128
  ds_write_b32 v12, v28 offset:192
  ds_write_b32 v12, v32 offset:256
  ds_write_b32 v12, v36 offset:320
  ds_write_b32 v12, v40 offset:384
  v_lshlrev_b32 v12, 4, v2
  v_add_u32 v12, 149760, v12
  v_accvgpr_read_b32 v61, a238
  v_accvgpr_read_b32 v63, a239
  v_lshlrev_b32 v60, 16, v61
  v_and_b32 v61, 0xffff0000, v61
  v_lshlrev_b32 v62, 16, v63
  v_and_b32 v63, 0xffff0000, v63
  s_mov_b32 s14, 0x0fffffff
  s_mov_b32 s15, 0
  s_waitcnt lgkmcnt(0)
  s_barrier
  ds_read_b128 v[44:47], v12 offset:0
  ds_read_b128 v[48:51], v12 offset:448
  ds_read_b128 v[52:55], v12 offset:896
  ds_read_b128 v[56:59], v12 offset:1344
  s_waitcnt lgkmcnt(0)
  s_barrier
  v_pk_add_f32 v[44:45], v[44:45], v[48:49]
  v_pk_add_f32 v[46:47], v[46:47], v[50:51]
  v_pk_add_f32 v[52:53], v[52:53], v[56:57]
  v_pk_add_f32 v[54:55], v[54:55], v[58:59]
  v_pk_add_f32 v[44:45], v[44:45], v[52:53]
  v_pk_add_f32 v[46:47], v[46:47], v[54:55]
  v_cndmask_b32 v44, v60, v44, s[14:15]
  v_cndmask_b32 v45, v61, v45, s[14:15]
  v_cndmask_b32 v46, v62, v46, s[14:15]
  v_cndmask_b32 v47, v63, v47, s[14:15]
  v_mul_f32 v44, 0x3fb8aa3b, v44
  v_mul_f32 v45, 0x3fb8aa3b, v45
  v_mul_f32 v46, 0x3fb8aa3b, v46
  v_mul_f32 v47, 0x3fb8aa3b, v47
  s_add_u32 s15, s3, 1
  s_and_b32 s15, s15, 3
  s_mul_i32 s15, s15, 12288
  s_add_u32 s15, s15, 117760
  v_lshl_add_u32 v1, v2, 4, s15
  ds_write_b128 v1, v[44:47]
  v_lshrrev_b32 v1, 4, v2
  v_lshl_add_u32 v1, v1, 4, s15
  v_accvgpr_write_b32 a234, v44
  v_accvgpr_write_b32 a235, v45
  v_accvgpr_write_b32 a236, v46
  v_accvgpr_write_b32 a237, v47
  buffer_load_dwordx4 v[116:119], v3, s[44:47], s16 offen offset:0 sc1
  buffer_load_dwordx4 v[120:123], v3, s[44:47], s16 offen offset:1024 sc1
  buffer_load_dwordx4 v[124:127], v4, s[44:47], s16 offen offset:0 sc1
  buffer_load_dwordx4 v[128:131], v4, s[44:47], s16 offen offset:1024 sc1
  buffer_load_dwordx4 v[132:135], v5, s[44:47], s16 offen offset:0 sc1
  buffer_load_dwordx4 v[136:139], v5, s[44:47], s16 offen offset:1024 sc1
  buffer_load_dwordx4 v[140:143], v6, s[44:47], s16 offen offset:0 sc1
  buffer_load_dwordx4 v[144:147], v6, s[44:47], s16 offen offset:1024 sc1
  buffer_load_dwordx4 v[148:151], v3, s[44:47], s17 offen offset:0 sc1
  buffer_load_dwordx4 v[152:155], v3, s[44:47], s17 offen offset:1024 sc1
  buffer_load_dwordx4 v[156:159], v4, s[44:47], s17 offen offset:0 sc1
  buffer_load_dwordx4 v[160:163], v4, s[44:47], s17 offen offset:1024 sc1
  s_waitcnt vmcnt(8)
  v_max3_u32 v111, v116, v118, v120
  v_max3_u32 v111, v111, v122, v124
  v_max3_u32 v111, v111, v126, v128
  v_max_u32 v111, v111, v130
  v_cmp_eq_u32 vcc, -1, v111
  s_cbranch_vccnz RSg11x0
BSg11x0:
  v_swap_b32 v117, v120
  v_swap_b32 v119, v122
  s_nop 1
  v_mfma_f32_16x16x32_bf16 v[228:231], v[244:247], v[116:119], 0
  v_swap_b32 v125, v128
  v_swap_b32 v127, v130
  v_mfma_f32_16x16x32_bf16 v[232:235], v[116:119], v[116:119], 0
  buffer_load_dwordx4 v[164:167], v5, s[44:47], s17 offen offset:0 sc1
  buffer_load_dwordx4 v[168:171], v5, s[44:47], s17 offen offset:1024 sc1
  v_mfma_f32_16x16x32_bf16 v[236:239], v[244:247], v[120:123], 0
  s_nop 4
  v_cndmask_b32 v232, v232, v233, s[20:21]
  v_mfma_f32_16x16x32_bf16 v[240:243], v[120:123], v[120:123], 0
  v_cndmask_b32 v232, v232, v234, s[22:23]
  v_cndmask_b32 v229, v232, v235, s[24:25]
  v_mfma_f32_16x16x32_bf16 v[16:19], v[72:75], v[116:119], 0
  v_mov_b32 v230, s10
  v_mov_b32 v231, s11
  s_nop 2
  v_cndmask_b32 v240, v240, v241, s[20:21]
  v_mfma_f32_16x16x32_bf16 v[20:23], v[72:75], v[120:123], 0
  v_cndmask_b32 v240, v240, v242, s[22:23]
  v_cndmask_b32 v237, v240, v243, s[24:25]
  v_mov_b32 v238, s10
  v_mfma_f32_16x16x32_bf16 v[24:27], v[76:79], v[116:119], 0
  ds_read_b64_tr_b16 v[72:73], v100 offset:7168
  v_mov_b32 v239, s11
  s_mov_b64 exec, s[26:27]
  buffer_store_dwordx4 v[228:231], v7, s[44:47], s28 offen offset:0 sc1
  buffer_store_dwordx4 v[236:239], v7, s[44:47], s28 offen offset:256 sc1
  s_mov_b64 exec, -1
  v_mfma_f32_16x16x32_bf16 v[28:31], v[76:79], v[120:123], 0
  ds_read_b64_tr_b16 v[74:75], v100 offset:10752
  v_bfe_u32 v12, v2, 4, 1
  v_mfma_f32_16x16x32_bf16 v[32:35], v[80:83], v[116:119], 0
  ds_read_b64_tr_b16 v[76:77], v100 offset:7200
  v_lshl_add_u32 v7, v12, 12, v7
  v_lshrrev_b32 v12, 5, v2
  v_mfma_f32_16x16x32_bf16 v[36:39], v[80:83], v[120:123], 0
  ds_read_b64_tr_b16 v[78:79], v100 offset:10784
  v_lshl_add_u32 v7, v12, 8, v7
  s_lshl2_add_u32 s12, s7, s3
  v_mfma_f32_16x16x32_bf16 v[40:43], v[84:87], v[116:119], 0
  ds_read_b64_tr_b16 v[80:81], v100 offset:7232
  s_mul_i32 s12, s12, 16896
  s_lshl_b32 s13, s8, 10
  v_mfma_f32_16x16x32_bf16 v[44:47], v[84:87], v[120:123], 0
  ds_read_b64_tr_b16 v[82:83], v100 offset:10816
  v_mfma_f32_16x16x32_bf16 v[48:51], v[88:91], v[116:119], 0
  ds_read_b64_tr_b16 v[84:85], v100 offset:7264
  s_add_u32 s12, s12, s13
  v_lshl_add_u32 v110, v2, 4, s12
  v_mfma_f32_16x16x32_bf16 v[52:55], v[88:91], v[120:123], 0
  ds_read_b64_tr_b16 v[86:87], v100 offset:10848
  v_mov_b64 v[112:113], -1
  v_mfma_f32_16x16x32_bf16 v[56:59], v[92:95], v[116:119], 0
  ds_read_b64_tr_b16 v[88:89], v100 offset:7296
  v_mov_b64 v[114:115], -1
  v_mfma_f32_16x16x32_bf16 v[60:63], v[92:95], v[120:123], 0
  ds_read_b64_tr_b16 v[90:91], v100 offset:10880
  v_mfma_f32_16x16x32_bf16 v[64:67], v[96:99], v[116:119], 0
  ds_read_b64_tr_b16 v[92:93], v100 offset:7328
  s_mov_b32 s12, 0x420000
  buffer_store_dwordx4 v[112:115], v110, s[44:47], s12 offen sc1
  v_mfma_f32_16x16x32_bf16 v[68:71], v[96:99], v[120:123], 0
  ds_read_b64_tr_b16 v[94:95], v100 offset:10912
  s_waitcnt lgkmcnt(8)
  v_mfma_f32_16x16x32_bf16 v[16:19], v[72:75], v[124:127], v[16:19]
  ds_read_b64_tr_b16 v[96:97], v101 offset:7168
  s_waitcnt vmcnt(9)
  v_max3_u32 v111, v132, v134, v136
  v_mfma_f32_16x16x32_bf16 v[20:23], v[72:75], v[128:131], v[20:23]
  ds_read_b64_tr_b16 v[98:99], v101 offset:10752
  v_max3_u32 v111, v111, v138, v140
  v_max3_u32 v111, v111, v142, v144
  v_mfma_f32_16x16x32_bf16 v[24:27], v[76:79], v[124:127], v[24:27]
  ds_read_b64_tr_b16 v[72:73], v100 offset:14336
  v_max_u32 v111, v111, v146
  v_mfma_f32_16x16x32_bf16 v[28:31], v[76:79], v[128:131], v[28:31]
  ds_read_b64_tr_b16 v[74:75], v100 offset:17920
  s_waitcnt lgkmcnt(8)
  v_mfma_f32_16x16x32_bf16 v[32:35], v[80:83], v[124:127], v[32:35]
  ds_read_b64_tr_b16 v[76:77], v100 offset:14368
  v_cmp_eq_u32 vcc, -1, v111
  s_cbranch_vccnz RSg11x1
BSg11x1:
  v_mfma_f32_16x16x32_bf16 v[36:39], v[80:83], v[128:131], v[36:39]
  ds_read_b64_tr_b16 v[78:79], v100 offset:17952
  v_swap_b32 v133, v136
  v_mfma_f32_16x16x32_bf16 v[40:43], v[84:87], v[124:127], v[40:43]
  ds_read_b64_tr_b16 v[80:81], v100 offset:14400
  v_swap_b32 v135, v138
  v_mfma_f32_16x16x32_bf16 v[44:47], v[84:87], v[128:131], v[44:47]
  ds_read_b64_tr_b16 v[82:83], v100 offset:17984
  s_waitcnt lgkmcnt(8)
  v_mfma_f32_16x16x32_bf16 v[48:51], v[88:91], v[124:127], v[48:51]
  ds_read_b64_tr_b16 v[84:85], v100 offset:14432
  buffer_load_dwordx4 v[172:175], v6, s[44:47], s17 offen offset:0 sc1
  v_mfma_f32_16x16x32_bf16 v[52:55], v[88:91], v[128:131], v[52:55]
  ds_read_b64_tr_b16 v[86:87], v100 offset:18016
  buffer_load_dwordx4 v[176:179], v6, s[44:47], s17 offen offset:1024 sc1
  v_mfma_f32_16x16x32_bf16 v[56:59], v[92:95], v[124:127], v[56:59]
  ds_read_b64_tr_b16 v[88:89], v100 offset:14464
  v_mfma_f32_16x16x32_bf16 v[60:63], v[92:95], v[128:131], v[60:63]
  ds_read_b64_tr_b16 v[90:91], v100 offset:18048
  s_waitcnt lgkmcnt(10)
  v_mfma_f32_16x16x32_bf16 v[64:67], v[96:99], v[124:127], v[64:67]
  ds_read_b64_tr_b16 v[92:93], v100 offset:14496
  s_mov_b32 s12, 0x422100
  buffer_store_dwordx4 v[112:115], v110, s[44:47], s12 offen sc1
  v_mfma_f32_16x16x32_bf16 v[68:71], v[96:99], v[128:131], v[68:71]
  ds_read_b64_tr_b16 v[94:95], v100 offset:18080
  s_waitcnt lgkmcnt(8)
  v_mfma_f32_16x16x32_bf16 v[16:19], v[72:75], v[132:135], v[16:19]
  ds_read_b64_tr_b16 v[96:97], v101 offset:14336
  v_swap_b32 v141, v144
  v_mfma_f32_16x16x32_bf16 v[20:23], v[72:75], v[136:139], v[20:23]
  ds_read_b64_tr_b16 v[98:99], v101 offset:17920
  v_swap_b32 v143, v146
  v_mfma_f32_16x16x32_bf16 v[24:27], v[76:79], v[132:135], v[24:27]
  ds_read_b64_tr_b16 v[72:73], v100 offset:21504
  buffer_load_dwordx4 v[180:183], v3, s[44:47], s18 offen offset:0 sc1
  v_mfma_f32_16x16x32_bf16 v[28:31], v[76:79], v[136:139], v[28:31]
  ds_read_b64_tr_b16 v[74:75], v100 offset:25088
  s_waitcnt lgkmcnt(8)
  v_mfma_f32_16x16x32_bf16 v[32:35], v[80:83], v[132:135], v[32:35]
  ds_read_b64_tr_b16 v[76:77], v100 offset:21536
  buffer_load_dwordx4 v[184:187], v3, s[44:47], s18 offen offset:1024 sc1
  v_mfma_f32_16x16x32_bf16 v[36:39], v[80:83], v[136:139], v[36:39]
  ds_read_b64_tr_b16 v[78:79], v100 offset:25120
  v_mfma_f32_16x16x32_bf16 v[40:43], v[84:87], v[132:135], v[40:43]
  ds_read_b64_tr_b16 v[80:81], v100 offset:21568
  s_mov_b32 s12, 0x640000
  buffer_store_dwordx4 v[112:115], v110, s[44:47], s12 offen sc1
  v_mfma_f32_16x16x32_bf16 v[44:47], v[84:87], v[136:139], v[44:47]
  ds_read_b64_tr_b16 v[82:83], v100 offset:25152
  s_waitcnt lgkmcnt(8)
  v_mfma_f32_16x16x32_bf16 v[48:51], v[88:91], v[132:135], v[48:51]
  ds_read_b64_tr_b16 v[84:85], v100 offset:21600
  v_mfma_f32_16x16x32_bf16 v[52:55], v[88:91], v[136:139], v[52:55]
  ds_read_b64_tr_b16 v[86:87], v100 offset:25184
  v_mfma_f32_16x16x32_bf16 v[56:59], v[92:95], v[132:135], v[56:59]
  ds_read_b64_tr_b16 v[88:89], v100 offset:21632
  v_mfma_f32_16x16x32_bf16 v[60:63], v[92:95], v[136:139], v[60:63]
  ds_read_b64_tr_b16 v[90:91], v100 offset:25216
  s_waitcnt lgkmcnt(10)
  v_mfma_f32_16x16x32_bf16 v[64:67], v[96:99], v[132:135], v[64:67]
  ds_read_b64_tr_b16 v[92:93], v100 offset:21664
  v_mfma_f32_16x16x32_bf16 v[68:71], v[96:99], v[136:139], v[68:71]
  ds_read_b64_tr_b16 v[94:95], v100 offset:25248
  s_waitcnt lgkmcnt(8)
  v_mfma_f32_16x16x32_bf16 v[16:19], v[72:75], v[140:143], v[16:19]
  ds_read_b64_tr_b16 v[96:97], v101 offset:21504
  s_waitcnt vmcnt(11)
  v_max3_u32 v111, v148, v150, v152
  v_mfma_f32_16x16x32_bf16 v[20:23], v[72:75], v[144:147], v[20:23]
  ds_read_b64_tr_b16 v[98:99], v101 offset:25088
  v_max3_u32 v111, v111, v154, v156
  v_max3_u32 v111, v111, v158, v160
  v_mfma_f32_16x16x32_bf16 v[24:27], v[76:79], v[140:143], v[24:27]
  ds_read_b64_tr_b16 v[72:73], v102 offset:0
  v_max_u32 v111, v111, v162
  v_mfma_f32_16x16x32_bf16 v[28:31], v[76:79], v[144:147], v[28:31]
  ds_read_b64_tr_b16 v[74:75], v102 offset:3584
  s_waitcnt lgkmcnt(8)
  v_mfma_f32_16x16x32_bf16 v[32:35], v[80:83], v[140:143], v[32:35]
  ds_read_b64_tr_b16 v[76:77], v102 offset:32
  v_cmp_eq_u32 vcc, -1, v111
  s_cbranch_vccnz RSg11x2
BSg11x2:
  v_mfma_f32_16x16x32_bf16 v[36:39], v[80:83], v[144:147], v[36:39]
  ds_read_b64_tr_b16 v[78:79], v102 offset:3616
  v_swap_b32 v149, v152
  v_mfma_f32_16x16x32_bf16 v[40:43], v[84:87], v[140:143], v[40:43]
  ds_read_b64_tr_b16 v[80:81], v102 offset:64
  v_swap_b32 v151, v154
  v_mfma_f32_16x16x32_bf16 v[44:47], v[84:87], v[144:147], v[44:47]
  ds_read_b64_tr_b16 v[82:83], v102 offset:3648
  s_waitcnt lgkmcnt(8)
  v_mfma_f32_16x16x32_bf16 v[48:51], v[88:91], v[140:143], v[48:51]
  ds_read_b64_tr_b16 v[84:85], v102 offset:96
  buffer_load_dwordx4 v[188:191], v4, s[44:47], s18 offen offset:0 sc1
  v_mfma_f32_16x16x32_bf16 v[52:55], v[88:91], v[144:147], v[52:55]
  ds_read_b64_tr_b16 v[86:87], v102 offset:3680
  buffer_load_dwordx4 v[192:195], v4, s[44:47], s18 offen offset:1024 sc1
  v_mfma_f32_16x16x32_bf16 v[56:59], v[92:95], v[140:143], v[56:59]
  ds_read_b64_tr_b16 v[88:89], v102 offset:128
  v_mfma_f32_16x16x32_bf16 v[60:63], v[92:95], v[144:147], v[60:63]
  ds_read_b64_tr_b16 v[90:91], v102 offset:3712
  s_waitcnt lgkmcnt(10)
  v_mfma_f32_16x16x32_bf16 v[64:67], v[96:99], v[140:143], v[64:67]
  ds_read_b64_tr_b16 v[92:93], v102 offset:160
  s_mov_b32 s12, 0x642100
  buffer_store_dwordx4 v[112:115], v110, s[44:47], s12 offen sc1
  v_mfma_f32_16x16x32_bf16 v[68:71], v[96:99], v[144:147], v[68:71]
  ds_read_b64_tr_b16 v[94:95], v102 offset:3744
  s_waitcnt lgkmcnt(8)
  v_mfma_f32_16x16x32_bf16 v[16:19], v[72:75], v[148:151], v[16:19]
  ds_read_b64_tr_b16 v[96:97], v103 offset:0
  v_swap_b32 v157, v160
  v_mfma_f32_16x16x32_bf16 v[20:23], v[72:75], v[152:155], v[20:23]
  ds_read_b64_tr_b16 v[98:99], v103 offset:3584
  v_swap_b32 v159, v162
  v_mfma_f32_16x16x32_bf16 v[24:27], v[76:79], v[148:151], v[24:27]
  ds_read_b64_tr_b16 v[72:73], v102 offset:7168
  buffer_load_dwordx4 v[196:199], v5, s[44:47], s18 offen offset:0 sc1
  v_mfma_f32_16x16x32_bf16 v[28:31], v[76:79], v[152:155], v[28:31]
  ds_read_b64_tr_b16 v[74:75], v102 offset:10752
  s_waitcnt lgkmcnt(8)
  v_mfma_f32_16x16x32_bf16 v[32:35], v[80:83], v[148:151], v[32:35]
  ds_read_b64_tr_b16 v[76:77], v102 offset:7200
  buffer_load_dwordx4 v[200:203], v5, s[44:47], s18 offen offset:1024 sc1
  v_mfma_f32_16x16x32_bf16 v[36:39], v[80:83], v[152:155], v[36:39]
  ds_read_b64_tr_b16 v[78:79], v102 offset:10784
  v_mfma_f32_16x16x32_bf16 v[40:43], v[84:87], v[148:151], v[40:43]
  ds_read_b64_tr_b16 v[80:81], v102 offset:7232
  v_mfma_f32_16x16x32_bf16 v[44:47], v[84:87], v[152:155], v[44:47]
  ds_read_b64_tr_b16 v[82:83], v102 offset:10816
  s_waitcnt lgkmcnt(8)
  v_mfma_f32_16x16x32_bf16 v[48:51], v[88:91], v[148:151], v[48:51]
  ds_read_b64_tr_b16 v[84:85], v102 offset:7264
  v_mfma_f32_16x16x32_bf16 v[52:55], v[88:91], v[152:155], v[52:55]
  ds_read_b64_tr_b16 v[86:87], v102 offset:10848
  v_mfma_f32_16x16x32_bf16 v[56:59], v[92:95], v[148:151], v[56:59]
  ds_read_b64_tr_b16 v[88:89], v102 offset:7296
  v_mfma_f32_16x16x32_bf16 v[60:63], v[92:95], v[152:155], v[60:63]
  ds_read_b64_tr_b16 v[90:91], v102 offset:10880
  s_waitcnt lgkmcnt(10)
  v_mfma_f32_16x16x32_bf16 v[64:67], v[96:99], v[148:151], v[64:67]
  ds_read_b64_tr_b16 v[92:93], v102 offset:7328
  v_mfma_f32_16x16x32_bf16 v[68:71], v[96:99], v[152:155], v[68:71]
  ds_read_b64_tr_b16 v[94:95], v102 offset:10912
  s_waitcnt lgkmcnt(8)
  v_mfma_f32_16x16x32_bf16 v[16:19], v[72:75], v[156:159], v[16:19]
  ds_read_b64_tr_b16 v[96:97], v103 offset:7168
  s_waitcnt vmcnt(9)
  v_max3_u32 v111, v164, v166, v168
  v_mfma_f32_16x16x32_bf16 v[20:23], v[72:75], v[160:163], v[20:23]
  ds_read_b64_tr_b16 v[98:99], v103 offset:10752
  v_max3_u32 v111, v111, v170, v172
  v_max3_u32 v111, v111, v174, v176
  v_mfma_f32_16x16x32_bf16 v[24:27], v[76:79], v[156:159], v[24:27]
  ds_read_b64_tr_b16 v[72:73], v102 offset:14336
  v_max_u32 v111, v111, v178
  v_mfma_f32_16x16x32_bf16 v[28:31], v[76:79], v[160:163], v[28:31]
  ds_read_b64_tr_b16 v[74:75], v102 offset:17920
  s_waitcnt lgkmcnt(8)
  v_mfma_f32_16x16x32_bf16 v[32:35], v[80:83], v[156:159], v[32:35]
  ds_read_b64_tr_b16 v[76:77], v102 offset:14368
  v_cmp_eq_u32 vcc, -1, v111
  v_mfma_f32_16x16x32_bf16 v[36:39], v[80:83], v[160:163], v[36:39]
  ds_read_b64_tr_b16 v[78:79], v102 offset:17952
  s_cbranch_vccnz RSg11x3
BSg11x3:
  v_mfma_f32_16x16x32_bf16 v[40:43], v[84:87], v[156:159], v[40:43]
  ds_read_b64_tr_b16 v[80:81], v102 offset:14400
  v_swap_b32 v165, v168
  v_mfma_f32_16x16x32_bf16 v[44:47], v[84:87], v[160:163], v[44:47]
  ds_read_b64_tr_b16 v[82:83], v102 offset:17984
  s_waitcnt lgkmcnt(8)
  v_mfma_f32_16x16x32_bf16 v[48:51], v[88:91], v[156:159], v[48:51]
  ds_read_b64_tr_b16 v[84:85], v102 offset:14432
  v_swap_b32 v167, v170
  v_mfma_f32_16x16x32_bf16 v[52:55], v[88:91], v[160:163], v[52:55]
  ds_read_b64_tr_b16 v[86:87], v102 offset:18016
  buffer_load_dwordx4 v[204:207], v6, s[44:47], s18 offen offset:0 sc1
  v_mfma_f32_16x16x32_bf16 v[56:59], v[92:95], v[156:159], v[56:59]
  ds_read_b64_tr_b16 v[88:89], v102 offset:14464
  buffer_load_dwordx4 v[208:211], v6, s[44:47], s18 offen offset:1024 sc1
  v_mfma_f32_16x16x32_bf16 v[60:63], v[92:95], v[160:163], v[60:63]
  ds_read_b64_tr_b16 v[90:91], v102 offset:18048
  s_waitcnt lgkmcnt(10)
  v_mfma_f32_16x16x32_bf16 v[64:67], v[96:99], v[156:159], v[64:67]
  ds_read_b64_tr_b16 v[92:93], v102 offset:14496
  v_mfma_f32_16x16x32_bf16 v[68:71], v[96:99], v[160:163], v[68:71]
  ds_read_b64_tr_b16 v[94:95], v102 offset:18080
  s_waitcnt lgkmcnt(8)
  v_mfma_f32_16x16x32_bf16 v[16:19], v[72:75], v[164:167], v[16:19]
  ds_read_b64_tr_b16 v[96:97], v103 offset:14336
  v_swap_b32 v173, v176
  v_mfma_f32_16x16x32_bf16 v[20:23], v[72:75], v[168:171], v[20:23]
  ds_read_b64_tr_b16 v[98:99], v103 offset:17920
  v_swap_b32 v175, v178
  v_mfma_f32_16x16x32_bf16 v[24:27], v[76:79], v[164:167], v[24:27]
  ds_read_b64_tr_b16 v[72:73], v102 offset:21504
  buffer_load_dwordx4 v[212:215], v3, s[44:47], s19 offen offset:0 sc1
  v_mfma_f32_16x16x32_bf16 v[28:31], v[76:79], v[168:171], v[28:31]
  ds_read_b64_tr_b16 v[74:75], v102 offset:25088
  s_waitcnt lgkmcnt(8)
  v_mfma_f32_16x16x32_bf16 v[32:35], v[80:83], v[164:167], v[32:35]
  ds_read_b64_tr_b16 v[76:77], v102 offset:21536
  buffer_load_dwordx4 v[216:219], v3, s[44:47], s19 offen offset:1024 sc1
  v_mfma_f32_16x16x32_bf16 v[36:39], v[80:83], v[168:171], v[36:39]
  ds_read_b64_tr_b16 v[78:79], v102 offset:25120
  v_mfma_f32_16x16x32_bf16 v[40:43], v[84:87], v[164:167], v[40:43]
  ds_read_b64_tr_b16 v[80:81], v102 offset:21568
  v_mfma_f32_16x16x32_bf16 v[44:47], v[84:87], v[168:171], v[44:47]
  ds_read_b64_tr_b16 v[82:83], v102 offset:25152
  s_waitcnt lgkmcnt(8)
  v_mfma_f32_16x16x32_bf16 v[48:51], v[88:91], v[164:167], v[48:51]
  ds_read_b64_tr_b16 v[84:85], v102 offset:21600
  v_mfma_f32_16x16x32_bf16 v[52:55], v[88:91], v[168:171], v[52:55]
  ds_read_b64_tr_b16 v[86:87], v102 offset:25184
  v_mfma_f32_16x16x32_bf16 v[56:59], v[92:95], v[164:167], v[56:59]
  ds_read_b64_tr_b16 v[88:89], v102 offset:21632
  v_mfma_f32_16x16x32_bf16 v[60:63], v[92:95], v[168:171], v[60:63]
  ds_read_b64_tr_b16 v[90:91], v102 offset:25216
  s_waitcnt lgkmcnt(10)
  v_mfma_f32_16x16x32_bf16 v[64:67], v[96:99], v[164:167], v[64:67]
  ds_read_b64_tr_b16 v[92:93], v102 offset:21664
  v_mfma_f32_16x16x32_bf16 v[68:71], v[96:99], v[168:171], v[68:71]
  ds_read_b64_tr_b16 v[94:95], v102 offset:25248
  s_waitcnt lgkmcnt(8)
  v_mfma_f32_16x16x32_bf16 v[16:19], v[72:75], v[172:175], v[16:19]
  ds_read_b64_tr_b16 v[96:97], v103 offset:21504
  s_waitcnt vmcnt(7)
  v_max3_u32 v111, v180, v182, v184
  v_mfma_f32_16x16x32_bf16 v[20:23], v[72:75], v[176:179], v[20:23]
  ds_read_b64_tr_b16 v[98:99], v103 offset:25088
  v_max3_u32 v111, v111, v186, v188
  v_max3_u32 v111, v111, v190, v192
  v_mfma_f32_16x16x32_bf16 v[24:27], v[76:79], v[172:175], v[24:27]
  ds_read_b64_tr_b16 v[72:73], v104 offset:0
  v_max_u32 v111, v111, v194
  v_mfma_f32_16x16x32_bf16 v[28:31], v[76:79], v[176:179], v[28:31]
  ds_read_b64_tr_b16 v[74:75], v104 offset:3584
  s_waitcnt lgkmcnt(8)
  v_mfma_f32_16x16x32_bf16 v[32:35], v[80:83], v[172:175], v[32:35]
  ds_read_b64_tr_b16 v[76:77], v104 offset:32
  v_cmp_eq_u32 vcc, -1, v111
  v_mfma_f32_16x16x32_bf16 v[36:39], v[80:83], v[176:179], v[36:39]
  ds_read_b64_tr_b16 v[78:79], v104 offset:3616
  s_cbranch_vccnz RSg11x4
BSg11x4:
  v_mfma_f32_16x16x32_bf16 v[40:43], v[84:87], v[172:175], v[40:43]
  ds_read_b64_tr_b16 v[80:81], v104 offset:64
  v_swap_b32 v181, v184
  v_mfma_f32_16x16x32_bf16 v[44:47], v[84:87], v[176:179], v[44:47]
  ds_read_b64_tr_b16 v[82:83], v104 offset:3648
  s_waitcnt lgkmcnt(8)
  v_mfma_f32_16x16x32_bf16 v[48:51], v[88:91], v[172:175], v[48:51]
  ds_read_b64_tr_b16 v[84:85], v104 offset:96
  v_swap_b32 v183, v186
  v_mfma_f32_16x16x32_bf16 v[52:55], v[88:91], v[176:179], v[52:55]
  ds_read_b64_tr_b16 v[86:87], v104 offset:3680
  buffer_load_dwordx4 v[220:223], v4, s[44:47], s19 offen offset:0 sc1
  v_mfma_f32_16x16x32_bf16 v[56:59], v[92:95], v[172:175], v[56:59]
  ds_read_b64_tr_b16 v[88:89], v104 offset:128
  buffer_load_dwordx4 v[224:227], v4, s[44:47], s19 offen offset:1024 sc1
  v_mfma_f32_16x16x32_bf16 v[60:63], v[92:95], v[176:179], v[60:63]
  ds_read_b64_tr_b16 v[90:91], v104 offset:3712
  s_waitcnt lgkmcnt(10)
  v_mfma_f32_16x16x32_bf16 v[64:67], v[96:99], v[172:175], v[64:67]
  ds_read_b64_tr_b16 v[92:93], v104 offset:160
  v_mfma_f32_16x16x32_bf16 v[68:71], v[96:99], v[176:179], v[68:71]
  ds_read_b64_tr_b16 v[94:95], v104 offset:3744
  s_waitcnt lgkmcnt(8)
  v_mfma_f32_16x16x32_bf16 v[16:19], v[72:75], v[180:183], v[16:19]
  ds_read_b64_tr_b16 v[96:97], v105 offset:0
  v_swap_b32 v189, v192
  v_mfma_f32_16x16x32_bf16 v[20:23], v[72:75], v[184:187], v[20:23]
  ds_read_b64_tr_b16 v[98:99], v105 offset:3584
  v_swap_b32 v191, v194
  v_mfma_f32_16x16x32_bf16 v[24:27], v[76:79], v[180:183], v[24:27]
  ds_read_b64_tr_b16 v[72:73], v104 offset:7168
  buffer_load_dwordx4 v[228:231], v5, s[44:47], s19 offen offset:0 sc1
  v_mfma_f32_16x16x32_bf16 v[28:31], v[76:79], v[184:187], v[28:31]
  ds_read_b64_tr_b16 v[74:75], v104 offset:10752
  s_waitcnt lgkmcnt(8)
  v_mfma_f32_16x16x32_bf16 v[32:35], v[80:83], v[180:183], v[32:35]
  ds_read_b64_tr_b16 v[76:77], v104 offset:7200
  buffer_load_dwordx4 v[232:235], v5, s[44:47], s19 offen offset:1024 sc1
  v_mfma_f32_16x16x32_bf16 v[36:39], v[80:83], v[184:187], v[36:39]
  ds_read_b64_tr_b16 v[78:79], v104 offset:10784
  v_mfma_f32_16x16x32_bf16 v[40:43], v[84:87], v[180:183], v[40:43]
  ds_read_b64_tr_b16 v[80:81], v104 offset:7232
  v_mfma_f32_16x16x32_bf16 v[44:47], v[84:87], v[184:187], v[44:47]
  ds_read_b64_tr_b16 v[82:83], v104 offset:10816
  s_waitcnt lgkmcnt(8)
  v_mfma_f32_16x16x32_bf16 v[48:51], v[88:91], v[180:183], v[48:51]
  ds_read_b64_tr_b16 v[84:85], v104 offset:7264
  v_mfma_f32_16x16x32_bf16 v[52:55], v[88:91], v[184:187], v[52:55]
  ds_read_b64_tr_b16 v[86:87], v104 offset:10848
  v_mfma_f32_16x16x32_bf16 v[56:59], v[92:95], v[180:183], v[56:59]
  ds_read_b64_tr_b16 v[88:89], v104 offset:7296
  v_mfma_f32_16x16x32_bf16 v[60:63], v[92:95], v[184:187], v[60:63]
  ds_read_b64_tr_b16 v[90:91], v104 offset:10880
  s_waitcnt lgkmcnt(10)
  v_mfma_f32_16x16x32_bf16 v[64:67], v[96:99], v[180:183], v[64:67]
  ds_read_b64_tr_b16 v[92:93], v104 offset:7328
  v_mfma_f32_16x16x32_bf16 v[68:71], v[96:99], v[184:187], v[68:71]
  ds_read_b64_tr_b16 v[94:95], v104 offset:10912
  s_waitcnt lgkmcnt(8)
  v_mfma_f32_16x16x32_bf16 v[16:19], v[72:75], v[188:191], v[16:19]
  ds_read_b64_tr_b16 v[96:97], v105 offset:7168
  s_waitcnt vmcnt(6)
  v_max3_u32 v111, v196, v198, v200
  v_mfma_f32_16x16x32_bf16 v[20:23], v[72:75], v[192:195], v[20:23]
  ds_read_b64_tr_b16 v[98:99], v105 offset:10752
  v_max3_u32 v111, v111, v202, v204
  v_max3_u32 v111, v111, v206, v208
  v_mfma_f32_16x16x32_bf16 v[24:27], v[76:79], v[188:191], v[24:27]
  ds_read_b64_tr_b16 v[72:73], v104 offset:14336
  v_max_u32 v111, v111, v210
  v_mfma_f32_16x16x32_bf16 v[28:31], v[76:79], v[192:195], v[28:31]
  ds_read_b64_tr_b16 v[74:75], v104 offset:17920
  s_waitcnt lgkmcnt(8)
  v_mfma_f32_16x16x32_bf16 v[32:35], v[80:83], v[188:191], v[32:35]
  ds_read_b64_tr_b16 v[76:77], v104 offset:14368
  v_cmp_eq_u32 vcc, -1, v111
  v_mfma_f32_16x16x32_bf16 v[36:39], v[80:83], v[192:195], v[36:39]
  ds_read_b64_tr_b16 v[78:79], v104 offset:17952
  s_cbranch_vccnz RSg11x5
BSg11x5:
  v_mfma_f32_16x16x32_bf16 v[40:43], v[84:87], v[188:191], v[40:43]
  ds_read_b64_tr_b16 v[80:81], v104 offset:14400
  v_swap_b32 v197, v200
  v_mfma_f32_16x16x32_bf16 v[44:47], v[84:87], v[192:195], v[44:47]
  ds_read_b64_tr_b16 v[82:83], v104 offset:17984
  s_waitcnt lgkmcnt(8)
  v_mfma_f32_16x16x32_bf16 v[48:51], v[88:91], v[188:191], v[48:51]
  ds_read_b64_tr_b16 v[84:85], v104 offset:14432
  v_swap_b32 v199, v202
  v_mfma_f32_16x16x32_bf16 v[52:55], v[88:91], v[192:195], v[52:55]
  ds_read_b64_tr_b16 v[86:87], v104 offset:18016
  buffer_load_dwordx4 v[236:239], v6, s[44:47], s19 offen offset:0 sc1
  v_mfma_f32_16x16x32_bf16 v[56:59], v[92:95], v[188:191], v[56:59]
  ds_read_b64_tr_b16 v[88:89], v104 offset:14464
  buffer_load_dwordx4 v[240:243], v6, s[44:47], s19 offen offset:1024 sc1
  v_mfma_f32_16x16x32_bf16 v[60:63], v[92:95], v[192:195], v[60:63]
  ds_read_b64_tr_b16 v[90:91], v104 offset:18048
  s_waitcnt lgkmcnt(10)
  v_mfma_f32_16x16x32_bf16 v[64:67], v[96:99], v[188:191], v[64:67]
  ds_read_b64_tr_b16 v[92:93], v104 offset:14496
  v_mfma_f32_16x16x32_bf16 v[68:71], v[96:99], v[192:195], v[68:71]
  ds_read_b64_tr_b16 v[94:95], v104 offset:18080
  s_waitcnt lgkmcnt(8)
  v_mfma_f32_16x16x32_bf16 v[16:19], v[72:75], v[196:199], v[16:19]
  ds_read_b64_tr_b16 v[96:97], v105 offset:14336
  v_swap_b32 v205, v208
  v_swap_b32 v207, v210
  v_mfma_f32_16x16x32_bf16 v[20:23], v[72:75], v[200:203], v[20:23]
  ds_read_b64_tr_b16 v[98:99], v105 offset:17920
  buffer_load_dwordx4 v[116:119], v7, s[44:47], s29 offen offset:0 sc1
  buffer_load_dwordx4 v[120:123], v7, s[44:47], s29 offen offset:512 sc1
  v_mfma_f32_16x16x32_bf16 v[24:27], v[76:79], v[196:199], v[24:27]
  ds_read_b64_tr_b16 v[72:73], v104 offset:21504
  buffer_load_dwordx4 a[48:51], v248, s[44:47], s55 offen sc1
  v_mfma_f32_16x16x32_bf16 v[28:31], v[76:79], v[200:203], v[28:31]
  ds_read_b64_tr_b16 v[74:75], v104 offset:25088
  s_waitcnt lgkmcnt(8)
  v_mfma_f32_16x16x32_bf16 v[32:35], v[80:83], v[196:199], v[32:35]
  ds_read_b64_tr_b16 v[76:77], v104 offset:21536
  buffer_load_dwordx4 v[124:127], v7, s[44:47], s29 offen offset:1024 sc1
  buffer_load_dwordx4 v[128:131], v7, s[44:47], s29 offen offset:1536 sc1
  v_mfma_f32_16x16x32_bf16 v[36:39], v[80:83], v[200:203], v[36:39]
  ds_read_b64_tr_b16 v[78:79], v104 offset:25120
  buffer_load_dwordx4 v[132:135], v7, s[44:47], s29 offen offset:2048 sc1
  v_mfma_f32_16x16x32_bf16 v[40:43], v[84:87], v[196:199], v[40:43]
  ds_read_b64_tr_b16 v[80:81], v104 offset:21568
  buffer_load_dwordx4 a[52:55], v249, s[44:47], s55 offen sc1
  v_mfma_f32_16x16x32_bf16 v[44:47], v[84:87], v[200:203], v[44:47]
  ds_read_b64_tr_b16 v[82:83], v104 offset:25152
  s_waitcnt lgkmcnt(8)
  v_mfma_f32_16x16x32_bf16 v[48:51], v[88:91], v[196:199], v[48:51]
  ds_read_b64_tr_b16 v[84:85], v104 offset:21600
  buffer_load_dwordx4 v[136:139], v7, s[44:47], s29 offen offset:2560 sc1
  v_mfma_f32_16x16x32_bf16 v[52:55], v[88:91], v[200:203], v[52:55]
  ds_read_b64_tr_b16 v[86:87], v104 offset:25184
  buffer_load_dwordx4 v[140:143], v7, s[44:47], s29 offen offset:3072 sc1
  v_mfma_f32_16x16x32_bf16 v[56:59], v[92:95], v[196:199], v[56:59]
  ds_read_b64_tr_b16 v[88:89], v104 offset:21632
  buffer_load_dwordx4 v[144:147], v7, s[44:47], s29 offen offset:3584 sc1
  v_mfma_f32_16x16x32_bf16 v[60:63], v[92:95], v[200:203], v[60:63]
  ds_read_b64_tr_b16 v[90:91], v104 offset:25216
  buffer_load_dwordx4 a[56:59], v250, s[44:47], s55 offen sc1
  s_waitcnt lgkmcnt(10)
  v_mfma_f32_16x16x32_bf16 v[64:67], v[96:99], v[196:199], v[64:67]
  ds_read_b64_tr_b16 v[92:93], v104 offset:21664
  v_mfma_f32_16x16x32_bf16 v[68:71], v[96:99], v[200:203], v[68:71]
  ds_read_b64_tr_b16 v[94:95], v104 offset:25248
  s_waitcnt lgkmcnt(8)
  v_mfma_f32_16x16x32_bf16 v[16:19], v[72:75], v[204:207], v[16:19]
  ds_read_b64_tr_b16 v[96:97], v105 offset:21504
  s_waitcnt vmcnt(15)
  v_max3_u32 v111, v212, v214, v216
  v_mfma_f32_16x16x32_bf16 v[20:23], v[72:75], v[208:211], v[20:23]
  ds_read_b64_tr_b16 v[98:99], v105 offset:25088
  buffer_load_dwordx4 a[60:63], v251, s[44:47], s55 offen sc1
  v_max3_u32 v111, v111, v218, v220
  v_mfma_f32_16x16x32_bf16 v[24:27], v[76:79], v[204:207], v[24:27]
  ds_read_b64_tr_b16 v[72:73], v106 offset:0
  v_max3_u32 v111, v111, v222, v224
  v_mfma_f32_16x16x32_bf16 v[28:31], v[76:79], v[208:211], v[28:31]
  ds_read_b64_tr_b16 v[74:75], v106 offset:3584
  s_waitcnt lgkmcnt(8)
  v_mfma_f32_16x16x32_bf16 v[32:35], v[80:83], v[204:207], v[32:35]
  ds_read_b64_tr_b16 v[76:77], v106 offset:32
  v_max_u32 v111, v111, v226
  v_cmp_eq_u32 vcc, -1, v111
  v_mfma_f32_16x16x32_bf16 v[36:39], v[80:83], v[208:211], v[36:39]
  ds_read_b64_tr_b16 v[78:79], v106 offset:3616
  buffer_load_dwordx4 a[64:67], v248, s[44:47], s56 offen sc1
  v_mfma_f32_16x16x32_bf16 v[40:43], v[84:87], v[204:207], v[40:43]
  ds_read_b64_tr_b16 v[80:81], v106 offset:64
  s_cbranch_vccnz RSg11x6
BSg11x6:
  v_mfma_f32_16x16x32_bf16 v[44:47], v[84:87], v[208:211], v[44:47]
  ds_read_b64_tr_b16 v[82:83], v106 offset:3648
  s_waitcnt lgkmcnt(8)
  v_mfma_f32_16x16x32_bf16 v[48:51], v[88:91], v[204:207], v[48:51]
  ds_read_b64_tr_b16 v[84:85], v106 offset:96
  buffer_load_dwordx4 a[68:71], v249, s[44:47], s56 offen sc1
  v_mfma_f32_16x16x32_bf16 v[52:55], v[88:91], v[208:211], v[52:55]
  ds_read_b64_tr_b16 v[86:87], v106 offset:3680
  v_swap_b32 v213, v216
  v_mfma_f32_16x16x32_bf16 v[56:59], v[92:95], v[204:207], v[56:59]
  ds_read_b64_tr_b16 v[88:89], v106 offset:128
  v_swap_b32 v215, v218
  v_mfma_f32_16x16x32_bf16 v[60:63], v[92:95], v[208:211], v[60:63]
  ds_read_b64_tr_b16 v[90:91], v106 offset:3712
  s_waitcnt lgkmcnt(10)
  v_mfma_f32_16x16x32_bf16 v[64:67], v[96:99], v[204:207], v[64:67]
  ds_read_b64_tr_b16 v[92:93], v106 offset:160
  buffer_load_dwordx4 a[72:75], v250, s[44:47], s56 offen sc1
  v_mfma_f32_16x16x32_bf16 v[68:71], v[96:99], v[208:211], v[68:71]
  ds_read_b64_tr_b16 v[94:95], v106 offset:3744
  s_waitcnt lgkmcnt(8)
  v_mfma_f32_16x16x32_bf16 v[16:19], v[72:75], v[212:215], v[16:19]
  ds_read_b64_tr_b16 v[96:97], v107 offset:0
  v_swap_b32 v221, v224
  v_mfma_f32_16x16x32_bf16 v[20:23], v[72:75], v[216:219], v[20:23]
  ds_read_b64_tr_b16 v[98:99], v107 offset:3584
  buffer_load_dwordx4 a[76:79], v251, s[44:47], s56 offen sc1
  v_mfma_f32_16x16x32_bf16 v[24:27], v[76:79], v[212:215], v[24:27]
  ds_read_b64_tr_b16 v[72:73], v106 offset:7168
  v_swap_b32 v223, v226
  v_mfma_f32_16x16x32_bf16 v[28:31], v[76:79], v[216:219], v[28:31]
  ds_read_b64_tr_b16 v[74:75], v106 offset:10752
  s_waitcnt lgkmcnt(8)
  v_mfma_f32_16x16x32_bf16 v[32:35], v[80:83], v[212:215], v[32:35]
  ds_read_b64_tr_b16 v[76:77], v106 offset:7200
  v_mfma_f32_16x16x32_bf16 v[36:39], v[80:83], v[216:219], v[36:39]
  ds_read_b64_tr_b16 v[78:79], v106 offset:10784
  buffer_load_dwordx4 a[80:83], v248, s[44:47], s57 offen sc1
  v_mfma_f32_16x16x32_bf16 v[40:43], v[84:87], v[212:215], v[40:43]
  ds_read_b64_tr_b16 v[80:81], v106 offset:7232
  v_mfma_f32_16x16x32_bf16 v[44:47], v[84:87], v[216:219], v[44:47]
  ds_read_b64_tr_b16 v[82:83], v106 offset:10816
  s_waitcnt lgkmcnt(8)
  v_mfma_f32_16x16x32_bf16 v[48:51], v[88:91], v[212:215], v[48:51]
  ds_read_b64_tr_b16 v[84:85], v106 offset:7264
  buffer_load_dwordx4 a[84:87], v249, s[44:47], s57 offen sc1
  v_mfma_f32_16x16x32_bf16 v[52:55], v[88:91], v[216:219], v[52:55]
  ds_read_b64_tr_b16 v[86:87], v106 offset:10848
  v_mfma_f32_16x16x32_bf16 v[56:59], v[92:95], v[212:215], v[56:59]
  ds_read_b64_tr_b16 v[88:89], v106 offset:7296
  v_mfma_f32_16x16x32_bf16 v[60:63], v[92:95], v[216:219], v[60:63]
  ds_read_b64_tr_b16 v[90:91], v106 offset:10880
  s_waitcnt lgkmcnt(10)
  v_mfma_f32_16x16x32_bf16 v[64:67], v[96:99], v[212:215], v[64:67]
  ds_read_b64_tr_b16 v[92:93], v106 offset:7328
  buffer_load_dwordx4 a[88:91], v250, s[44:47], s57 offen sc1
  v_mfma_f32_16x16x32_bf16 v[68:71], v[96:99], v[216:219], v[68:71]
  ds_read_b64_tr_b16 v[94:95], v106 offset:10912
  s_waitcnt lgkmcnt(8)
  v_mfma_f32_16x16x32_bf16 v[16:19], v[72:75], v[220:223], v[16:19]
  ds_read_b64_tr_b16 v[96:97], v107 offset:7168
  s_waitcnt vmcnt(19)
  v_max3_u32 v111, v228, v230, v232
  v_mfma_f32_16x16x32_bf16 v[20:23], v[72:75], v[224:227], v[20:23]
  ds_read_b64_tr_b16 v[98:99], v107 offset:10752
  buffer_load_dwordx4 a[92:95], v251, s[44:47], s57 offen sc1
  v_max3_u32 v111, v111, v234, v236
  v_mfma_f32_16x16x32_bf16 v[24:27], v[76:79], v[220:223], v[24:27]
  ds_read_b64_tr_b16 v[72:73], v106 offset:14336
  v_max3_u32 v111, v111, v238, v240
  v_mfma_f32_16x16x32_bf16 v[28:31], v[76:79], v[224:227], v[28:31]
  ds_read_b64_tr_b16 v[74:75], v106 offset:17920
  s_waitcnt lgkmcnt(8)
  v_mfma_f32_16x16x32_bf16 v[32:35], v[80:83], v[220:223], v[32:35]
  ds_read_b64_tr_b16 v[76:77], v106 offset:14368
  v_max_u32 v111, v111, v242
  v_cmp_eq_u32 vcc, -1, v111
  v_mfma_f32_16x16x32_bf16 v[36:39], v[80:83], v[224:227], v[36:39]
  ds_read_b64_tr_b16 v[78:79], v106 offset:17952
  buffer_load_dwordx4 a[96:99], v248, s[44:47], s58 offen sc1
  v_mfma_f32_16x16x32_bf16 v[40:43], v[84:87], v[220:223], v[40:43]
  ds_read_b64_tr_b16 v[80:81], v106 offset:14400
  s_cbranch_vccnz RSg11x7
BSg11x7:
  v_mfma_f32_16x16x32_bf16 v[44:47], v[84:87], v[224:227], v[44:47]
  ds_read_b64_tr_b16 v[82:83], v106 offset:17984
  s_waitcnt lgkmcnt(8)
  v_mfma_f32_16x16x32_bf16 v[48:51], v[88:91], v[220:223], v[48:51]
  ds_read_b64_tr_b16 v[84:85], v106 offset:14432
  buffer_load_dwordx4 a[100:103], v249, s[44:47], s58 offen sc1
  v_mfma_f32_16x16x32_bf16 v[52:55], v[88:91], v[224:227], v[52:55]
  ds_read_b64_tr_b16 v[86:87], v106 offset:18016
  v_swap_b32 v229, v232
  v_mfma_f32_16x16x32_bf16 v[56:59], v[92:95], v[220:223], v[56:59]
  ds_read_b64_tr_b16 v[88:89], v106 offset:14464
  v_swap_b32 v231, v234
  v_mfma_f32_16x16x32_bf16 v[60:63], v[92:95], v[224:227], v[60:63]
  ds_read_b64_tr_b16 v[90:91], v106 offset:18048
  s_waitcnt lgkmcnt(10)
  v_mfma_f32_16x16x32_bf16 v[64:67], v[96:99], v[220:223], v[64:67]
  ds_read_b64_tr_b16 v[92:93], v106 offset:14496
  buffer_load_dwordx4 a[104:107], v250, s[44:47], s58 offen sc1
  v_mfma_f32_16x16x32_bf16 v[68:71], v[96:99], v[224:227], v[68:71]
  ds_read_b64_tr_b16 v[94:95], v106 offset:18080
  s_waitcnt lgkmcnt(8)
  v_mfma_f32_16x16x32_bf16 v[16:19], v[72:75], v[228:231], v[16:19]
  ds_read_b64_tr_b16 v[96:97], v107 offset:14336
  v_swap_b32 v237, v240
  v_swap_b32 v239, v242
  v_mfma_f32_16x16x32_bf16 v[20:23], v[72:75], v[232:235], v[20:23]
  ds_read_b64_tr_b16 v[98:99], v107 offset:17920
  buffer_load_dwordx4 a[108:111], v251, s[44:47], s58 offen sc1
  v_mov_b32 v4, s10
  v_mfma_f32_16x16x32_bf16 v[24:27], v[76:79], v[228:231], v[24:27]
  ds_read_b64_tr_b16 v[72:73], v106 offset:21504
  v_mov_b32 v5, s11
  v_lshlrev_b32 v6, 26, v2
  v_mfma_f32_16x16x32_bf16 v[28:31], v[76:79], v[232:235], v[28:31]
  ds_read_b64_tr_b16 v[74:75], v106 offset:25088
  s_waitcnt lgkmcnt(8)
  v_mfma_f32_16x16x32_bf16 v[32:35], v[80:83], v[228:231], v[32:35]
  ds_read_b64_tr_b16 v[76:77], v106 offset:21536
  v_and_b32 v3, 15, v2
  v_bfe_u32 v111, v2, 4, 1
  v_mfma_f32_16x16x32_bf16 v[36:39], v[80:83], v[232:235], v[36:39]
  ds_read_b64_tr_b16 v[78:79], v106 offset:25120
  buffer_load_dwordx4 a[112:115], v248, s[44:47], s59 offen sc1
  v_mfma_f32_16x16x32_bf16 v[40:43], v[84:87], v[228:231], v[40:43]
  ds_read_b64_tr_b16 v[80:81], v106 offset:21568
  v_lshlrev_b32 v3, 3, v3
  v_mfma_f32_16x16x32_bf16 v[44:47], v[84:87], v[232:235], v[44:47]
  ds_read_b64_tr_b16 v[82:83], v106 offset:25152
  s_waitcnt lgkmcnt(8)
  v_mfma_f32_16x16x32_bf16 v[48:51], v[88:91], v[228:231], v[48:51]
  ds_read_b64_tr_b16 v[84:85], v106 offset:21600
  buffer_load_dwordx4 a[116:119], v249, s[44:47], s59 offen sc1
  v_mfma_f32_16x16x32_bf16 v[52:55], v[88:91], v[232:235], v[52:55]
  ds_read_b64_tr_b16 v[86:87], v106 offset:25184
  v_lshl_add_u32 v3, v111, 9, v3
  v_mfma_f32_16x16x32_bf16 v[56:59], v[92:95], v[228:231], v[56:59]
  ds_read_b64_tr_b16 v[88:89], v106 offset:21632
  buffer_load_dwordx2 v[108:109], v3, s[44:47], s31 offen sc1
  v_mfma_f32_16x16x32_bf16 v[60:63], v[92:95], v[232:235], v[60:63]
  ds_read_b64_tr_b16 v[90:91], v106 offset:25216
  s_waitcnt lgkmcnt(10)
  v_mfma_f32_16x16x32_bf16 v[64:67], v[96:99], v[228:231], v[64:67]
  ds_read_b64_tr_b16 v[92:93], v106 offset:21664
  buffer_load_dwordx4 a[120:123], v250, s[44:47], s59 offen sc1
  v_mfma_f32_16x16x32_bf16 v[68:71], v[96:99], v[232:235], v[68:71]
  ds_read_b64_tr_b16 v[94:95], v106 offset:25248
  s_waitcnt lgkmcnt(8)
  v_mfma_f32_16x16x32_bf16 v[16:19], v[72:75], v[236:239], v[16:19]
  ds_read_b64_tr_b16 v[96:97], v107 offset:21504
  s_waitcnt vmcnt(18)
  v_cmp_ne_u64 s[24:25], s[10:11], v[118:119]
  v_mfma_f32_16x16x32_bf16 v[20:23], v[72:75], v[240:243], v[20:23]
  ds_read_b64_tr_b16 v[98:99], v107 offset:25088
  buffer_load_dwordx4 a[124:127], v251, s[44:47], s59 offen sc1
  v_mfma_f32_16x16x32_bf16 v[24:27], v[76:79], v[236:239], v[24:27]
  ds_read_b128 v[148:151], v1 offset:0
  v_cmp_ne_u64 s[22:23], s[10:11], v[122:123]
  v_mfma_f32_16x16x32_bf16 v[28:31], v[76:79], v[240:243], v[28:31]
  ds_read_b128 v[176:179], v1 offset:448
  s_waitcnt lgkmcnt(8)
  v_mfma_f32_16x16x32_bf16 v[32:35], v[80:83], v[236:239], v[32:35]
  ds_read_b128 v[152:155], v1 offset:64
  v_cmp_ne_u64 s[20:21], s[10:11], v[126:127]
  v_mfma_f32_16x16x32_bf16 v[36:39], v[80:83], v[240:243], v[36:39]
  ds_read_b128 v[180:183], v1 offset:512
  buffer_load_dwordx4 a[128:131], v248, s[44:47], s60 offen sc1
  v_mfma_f32_16x16x32_bf16 v[40:43], v[84:87], v[236:239], v[40:43]
  ds_read_b128 v[156:159], v1 offset:128
  s_or_b64 s[24:25], s[24:25], s[22:23]
  v_mfma_f32_16x16x32_bf16 v[44:47], v[84:87], v[240:243], v[44:47]
  ds_read_b128 v[184:187], v1 offset:576
  s_waitcnt lgkmcnt(8)
  v_mfma_f32_16x16x32_bf16 v[48:51], v[88:91], v[236:239], v[48:51]
  ds_read_b128 v[160:163], v1 offset:192
  buffer_load_dwordx4 a[132:135], v249, s[44:47], s60 offen sc1
  v_mfma_f32_16x16x32_bf16 v[52:55], v[88:91], v[240:243], v[52:55]
  ds_read_b128 v[188:191], v1 offset:640
  v_cmp_ne_u64 s[22:23], s[10:11], v[130:131]
  v_mfma_f32_16x16x32_bf16 v[56:59], v[92:95], v[236:239], v[56:59]
  ds_read_b128 v[164:167], v1 offset:256
  s_or_b64 s[24:25], s[24:25], s[20:21]
  v_mfma_f32_16x16x32_bf16 v[60:63], v[92:95], v[240:243], v[60:63]
  ds_read_b128 v[192:195], v1 offset:704
  s_waitcnt lgkmcnt(10)
  v_mfma_f32_16x16x32_bf16 v[64:67], v[96:99], v[236:239], v[64:67]
  ds_read_b128 v[168:171], v1 offset:320
  buffer_load_dwordx4 a[136:139], v250, s[44:47], s60 offen sc1
  v_mfma_f32_16x16x32_bf16 v[68:71], v[96:99], v[240:243], v[68:71]
  ds_read_b128 v[196:199], v1 offset:768
  ds_read_b128 v[172:175], v1 offset:384
  ds_read_b128 v[200:203], v1 offset:832
  v_cmp_ne_u64 s[20:21], s[10:11], v[134:135]
  s_or_b64 s[24:25], s[24:25], s[22:23]
  v_cmp_ne_u64 s[22:23], s[10:11], v[138:139]
  s_or_b64 s[24:25], s[24:25], s[20:21]
  v_cmp_ne_u64 s[20:21], s[10:11], v[142:143]
  s_or_b64 s[24:25], s[24:25], s[22:23]
  v_cmp_ne_u64 s[22:23], s[10:11], v[146:147]
  s_or_b64 s[24:25], s[24:25], s[20:21]
  s_or_b64 vcc, s[24:25], s[22:23]
  s_cbranch_vccnz RSg11p
BSg11p:
  v_add_f32 v116, v116, v120
  v_add_f32 v117, v117, v121
  v_add_f32 v124, v124, v128
  v_add_f32 v125, v125, v129
  v_add_f32 v132, v132, v136
  v_add_f32 v133, v133, v137
  v_add_f32 v140, v140, v144
  v_add_f32 v141, v141, v145
  v_add_f32 v116, v116, v124
  v_add_f32 v117, v117, v125
  v_add_f32 v132, v132, v140
  v_add_f32 v133, v133, v141
  v_add_f32 v116, v116, v132
  v_add_f32 v117, v117, v133
  v_mov_b32 v120, v116
  v_mov_b32 v121, v117
  s_nop 0
  v_permlane16_swap_b32 v116, v120
  v_permlane16_swap_b32 v117, v121
  v_add_f32 v116, v116, v120
  v_add_f32 v117, v117, v121
  v_mul_f32 v116, 0x3b000000, v116
  v_mul_f32 v117, 0x3b000000, v117
  v_fma_f32 v117, -v116, v116, v117
  v_max_f32 v117, 0, v117
  v_cvt_pk_bf16_f32 v119, 0, v117
  v_add_f32 v119, 0x3727c5ac, v119
  v_cvt_pk_bf16_f32 v119, 0, v119
  v_sqrt_f32 v119, v119
  s_nop 0
  v_cvt_pk_bf16_f32 v118, v116, v119
  v_and_b32 v13, 0xffff0000, v118
  v_rcp_f32 v13, v13
  v_lshlrev_b32 v12, 16, v118
  v_mul_f32 v12, v12, v13
  v_mul_f32 v13, 0x3fb8aa3b, v13
  v_mov_b32 v14, v12
  v_mov_b32 v15, v13
  s_nop 0
  v_permlane32_swap_b32 v12, v14
  v_permlane32_swap_b32 v13, v15
  s_mov_b32 s20, 1.0
  s_mov_b32 s21, 1.0
  s_mov_b32 s22, 0x3f317218
  s_mov_b32 s23, 0xbfb17218
  s_lshl2_add_u32 s12, s2, s3
  s_lshl_b32 s12, s12, 3
  s_add_u32 s12, s12, 0x18b2000
  buffer_store_dwordx2 v[4:5], v6, s[44:47], s12 offen sc1
  s_waitcnt lgkmcnt(0)
  v_pk_fma_f32 v[204:205], v[148:149], v[12:13], v[176:177] op_sel:[0,0,0] op_sel_hi:[1,0,1] neg_lo:[0,1,0] neg_hi:[0,1,0]
  v_pk_fma_f32 v[206:207], v[150:151], v[12:13], v[178:179] op_sel:[0,0,0] op_sel_hi:[1,0,1] neg_lo:[0,1,0] neg_hi:[0,1,0]
  v_pk_fma_f32 v[212:213], v[152:153], v[12:13], v[180:181] op_sel:[0,0,0] op_sel_hi:[1,0,1] neg_lo:[0,1,0] neg_hi:[0,1,0]
  v_pk_fma_f32 v[214:215], v[154:155], v[12:13], v[182:183] op_sel:[0,0,0] op_sel_hi:[1,0,1] neg_lo:[0,1,0] neg_hi:[0,1,0]
  v_pk_fma_f32 v[204:205], v[16:17], v[12:13], v[204:205] op_sel:[0,1,0] op_sel_hi:[1,1,1]
  v_pk_fma_f32 v[206:207], v[18:19], v[12:13], v[206:207] op_sel:[0,1,0] op_sel_hi:[1,1,1]
  v_pk_fma_f32 v[212:213], v[24:25], v[12:13], v[212:213] op_sel:[0,1,0] op_sel_hi:[1,1,1]
  v_pk_fma_f32 v[214:215], v[26:27], v[12:13], v[214:215] op_sel:[0,1,0] op_sel_hi:[1,1,1]
  v_exp_f32 v208, v204
  v_exp_f32 v209, v205
  v_exp_f32 v216, v212
  v_exp_f32 v217, v213
  v_exp_f32 v210, v206
  v_exp_f32 v211, v207
  v_exp_f32 v218, v214
  v_exp_f32 v219, v215
  v_pk_add_f32 v[208:209], v[208:209], s[20:21]
  v_pk_add_f32 v[210:211], v[210:211], s[20:21]
  v_pk_add_f32 v[216:217], v[216:217], s[20:21]
  v_pk_add_f32 v[218:219], v[218:219], s[20:21]
  v_pk_fma_f32 v[208:209], v[208:209], v[208:209], s[20:21]
  v_pk_fma_f32 v[210:211], v[210:211], v[210:211], s[20:21]
  v_pk_fma_f32 v[216:217], v[216:217], v[216:217], s[20:21]
  v_pk_fma_f32 v[218:219], v[218:219], v[218:219], s[20:21]
  v_rcp_f32 v208, v208
  v_rcp_f32 v209, v209
  v_rcp_f32 v216, v216
  v_rcp_f32 v217, v217
  v_rcp_f32 v210, v210
  v_rcp_f32 v211, v211
  v_rcp_f32 v218, v218
  v_rcp_f32 v219, v219
  v_pk_fma_f32 v[208:209], v[208:209], s[22:23], s[22:23] op_sel:[0,1,0] op_sel_hi:[1,1,0]
  v_pk_fma_f32 v[210:211], v[210:211], s[22:23], s[22:23] op_sel:[0,1,0] op_sel_hi:[1,1,0]
  v_pk_fma_f32 v[216:217], v[216:217], s[22:23], s[22:23] op_sel:[0,1,0] op_sel_hi:[1,1,0]
  v_pk_fma_f32 v[218:219], v[218:219], s[22:23], s[22:23] op_sel:[0,1,0] op_sel_hi:[1,1,0]
  v_pk_mul_f32 v[208:209], v[208:209], v[204:205]
  v_pk_mul_f32 v[210:211], v[210:211], v[206:207]
  v_pk_mul_f32 v[216:217], v[216:217], v[212:213]
  v_pk_mul_f32 v[218:219], v[218:219], v[214:215]
  v_cvt_pk_bf16_f32 v236, v208, v209
  v_cvt_pk_bf16_f32 v237, v210, v211
  v_cvt_pk_bf16_f32 v238, v216, v217
  v_cvt_pk_bf16_f32 v239, v218, v219
  buffer_store_dwordx4 v[236:239], v252, s[44:47], 0 offen offset:0 sc1
  buffer_load_dwordx4 a[140:143], v251, s[44:47], s60 offen sc1
  buffer_load_dwordx4 a[144:147], v248, s[44:47], s61 offen sc1
  buffer_load_dwordx4 a[148:151], v249, s[44:47], s61 offen sc1
  buffer_load_dwordx4 a[152:155], v250, s[44:47], s61 offen sc1
  v_pk_fma_f32 v[220:221], v[148:149], v[14:15], v[176:177] op_sel:[0,0,0] op_sel_hi:[1,0,1] neg_lo:[0,1,0] neg_hi:[0,1,0]
  v_pk_fma_f32 v[222:223], v[150:151], v[14:15], v[178:179] op_sel:[0,0,0] op_sel_hi:[1,0,1] neg_lo:[0,1,0] neg_hi:[0,1,0]
  v_pk_fma_f32 v[228:229], v[152:153], v[14:15], v[180:181] op_sel:[0,0,0] op_sel_hi:[1,0,1] neg_lo:[0,1,0] neg_hi:[0,1,0]
  v_pk_fma_f32 v[230:231], v[154:155], v[14:15], v[182:183] op_sel:[0,0,0] op_sel_hi:[1,0,1] neg_lo:[0,1,0] neg_hi:[0,1,0]
  v_pk_fma_f32 v[220:221], v[20:21], v[14:15], v[220:221] op_sel:[0,1,0] op_sel_hi:[1,1,1]
  v_pk_fma_f32 v[222:223], v[22:23], v[14:15], v[222:223] op_sel:[0,1,0] op_sel_hi:[1,1,1]
  v_pk_fma_f32 v[228:229], v[28:29], v[14:15], v[228:229] op_sel:[0,1,0] op_sel_hi:[1,1,1]
  v_pk_fma_f32 v[230:231], v[30:31], v[14:15], v[230:231] op_sel:[0,1,0] op_sel_hi:[1,1,1]
  v_exp_f32 v224, v220
  v_exp_f32 v225, v221
  v_exp_f32 v232, v228
  v_exp_f32 v233, v229
  v_exp_f32 v226, v222
  v_exp_f32 v227, v223
  v_exp_f32 v234, v230
  v_exp_f32 v235, v231
  v_pk_add_f32 v[224:225], v[224:225], s[20:21]
  v_pk_add_f32 v[226:227], v[226:227], s[20:21]
  v_pk_add_f32 v[232:233], v[232:233], s[20:21]
  v_pk_add_f32 v[234:235], v[234:235], s[20:21]
  v_pk_fma_f32 v[224:225], v[224:225], v[224:225], s[20:21]
  v_pk_fma_f32 v[226:227], v[226:227], v[226:227], s[20:21]
  v_pk_fma_f32 v[232:233], v[232:233], v[232:233], s[20:21]
  v_pk_fma_f32 v[234:235], v[234:235], v[234:235], s[20:21]
  v_rcp_f32 v224, v224
  v_rcp_f32 v225, v225
  v_rcp_f32 v232, v232
  v_rcp_f32 v233, v233
  v_rcp_f32 v226, v226
  v_rcp_f32 v227, v227
  v_rcp_f32 v234, v234
  v_rcp_f32 v235, v235
  v_pk_fma_f32 v[224:225], v[224:225], s[22:23], s[22:23] op_sel:[0,1,0] op_sel_hi:[1,1,0]
  v_pk_fma_f32 v[226:227], v[226:227], s[22:23], s[22:23] op_sel:[0,1,0] op_sel_hi:[1,1,0]
  v_pk_fma_f32 v[232:233], v[232:233], s[22:23], s[22:23] op_sel:[0,1,0] op_sel_hi:[1,1,0]
  v_pk_fma_f32 v[234:235], v[234:235], s[22:23], s[22:23] op_sel:[0,1,0] op_sel_hi:[1,1,0]
  v_pk_mul_f32 v[224:225], v[224:225], v[220:221]
  v_pk_mul_f32 v[226:227], v[226:227], v[222:223]
  v_pk_mul_f32 v[232:233], v[232:233], v[228:229]
  v_pk_mul_f32 v[234:235], v[234:235], v[230:231]
  v_cvt_pk_bf16_f32 v240, v224, v225
  v_cvt_pk_bf16_f32 v241, v226, v227
  v_cvt_pk_bf16_f32 v242, v232, v233
  v_cvt_pk_bf16_f32 v243, v234, v235
  buffer_store_dwordx4 v[240:243], v253, s[44:47], 0 offen offset:0 sc1
  buffer_load_dwordx4 a[156:159], v251, s[44:47], s61 offen sc1
  buffer_load_dwordx4 a[160:163], v248, s[44:47], s62 offen sc1
  buffer_load_dwordx4 a[164:167], v249, s[44:47], s62 offen sc1
  buffer_load_dwordx4 a[168:171], v250, s[44:47], s62 offen sc1
  v_pk_fma_f32 v[204:205], v[156:157], v[12:13], v[184:185] op_sel:[0,0,0] op_sel_hi:[1,0,1] neg_lo:[0,1,0] neg_hi:[0,1,0]
  v_pk_fma_f32 v[206:207], v[158:159], v[12:13], v[186:187] op_sel:[0,0,0] op_sel_hi:[1,0,1] neg_lo:[0,1,0] neg_hi:[0,1,0]
  v_pk_fma_f32 v[212:213], v[160:161], v[12:13], v[188:189] op_sel:[0,0,0] op_sel_hi:[1,0,1] neg_lo:[0,1,0] neg_hi:[0,1,0]
  v_pk_fma_f32 v[214:215], v[162:163], v[12:13], v[190:191] op_sel:[0,0,0] op_sel_hi:[1,0,1] neg_lo:[0,1,0] neg_hi:[0,1,0]
  v_pk_fma_f32 v[204:205], v[32:33], v[12:13], v[204:205] op_sel:[0,1,0] op_sel_hi:[1,1,1]
  v_pk_fma_f32 v[206:207], v[34:35], v[12:13], v[206:207] op_sel:[0,1,0] op_sel_hi:[1,1,1]
  v_pk_fma_f32 v[212:213], v[40:41], v[12:13], v[212:213] op_sel:[0,1,0] op_sel_hi:[1,1,1]
  v_pk_fma_f32 v[214:215], v[42:43], v[12:13], v[214:215] op_sel:[0,1,0] op_sel_hi:[1,1,1]
  v_exp_f32 v208, v204
  v_exp_f32 v209, v205
  v_exp_f32 v216, v212
  v_exp_f32 v217, v213
  v_exp_f32 v210, v206
  v_exp_f32 v211, v207
  v_exp_f32 v218, v214
  v_exp_f32 v219, v215
  v_pk_add_f32 v[208:209], v[208:209], s[20:21]
  v_pk_add_f32 v[210:211], v[210:211], s[20:21]
  v_pk_add_f32 v[216:217], v[216:217], s[20:21]
  v_pk_add_f32 v[218:219], v[218:219], s[20:21]
  v_pk_fma_f32 v[208:209], v[208:209], v[208:209], s[20:21]
  v_pk_fma_f32 v[210:211], v[210:211], v[210:211], s[20:21]
  v_pk_fma_f32 v[216:217], v[216:217], v[216:217], s[20:21]
  v_pk_fma_f32 v[218:219], v[218:219], v[218:219], s[20:21]
  v_rcp_f32 v208, v208
  v_rcp_f32 v209, v209
  v_rcp_f32 v216, v216
  v_rcp_f32 v217, v217
  v_rcp_f32 v210, v210
  v_rcp_f32 v211, v211
  v_rcp_f32 v218, v218
  v_rcp_f32 v219, v219
  v_pk_fma_f32 v[208:209], v[208:209], s[22:23], s[22:23] op_sel:[0,1,0] op_sel_hi:[1,1,0]
  v_pk_fma_f32 v[210:211], v[210:211], s[22:23], s[22:23] op_sel:[0,1,0] op_sel_hi:[1,1,0]
  v_pk_fma_f32 v[216:217], v[216:217], s[22:23], s[22:23] op_sel:[0,1,0] op_sel_hi:[1,1,0]
  v_pk_fma_f32 v[218:219], v[218:219], s[22:23], s[22:23] op_sel:[0,1,0] op_sel_hi:[1,1,0]
  v_pk_mul_f32 v[208:209], v[208:209], v[204:205]
  v_pk_mul_f32 v[210:211], v[210:211], v[206:207]
  v_pk_mul_f32 v[216:217], v[216:217], v[212:213]
  v_pk_mul_f32 v[218:219], v[218:219], v[214:215]
  v_cvt_pk_bf16_f32 v236, v208, v209
  v_cvt_pk_bf16_f32 v237, v210, v211
  v_cvt_pk_bf16_f32 v238, v216, v217
  v_cvt_pk_bf16_f32 v239, v218, v219
  buffer_store_dwordx4 v[236:239], v252, s[44:47], 0 offen offset:1024 sc1
  s_waitcnt vmcnt(5)
  buffer_store_dwordx2 v[4:5], v6, s[44:47], s30 offen offset:0 sc1
  buffer_load_dwordx4 a[172:175], v251, s[44:47], s62 offen sc1
  buffer_load_dwordx4 a[176:179], v248, s[44:47], s63 offen sc1
  buffer_load_dwordx4 a[180:183], v249, s[44:47], s63 offen sc1
  buffer_load_dwordx4 a[184:187], v250, s[44:47], s63 offen sc1
  v_pk_fma_f32 v[220:221], v[156:157], v[14:15], v[184:185] op_sel:[0,0,0] op_sel_hi:[1,0,1] neg_lo:[0,1,0] neg_hi:[0,1,0]
  v_pk_fma_f32 v[222:223], v[158:159], v[14:15], v[186:187] op_sel:[0,0,0] op_sel_hi:[1,0,1] neg_lo:[0,1,0] neg_hi:[0,1,0]
  v_pk_fma_f32 v[228:229], v[160:161], v[14:15], v[188:189] op_sel:[0,0,0] op_sel_hi:[1,0,1] neg_lo:[0,1,0] neg_hi:[0,1,0]
  v_pk_fma_f32 v[230:231], v[162:163], v[14:15], v[190:191] op_sel:[0,0,0] op_sel_hi:[1,0,1] neg_lo:[0,1,0] neg_hi:[0,1,0]
  v_pk_fma_f32 v[220:221], v[36:37], v[14:15], v[220:221] op_sel:[0,1,0] op_sel_hi:[1,1,1]
  v_pk_fma_f32 v[222:223], v[38:39], v[14:15], v[222:223] op_sel:[0,1,0] op_sel_hi:[1,1,1]
  v_pk_fma_f32 v[228:229], v[44:45], v[14:15], v[228:229] op_sel:[0,1,0] op_sel_hi:[1,1,1]
  v_pk_fma_f32 v[230:231], v[46:47], v[14:15], v[230:231] op_sel:[0,1,0] op_sel_hi:[1,1,1]
  v_exp_f32 v224, v220
  v_exp_f32 v225, v221
  v_exp_f32 v232, v228
  v_exp_f32 v233, v229
  v_exp_f32 v226, v222
  v_exp_f32 v227, v223
  v_exp_f32 v234, v230
  v_exp_f32 v235, v231
  v_pk_add_f32 v[224:225], v[224:225], s[20:21]
  v_pk_add_f32 v[226:227], v[226:227], s[20:21]
  v_pk_add_f32 v[232:233], v[232:233], s[20:21]
  v_pk_add_f32 v[234:235], v[234:235], s[20:21]
  v_pk_fma_f32 v[224:225], v[224:225], v[224:225], s[20:21]
  v_pk_fma_f32 v[226:227], v[226:227], v[226:227], s[20:21]
  v_pk_fma_f32 v[232:233], v[232:233], v[232:233], s[20:21]
  v_pk_fma_f32 v[234:235], v[234:235], v[234:235], s[20:21]
  v_rcp_f32 v224, v224
  v_rcp_f32 v225, v225
  v_rcp_f32 v232, v232
  v_rcp_f32 v233, v233
  v_rcp_f32 v226, v226
  v_rcp_f32 v227, v227
  v_rcp_f32 v234, v234
  v_rcp_f32 v235, v235
  v_pk_fma_f32 v[224:225], v[224:225], s[22:23], s[22:23] op_sel:[0,1,0] op_sel_hi:[1,1,0]
  v_pk_fma_f32 v[226:227], v[226:227], s[22:23], s[22:23] op_sel:[0,1,0] op_sel_hi:[1,1,0]
  v_pk_fma_f32 v[232:233], v[232:233], s[22:23], s[22:23] op_sel:[0,1,0] op_sel_hi:[1,1,0]
  v_pk_fma_f32 v[234:235], v[234:235], s[22:23], s[22:23] op_sel:[0,1,0] op_sel_hi:[1,1,0]
  v_pk_mul_f32 v[224:225], v[224:225], v[220:221]
  v_pk_mul_f32 v[226:227], v[226:227], v[222:223]
  v_pk_mul_f32 v[232:233], v[232:233], v[228:229]
  v_pk_mul_f32 v[234:235], v[234:235], v[230:231]
  v_cvt_pk_bf16_f32 v240, v224, v225
  v_cvt_pk_bf16_f32 v241, v226, v227
  v_cvt_pk_bf16_f32 v242, v232, v233
  v_cvt_pk_bf16_f32 v243, v234, v235
  buffer_store_dwordx4 v[240:243], v253, s[44:47], 0 offen offset:1024 sc1
  buffer_load_dwordx4 a[188:191], v251, s[44:47], s63 offen sc1
  buffer_load_dwordx4 a[192:195], v248, s[44:47], s64 offen sc1
  buffer_load_dwordx4 a[196:199], v249, s[44:47], s64 offen sc1
  buffer_load_dwordx4 a[200:203], v250, s[44:47], s64 offen sc1
  v_pk_fma_f32 v[204:205], v[164:165], v[12:13], v[192:193] op_sel:[0,0,0] op_sel_hi:[1,0,1] neg_lo:[0,1,0] neg_hi:[0,1,0]
  v_pk_fma_f32 v[206:207], v[166:167], v[12:13], v[194:195] op_sel:[0,0,0] op_sel_hi:[1,0,1] neg_lo:[0,1,0] neg_hi:[0,1,0]
  v_pk_fma_f32 v[212:213], v[168:169], v[12:13], v[196:197] op_sel:[0,0,0] op_sel_hi:[1,0,1] neg_lo:[0,1,0] neg_hi:[0,1,0]
  v_pk_fma_f32 v[214:215], v[170:171], v[12:13], v[198:199] op_sel:[0,0,0] op_sel_hi:[1,0,1] neg_lo:[0,1,0] neg_hi:[0,1,0]
  v_pk_fma_f32 v[204:205], v[48:49], v[12:13], v[204:205] op_sel:[0,1,0] op_sel_hi:[1,1,1]
  v_pk_fma_f32 v[206:207], v[50:51], v[12:13], v[206:207] op_sel:[0,1,0] op_sel_hi:[1,1,1]
  v_pk_fma_f32 v[212:213], v[56:57], v[12:13], v[212:213] op_sel:[0,1,0] op_sel_hi:[1,1,1]
  v_pk_fma_f32 v[214:215], v[58:59], v[12:13], v[214:215] op_sel:[0,1,0] op_sel_hi:[1,1,1]
  v_exp_f32 v208, v204
  v_exp_f32 v209, v205
  v_exp_f32 v216, v212
  v_exp_f32 v217, v213
  v_exp_f32 v210, v206
  v_exp_f32 v211, v207
  v_exp_f32 v218, v214
  v_exp_f32 v219, v215
  v_pk_add_f32 v[208:209], v[208:209], s[20:21]
  v_pk_add_f32 v[210:211], v[210:211], s[20:21]
  v_pk_add_f32 v[216:217], v[216:217], s[20:21]
  v_pk_add_f32 v[218:219], v[218:219], s[20:21]
  v_pk_fma_f32 v[208:209], v[208:209], v[208:209], s[20:21]
  v_pk_fma_f32 v[210:211], v[210:211], v[210:211], s[20:21]
  v_pk_fma_f32 v[216:217], v[216:217], v[216:217], s[20:21]
  v_pk_fma_f32 v[218:219], v[218:219], v[218:219], s[20:21]
  v_rcp_f32 v208, v208
  v_rcp_f32 v209, v209
  v_rcp_f32 v216, v216
  v_rcp_f32 v217, v217
  v_rcp_f32 v210, v210
  v_rcp_f32 v211, v211
  v_rcp_f32 v218, v218
  v_rcp_f32 v219, v219
  v_pk_fma_f32 v[208:209], v[208:209], s[22:23], s[22:23] op_sel:[0,1,0] op_sel_hi:[1,1,0]
  v_pk_fma_f32 v[210:211], v[210:211], s[22:23], s[22:23] op_sel:[0,1,0] op_sel_hi:[1,1,0]
  v_pk_fma_f32 v[216:217], v[216:217], s[22:23], s[22:23] op_sel:[0,1,0] op_sel_hi:[1,1,0]
  v_pk_fma_f32 v[218:219], v[218:219], s[22:23], s[22:23] op_sel:[0,1,0] op_sel_hi:[1,1,0]
  v_pk_mul_f32 v[208:209], v[208:209], v[204:205]
  v_pk_mul_f32 v[210:211], v[210:211], v[206:207]
  v_pk_mul_f32 v[216:217], v[216:217], v[212:213]
  v_pk_mul_f32 v[218:219], v[218:219], v[214:215]
  v_cvt_pk_bf16_f32 v236, v208, v209
  v_cvt_pk_bf16_f32 v237, v210, v211
  v_cvt_pk_bf16_f32 v238, v216, v217
  v_cvt_pk_bf16_f32 v239, v218, v219
  buffer_store_dwordx4 v[236:239], v252, s[44:47], 0 offen offset:2048 sc1
  s_waitcnt vmcnt(5)
  buffer_store_dwordx2 v[4:5], v6, s[44:47], s30 offen offset:8 sc1
  buffer_load_dwordx4 a[204:207], v251, s[44:47], s64 offen sc1
  buffer_load_dwordx4 a[208:211], v248, s[44:47], s65 offen sc1
  buffer_load_dwordx4 a[212:215], v249, s[44:47], s65 offen sc1
  buffer_load_dwordx4 a[216:219], v250, s[44:47], s65 offen sc1
  buffer_load_dwordx4 a[220:223], v251, s[44:47], s65 offen sc1
  v_pk_fma_f32 v[220:221], v[164:165], v[14:15], v[192:193] op_sel:[0,0,0] op_sel_hi:[1,0,1] neg_lo:[0,1,0] neg_hi:[0,1,0]
  v_pk_fma_f32 v[222:223], v[166:167], v[14:15], v[194:195] op_sel:[0,0,0] op_sel_hi:[1,0,1] neg_lo:[0,1,0] neg_hi:[0,1,0]
  v_pk_fma_f32 v[228:229], v[168:169], v[14:15], v[196:197] op_sel:[0,0,0] op_sel_hi:[1,0,1] neg_lo:[0,1,0] neg_hi:[0,1,0]
  v_pk_fma_f32 v[230:231], v[170:171], v[14:15], v[198:199] op_sel:[0,0,0] op_sel_hi:[1,0,1] neg_lo:[0,1,0] neg_hi:[0,1,0]
  v_pk_fma_f32 v[220:221], v[52:53], v[14:15], v[220:221] op_sel:[0,1,0] op_sel_hi:[1,1,1]
  v_pk_fma_f32 v[222:223], v[54:55], v[14:15], v[222:223] op_sel:[0,1,0] op_sel_hi:[1,1,1]
  v_pk_fma_f32 v[228:229], v[60:61], v[14:15], v[228:229] op_sel:[0,1,0] op_sel_hi:[1,1,1]
  v_pk_fma_f32 v[230:231], v[62:63], v[14:15], v[230:231] op_sel:[0,1,0] op_sel_hi:[1,1,1]
  v_exp_f32 v224, v220
  v_exp_f32 v225, v221
  v_exp_f32 v232, v228
  v_exp_f32 v233, v229
  v_exp_f32 v226, v222
  v_exp_f32 v227, v223
  v_exp_f32 v234, v230
  v_exp_f32 v235, v231
  v_pk_add_f32 v[224:225], v[224:225], s[20:21]
  v_pk_add_f32 v[226:227], v[226:227], s[20:21]
  v_pk_add_f32 v[232:233], v[232:233], s[20:21]
  v_pk_add_f32 v[234:235], v[234:235], s[20:21]
  v_pk_fma_f32 v[224:225], v[224:225], v[224:225], s[20:21]
  v_pk_fma_f32 v[226:227], v[226:227], v[226:227], s[20:21]
  v_pk_fma_f32 v[232:233], v[232:233], v[232:233], s[20:21]
  v_pk_fma_f32 v[234:235], v[234:235], v[234:235], s[20:21]
  v_rcp_f32 v224, v224
  v_rcp_f32 v225, v225
  v_rcp_f32 v232, v232
  v_rcp_f32 v233, v233
  v_rcp_f32 v226, v226
  v_rcp_f32 v227, v227
  v_rcp_f32 v234, v234
  v_rcp_f32 v235, v235
  v_pk_fma_f32 v[224:225], v[224:225], s[22:23], s[22:23] op_sel:[0,1,0] op_sel_hi:[1,1,0]
  v_pk_fma_f32 v[226:227], v[226:227], s[22:23], s[22:23] op_sel:[0,1,0] op_sel_hi:[1,1,0]
  v_pk_fma_f32 v[232:233], v[232:233], s[22:23], s[22:23] op_sel:[0,1,0] op_sel_hi:[1,1,0]
  v_pk_fma_f32 v[234:235], v[234:235], s[22:23], s[22:23] op_sel:[0,1,0] op_sel_hi:[1,1,0]
  v_pk_mul_f32 v[224:225], v[224:225], v[220:221]
  v_pk_mul_f32 v[226:227], v[226:227], v[222:223]
  v_pk_mul_f32 v[232:233], v[232:233], v[228:229]
  v_pk_mul_f32 v[234:235], v[234:235], v[230:231]
  v_cvt_pk_bf16_f32 v240, v224, v225
  v_cvt_pk_bf16_f32 v241, v226, v227
  v_cvt_pk_bf16_f32 v242, v232, v233
  v_cvt_pk_bf16_f32 v243, v234, v235
  buffer_store_dwordx4 v[240:243], v253, s[44:47], 0 offen offset:2048 sc1
  buffer_load_dwordx2 v[72:73], v3, s[44:47], s31 offen sc1
  v_pk_fma_f32 v[204:205], v[172:173], v[12:13], v[200:201] op_sel:[0,0,0] op_sel_hi:[1,0,1] neg_lo:[0,1,0] neg_hi:[0,1,0]
  v_pk_fma_f32 v[206:207], v[174:175], v[12:13], v[202:203] op_sel:[0,0,0] op_sel_hi:[1,0,1] neg_lo:[0,1,0] neg_hi:[0,1,0]
  v_pk_fma_f32 v[212:213], v[172:173], v[14:15], v[200:201] op_sel:[0,0,0] op_sel_hi:[1,0,1] neg_lo:[0,1,0] neg_hi:[0,1,0]
  v_pk_fma_f32 v[214:215], v[174:175], v[14:15], v[202:203] op_sel:[0,0,0] op_sel_hi:[1,0,1] neg_lo:[0,1,0] neg_hi:[0,1,0]
  v_pk_fma_f32 v[204:205], v[64:65], v[12:13], v[204:205] op_sel:[0,1,0] op_sel_hi:[1,1,1]
  v_pk_fma_f32 v[206:207], v[66:67], v[12:13], v[206:207] op_sel:[0,1,0] op_sel_hi:[1,1,1]
  v_pk_fma_f32 v[212:213], v[68:69], v[14:15], v[212:213] op_sel:[0,1,0] op_sel_hi:[1,1,1]
  v_pk_fma_f32 v[214:215], v[70:71], v[14:15], v[214:215] op_sel:[0,1,0] op_sel_hi:[1,1,1]
  v_exp_f32 v208, v204
  v_exp_f32 v209, v205
  v_exp_f32 v216, v212
  v_exp_f32 v217, v213
  v_exp_f32 v210, v206
  v_exp_f32 v211, v207
  v_exp_f32 v218, v214
  v_exp_f32 v219, v215
  v_pk_add_f32 v[208:209], v[208:209], s[20:21]
  v_pk_add_f32 v[210:211], v[210:211], s[20:21]
  v_pk_add_f32 v[216:217], v[216:217], s[20:21]
  v_pk_add_f32 v[218:219], v[218:219], s[20:21]
  v_pk_fma_f32 v[208:209], v[208:209], v[208:209], s[20:21]
  v_pk_fma_f32 v[210:211], v[210:211], v[210:211], s[20:21]
  v_pk_fma_f32 v[216:217], v[216:217], v[216:217], s[20:21]
  v_pk_fma_f32 v[218:219], v[218:219], v[218:219], s[20:21]
  v_rcp_f32 v208, v208
  v_rcp_f32 v209, v209
  v_rcp_f32 v216, v216
  v_rcp_f32 v217, v217
  v_rcp_f32 v210, v210
  v_rcp_f32 v211, v211
  v_rcp_f32 v218, v218
  v_rcp_f32 v219, v219
  v_pk_fma_f32 v[208:209], v[208:209], s[22:23], s[22:23] op_sel:[0,1,0] op_sel_hi:[1,1,0]
  v_pk_fma_f32 v[210:211], v[210:211], s[22:23], s[22:23] op_sel:[0,1,0] op_sel_hi:[1,1,0]
  v_pk_fma_f32 v[216:217], v[216:217], s[22:23], s[22:23] op_sel:[0,1,0] op_sel_hi:[1,1,0]
  v_pk_fma_f32 v[218:219], v[218:219], s[22:23], s[22:23] op_sel:[0,1,0] op_sel_hi:[1,1,0]
  v_pk_mul_f32 v[208:209], v[208:209], v[204:205]
  v_pk_mul_f32 v[210:211], v[210:211], v[206:207]
  v_pk_mul_f32 v[216:217], v[216:217], v[212:213]
  v_pk_mul_f32 v[218:219], v[218:219], v[214:215]
  v_cvt_pk_bf16_f32 v236, v208, v209
  v_cvt_pk_bf16_f32 v237, v210, v211
  v_cvt_pk_bf16_f32 v238, v216, v217
  v_cvt_pk_bf16_f32 v239, v218, v219
  s_nop 0
  v_permlane16_swap_b32 v236, v238
  v_permlane16_swap_b32 v237, v239
  buffer_store_dwordx4 v[236:239], v254, s[44:47], 0 offen sc1
  s_waitcnt vmcnt(2)
  buffer_store_dwordx2 v[4:5], v6, s[44:47], s30 offen offset:16 sc1
  s_lshl_b32 s12, s7, 1
  s_lshr_b32 s13, s3, 1
  s_add_u32 s12, s12, s13
  s_mul_i32 s12, s12, 33024
  s_lshl_b32 s13, s8, 12
  s_add_u32 s12, s12, s13
  s_and_b32 s13, s3, 1
  s_lshl_b32 s14, s13, 11
  s_add_u32 s14, s14, s12
  s_add_u32 s19, s14, 0x210000
  s_lshl_b32 s13, s13, 2
  s_add_u32 s12, s12, s13
  s_add_u32 s17, s12, 0x0
  v_lshlrev_b32 v7, 4, v2
  s_lshl2_add_u32 s15, s7, s3
  s_lshl_b32 s15, s15, 14
  s_load_dword s15, s[38:39], s15
  s_waitcnt vmcnt(2)
  v_cmp_ne_u64 vcc, s[10:11], v[72:73]
  s_nop 0
  s_and_b32 s12, vcc_lo, 0x11111111
  s_cbranch_scc1 RSg21f0
BSg21f0:
  buffer_load_dwordx4 v[80:83], v8, s[44:47], s52 offen sc1
  buffer_load_dwordx4 v[84:87], v9, s[44:47], s52 offen sc1
  buffer_load_dwordx4 v[88:91], v10, s[44:47], s52 offen sc1
  buffer_load_dwordx4 v[92:95], v11, s[44:47], s52 offen sc1
  buffer_load_dwordx2 v[12:13], v3, s[44:47], s31 offen sc1
  buffer_load_dwordx4 v[96:99], v8, s[44:47], s53 offen sc1
  buffer_load_dwordx4 v[100:103], v9, s[44:47], s53 offen sc1
  buffer_load_dwordx4 v[104:107], v10, s[44:47], s53 offen sc1
  buffer_load_dwordx4 v[108:111], v11, s[44:47], s53 offen sc1
  buffer_load_dwordx4 v[112:115], v8, s[44:47], s54 offen sc1
  buffer_load_dwordx4 v[116:119], v9, s[44:47], s54 offen sc1
  buffer_load_dwordx4 v[120:123], v10, s[44:47], s54 offen sc1
  buffer_load_dwordx4 v[124:127], v11, s[44:47], s54 offen sc1
  buffer_load_dwordx4 v[128:131], v8, s[44:47], s55 offen sc1
  buffer_load_dwordx4 v[132:135], v9, s[44:47], s55 offen sc1
  buffer_load_dwordx4 v[136:139], v10, s[44:47], s55 offen sc1
  buffer_load_dwordx4 v[140:143], v11, s[44:47], s55 offen sc1
  s_waitcnt vmcnt(18)
  buffer_store_dwordx2 v[4:5], v6, s[44:47], s30 offen offset:24 sc1
  s_waitcnt vmcnt(13)
  v_cmp_ne_u64 vcc, s[10:11], v[12:13]
  s_nop 0
  s_and_b32 s12, vcc_lo, 0x22222222
  s_cbranch_scc1 RSg21f1
BSg21f1:
  v_mfma_f32_16x16x32_bf16 v[16:19], v[80:83], a[0:3], 0
  buffer_load_dwordx4 v[144:147], v8, s[44:47], s56 offen sc1
  v_mfma_f32_16x16x32_bf16 v[20:23], v[80:83], a[4:7], 0
  v_mfma_f32_16x16x32_bf16 v[24:27], v[80:83], a[8:11], 0
  v_mfma_f32_16x16x32_bf16 v[28:31], v[80:83], a[12:15], 0
  v_mfma_f32_16x16x32_bf16 v[32:35], v[84:87], a[0:3], 0
  buffer_load_dwordx4 v[148:151], v9, s[44:47], s56 offen sc1
  v_mfma_f32_16x16x32_bf16 v[36:39], v[84:87], a[4:7], 0
  v_mfma_f32_16x16x32_bf16 v[40:43], v[84:87], a[8:11], 0
  v_mfma_f32_16x16x32_bf16 v[44:47], v[84:87], a[12:15], 0
  buffer_load_dwordx4 v[152:155], v10, s[44:47], s56 offen sc1
  v_mfma_f32_16x16x32_bf16 v[48:51], v[88:91], a[0:3], 0
  v_mfma_f32_16x16x32_bf16 v[52:55], v[88:91], a[4:7], 0
  v_mfma_f32_16x16x32_bf16 v[56:59], v[88:91], a[8:11], 0
  buffer_load_dwordx4 v[156:159], v11, s[44:47], s56 offen sc1
  v_mfma_f32_16x16x32_bf16 v[60:63], v[88:91], a[12:15], 0
  v_mfma_f32_16x16x32_bf16 v[64:67], v[92:95], a[0:3], 0
  v_mfma_f32_16x16x32_bf16 v[68:71], v[92:95], a[4:7], 0
  buffer_load_dwordx2 v[12:13], v3, s[44:47], s31 offen sc1
  v_mfma_f32_16x16x32_bf16 v[72:75], v[92:95], a[8:11], 0
  v_mfma_f32_16x16x32_bf16 v[76:79], v[92:95], a[12:15], 0
  s_waitcnt vmcnt(14)
  v_mfma_f32_16x16x32_bf16 v[16:19], v[96:99], a[16:19], v[16:19]
  buffer_load_dwordx4 v[160:163], v8, s[44:47], s57 offen sc1
  v_mfma_f32_16x16x32_bf16 v[20:23], v[96:99], a[20:23], v[20:23]
  v_mfma_f32_16x16x32_bf16 v[24:27], v[96:99], a[24:27], v[24:27]
  v_mfma_f32_16x16x32_bf16 v[28:31], v[96:99], a[28:31], v[28:31]
  v_mfma_f32_16x16x32_bf16 v[32:35], v[100:103], a[16:19], v[32:35]
  buffer_load_dwordx4 v[164:167], v9, s[44:47], s57 offen sc1
  v_mfma_f32_16x16x32_bf16 v[36:39], v[100:103], a[20:23], v[36:39]
  v_mfma_f32_16x16x32_bf16 v[40:43], v[100:103], a[24:27], v[40:43]
  v_mfma_f32_16x16x32_bf16 v[44:47], v[100:103], a[28:31], v[44:47]
  buffer_load_dwordx4 v[168:171], v10, s[44:47], s57 offen sc1
  v_mfma_f32_16x16x32_bf16 v[48:51], v[104:107], a[16:19], v[48:51]
  v_mfma_f32_16x16x32_bf16 v[52:55], v[104:107], a[20:23], v[52:55]
  v_mfma_f32_16x16x32_bf16 v[56:59], v[104:107], a[24:27], v[56:59]
  buffer_load_dwordx4 v[172:175], v11, s[44:47], s57 offen sc1
  v_mfma_f32_16x16x32_bf16 v[60:63], v[104:107], a[28:31], v[60:63]
  v_mfma_f32_16x16x32_bf16 v[64:67], v[108:111], a[16:19], v[64:67]
  v_mfma_f32_16x16x32_bf16 v[68:71], v[108:111], a[20:23], v[68:71]
  buffer_load_dwordx4 v[176:179], v8, s[44:47], s58 offen sc1
  v_mfma_f32_16x16x32_bf16 v[72:75], v[108:111], a[24:27], v[72:75]
  v_mfma_f32_16x16x32_bf16 v[76:79], v[108:111], a[28:31], v[76:79]
  s_waitcnt vmcnt(15)
  v_mfma_f32_16x16x32_bf16 v[16:19], v[112:115], a[32:35], v[16:19]
  buffer_load_dwordx4 v[180:183], v9, s[44:47], s58 offen sc1
  v_mfma_f32_16x16x32_bf16 v[20:23], v[112:115], a[36:39], v[20:23]
  v_mfma_f32_16x16x32_bf16 v[24:27], v[112:115], a[40:43], v[24:27]
  v_mfma_f32_16x16x32_bf16 v[28:31], v[112:115], a[44:47], v[28:31]
  v_mfma_f32_16x16x32_bf16 v[32:35], v[116:119], a[32:35], v[32:35]
  buffer_load_dwordx4 v[184:187], v10, s[44:47], s58 offen sc1
  v_mfma_f32_16x16x32_bf16 v[36:39], v[116:119], a[36:39], v[36:39]
  v_mfma_f32_16x16x32_bf16 v[40:43], v[116:119], a[40:43], v[40:43]
  v_mfma_f32_16x16x32_bf16 v[44:47], v[116:119], a[44:47], v[44:47]
  buffer_load_dwordx4 v[188:191], v11, s[44:47], s58 offen sc1
  v_mfma_f32_16x16x32_bf16 v[48:51], v[120:123], a[32:35], v[48:51]
  v_mfma_f32_16x16x32_bf16 v[52:55], v[120:123], a[36:39], v[52:55]
  v_mfma_f32_16x16x32_bf16 v[56:59], v[120:123], a[40:43], v[56:59]
  buffer_load_dwordx4 v[192:195], v8, s[44:47], s59 offen sc1
  v_mfma_f32_16x16x32_bf16 v[60:63], v[120:123], a[44:47], v[60:63]
  v_mfma_f32_16x16x32_bf16 v[64:67], v[124:127], a[32:35], v[64:67]
  v_mfma_f32_16x16x32_bf16 v[68:71], v[124:127], a[36:39], v[68:71]
  buffer_load_dwordx4 v[196:199], v9, s[44:47], s59 offen sc1
  v_mfma_f32_16x16x32_bf16 v[72:75], v[124:127], a[40:43], v[72:75]
  v_mfma_f32_16x16x32_bf16 v[76:79], v[124:127], a[44:47], v[76:79]
  s_waitcnt vmcnt(16)
  v_mfma_f32_16x16x32_bf16 v[16:19], v[128:131], a[48:51], v[16:19]
  buffer_load_dwordx4 v[200:203], v10, s[44:47], s59 offen sc1
  v_mfma_f32_16x16x32_bf16 v[20:23], v[128:131], a[52:55], v[20:23]
  v_mfma_f32_16x16x32_bf16 v[24:27], v[128:131], a[56:59], v[24:27]
  v_mfma_f32_16x16x32_bf16 v[28:31], v[128:131], a[60:63], v[28:31]
  v_mfma_f32_16x16x32_bf16 v[32:35], v[132:135], a[48:51], v[32:35]
  buffer_load_dwordx4 v[204:207], v11, s[44:47], s59 offen sc1
  v_mfma_f32_16x16x32_bf16 v[36:39], v[132:135], a[52:55], v[36:39]
  v_mfma_f32_16x16x32_bf16 v[40:43], v[132:135], a[56:59], v[40:43]
  v_mfma_f32_16x16x32_bf16 v[44:47], v[132:135], a[60:63], v[44:47]
  s_waitcnt vmcnt(12)
  v_cmp_ne_u64 vcc, s[10:11], v[12:13]
  s_nop 0
  s_and_b32 s12, vcc_lo, 0x44444444
  s_cbranch_scc1 RSg21f2
BSg21f2:
  v_mfma_f32_16x16x32_bf16 v[48:51], v[136:139], a[48:51], v[48:51]
  v_mfma_f32_16x16x32_bf16 v[52:55], v[136:139], a[52:55], v[52:55]
  v_mfma_f32_16x16x32_bf16 v[56:59], v[136:139], a[56:59], v[56:59]
  buffer_load_dwordx4 v[208:211], v8, s[44:47], s60 offen sc1
  v_mfma_f32_16x16x32_bf16 v[60:63], v[136:139], a[60:63], v[60:63]
  v_mfma_f32_16x16x32_bf16 v[64:67], v[140:143], a[48:51], v[64:67]
  v_mfma_f32_16x16x32_bf16 v[68:71], v[140:143], a[52:55], v[68:71]
  buffer_load_dwordx4 v[212:215], v9, s[44:47], s60 offen sc1
  v_mfma_f32_16x16x32_bf16 v[72:75], v[140:143], a[56:59], v[72:75]
  v_mfma_f32_16x16x32_bf16 v[76:79], v[140:143], a[60:63], v[76:79]
  v_mfma_f32_16x16x32_bf16 v[16:19], v[144:147], a[64:67], v[16:19]
  buffer_load_dwordx4 v[216:219], v10, s[44:47], s60 offen sc1
  v_mfma_f32_16x16x32_bf16 v[20:23], v[144:147], a[68:71], v[20:23]
  v_mfma_f32_16x16x32_bf16 v[24:27], v[144:147], a[72:75], v[24:27]
  v_mfma_f32_16x16x32_bf16 v[28:31], v[144:147], a[76:79], v[28:31]
  v_mfma_f32_16x16x32_bf16 v[32:35], v[148:151], a[64:67], v[32:35]
  buffer_load_dwordx4 v[220:223], v11, s[44:47], s60 offen sc1
  v_mfma_f32_16x16x32_bf16 v[36:39], v[148:151], a[68:71], v[36:39]
  v_mfma_f32_16x16x32_bf16 v[40:43], v[148:151], a[72:75], v[40:43]
  v_mfma_f32_16x16x32_bf16 v[44:47], v[148:151], a[76:79], v[44:47]
  buffer_load_dwordx2 v[12:13], v3, s[44:47], s31 offen sc1
  v_mfma_f32_16x16x32_bf16 v[48:51], v[152:155], a[64:67], v[48:51]
  v_mfma_f32_16x16x32_bf16 v[52:55], v[152:155], a[68:71], v[52:55]
  v_mfma_f32_16x16x32_bf16 v[56:59], v[152:155], a[72:75], v[56:59]
  buffer_load_dwordx4 v[224:227], v8, s[44:47], s61 offen sc1
  v_mfma_f32_16x16x32_bf16 v[60:63], v[152:155], a[76:79], v[60:63]
  v_mfma_f32_16x16x32_bf16 v[64:67], v[156:159], a[64:67], v[64:67]
  v_mfma_f32_16x16x32_bf16 v[68:71], v[156:159], a[68:71], v[68:71]
  buffer_load_dwordx4 v[228:231], v9, s[44:47], s61 offen sc1
  v_mfma_f32_16x16x32_bf16 v[72:75], v[156:159], a[72:75], v[72:75]
  v_mfma_f32_16x16x32_bf16 v[76:79], v[156:159], a[76:79], v[76:79]
  s_waitcnt vmcnt(15)
  v_mfma_f32_16x16x32_bf16 v[16:19], v[160:163], a[80:83], v[16:19]
  buffer_load_dwordx4 v[232:235], v10, s[44:47], s61 offen sc1
  v_mov_b32 v144, -1
  v_mfma_f32_16x16x32_bf16 v[20:23], v[160:163], a[84:87], v[20:23]
  v_mov_b32 v145, -1
  v_mov_b32 v146, -1
  v_mfma_f32_16x16x32_bf16 v[24:27], v[160:163], a[88:91], v[24:27]
  v_mov_b32 v147, -1
  v_mfma_f32_16x16x32_bf16 v[28:31], v[160:163], a[92:95], v[28:31]
  v_mfma_f32_16x16x32_bf16 v[32:35], v[164:167], a[80:83], v[32:35]
  buffer_load_dwordx4 v[236:239], v11, s[44:47], s61 offen sc1
  v_mfma_f32_16x16x32_bf16 v[36:39], v[164:167], a[84:87], v[36:39]
  v_mfma_f32_16x16x32_bf16 v[40:43], v[164:167], a[88:91], v[40:43]
  v_mfma_f32_16x16x32_bf16 v[44:47], v[164:167], a[92:95], v[44:47]
  buffer_load_dwordx4 v[240:243], v8, s[44:47], s62 offen sc1
  v_mfma_f32_16x16x32_bf16 v[48:51], v[168:171], a[80:83], v[48:51]
  v_mfma_f32_16x16x32_bf16 v[52:55], v[168:171], a[84:87], v[52:55]
  v_mfma_f32_16x16x32_bf16 v[56:59], v[168:171], a[88:91], v[56:59]
  buffer_load_dwordx4 v[244:247], v9, s[44:47], s62 offen sc1
  v_mfma_f32_16x16x32_bf16 v[60:63], v[168:171], a[92:95], v[60:63]
  v_mfma_f32_16x16x32_bf16 v[64:67], v[172:175], a[80:83], v[64:67]
  v_mfma_f32_16x16x32_bf16 v[68:71], v[172:175], a[84:87], v[68:71]
  buffer_load_dwordx4 v[248:251], v10, s[44:47], s62 offen sc1
  v_mfma_f32_16x16x32_bf16 v[72:75], v[172:175], a[88:91], v[72:75]
  v_mfma_f32_16x16x32_bf16 v[76:79], v[172:175], a[92:95], v[76:79]
  s_waitcnt vmcnt(16)
  v_mfma_f32_16x16x32_bf16 v[16:19], v[176:179], a[96:99], v[16:19]
  buffer_load_dwordx4 v[252:255], v11, s[44:47], s62 offen sc1
  v_mfma_f32_16x16x32_bf16 v[20:23], v[176:179], a[100:103], v[20:23]
  v_mfma_f32_16x16x32_bf16 v[24:27], v[176:179], a[104:107], v[24:27]
  v_mfma_f32_16x16x32_bf16 v[28:31], v[176:179], a[108:111], v[28:31]
  v_mfma_f32_16x16x32_bf16 v[32:35], v[180:183], a[96:99], v[32:35]
  buffer_load_dwordx4 v[80:83], v8, s[44:47], s63 offen sc1
  v_mfma_f32_16x16x32_bf16 v[36:39], v[180:183], a[100:103], v[36:39]
  v_mfma_f32_16x16x32_bf16 v[40:43], v[180:183], a[104:107], v[40:43]
  v_mfma_f32_16x16x32_bf16 v[44:47], v[180:183], a[108:111], v[44:47]
  buffer_load_dwordx4 v[84:87], v9, s[44:47], s63 offen sc1
  v_mfma_f32_16x16x32_bf16 v[48:51], v[184:187], a[96:99], v[48:51]
  v_mfma_f32_16x16x32_bf16 v[52:55], v[184:187], a[100:103], v[52:55]
  v_mfma_f32_16x16x32_bf16 v[56:59], v[184:187], a[104:107], v[56:59]
  buffer_load_dwordx4 v[88:91], v10, s[44:47], s63 offen sc1
  v_mfma_f32_16x16x32_bf16 v[60:63], v[184:187], a[108:111], v[60:63]
  v_mfma_f32_16x16x32_bf16 v[64:67], v[188:191], a[96:99], v[64:67]
  v_mfma_f32_16x16x32_bf16 v[68:71], v[188:191], a[100:103], v[68:71]
  buffer_load_dwordx4 v[92:95], v11, s[44:47], s63 offen sc1
  v_mfma_f32_16x16x32_bf16 v[72:75], v[188:191], a[104:107], v[72:75]
  v_mfma_f32_16x16x32_bf16 v[76:79], v[188:191], a[108:111], v[76:79]
  s_waitcnt vmcnt(17)
  v_mfma_f32_16x16x32_bf16 v[16:19], v[192:195], a[112:115], v[16:19]
  s_waitcnt vmcnt(12)
  v_cmp_ne_u64 vcc, s[10:11], v[12:13]
  s_nop 0
  s_and_b32 s12, vcc_lo, 0x88888888
  s_cbranch_scc1 RSg21f3
BSg21f3:
  v_mfma_f32_16x16x32_bf16 v[20:23], v[192:195], a[116:119], v[20:23]
  v_mfma_f32_16x16x32_bf16 v[24:27], v[192:195], a[120:123], v[24:27]
  v_mfma_f32_16x16x32_bf16 v[28:31], v[192:195], a[124:127], v[28:31]
  v_mfma_f32_16x16x32_bf16 v[32:35], v[196:199], a[112:115], v[32:35]
  s_add_u32 s12, s3, 0
  v_mfma_f32_16x16x32_bf16 v[36:39], v[196:199], a[116:119], v[36:39]
  s_and_b32 s12, s12, 3
  s_mul_i32 s13, s12, 12288
  v_mfma_f32_16x16x32_bf16 v[40:43], v[196:199], a[120:123], v[40:43]
  s_add_u32 s13, s13, 114688
  v_lshl_add_u32 v3, v2, 4, s13
  v_mfma_f32_16x16x32_bf16 v[44:47], v[196:199], a[124:127], v[44:47]
  buffer_load_dwordx4 v[96:99], v8, s[44:47], s64 offen sc1
  s_add_u32 s12, s3, 1
  v_mfma_f32_16x16x32_bf16 v[48:51], v[200:203], a[112:115], v[48:51]
  s_and_b32 s12, s12, 3
  s_mul_i32 s13, s12, 12288
  v_mfma_f32_16x16x32_bf16 v[52:55], v[200:203], a[116:119], v[52:55]
  s_add_u32 s18, s13, 114688
  v_lshl_add_u32 v4, v2, 4, s18
  v_mfma_f32_16x16x32_bf16 v[56:59], v[200:203], a[120:123], v[56:59]
  buffer_load_dwordx4 v[100:103], v9, s[44:47], s64 offen sc1
  s_add_u32 s12, s3, 2
  v_mfma_f32_16x16x32_bf16 v[60:63], v[200:203], a[124:127], v[60:63]
  s_and_b32 s12, s12, 3
  s_mul_i32 s13, s12, 12288
  v_mfma_f32_16x16x32_bf16 v[64:67], v[204:207], a[112:115], v[64:67]
  s_add_u32 s13, s13, 114688
  v_lshl_add_u32 v5, v2, 4, s13
  v_mfma_f32_16x16x32_bf16 v[68:71], v[204:207], a[116:119], v[68:71]
  buffer_load_dwordx4 v[104:107], v10, s[44:47], s64 offen sc1
  s_add_u32 s12, s3, 3
  v_mfma_f32_16x16x32_bf16 v[72:75], v[204:207], a[120:123], v[72:75]
  s_and_b32 s12, s12, 3
  s_mul_i32 s13, s12, 12288
  v_mfma_f32_16x16x32_bf16 v[76:79], v[204:207], a[124:127], v[76:79]
  s_add_u32 s13, s13, 114688
  v_lshl_add_u32 v6, v2, 4, s13
  v_mfma_f32_16x16x32_bf16 v[16:19], v[208:211], a[128:131], v[16:19]
  buffer_load_dwordx4 v[108:111], v11, s[44:47], s64 offen sc1
  v_and_b32 v14, 15, v2
  v_mfma_f32_16x16x32_bf16 v[20:23], v[208:211], a[132:135], v[20:23]
  v_lshrrev_b32 v15, 4, v2
  v_mul_u32_u24 v14, 136, v14
  v_mfma_f32_16x16x32_bf16 v[24:27], v[208:211], a[136:139], v[24:27]
  v_lshl_add_u32 v14, v15, 3, v14
  v_add_u32 v14, s18, v14
  v_mfma_f32_16x16x32_bf16 v[28:31], v[208:211], a[140:143], v[28:31]
  v_lshrrev_b32 v13, 2, v2
  v_mul_u32_u24 v13, 136, v13
  v_mfma_f32_16x16x32_bf16 v[32:35], v[212:215], a[128:131], v[32:35]
  buffer_load_dwordx4 v[112:115], v8, s[44:47], s65 offen sc1
  v_and_b32 v12, 3, v2
  v_mfma_f32_16x16x32_bf16 v[36:39], v[212:215], a[132:135], v[36:39]
  v_lshl_add_u32 v13, v12, 3, v13
  v_add_u32 v13, s18, v13
  v_mfma_f32_16x16x32_bf16 v[40:43], v[212:215], a[136:139], v[40:43]
  v_mfma_f32_16x16x32_bf16 v[44:47], v[212:215], a[140:143], v[44:47]
  buffer_load_dwordx4 v[116:119], v9, s[44:47], s65 offen sc1
  v_mfma_f32_16x16x32_bf16 v[48:51], v[216:219], a[128:131], v[48:51]
  v_mfma_f32_16x16x32_bf16 v[52:55], v[216:219], a[132:135], v[52:55]
  v_mfma_f32_16x16x32_bf16 v[56:59], v[216:219], a[136:139], v[56:59]
  buffer_load_dwordx4 v[120:123], v10, s[44:47], s65 offen sc1
  v_mfma_f32_16x16x32_bf16 v[60:63], v[216:219], a[140:143], v[60:63]
  v_mfma_f32_16x16x32_bf16 v[64:67], v[220:223], a[128:131], v[64:67]
  v_mfma_f32_16x16x32_bf16 v[68:71], v[220:223], a[132:135], v[68:71]
  buffer_load_dwordx4 v[124:127], v11, s[44:47], s65 offen sc1
  v_mfma_f32_16x16x32_bf16 v[72:75], v[220:223], a[136:139], v[72:75]
  v_mfma_f32_16x16x32_bf16 v[76:79], v[220:223], a[140:143], v[76:79]
  s_waitcnt vmcnt(16)
  v_mfma_f32_16x16x32_bf16 v[16:19], v[224:227], a[144:147], v[16:19]
  buffer_load_dwordx3 v[128:130], v7, s[44:47], s17 offen offset:0 sc1
  v_mfma_f32_16x16x32_bf16 v[20:23], v[224:227], a[148:151], v[20:23]
  v_mfma_f32_16x16x32_bf16 v[24:27], v[224:227], a[152:155], v[24:27]
  v_mfma_f32_16x16x32_bf16 v[28:31], v[224:227], a[156:159], v[28:31]
  v_mfma_f32_16x16x32_bf16 v[32:35], v[228:231], a[144:147], v[32:35]
  buffer_load_dwordx3 v[132:134], v7, s[44:47], s17 offen offset:1024 sc1
  v_mfma_f32_16x16x32_bf16 v[36:39], v[228:231], a[148:151], v[36:39]
  v_mfma_f32_16x16x32_bf16 v[40:43], v[228:231], a[152:155], v[40:43]
  v_mfma_f32_16x16x32_bf16 v[44:47], v[228:231], a[156:159], v[44:47]
  buffer_load_dwordx3 v[136:138], v7, s[44:47], s17 offen offset:2048 sc1
  v_mfma_f32_16x16x32_bf16 v[48:51], v[232:235], a[144:147], v[48:51]
  v_mfma_f32_16x16x32_bf16 v[52:55], v[232:235], a[148:151], v[52:55]
  v_mfma_f32_16x16x32_bf16 v[56:59], v[232:235], a[152:155], v[56:59]
  buffer_load_dwordx3 v[140:142], v7, s[44:47], s17 offen offset:3072 sc1
  v_mfma_f32_16x16x32_bf16 v[60:63], v[232:235], a[156:159], v[60:63]
  v_mfma_f32_16x16x32_bf16 v[64:67], v[236:239], a[144:147], v[64:67]
  v_mfma_f32_16x16x32_bf16 v[68:71], v[236:239], a[148:151], v[68:71]
  buffer_store_dwordx4 v[144:147], v7, s[44:47], s19 offen offset:0 sc1
  v_mfma_f32_16x16x32_bf16 v[72:75], v[236:239], a[152:155], v[72:75]
  v_mfma_f32_16x16x32_bf16 v[76:79], v[236:239], a[156:159], v[76:79]
  s_waitcnt vmcnt(17)
  v_mfma_f32_16x16x32_bf16 v[16:19], v[240:243], a[160:163], v[16:19]
  buffer_store_dwordx4 v[144:147], v7, s[44:47], s19 offen offset:1024 sc1
  v_mfma_f32_16x16x32_bf16 v[20:23], v[240:243], a[164:167], v[20:23]
  v_mfma_f32_16x16x32_bf16 v[24:27], v[240:243], a[168:171], v[24:27]
  v_mfma_f32_16x16x32_bf16 v[28:31], v[240:243], a[172:175], v[28:31]
  v_mfma_f32_16x16x32_bf16 v[32:35], v[244:247], a[160:163], v[32:35]
  v_mfma_f32_16x16x32_bf16 v[36:39], v[244:247], a[164:167], v[36:39]
  v_mfma_f32_16x16x32_bf16 v[40:43], v[244:247], a[168:171], v[40:43]
  v_mfma_f32_16x16x32_bf16 v[44:47], v[244:247], a[172:175], v[44:47]
  v_mfma_f32_16x16x32_bf16 v[48:51], v[248:251], a[160:163], v[48:51]
  v_mfma_f32_16x16x32_bf16 v[52:55], v[248:251], a[164:167], v[52:55]
  v_mfma_f32_16x16x32_bf16 v[56:59], v[248:251], a[168:171], v[56:59]
  v_mfma_f32_16x16x32_bf16 v[60:63], v[248:251], a[172:175], v[60:63]
  v_mfma_f32_16x16x32_bf16 v[64:67], v[252:255], a[160:163], v[64:67]
  v_mfma_f32_16x16x32_bf16 v[68:71], v[252:255], a[164:167], v[68:71]
  v_mfma_f32_16x16x32_bf16 v[72:75], v[252:255], a[168:171], v[72:75]
  v_mfma_f32_16x16x32_bf16 v[76:79], v[252:255], a[172:175], v[76:79]
  s_waitcnt vmcnt(14)
  v_mfma_f32_16x16x32_bf16 v[16:19], v[80:83], a[176:179], v[16:19]
  v_mfma_f32_16x16x32_bf16 v[20:23], v[80:83], a[180:183], v[20:23]
  v_mfma_f32_16x16x32_bf16 v[24:27], v[80:83], a[184:187], v[24:27]
  v_mfma_f32_16x16x32_bf16 v[28:31], v[80:83], a[188:191], v[28:31]
  v_mfma_f32_16x16x32_bf16 v[32:35], v[84:87], a[176:179], v[32:35]
  v_mfma_f32_16x16x32_bf16 v[36:39], v[84:87], a[180:183], v[36:39]
  v_mfma_f32_16x16x32_bf16 v[40:43], v[84:87], a[184:187], v[40:43]
  v_mfma_f32_16x16x32_bf16 v[44:47], v[84:87], a[188:191], v[44:47]
  v_mfma_f32_16x16x32_bf16 v[48:51], v[88:91], a[176:179], v[48:51]
  v_mfma_f32_16x16x32_bf16 v[52:55], v[88:91], a[180:183], v[52:55]
  v_mfma_f32_16x16x32_bf16 v[56:59], v[88:91], a[184:187], v[56:59]
  v_mfma_f32_16x16x32_bf16 v[60:63], v[88:91], a[188:191], v[60:63]
  v_mfma_f32_16x16x32_bf16 v[64:67], v[92:95], a[176:179], v[64:67]
  v_mfma_f32_16x16x32_bf16 v[68:71], v[92:95], a[180:183], v[68:71]
  v_mfma_f32_16x16x32_bf16 v[72:75], v[92:95], a[184:187], v[72:75]
  v_mfma_f32_16x16x32_bf16 v[76:79], v[92:95], a[188:191], v[76:79]
  s_waitcnt vmcnt(10)
  v_mfma_f32_16x16x32_bf16 v[32:35], v[100:103], a[192:195], v[32:35]
  s_waitcnt vmcnt(2)
  v_mfma_f32_16x16x32_bf16 v[36:39], v[100:103], a[196:199], v[36:39]
  ds_write2_b32 v14, v128, v132 offset0:0 offset1:1
  v_mfma_f32_16x16x32_bf16 v[40:43], v[100:103], a[200:203], v[40:43]
  ds_write2_b32 v14, v130, v134 offset0:8 offset1:9
  v_mfma_f32_16x16x32_bf16 v[44:47], v[100:103], a[204:207], v[44:47]
  ds_write2_b32 v14, v136, v140 offset0:16 offset1:17
  v_mfma_f32_16x16x32_bf16 v[32:35], v[116:119], a[208:211], v[32:35]
  ds_write2_b32 v14, v138, v142 offset0:24 offset1:25
  v_mfma_f32_16x16x32_bf16 v[36:39], v[116:119], a[212:215], v[36:39]
  ds_read_b64_tr_b16 v[208:209], v13 offset:0
  v_mfma_f32_16x16x32_bf16 v[40:43], v[116:119], a[216:219], v[40:43]
  ds_read_b64_tr_b16 v[210:211], v13 offset:32
  v_mfma_f32_16x16x32_bf16 v[44:47], v[116:119], a[220:223], v[44:47]
  ds_read_b64_tr_b16 v[212:213], v13 offset:64
  ds_read_b64_tr_b16 v[214:215], v13 offset:96
  v_mfma_f32_16x16x32_bf16 v[48:51], v[104:107], a[192:195], v[48:51]
  v_mfma_f32_16x16x32_bf16 v[52:55], v[104:107], a[196:199], v[52:55]
  ds_write_b128 v4, v[32:35] offset:0
  v_mfma_f32_16x16x32_bf16 v[56:59], v[104:107], a[200:203], v[56:59]
  v_mfma_f32_16x16x32_bf16 v[60:63], v[104:107], a[204:207], v[60:63]
  v_mfma_f32_16x16x32_bf16 v[48:51], v[120:123], a[208:211], v[48:51]
  ds_write_b128 v4, v[36:39] offset:1024
  v_mfma_f32_16x16x32_bf16 v[52:55], v[120:123], a[212:215], v[52:55]
  v_mfma_f32_16x16x32_bf16 v[56:59], v[120:123], a[216:219], v[56:59]
  v_mfma_f32_16x16x32_bf16 v[60:63], v[120:123], a[220:223], v[60:63]
  ds_write_b128 v4, v[40:43] offset:2048
  ds_write_b128 v4, v[44:47] offset:3072
  v_mfma_f32_16x16x32_bf16 v[64:67], v[108:111], a[192:195], v[64:67]
  s_waitcnt lgkmcnt(4)
  v_lshlrev_b32 v144, 16, v208
  v_and_b32 v145, 0xffff0000, v208
  v_mfma_f32_16x16x32_bf16 v[68:71], v[108:111], a[196:199], v[68:71]
  ds_write_b128 v5, v[48:51] offset:4096
  v_mfma_f32_16x16x32_bf16 v[72:75], v[108:111], a[200:203], v[72:75]
  v_lshlrev_b32 v146, 16, v209
  v_and_b32 v147, 0xffff0000, v209
  v_mfma_f32_16x16x32_bf16 v[76:79], v[108:111], a[204:207], v[76:79]
  v_lshlrev_b32 v148, 16, v210
  v_and_b32 v149, 0xffff0000, v210
  v_mfma_f32_16x16x32_bf16 v[64:67], v[124:127], a[208:211], v[64:67]
  ds_write_b128 v5, v[52:55] offset:5120
  v_mfma_f32_16x16x32_bf16 v[68:71], v[124:127], a[212:215], v[68:71]
  v_lshlrev_b32 v150, 16, v211
  v_and_b32 v151, 0xffff0000, v211
  v_mfma_f32_16x16x32_bf16 v[72:75], v[124:127], a[216:219], v[72:75]
  v_lshlrev_b32 v152, 16, v212
  v_and_b32 v153, 0xffff0000, v212
  v_mfma_f32_16x16x32_bf16 v[76:79], v[124:127], a[220:223], v[76:79]
  ds_write_b128 v5, v[56:59] offset:6144
  ds_write_b128 v5, v[60:63] offset:7168
  v_mfma_f32_16x16x32_bf16 v[16:19], v[96:99], a[192:195], v[16:19]
  v_lshlrev_b32 v154, 16, v213
  v_and_b32 v155, 0xffff0000, v213
  v_mfma_f32_16x16x32_bf16 v[20:23], v[96:99], a[196:199], v[20:23]
  ds_write_b128 v6, v[64:67] offset:8192
  v_mfma_f32_16x16x32_bf16 v[24:27], v[96:99], a[200:203], v[24:27]
  v_lshlrev_b32 v156, 16, v214
  v_and_b32 v157, 0xffff0000, v214
  v_mfma_f32_16x16x32_bf16 v[28:31], v[96:99], a[204:207], v[28:31]
  v_lshlrev_b32 v158, 16, v215
  v_and_b32 v159, 0xffff0000, v215
  v_mfma_f32_16x16x32_bf16 v[16:19], v[112:115], a[208:211], v[16:19]
  ds_write_b128 v6, v[68:71] offset:9216
  v_mfma_f32_16x16x32_bf16 v[20:23], v[112:115], a[212:215], v[20:23]
  v_mfma_f32_16x16x32_bf16 v[24:27], v[112:115], a[216:219], v[24:27]
  v_mfma_f32_16x16x32_bf16 v[28:31], v[112:115], a[220:223], v[28:31]
  ds_write_b128 v6, v[72:75] offset:10240
  ds_write_b128 v6, v[76:79] offset:11264
  s_waitcnt lgkmcnt(0)
  s_barrier
  ds_read_b128 v[160:163], v3 offset:0
  ds_read_b128 v[164:167], v3 offset:1024
  ds_read_b128 v[168:171], v3 offset:2048
  ds_read_b128 v[172:175], v3 offset:3072
  ds_read_b128 v[176:179], v3 offset:4096
  ds_read_b128 v[180:183], v3 offset:5120
  ds_read_b128 v[184:187], v3 offset:6144
  ds_read_b128 v[188:191], v3 offset:7168
  ds_read_b128 v[192:195], v3 offset:8192
  ds_read_b128 v[196:199], v3 offset:9216
  ds_read_b128 v[200:203], v3 offset:10240
  ds_read_b128 v[204:207], v3 offset:11264
  v_lshlrev_b32 v120, 5, v0
  v_add_u32 v120, 0x18b2000, v120
  buffer_load_dwordx4 v[112:115], v120, s[44:47], 0 offen offset:0 sc1
  buffer_load_dwordx4 v[116:119], v120, s[44:47], 0 offen offset:16 sc1
  s_lshl_b32 s12, s7, 2
  s_add_u32 s12, s12, s3
  s_lshl_b32 s19, s12, 11
  s_add_u32 s19, s19, 0x1160000
  s_lshl_b32 s13, s8, 8
  s_add_u32 s18, s19, s13
  s_mul_i32 s12, s12, 16896
  s_lshl_b32 s13, s8, 10
  s_add_u32 s12, s12, s13
  v_lshrrev_b32 v7, 1, v15
  v_mul_u32_u24 v95, 0x2100, v7
  v_and_b32 v7, 31, v2
  v_lshl_add_u32 v95, v7, 4, v95
  v_add_u32 v95, s12, v95
  v_lshlrev_b32 v7, 2, v2
  s_mov_b32 s20, 0x11111111
  s_mov_b32 s21, 0x11111111
  s_mov_b32 s22, 0x420000
  s_mov_b32 s23, 0x640000
  s_waitcnt lgkmcnt(8)
  v_pk_add_f32 v[16:17], v[16:17], v[160:161]
  v_pk_add_f32 v[18:19], v[18:19], v[162:163]
  v_pk_add_f32 v[20:21], v[20:21], v[164:165]
  v_pk_add_f32 v[22:23], v[22:23], v[166:167]
  v_pk_add_f32 v[24:25], v[24:25], v[168:169]
  v_pk_add_f32 v[26:27], v[26:27], v[170:171]
  v_pk_add_f32 v[28:29], v[28:29], v[172:173]
  v_pk_add_f32 v[30:31], v[30:31], v[174:175]
  s_waitcnt lgkmcnt(4)
  v_pk_add_f32 v[16:17], v[16:17], v[176:177]
  v_pk_add_f32 v[18:19], v[18:19], v[178:179]
  v_pk_add_f32 v[20:21], v[20:21], v[180:181]
  v_pk_add_f32 v[22:23], v[22:23], v[182:183]
  v_pk_add_f32 v[24:25], v[24:25], v[184:185]
  v_pk_add_f32 v[26:27], v[26:27], v[186:187]
  v_pk_add_f32 v[28:29], v[28:29], v[188:189]
  v_pk_add_f32 v[30:31], v[30:31], v[190:191]
  s_waitcnt lgkmcnt(0)
  v_pk_add_f32 v[16:17], v[16:17], v[192:193]
  v_pk_add_f32 v[18:19], v[18:19], v[194:195]
  v_pk_add_f32 v[20:21], v[20:21], v[196:197]
  v_pk_add_f32 v[22:23], v[22:23], v[198:199]
  v_pk_add_f32 v[24:25], v[24:25], v[200:201]
  v_pk_add_f32 v[26:27], v[26:27], v[202:203]
  v_pk_add_f32 v[28:29], v[28:29], v[204:205]
  v_pk_add_f32 v[30:31], v[30:31], v[206:207]
  v_cvt_pk_bf16_f32 v16, v16, v17
  v_cvt_pk_bf16_f32 v18, v18, v19
  v_cvt_pk_bf16_f32 v20, v20, v21
  v_cvt_pk_bf16_f32 v22, v22, v23
  v_cvt_pk_bf16_f32 v24, v24, v25
  v_cvt_pk_bf16_f32 v26, v26, v27
  v_cvt_pk_bf16_f32 v28, v28, v29
  v_cvt_pk_bf16_f32 v30, v30, v31
  v_and_b32 v17, 0xffff0000, v16
  v_lshlrev_b32 v16, 16, v16
  v_and_b32 v19, 0xffff0000, v18
  v_lshlrev_b32 v18, 16, v18
  v_and_b32 v21, 0xffff0000, v20
  v_lshlrev_b32 v20, 16, v20
  v_and_b32 v23, 0xffff0000, v22
  v_lshlrev_b32 v22, 16, v22
  v_and_b32 v25, 0xffff0000, v24
  v_lshlrev_b32 v24, 16, v24
  v_and_b32 v27, 0xffff0000, v26
  v_lshlrev_b32 v26, 16, v26
  v_and_b32 v29, 0xffff0000, v28
  v_lshlrev_b32 v28, 16, v28
  v_and_b32 v31, 0xffff0000, v30
  v_lshlrev_b32 v30, 16, v30
  v_pk_add_f32 v[16:17], v[16:17], v[144:145]
  v_pk_add_f32 v[18:19], v[18:19], v[146:147]
  v_pk_add_f32 v[20:21], v[20:21], v[148:149]
  v_pk_add_f32 v[22:23], v[22:23], v[150:151]
  v_pk_add_f32 v[24:25], v[24:25], v[152:153]
  v_pk_add_f32 v[26:27], v[26:27], v[154:155]
  v_pk_add_f32 v[28:29], v[28:29], v[156:157]
  v_pk_add_f32 v[30:31], v[30:31], v[158:159]
  v_cvt_pk_bf16_f32 v32, v16, v17
  v_cvt_pk_bf16_f32 v33, v18, v19
  v_cvt_pk_bf16_f32 v34, v20, v21
  v_cvt_pk_bf16_f32 v35, v22, v23
  v_cvt_pk_bf16_f32 v36, v24, v25
  v_cvt_pk_bf16_f32 v37, v26, v27
  v_cvt_pk_bf16_f32 v38, v28, v29
  v_cvt_pk_bf16_f32 v39, v30, v31
  v_lshlrev_b32 v96, 16, v32
  v_and_b32 v97, 0xffff0000, v32
  v_lshlrev_b32 v98, 16, v33
  v_and_b32 v99, 0xffff0000, v33
  v_lshlrev_b32 v100, 16, v34
  v_and_b32 v101, 0xffff0000, v34
  v_lshlrev_b32 v102, 16, v35
  v_and_b32 v103, 0xffff0000, v35
  v_lshlrev_b32 v104, 16, v36
  v_and_b32 v105, 0xffff0000, v36
  v_lshlrev_b32 v106, 16, v37
  v_and_b32 v107, 0xffff0000, v37
  v_lshlrev_b32 v108, 16, v38
  v_and_b32 v109, 0xffff0000, v38
  v_lshlrev_b32 v110, 16, v39
  v_and_b32 v111, 0xffff0000, v39
  v_pk_add_f32 v[16:17], v[96:97], v[100:101]
  v_pk_add_f32 v[18:19], v[98:99], v[102:103]
  v_pk_add_f32 v[24:25], v[104:105], v[108:109]
  v_pk_add_f32 v[26:27], v[106:107], v[110:111]
  v_pk_mul_f32 v[20:21], v[96:97], v[96:97]
  v_pk_mul_f32 v[22:23], v[98:99], v[98:99]
  v_pk_mul_f32 v[28:29], v[104:105], v[104:105]
  v_pk_mul_f32 v[30:31], v[106:107], v[106:107]
  v_pk_fma_f32 v[20:21], v[100:101], v[100:101], v[20:21]
  v_pk_fma_f32 v[22:23], v[102:103], v[102:103], v[22:23]
  v_pk_fma_f32 v[28:29], v[108:109], v[108:109], v[28:29]
  v_pk_fma_f32 v[30:31], v[110:111], v[110:111], v[30:31]
  v_pk_add_f32 v[16:17], v[16:17], v[24:25]
  v_pk_add_f32 v[18:19], v[18:19], v[26:27]
  v_pk_add_f32 v[20:21], v[20:21], v[28:29]
  v_pk_add_f32 v[22:23], v[22:23], v[30:31]
  v_add_f32_dpp v16, v16, v16 row_ror:8 row_mask:0xf bank_mask:0x3
  v_add_f32_dpp v17, v17, v17 row_ror:8 row_mask:0xf bank_mask:0x3
  v_add_f32_dpp v20, v20, v20 row_ror:8 row_mask:0xf bank_mask:0x3
  v_add_f32_dpp v21, v21, v21 row_ror:8 row_mask:0xf bank_mask:0x3
  v_add_f32_dpp v16, v18, v18 row_ror:8 row_mask:0xf bank_mask:0xc
  v_add_f32_dpp v17, v19, v19 row_ror:8 row_mask:0xf bank_mask:0xc
  v_add_f32_dpp v20, v22, v22 row_ror:8 row_mask:0xf bank_mask:0xc
  v_add_f32_dpp v21, v23, v23 row_ror:8 row_mask:0xf bank_mask:0xc
  v_mov_b32 v26, s10
  v_mov_b32 v27, s11
  v_add_f32_dpp v24, v16, v16 row_ror:12 row_mask:0xf bank_mask:0x5
  v_add_f32_dpp v25, v20, v20 row_ror:12 row_mask:0xf bank_mask:0x5
  s_nop 0
  v_add_f32_dpp v24, v17, v17 row_ror:4 row_mask:0xf bank_mask:0xa
  v_add_f32_dpp v25, v21, v21 row_ror:4 row_mask:0xf bank_mask:0xa
  s_nop 0
  v_add_f32_dpp v24, v24, v24 quad_perm:[1,0,3,2] row_mask:0xf bank_mask:0xf
  v_add_f32_dpp v25, v25, v25 quad_perm:[1,0,3,2] row_mask:0xf bank_mask:0xf
  s_nop 0
  v_add_f32_dpp v24, v24, v24 quad_perm:[2,3,0,1] row_mask:0xf bank_mask:0xf
  v_add_f32_dpp v25, v25, v25 quad_perm:[2,3,0,1] row_mask:0xf bank_mask:0xf
  s_waitcnt vmcnt(2)
  s_mov_b64 exec, s[20:21]
  buffer_store_dwordx4 v[24:27], v7, s[44:47], s18 offen sc1
  s_mov_b64 exec, -1
  v_permlane16_swap_b32 v32, v34
  v_permlane16_swap_b32 v33, v35
  v_permlane16_swap_b32 v36, v38
  v_permlane16_swap_b32 v37, v39
  v_min_u32 v32, -2, v32
  buffer_store_dwordx4 v[32:35], v95, s[44:47], s22 offen offset:0 sc1
  v_min_u32 v36, -2, v36
  buffer_store_dwordx4 v[36:39], v95, s[44:47], s22 offen offset:512 sc1
  v_accvgpr_read_b32 v48, a224
  v_accvgpr_read_b32 v49, a225
  v_accvgpr_read_b32 v50, a226
  v_accvgpr_read_b32 v51, a227
  v_accvgpr_read_b32 v52, a228
  v_accvgpr_read_b32 v56, a229
  v_accvgpr_read_b32 v57, a230
  v_accvgpr_read_b32 v58, a231
  v_accvgpr_read_b32 v59, a232
  v_accvgpr_read_b32 v60, a233
  s_lshr_b32 s12, s3, 1
  s_mul_i32 s12, s12, 8320
  s_add_u32 s12, s12, 133120
  v_and_b32 v78, 127, v0
  v_lshl_add_u32 v76, v78, 4, s12
  v_sub_u32 v78, 127, v78
  v_and_b32 v79, 1, v78
  v_lshl_add_u32 v77, v79, 4, s12
  v_bfe_u32 v79, v78, 1, 1
  v_mul_u32_u24 v79, 0x1040, v79
  v_add3_u32 v77, v77, v79, 64
  v_add_u32 v77, 4032, v77
  v_and_b32 v1, 3, v2
  v_lshlrev_b32 v94, 9, v1
  v_lshrrev_b32 v1, 2, v2
  v_lshl_add_u32 v94, v1, 4, v94
  s_waitcnt lgkmcnt(0)
  s_barrier
  ds_write_b128 v76, v[48:51] offset:0
  v_alignbit_b32 v64, v49, v48, 16
  v_alignbit_b32 v65, v50, v49, 16
  v_alignbit_b32 v66, v51, v50, 16
  v_alignbit_b32 v67, v52, v51, 16
  ds_write_b128 v76, v[64:67] offset:4160
  ds_write_b128 v76, v[56:59] offset:2048
  v_alignbit_b32 v68, v57, v56, 16
  v_alignbit_b32 v69, v58, v57, 16
  v_alignbit_b32 v70, v59, v58, 16
  v_alignbit_b32 v71, v60, v59, 16
  ds_write_b128 v76, v[68:71] offset:6208
  v_mov_b32 v73, 0
  v_mov_b32 v74, 0
  v_mov_b32 v75, 0
  v_mov_b32 v72, 0
  v_lshrrev_b32 v64, 5, v2
  v_mul_u32_u24 v64, 0x1000, v64
  v_lshl_add_u32 v64, v2, 4, v64
  v_add_u32 v64, 0x1c000, v64
  ds_write_b128 v64, v[72:75]
  v_and_b32 v65, 127, v0
  v_and_b32 v66, 0xffff, v60
  v_cmp_eq_u32 vcc, 127, v65
  s_nop 1
  v_cndmask_b32 v72, 0, v66, vcc
  s_bitcmp0_b32 s3, 0
  s_cbranch_scc1 KTS2
  s_mov_b32 exec_lo, 0
  s_mov_b32 exec_hi, 0xf0000000
  ds_write_b128 v77, v[72:75]
  s_mov_b64 exec, -1
KTS2:
  v_and_b32 v8, 15, v2
  v_lshrrev_b32 v9, 4, v2
  v_and_b32 v10, 1, v2
  v_add_u32 v11, v8, v10
  v_mul_u32_u24 v10, 0x1040, v10
  v_lshl_add_u32 v10, v9, 4, v10
  v_lshlrev_b32 v11, 1, v11
  v_sub_u32 v10, v10, v11
  s_lshr_b32 s12, s3, 1
  s_mul_i32 s13, s12, 8320
  s_and_b32 s14, s3, 1
  s_lshl_b32 s14, s14, 8
  s_sub_u32 s13, s13, s14
  s_add_u32 s13, s13, 136480
  v_add_u32 v3, s13, v10
  v_add_u32 v4, 4294966272, v3
  v_add_u32 v5, 4294965248, v3
  v_add_u32 v6, 4294964224, v3
  s_mul_i32 s13, s12, 4608
  s_sub_u32 s13, s13, s14
  s_add_u32 s13, s13, 114976
  v_lshlrev_b32 v7, 5, v8
  v_lshl_add_u32 v7, v9, 4, v7
  v_add_u32 v7, s13, v7
  v_bfe_u32 v1, v0, 1, 6
  v_mul_u32_u24 v12, 0x2100, v1
  v_and_b32 v1, 1, v0
  v_lshl_add_u32 v12, v1, 4, v12
  s_cmp_lt_u32 s3, 2
  s_mov_b32 s12, 0x420000
  s_cselect_b32 s12, 0x640000, s12
  s_lshl_b32 s13, s4, 5
  s_add_u32 s28, s12, s13
  s_add_u32 s29, s28, 0x84000
  s_add_u32 s30, s28, 0x108000
  s_add_u32 s31, s28, 0x18c000
  s_waitcnt vmcnt(3)
  v_cmp_ne_u64 vcc, s[10:11], v[112:113]
  v_cmp_ne_u64 s[26:27], s[10:11], v[114:115]
  v_cmp_ne_u64 s[24:25], s[10:11], v[116:117]
  s_or_b64 vcc, vcc, s[26:27]
  v_cmp_ne_u64 s[26:27], s[10:11], v[118:119]
  s_or_b64 vcc, vcc, s[24:25]
  s_or_b64 vcc, vcc, s[26:27]
  s_cbranch_vccnz RSmidfb
BSmidfb:
  s_waitcnt lgkmcnt(0)
  s_barrier
  buffer_load_dwordx4 v[80:83], v94, s[44:47], s19 offen offset:0 sc1
  buffer_load_dwordx4 v[84:87], v94, s[44:47], s19 offen offset:256 sc1
  s_lshr_b32 s12, s3, 1
  v_and_b32 v1, 15, v2
  v_lshrrev_b32 v15, 4, v2
  s_lshl_b32 s14, s3, 6
  s_add_u32 s14, s14, 133120
  v_mul_u32_u24 v8, 272, v1
  v_lshl_add_u32 v8, v15, 4, v8
  v_add_u32 v8, s14, v8
  v_bfrev_b32 v13, v15
  v_lshrrev_b32 v13, 30, v13
  s_mul_i32 s14, s3, 2176
  s_add_u32 s14, s14, 133120
  v_mul_u32_u24 v14, 544, v13
  v_lshl_add_u32 v14, v1, 2, v14
  v_add_u32 v14, s14, v14
  v_add_u32 v9, 16640, v14
  s_lshl_b32 s14, s3, 8
  s_add_u32 s14, s14, 115200
  v_lshl_add_u32 v10, v13, 6, s14
  v_lshl_add_u32 v10, v1, 1, v10
  v_mul_u32_u24 v13, 0x8100, v13
  v_lshl_add_u32 v13, v1, 4, v13
  s_lshr_b32 s14, s4, 4
  s_lshl_b32 s14, s14, 11
  s_and_b32 s15, s4, 1
  s_lshl_b32 s15, s15, 10
  s_add_u32 s14, s14, s15
  s_and_b32 s15, s4, 6
  s_lshl_b32 s15, s15, 7
  s_add_u32 s14, s14, s15
  s_and_b32 s15, s4, 8
  s_add_u32 s14, s14, s15
  s_mul_i32 s15, s3, 132096
  s_add_u32 s14, s14, s15
  s_add_u32 s68, s14, 0x210000
  v_and_b32 v1, 1, v2
  v_mul_u32_u24 v11, 0x1200, v1
  v_bfe_u32 v15, v0, 1, 6
  v_lshl_add_u32 v11, v15, 4, v11
  s_mul_i32 s14, s12, 9216
  s_add_u32 s14, s14, 115200
  v_add_u32 v11, s14, v11
  s_waitcnt vmcnt(0)
  v_cmp_ne_u64 vcc, s[10:11], v[82:83]
  v_cmp_ne_u64 s[20:21], s[10:11], v[86:87]
  s_nop 0
  s_or_b64 vcc, vcc, s[20:21]
  s_cbranch_vccnz RSmid
BSmid:
  v_pk_add_f32 v[80:81], v[80:81], v[84:85]
  s_nop 1
  v_add_f32_dpp v80, v80, v80 quad_perm:[1,0,3,2] row_mask:0xf bank_mask:0xf
  v_add_f32_dpp v81, v81, v81 quad_perm:[1,0,3,2] row_mask:0xf bank_mask:0xf
  s_nop 0
  v_add_f32_dpp v80, v80, v80 quad_perm:[2,3,0,1] row_mask:0xf bank_mask:0xf
  v_add_f32_dpp v81, v81, v81 quad_perm:[2,3,0,1] row_mask:0xf bank_mask:0xf
  v_mul_f32 v80, 0x3b000000, v80
  v_mul_f32 v81, 0x3b000000, v81
  v_fma_f32 v81, -v80, v80, v81
  v_max_f32 v81, 0, v81
  v_cvt_pk_bf16_f32 v83, 0, v81
  v_add_f32 v83, 0x3727c5ac, v83
  v_cvt_pk_bf16_f32 v83, 0, v83
  v_sqrt_f32 v83, v83
  s_nop 0
  v_cvt_pk_bf16_f32 v82, v80, v83
  v_and_b32 v83, 0xffff0000, v82
  v_rcp_f32 v83, v83
  v_lshlrev_b32 v82, 16, v82
  s_nop 1
  v_mov_b32_dpp v48, v82 row_newbcast:0 row_mask:0xf bank_mask:0xf
  v_mov_b32_dpp v49, v82 row_newbcast:4 row_mask:0xf bank_mask:0xf
  v_mov_b32_dpp v50, v82 row_newbcast:8 row_mask:0xf bank_mask:0xf
  v_mov_b32_dpp v51, v82 row_newbcast:12 row_mask:0xf bank_mask:0xf
  v_mov_b32_dpp v52, v83 row_newbcast:0 row_mask:0xf bank_mask:0xf
  v_mov_b32_dpp v53, v83 row_newbcast:4 row_mask:0xf bank_mask:0xf
  v_mov_b32_dpp v54, v83 row_newbcast:8 row_mask:0xf bank_mask:0xf
  v_mov_b32_dpp v55, v83 row_newbcast:12 row_mask:0xf bank_mask:0xf
  v_pk_add_f32 v[96:97], v[96:97], v[48:49] neg_lo:[0,1] neg_hi:[0,1]
  v_pk_add_f32 v[98:99], v[98:99], v[50:51] neg_lo:[0,1] neg_hi:[0,1]
  v_pk_add_f32 v[100:101], v[100:101], v[48:49] neg_lo:[0,1] neg_hi:[0,1]
  v_pk_add_f32 v[102:103], v[102:103], v[50:51] neg_lo:[0,1] neg_hi:[0,1]
  v_cvt_pk_bf16_f32 v96, v96, v97
  v_cvt_pk_bf16_f32 v98, v98, v99
  v_cvt_pk_bf16_f32 v100, v100, v101
  v_cvt_pk_bf16_f32 v102, v102, v103
  v_and_b32 v97, 0xffff0000, v96
  v_lshlrev_b32 v96, 16, v96
  v_and_b32 v99, 0xffff0000, v98
  v_lshlrev_b32 v98, 16, v98
  v_and_b32 v101, 0xffff0000, v100
  v_lshlrev_b32 v100, 16, v100
  v_and_b32 v103, 0xffff0000, v102
  v_lshlrev_b32 v102, 16, v102
  v_pk_mul_f32 v[96:97], v[96:97], v[52:53]
  v_pk_mul_f32 v[98:99], v[98:99], v[54:55]
  v_pk_mul_f32 v[100:101], v[100:101], v[52:53]
  v_pk_mul_f32 v[102:103], v[102:103], v[54:55]
  v_cvt_pk_bf16_f32 v56, v96, v97
  v_cvt_pk_bf16_f32 v57, v98, v99
  v_cvt_pk_bf16_f32 v58, v100, v101
  v_cvt_pk_bf16_f32 v59, v102, v103
  s_nop 0
  v_permlane16_swap_b32 v56, v58
  v_permlane16_swap_b32 v57, v59
  v_min_u32 v56, -2, v56
  buffer_store_dwordx4 v[56:59], v95, s[44:47], s23 offen offset:0 sc1
  v_pk_add_f32 v[104:105], v[104:105], v[48:49] neg_lo:[0,1] neg_hi:[0,1]
  v_pk_add_f32 v[106:107], v[106:107], v[50:51] neg_lo:[0,1] neg_hi:[0,1]
  v_pk_add_f32 v[108:109], v[108:109], v[48:49] neg_lo:[0,1] neg_hi:[0,1]
  v_pk_add_f32 v[110:111], v[110:111], v[50:51] neg_lo:[0,1] neg_hi:[0,1]
  v_cvt_pk_bf16_f32 v104, v104, v105
  v_cvt_pk_bf16_f32 v106, v106, v107
  v_cvt_pk_bf16_f32 v108, v108, v109
  v_cvt_pk_bf16_f32 v110, v110, v111
  v_and_b32 v105, 0xffff0000, v104
  v_lshlrev_b32 v104, 16, v104
  v_and_b32 v107, 0xffff0000, v106
  v_lshlrev_b32 v106, 16, v106
  v_and_b32 v109, 0xffff0000, v108
  v_lshlrev_b32 v108, 16, v108
  v_and_b32 v111, 0xffff0000, v110
  v_lshlrev_b32 v110, 16, v110
  v_pk_mul_f32 v[104:105], v[104:105], v[52:53]
  v_pk_mul_f32 v[106:107], v[106:107], v[54:55]
  v_pk_mul_f32 v[108:109], v[108:109], v[52:53]
  v_pk_mul_f32 v[110:111], v[110:111], v[54:55]
  v_cvt_pk_bf16_f32 v60, v104, v105
  v_cvt_pk_bf16_f32 v61, v106, v107
  v_cvt_pk_bf16_f32 v62, v108, v109
  v_cvt_pk_bf16_f32 v63, v110, v111
  s_nop 0
  v_permlane16_swap_b32 v60, v62
  v_permlane16_swap_b32 v61, v63
  v_min_u32 v60, -2, v60
  buffer_store_dwordx4 v[60:63], v95, s[44:47], s23 offen offset:512 sc1
  ds_read2_b32 v[128:129], v3 offset0:176 offset1:177
  ds_read2_b32 v[130:131], v3 offset0:178 offset1:179
  ds_read2_b32 v[132:133], v3 offset0:160 offset1:161
  ds_read2_b32 v[134:135], v3 offset0:162 offset1:163
  ds_read2_b32 v[136:137], v3 offset0:144 offset1:145
  ds_read2_b32 v[138:139], v3 offset0:146 offset1:147
  ds_read2_b32 v[140:141], v3 offset0:128 offset1:129
  ds_read2_b32 v[142:143], v3 offset0:130 offset1:131
  ds_read2_b32 v[144:145], v3 offset0:48 offset1:49
  ds_read2_b32 v[146:147], v3 offset0:50 offset1:51
  ds_read2_b32 v[148:149], v3 offset0:32 offset1:33
  ds_read2_b32 v[150:151], v3 offset0:34 offset1:35
  ds_read2_b32 v[152:153], v3 offset0:16 offset1:17
  ds_read2_b32 v[154:155], v3 offset0:18 offset1:19
  ds_read2_b32 v[156:157], v3 offset0:0 offset1:1
  ds_read2_b32 v[158:159], v3 offset0:2 offset1:3
  ds_read2_b32 v[240:241], v6 offset0:48 offset1:49
  ds_read2_b32 v[242:243], v6 offset0:50 offset1:51
  ds_read2_b32 v[244:245], v6 offset0:32 offset1:33
  ds_read2_b32 v[246:247], v6 offset0:34 offset1:35
  ds_read2_b32 v[248:249], v6 offset0:16 offset1:17
  ds_read2_b32 v[250:251], v6 offset0:18 offset1:19
  ds_read2_b32 v[252:253], v6 offset0:0 offset1:1
  ds_read2_b32 v[254:255], v6 offset0:2 offset1:3
  ds_read2_b32 v[224:225], v6 offset0:176 offset1:177
  ds_read2_b32 v[226:227], v6 offset0:178 offset1:179
  ds_read2_b32 v[228:229], v6 offset0:160 offset1:161
  ds_read2_b32 v[230:231], v6 offset0:162 offset1:163
  ds_read2_b32 v[232:233], v6 offset0:144 offset1:145
  ds_read2_b32 v[234:235], v6 offset0:146 offset1:147
  ds_read2_b32 v[236:237], v6 offset0:128 offset1:129
  ds_read2_b32 v[238:239], v6 offset0:130 offset1:131
  ds_read2_b32 v[208:209], v5 offset0:48 offset1:49
  ds_read2_b32 v[210:211], v5 offset0:50 offset1:51
  ds_read2_b32 v[212:213], v5 offset0:32 offset1:33
  ds_read2_b32 v[214:215], v5 offset0:34 offset1:35
  ds_read2_b32 v[216:217], v5 offset0:16 offset1:17
  ds_read2_b32 v[218:219], v5 offset0:18 offset1:19
  ds_read2_b32 v[220:221], v5 offset0:0 offset1:1
  ds_read2_b32 v[222:223], v5 offset0:2 offset1:3
  ds_read2_b32 v[192:193], v5 offset0:176 offset1:177
  ds_read2_b32 v[194:195], v5 offset0:178 offset1:179
  ds_read2_b32 v[196:197], v5 offset0:160 offset1:161
  ds_read2_b32 v[198:199], v5 offset0:162 offset1:163
  ds_read2_b32 v[200:201], v5 offset0:144 offset1:145
  ds_read2_b32 v[202:203], v5 offset0:146 offset1:147
  ds_read2_b32 v[204:205], v5 offset0:128 offset1:129
  ds_read2_b32 v[206:207], v5 offset0:130 offset1:131
  ds_read2_b32 v[176:177], v4 offset0:48 offset1:49
  ds_read2_b32 v[178:179], v4 offset0:50 offset1:51
  ds_read2_b32 v[180:181], v4 offset0:32 offset1:33
  ds_read2_b32 v[182:183], v4 offset0:34 offset1:35
  ds_read2_b32 v[184:185], v4 offset0:16 offset1:17
  ds_read2_b32 v[186:187], v4 offset0:18 offset1:19
  ds_read2_b32 v[188:189], v4 offset0:0 offset1:1
  ds_read2_b32 v[190:191], v4 offset0:2 offset1:3
  ds_read2_b32 v[160:161], v4 offset0:176 offset1:177
  ds_read2_b32 v[162:163], v4 offset0:178 offset1:179
  ds_read2_b32 v[164:165], v4 offset0:160 offset1:161
  ds_read2_b32 v[166:167], v4 offset0:162 offset1:163
  ds_read2_b32 v[168:169], v4 offset0:144 offset1:145
  ds_read2_b32 v[170:171], v4 offset0:146 offset1:147
  ds_read2_b32 v[172:173], v4 offset0:128 offset1:129
  ds_read2_b32 v[174:175], v4 offset0:130 offset1:131
  buffer_load_dwordx4 v[112:115], v12, s[44:47], s28 offen sc1
  s_waitcnt vmcnt(0)
  v_cmp_eq_u32 vcc, -1, v112
  s_cbranch_vccnz RSc2s0
BSc2s0:
  ds_write_b128 v11, v[112:115] offset:0
  s_waitcnt lgkmcnt(0)
  s_barrier
  ds_read_b128 v[48:51], v7 offset:192
  ds_read_b128 v[52:55], v7 offset:128
  ds_read_b128 v[56:59], v7 offset:64
  ds_read_b128 v[60:63], v7 offset:0
  ds_read_b128 v[64:67], v7 offset:704
  ds_read_b128 v[68:71], v7 offset:640
  ds_read_b128 v[72:75], v7 offset:576
  ds_read_b128 v[76:79], v7 offset:512
  s_lshl_b32 s24, s66, 16
  s_and_b32 s25, s66, 0xffff0000
  s_waitcnt lgkmcnt(7)
  v_mfma_f32_16x16x32_bf16 v[16:19], v[128:131], v[48:51], 0
  buffer_load_dwordx4 v[116:119], v12, s[44:47], s29 offen sc1
  s_waitcnt lgkmcnt(6)
  v_mfma_f32_16x16x32_bf16 v[16:19], v[132:135], v[52:55], v[16:19]
  s_waitcnt lgkmcnt(5)
  v_mfma_f32_16x16x32_bf16 v[16:19], v[136:139], v[56:59], v[16:19]
  s_waitcnt lgkmcnt(4)
  v_mfma_f32_16x16x32_bf16 v[16:19], v[140:143], v[60:63], v[16:19]
  v_mfma_f32_16x16x32_bf16 v[20:23], v[144:147], v[48:51], 0
  v_mfma_f32_16x16x32_bf16 v[20:23], v[148:151], v[52:55], v[20:23]
  v_mfma_f32_16x16x32_bf16 v[20:23], v[152:155], v[56:59], v[20:23]
  v_mfma_f32_16x16x32_bf16 v[20:23], v[156:159], v[60:63], v[20:23]
  s_waitcnt lgkmcnt(3)
  v_mfma_f32_16x16x32_bf16 v[20:23], v[128:131], v[64:67], v[20:23]
  s_waitcnt lgkmcnt(2)
  v_mfma_f32_16x16x32_bf16 v[20:23], v[132:135], v[68:71], v[20:23]
  s_waitcnt lgkmcnt(1)
  v_mfma_f32_16x16x32_bf16 v[20:23], v[136:139], v[72:75], v[20:23]
  buffer_load_dwordx4 v[120:123], v12, s[44:47], s30 offen sc1
  s_waitcnt lgkmcnt(0)
  v_mfma_f32_16x16x32_bf16 v[20:23], v[140:143], v[76:79], v[20:23]
  v_mfma_f32_16x16x32_bf16 v[44:47], v[240:243], v[48:51], 0
  v_mfma_f32_16x16x32_bf16 v[44:47], v[244:247], v[52:55], v[44:47]
  v_mfma_f32_16x16x32_bf16 v[44:47], v[248:251], v[56:59], v[44:47]
  v_mfma_f32_16x16x32_bf16 v[44:47], v[252:255], v[60:63], v[44:47]
  ds_write_b128 v8, v[16:19] offset:16640
  s_nop 2
  ds_write_b128 v8, v[20:23] offset:20992
  v_mfma_f32_16x16x32_bf16 v[40:43], v[224:227], v[48:51], 0
  v_mfma_f32_16x16x32_bf16 v[40:43], v[228:231], v[52:55], v[40:43]
  v_mov_b32 v240, 0
  v_mov_b32 v241, 0
  v_mfma_f32_16x16x32_bf16 v[40:43], v[232:235], v[56:59], v[40:43]
  v_mov_b32 v242, 0
  v_mov_b32 v243, 0
  v_mfma_f32_16x16x32_bf16 v[40:43], v[236:239], v[60:63], v[40:43]
  s_waitcnt lgkmcnt(0)
  s_barrier
  ds_read2_b32 v[248:249], v9 offset0:0 offset1:68
  v_mfma_f32_16x16x32_bf16 v[36:39], v[208:211], v[48:51], 0
  ds_read2_b32 v[252:253], v9 offset0:16 offset1:84
  ds_read2_b32 v[250:251], v9 offset0:32 offset1:100
  v_mfma_f32_16x16x32_bf16 v[36:39], v[212:215], v[52:55], v[36:39]
  ds_read2_b32 v[254:255], v9 offset0:48 offset1:116
  v_mov_b32 v244, 0
  v_mfma_f32_16x16x32_bf16 v[36:39], v[216:219], v[56:59], v[36:39]
  v_mov_b32 v245, 0
  v_mov_b32 v246, 0
  v_mfma_f32_16x16x32_bf16 v[36:39], v[220:223], v[60:63], v[36:39]
  v_mov_b32 v247, 0
  ds_read_u16_d16_hi v240, v10 offset:0
  v_mfma_f32_16x16x32_bf16 v[32:35], v[192:195], v[48:51], 0
  ds_read_u16_d16_hi v241, v10 offset:32
  ds_read_u16_d16_hi v242, v10 offset:4608
  v_mfma_f32_16x16x32_bf16 v[32:35], v[196:199], v[52:55], v[32:35]
  ds_read_u16_d16_hi v243, v10 offset:4640
  ds_read_u16_d16_hi v244, v10 offset:9216
  v_mfma_f32_16x16x32_bf16 v[32:35], v[200:203], v[56:59], v[32:35]
  ds_read_u16_d16_hi v245, v10 offset:9248
  ds_read_u16_d16_hi v246, v10 offset:13824
  v_mfma_f32_16x16x32_bf16 v[32:35], v[204:207], v[60:63], v[32:35]
  s_waitcnt lgkmcnt(7)
  v_add_f32 v248, v248, v252
  v_add_f32 v249, v249, v253
  v_mfma_f32_16x16x32_bf16 v[28:31], v[176:179], v[48:51], 0
  v_add_f32 v250, v250, v254
  v_add_f32 v251, v251, v255
  v_mfma_f32_16x16x32_bf16 v[28:31], v[180:183], v[52:55], v[28:31]
  v_cvt_pk_bf16_f32 v248, v248, v249
  v_cvt_pk_bf16_f32 v250, v250, v251
  v_mfma_f32_16x16x32_bf16 v[28:31], v[184:187], v[56:59], v[28:31]
  v_and_b32 v249, 0xffff0000, v248
  v_and_b32 v251, 0xffff0000, v250
  v_mfma_f32_16x16x32_bf16 v[28:31], v[188:191], v[60:63], v[28:31]
  v_lshlrev_b32 v248, 16, v248
  v_lshlrev_b32 v250, 16, v250
  v_mfma_f32_16x16x32_bf16 v[24:27], v[160:163], v[48:51], 0
  ds_read_u16_d16_hi v247, v10 offset:13856
  v_mfma_f32_16x16x32_bf16 v[24:27], v[164:167], v[52:55], v[24:27]
  v_mfma_f32_16x16x32_bf16 v[24:27], v[168:171], v[56:59], v[24:27]
  v_mfma_f32_16x16x32_bf16 v[24:27], v[172:175], v[60:63], v[24:27]
  v_mfma_f32_16x16x32_bf16 v[44:47], v[224:227], v[64:67], v[44:47]
  s_waitcnt lgkmcnt(4)
  v_mul_f32 v240, s24, v240
  v_mul_f32 v241, s24, v241
  v_mfma_f32_16x16x32_bf16 v[44:47], v[228:231], v[68:71], v[44:47]
  v_mul_f32 v242, s25, v242
  v_mul_f32 v243, s25, v243
  v_mfma_f32_16x16x32_bf16 v[44:47], v[232:235], v[72:75], v[44:47]
  v_cvt_pk_bf16_f32 v240, v240, v241
  v_cvt_pk_bf16_f32 v242, v242, v243
  v_mfma_f32_16x16x32_bf16 v[44:47], v[236:239], v[76:79], v[44:47]
  v_and_b32 v241, 0xffff0000, v240
  v_and_b32 v243, 0xffff0000, v242
  v_mfma_f32_16x16x32_bf16 v[40:43], v[208:211], v[64:67], v[40:43]
  buffer_load_dwordx4 v[124:127], v12, s[44:47], s31 offen sc1
  v_lshlrev_b32 v240, 16, v240
  v_mfma_f32_16x16x32_bf16 v[40:43], v[212:215], v[68:71], v[40:43]
  v_lshlrev_b32 v242, 16, v242
  v_add_f32 v248, v248, v240
  v_mfma_f32_16x16x32_bf16 v[40:43], v[216:219], v[72:75], v[40:43]
  v_add_f32 v249, v249, v241
  v_add_f32 v250, v250, v242
  v_mfma_f32_16x16x32_bf16 v[40:43], v[220:223], v[76:79], v[40:43]
  s_waitcnt vmcnt(2)
  v_cmp_eq_u32 vcc, -1, v116
  s_cbranch_vccnz RSc2s1
BSc2s1:
  v_mfma_f32_16x16x32_bf16 v[36:39], v[192:195], v[64:67], v[36:39]
  ds_write_b128 v11, v[116:119] offset:1024
  v_add_f32 v251, v251, v243
  v_mfma_f32_16x16x32_bf16 v[36:39], v[196:199], v[68:71], v[36:39]
  v_cvt_pk_bf16_f32 v248, v248, v249
  v_cvt_pk_bf16_f32 v250, v250, v251
  v_mfma_f32_16x16x32_bf16 v[36:39], v[200:203], v[72:75], v[36:39]
  v_and_b32 v249, 0xffff0000, v248
  v_and_b32 v251, 0xffff0000, v250
  v_mfma_f32_16x16x32_bf16 v[36:39], v[204:207], v[76:79], v[36:39]
  v_lshlrev_b32 v248, 16, v248
  v_lshlrev_b32 v250, 16, v250
  v_mfma_f32_16x16x32_bf16 v[32:35], v[176:179], v[64:67], v[32:35]
  s_waitcnt lgkmcnt(0)
  s_barrier
  ds_read_b128 v[80:83], v7 offset:1216
  v_mfma_f32_16x16x32_bf16 v[32:35], v[180:183], v[68:71], v[32:35]
  ds_read_b128 v[84:87], v7 offset:1152
  ds_read_b128 v[88:91], v7 offset:1088
  v_mfma_f32_16x16x32_bf16 v[32:35], v[184:187], v[72:75], v[32:35]
  ds_read_b128 v[92:95], v7 offset:1024
  ds_read_b128 v[96:99], v7 offset:1728
  v_mfma_f32_16x16x32_bf16 v[32:35], v[188:191], v[76:79], v[32:35]
  ds_read_b128 v[100:103], v7 offset:1664
  ds_read_b128 v[104:107], v7 offset:1600
  v_mfma_f32_16x16x32_bf16 v[28:31], v[160:163], v[64:67], v[28:31]
  ds_read_b128 v[108:111], v7 offset:1536
  v_add_f32 v248, v248, v244
  v_mfma_f32_16x16x32_bf16 v[28:31], v[164:167], v[68:71], v[28:31]
  v_add_f32 v249, v249, v245
  v_add_f32 v250, v250, v246
  v_mfma_f32_16x16x32_bf16 v[28:31], v[168:171], v[72:75], v[28:31]
  v_add_f32 v251, v251, v247
  v_cvt_pk_bf16_f32 v252, v248, v250
  v_mfma_f32_16x16x32_bf16 v[28:31], v[172:175], v[76:79], v[28:31]
  v_cvt_pk_bf16_f32 v253, v249, v251
  v_min_u32 v252, -2, v252
  v_mfma_f32_16x16x32_bf16 v[24:27], v[144:147], v[64:67], v[24:27]
  buffer_store_dwordx2 v[252:253], v13, s[44:47], s68 offen sc1
  s_add_u32 s68, s68, 0x81000
  v_mov_b32 v224, 0
  v_mfma_f32_16x16x32_bf16 v[24:27], v[148:151], v[68:71], v[24:27]
  v_mov_b32 v225, 0
  v_mov_b32 v226, 0
  v_mfma_f32_16x16x32_bf16 v[24:27], v[152:155], v[72:75], v[24:27]
  v_mov_b32 v227, 0
  v_mov_b32 v228, 0
  v_mfma_f32_16x16x32_bf16 v[24:27], v[156:159], v[76:79], v[24:27]
  v_mov_b32 v229, 0
  v_mov_b32 v230, 0
  s_waitcnt lgkmcnt(7)
  v_mfma_f32_16x16x32_bf16 v[24:27], v[128:131], v[80:83], v[24:27]
  v_mov_b32 v231, 0
  ds_read_u16_d16_hi v224, v10 offset:1024
  s_waitcnt lgkmcnt(7)
  v_mfma_f32_16x16x32_bf16 v[24:27], v[132:135], v[84:87], v[24:27]
  ds_read_u16_d16_hi v225, v10 offset:1056
  ds_read_u16_d16_hi v226, v10 offset:5632
  s_waitcnt lgkmcnt(8)
  v_mfma_f32_16x16x32_bf16 v[24:27], v[136:139], v[88:91], v[24:27]
  ds_read_u16_d16_hi v227, v10 offset:5664
  ds_read_u16_d16_hi v228, v10 offset:10240
  s_waitcnt lgkmcnt(9)
  v_mfma_f32_16x16x32_bf16 v[24:27], v[140:143], v[92:95], v[24:27]
  ds_read_u16_d16_hi v229, v10 offset:10272
  ds_read_u16_d16_hi v230, v10 offset:14848
  v_mfma_f32_16x16x32_bf16 v[28:31], v[144:147], v[80:83], v[28:31]
  ds_read_u16_d16_hi v231, v10 offset:14880
  v_mfma_f32_16x16x32_bf16 v[28:31], v[148:151], v[84:87], v[28:31]
  v_mfma_f32_16x16x32_bf16 v[28:31], v[152:155], v[88:91], v[28:31]
  v_mfma_f32_16x16x32_bf16 v[28:31], v[156:159], v[92:95], v[28:31]
  s_waitcnt lgkmcnt(11)
  v_mfma_f32_16x16x32_bf16 v[28:31], v[128:131], v[96:99], v[28:31]
  s_waitcnt lgkmcnt(4)
  v_mul_f32 v224, s24, v224
  v_mul_f32 v225, s24, v225
  v_mfma_f32_16x16x32_bf16 v[28:31], v[132:135], v[100:103], v[28:31]
  v_mul_f32 v226, s25, v226
  v_mul_f32 v227, s25, v227
  v_mfma_f32_16x16x32_bf16 v[28:31], v[136:139], v[104:107], v[28:31]
  v_cvt_pk_bf16_f32 v224, v224, v225
  v_cvt_pk_bf16_f32 v226, v226, v227
  v_mfma_f32_16x16x32_bf16 v[28:31], v[140:143], v[108:111], v[28:31]
  v_and_b32 v225, 0xffff0000, v224
  v_and_b32 v227, 0xffff0000, v226
  v_mfma_f32_16x16x32_bf16 v[44:47], v[208:211], v[80:83], v[44:47]
  v_lshlrev_b32 v224, 16, v224
  v_lshlrev_b32 v226, 16, v226
  v_mfma_f32_16x16x32_bf16 v[44:47], v[212:215], v[84:87], v[44:47]
  v_mfma_f32_16x16x32_bf16 v[44:47], v[216:219], v[88:91], v[44:47]
  v_mfma_f32_16x16x32_bf16 v[44:47], v[220:223], v[92:95], v[44:47]
  ds_write_b128 v8, v[24:27] offset:0
  ds_write_b128 v8, v[28:31] offset:4352
  v_mfma_f32_16x16x32_bf16 v[40:43], v[192:195], v[80:83], v[40:43]
  v_mfma_f32_16x16x32_bf16 v[40:43], v[196:199], v[84:87], v[40:43]
  v_mfma_f32_16x16x32_bf16 v[40:43], v[200:203], v[88:91], v[40:43]
  v_mfma_f32_16x16x32_bf16 v[40:43], v[204:207], v[92:95], v[40:43]
  s_waitcnt lgkmcnt(0)
  s_barrier
  ds_read2_b32 v[232:233], v14 offset0:0 offset1:68
  v_mfma_f32_16x16x32_bf16 v[36:39], v[176:179], v[80:83], v[36:39]
  ds_read2_b32 v[236:237], v14 offset0:16 offset1:84
  ds_read2_b32 v[234:235], v14 offset0:32 offset1:100
  v_mfma_f32_16x16x32_bf16 v[36:39], v[180:183], v[84:87], v[36:39]
  ds_read2_b32 v[238:239], v14 offset0:48 offset1:116
  v_mfma_f32_16x16x32_bf16 v[36:39], v[184:187], v[88:91], v[36:39]
  v_mfma_f32_16x16x32_bf16 v[36:39], v[188:191], v[92:95], v[36:39]
  v_mfma_f32_16x16x32_bf16 v[32:35], v[160:163], v[80:83], v[32:35]
  v_mfma_f32_16x16x32_bf16 v[32:35], v[164:167], v[84:87], v[32:35]
  v_mfma_f32_16x16x32_bf16 v[32:35], v[168:171], v[88:91], v[32:35]
  v_mfma_f32_16x16x32_bf16 v[32:35], v[172:175], v[92:95], v[32:35]
  s_waitcnt vmcnt(2)
  v_cmp_eq_u32 vcc, -1, v120
  s_cbranch_vccnz RSc2s2
BSc2s2:
  v_mfma_f32_16x16x32_bf16 v[44:47], v[192:195], v[96:99], v[44:47]
  ds_write_b128 v11, v[120:123] offset:2048
  s_waitcnt lgkmcnt(1)
  v_add_f32 v232, v232, v236
  v_mfma_f32_16x16x32_bf16 v[44:47], v[196:199], v[100:103], v[44:47]
  v_add_f32 v233, v233, v237
  v_add_f32 v234, v234, v238
  v_mfma_f32_16x16x32_bf16 v[44:47], v[200:203], v[104:107], v[44:47]
  v_add_f32 v235, v235, v239
  v_cvt_pk_bf16_f32 v232, v232, v233
  v_mfma_f32_16x16x32_bf16 v[44:47], v[204:207], v[108:111], v[44:47]
  v_cvt_pk_bf16_f32 v234, v234, v235
  v_and_b32 v233, 0xffff0000, v232
  v_mfma_f32_16x16x32_bf16 v[40:43], v[176:179], v[96:99], v[40:43]
  s_waitcnt lgkmcnt(0)
  s_barrier
  ds_read_b128 v[48:51], v7 offset:2240
  v_mfma_f32_16x16x32_bf16 v[40:43], v[180:183], v[100:103], v[40:43]
  ds_read_b128 v[52:55], v7 offset:2176
  ds_read_b128 v[56:59], v7 offset:2112
  v_mfma_f32_16x16x32_bf16 v[40:43], v[184:187], v[104:107], v[40:43]
  ds_read_b128 v[60:63], v7 offset:2048
  ds_read_b128 v[64:67], v7 offset:2752
  v_mfma_f32_16x16x32_bf16 v[40:43], v[188:191], v[108:111], v[40:43]
  ds_read_b128 v[68:71], v7 offset:2688
  ds_read_b128 v[72:75], v7 offset:2624
  v_mfma_f32_16x16x32_bf16 v[36:39], v[160:163], v[96:99], v[36:39]
  ds_read_b128 v[76:79], v7 offset:2560
  v_and_b32 v235, 0xffff0000, v234
  v_mfma_f32_16x16x32_bf16 v[36:39], v[164:167], v[100:103], v[36:39]
  v_lshlrev_b32 v232, 16, v232
  v_lshlrev_b32 v234, 16, v234
  v_mfma_f32_16x16x32_bf16 v[36:39], v[168:171], v[104:107], v[36:39]
  v_add_f32 v232, v232, v224
  v_add_f32 v233, v233, v225
  v_mfma_f32_16x16x32_bf16 v[36:39], v[172:175], v[108:111], v[36:39]
  v_add_f32 v234, v234, v226
  v_add_f32 v235, v235, v227
  v_mfma_f32_16x16x32_bf16 v[32:35], v[144:147], v[96:99], v[32:35]
  v_cvt_pk_bf16_f32 v232, v232, v233
  v_cvt_pk_bf16_f32 v234, v234, v235
  v_mfma_f32_16x16x32_bf16 v[32:35], v[148:151], v[100:103], v[32:35]
  v_and_b32 v233, 0xffff0000, v232
  v_and_b32 v235, 0xffff0000, v234
  v_mfma_f32_16x16x32_bf16 v[32:35], v[152:155], v[104:107], v[32:35]
  v_lshlrev_b32 v232, 16, v232
  v_lshlrev_b32 v234, 16, v234
  v_mfma_f32_16x16x32_bf16 v[32:35], v[156:159], v[108:111], v[32:35]
  v_add_f32 v232, v232, v228
  v_add_f32 v233, v233, v229
  s_waitcnt lgkmcnt(7)
  v_mfma_f32_16x16x32_bf16 v[32:35], v[128:131], v[48:51], v[32:35]
  v_add_f32 v234, v234, v230
  v_add_f32 v235, v235, v231
  s_waitcnt lgkmcnt(6)
  v_mfma_f32_16x16x32_bf16 v[32:35], v[132:135], v[52:55], v[32:35]
  v_cvt_pk_bf16_f32 v236, v232, v234
  v_cvt_pk_bf16_f32 v237, v233, v235
  s_waitcnt lgkmcnt(5)
  v_mfma_f32_16x16x32_bf16 v[32:35], v[136:139], v[56:59], v[32:35]
  v_min_u32 v236, -2, v236
  buffer_store_dwordx2 v[236:237], v13, s[44:47], s68 offen sc1
  s_add_u32 s68, s68, 0x81000
  s_waitcnt lgkmcnt(4)
  v_mfma_f32_16x16x32_bf16 v[32:35], v[140:143], v[60:63], v[32:35]
  ds_read_u16_d16_hi v240, v10 offset:2048
  ds_read_u16_d16_hi v241, v10 offset:2080
  v_mfma_f32_16x16x32_bf16 v[36:39], v[144:147], v[48:51], v[36:39]
  ds_read_u16_d16_hi v242, v10 offset:6656
  ds_read_u16_d16_hi v243, v10 offset:6688
  v_mfma_f32_16x16x32_bf16 v[36:39], v[148:151], v[52:55], v[36:39]
  ds_read_u16_d16_hi v244, v10 offset:11264
  ds_read_u16_d16_hi v245, v10 offset:11296
  v_mfma_f32_16x16x32_bf16 v[36:39], v[152:155], v[56:59], v[36:39]
  ds_read_u16_d16_hi v246, v10 offset:15872
  ds_read_u16_d16_hi v247, v10 offset:15904
  v_mfma_f32_16x16x32_bf16 v[36:39], v[156:159], v[60:63], v[36:39]
  s_waitcnt lgkmcnt(11)
  v_mfma_f32_16x16x32_bf16 v[36:39], v[128:131], v[64:67], v[36:39]
  s_waitcnt lgkmcnt(10)
  v_mfma_f32_16x16x32_bf16 v[36:39], v[132:135], v[68:71], v[36:39]
  s_waitcnt lgkmcnt(9)
  v_mfma_f32_16x16x32_bf16 v[36:39], v[136:139], v[72:75], v[36:39]
  s_waitcnt lgkmcnt(4)
  v_mul_f32 v240, s24, v240
  v_mul_f32 v241, s24, v241
  v_mfma_f32_16x16x32_bf16 v[36:39], v[140:143], v[76:79], v[36:39]
  v_mul_f32 v242, s25, v242
  v_mul_f32 v243, s25, v243
  v_mfma_f32_16x16x32_bf16 v[44:47], v[176:179], v[48:51], v[44:47]
  v_cvt_pk_bf16_f32 v240, v240, v241
  v_cvt_pk_bf16_f32 v242, v242, v243
  v_mfma_f32_16x16x32_bf16 v[44:47], v[180:183], v[52:55], v[44:47]
  v_and_b32 v241, 0xffff0000, v240
  v_and_b32 v243, 0xffff0000, v242
  v_mfma_f32_16x16x32_bf16 v[44:47], v[184:187], v[56:59], v[44:47]
  s_waitcnt vmcnt(2)
  v_cmp_eq_u32 vcc, -1, v124
  s_cbranch_vccnz RSc2s3
BSc2s3:
  v_mfma_f32_16x16x32_bf16 v[44:47], v[188:191], v[60:63], v[44:47]
  ds_write_b128 v11, v[124:127] offset:3072
  ds_write_b128 v8, v[32:35] offset:16640
  v_mfma_f32_16x16x32_bf16 v[40:43], v[160:163], v[48:51], v[40:43]
  ds_write_b128 v8, v[36:39] offset:20992
  v_lshlrev_b32 v240, 16, v240
  v_mfma_f32_16x16x32_bf16 v[40:43], v[164:167], v[52:55], v[40:43]
  v_lshlrev_b32 v242, 16, v242
  v_mfma_f32_16x16x32_bf16 v[40:43], v[168:171], v[56:59], v[40:43]
  v_mfma_f32_16x16x32_bf16 v[40:43], v[172:175], v[60:63], v[40:43]
  v_mfma_f32_16x16x32_bf16 v[44:47], v[160:163], v[64:67], v[44:47]
  s_waitcnt lgkmcnt(0)
  s_barrier
  ds_read_b128 v[80:83], v7 offset:3264
  v_mfma_f32_16x16x32_bf16 v[44:47], v[164:167], v[68:71], v[44:47]
  ds_read_b128 v[84:87], v7 offset:3200
  ds_read_b128 v[88:91], v7 offset:3136
  v_mfma_f32_16x16x32_bf16 v[44:47], v[168:171], v[72:75], v[44:47]
  ds_read_b128 v[92:95], v7 offset:3072
  ds_read_b128 v[96:99], v7 offset:3776
  v_mfma_f32_16x16x32_bf16 v[44:47], v[172:175], v[76:79], v[44:47]
  ds_read_b128 v[100:103], v7 offset:3712
  ds_read_b128 v[104:107], v7 offset:3648
  v_mfma_f32_16x16x32_bf16 v[40:43], v[144:147], v[64:67], v[40:43]
  ds_read_b128 v[108:111], v7 offset:3584
  ds_read2_b32 v[248:249], v9 offset0:0 offset1:68
  v_mfma_f32_16x16x32_bf16 v[40:43], v[148:151], v[68:71], v[40:43]
  ds_read2_b32 v[252:253], v9 offset0:16 offset1:84
  ds_read2_b32 v[250:251], v9 offset0:32 offset1:100
  v_mfma_f32_16x16x32_bf16 v[40:43], v[152:155], v[72:75], v[40:43]
  ds_read2_b32 v[254:255], v9 offset0:48 offset1:116
  ds_read_u16_d16_hi v224, v10 offset:3072
  v_mfma_f32_16x16x32_bf16 v[40:43], v[156:159], v[76:79], v[40:43]
  ds_read_u16_d16_hi v225, v10 offset:3104
  ds_read_u16_d16_hi v226, v10 offset:7680
  s_waitcnt lgkmcnt(14)
  v_mfma_f32_16x16x32_bf16 v[40:43], v[128:131], v[80:83], v[40:43]
  ds_read_u16_d16_hi v227, v10 offset:7712
  ds_read_u16_d16_hi v228, v10 offset:12288
  s_waitcnt lgkmcnt(15)
  v_mfma_f32_16x16x32_bf16 v[40:43], v[132:135], v[84:87], v[40:43]
  ds_read_u16_d16_hi v229, v10 offset:12320
  ds_read_u16_d16_hi v230, v10 offset:16896
  s_waitcnt lgkmcnt(15)
  v_mfma_f32_16x16x32_bf16 v[40:43], v[136:139], v[88:91], v[40:43]
  ds_read_u16_d16_hi v231, v10 offset:16928
  v_mfma_f32_16x16x32_bf16 v[40:43], v[140:143], v[92:95], v[40:43]
  v_mfma_f32_16x16x32_bf16 v[44:47], v[144:147], v[80:83], v[44:47]
  s_waitcnt lgkmcnt(8)
  v_add_f32 v248, v248, v252
  v_add_f32 v249, v249, v253
  v_mfma_f32_16x16x32_bf16 v[44:47], v[148:151], v[84:87], v[44:47]
  v_add_f32 v250, v250, v254
  v_add_f32 v251, v251, v255
  v_mfma_f32_16x16x32_bf16 v[44:47], v[152:155], v[88:91], v[44:47]
  v_cvt_pk_bf16_f32 v248, v248, v249
  v_cvt_pk_bf16_f32 v250, v250, v251
  v_mfma_f32_16x16x32_bf16 v[44:47], v[156:159], v[92:95], v[44:47]
  v_and_b32 v249, 0xffff0000, v248
  v_and_b32 v251, 0xffff0000, v250
  v_mfma_f32_16x16x32_bf16 v[44:47], v[128:131], v[96:99], v[44:47]
  v_lshlrev_b32 v248, 16, v248
  v_lshlrev_b32 v250, 16, v250
  v_mfma_f32_16x16x32_bf16 v[44:47], v[132:135], v[100:103], v[44:47]
  v_add_f32 v248, v248, v240
  v_add_f32 v249, v249, v241
  v_mfma_f32_16x16x32_bf16 v[44:47], v[136:139], v[104:107], v[44:47]
  v_add_f32 v250, v250, v242
  v_add_f32 v251, v251, v243
  v_mfma_f32_16x16x32_bf16 v[44:47], v[140:143], v[108:111], v[44:47]
  v_cvt_pk_bf16_f32 v248, v248, v249
  v_cvt_pk_bf16_f32 v250, v250, v251
  ds_write_b128 v8, v[40:43] offset:0
  s_nop 4
  ds_write_b128 v8, v[44:47] offset:4352
  v_and_b32 v249, 0xffff0000, v248
  v_and_b32 v251, 0xffff0000, v250
  v_lshlrev_b32 v248, 16, v248
  v_lshlrev_b32 v250, 16, v250
  v_add_f32 v248, v248, v244
  v_add_f32 v249, v249, v245
  v_add_f32 v250, v250, v246
  v_add_f32 v251, v251, v247
  v_cvt_pk_bf16_f32 v252, v248, v250
  v_cvt_pk_bf16_f32 v253, v249, v251
  v_min_u32 v252, -2, v252
  buffer_store_dwordx2 v[252:253], v13, s[44:47], s68 offen sc1
  s_add_u32 s68, s68, 0x81000
  s_waitcnt lgkmcnt(0)
  s_barrier
  ds_read2_b32 v[232:233], v14 offset0:0 offset1:68
  ds_read2_b32 v[236:237], v14 offset0:16 offset1:84
  ds_read2_b32 v[234:235], v14 offset0:32 offset1:100
  ds_read2_b32 v[238:239], v14 offset0:48 offset1:116
  v_mul_f32 v224, s24, v224
  v_mul_f32 v225, s24, v225
  v_mul_f32 v226, s25, v226
  v_mul_f32 v227, s25, v227
  v_cvt_pk_bf16_f32 v224, v224, v225
  v_cvt_pk_bf16_f32 v226, v226, v227
  v_and_b32 v225, 0xffff0000, v224
  v_and_b32 v227, 0xffff0000, v226
  v_lshlrev_b32 v224, 16, v224
  v_lshlrev_b32 v226, 16, v226
  s_waitcnt lgkmcnt(0)
  v_pk_add_f32 v[232:233], v[232:233], v[236:237]
  v_pk_add_f32 v[234:235], v[234:235], v[238:239]
  v_cvt_pk_bf16_f32 v232, v232, v233
  v_cvt_pk_bf16_f32 v234, v234, v235
  v_and_b32 v233, 0xffff0000, v232
  v_and_b32 v235, 0xffff0000, v234
  v_lshlrev_b32 v232, 16, v232
  v_lshlrev_b32 v234, 16, v234
  v_pk_add_f32 v[232:233], v[232:233], v[224:225]
  v_pk_add_f32 v[234:235], v[234:235], v[226:227]
  v_cvt_pk_bf16_f32 v232, v232, v233
  v_cvt_pk_bf16_f32 v234, v234, v235
  v_and_b32 v233, 0xffff0000, v232
  v_and_b32 v235, 0xffff0000, v234
  v_lshlrev_b32 v232, 16, v232
  v_lshlrev_b32 v234, 16, v234
  v_pk_add_f32 v[232:233], v[232:233], v[228:229]
  v_pk_add_f32 v[234:235], v[234:235], v[230:231]
  v_cvt_pk_bf16_f32 v236, v232, v234
  v_cvt_pk_bf16_f32 v237, v233, v235
  v_min_u32 v236, -2, v236
  buffer_store_dwordx2 v[236:237], v13, s[44:47], s68 offen sc1
  s_and_b32 s13, s6, 3
  s_lshl_b32 s13, s13, 11
  v_lshl_add_u32 v3, v2, 4, s13
  s_lshl_b32 s12, s5, 2
  s_add_u32 s12, s12, s3
  s_mul_i32 s13, s12, 33024
  s_add_u32 s13, s13, 0x210000
  s_lshr_b32 s14, s6, 2
  s_xor_b32 s14, s14, s3
  s_lshl_b32 s14, s14, 13
  s_add_u32 s16, s13, s14
  v_xor_b32 v4, 2048, v3
  v_xor_b32 v5, 4096, v3
  v_xor_b32 v6, 6144, v3
  s_xor_b32 s15, s14, 8192
  s_add_u32 s17, s13, s15
  s_xor_b32 s15, s14, 16384
  s_add_u32 s18, s13, s15
  s_xor_b32 s15, s14, 24576
  s_add_u32 s19, s13, s15
  v_lshrrev_b32 v13, 2, v2
  v_and_b32 v12, 3, v2
  v_mul_u32_u24 v13, 224, v13
  v_lshl_add_u32 v13, v12, 3, v13
  s_and_b32 s13, s6, 1
  s_lshl_b32 s14, s13, 5
  v_add_u32 v13, s14, v13
  s_mul_i32 s30, s13, -224
  s_add_u32 s30, s30, 192
  s_xor_b32 s13, s3, 0
  s_mul_i32 s13, s13, 28672
  v_add_u32 v100, s13, v13
  v_add_u32 v101, s30, v100
  s_xor_b32 s13, s3, 1
  s_mul_i32 s13, s13, 28672
  v_add_u32 v102, s13, v13
  v_add_u32 v103, s30, v102
  s_xor_b32 s13, s3, 2
  s_mul_i32 s13, s13, 28672
  v_add_u32 v104, s13, v13
  v_add_u32 v105, s30, v104
  s_xor_b32 s13, s3, 3
  s_mul_i32 s13, s13, 28672
  v_add_u32 v106, s13, v13
  v_add_u32 v107, s30, v106
  v_mov_b32 v244, 0x3f803f80
  v_mov_b32 v245, 0x3f803f80
  v_mov_b32 v246, 0x3f803f80
  v_mov_b32 v247, 0x3f803f80
  ds_read_b64_tr_b16 v[72:73], v100 offset:0
  ds_read_b64_tr_b16 v[74:75], v100 offset:3584
  ds_read_b64_tr_b16 v[76:77], v100 offset:32
  ds_read_b64_tr_b16 v[78:79], v100 offset:3616
  ds_read_b64_tr_b16 v[80:81], v100 offset:64
  ds_read_b64_tr_b16 v[82:83], v100 offset:3648
  ds_read_b64_tr_b16 v[84:85], v100 offset:96
  ds_read_b64_tr_b16 v[86:87], v100 offset:3680
  ds_read_b64_tr_b16 v[88:89], v100 offset:128
  ds_read_b64_tr_b16 v[90:91], v100 offset:3712
  ds_read_b64_tr_b16 v[92:93], v100 offset:160
  ds_read_b64_tr_b16 v[94:95], v100 offset:3744
  ds_read_b64_tr_b16 v[96:97], v101 offset:0
  ds_read_b64_tr_b16 v[98:99], v101 offset:3584
  v_accvgpr_read_b32 v44, a234
  v_accvgpr_read_b32 v45, a235
  v_accvgpr_read_b32 v46, a236
  v_accvgpr_read_b32 v47, a237
  s_add_u32 s15, s3, 1
  s_and_b32 s15, s15, 3
  s_mul_i32 s15, s15, 12288
  s_add_u32 s15, s15, 117760
  v_lshl_add_u32 v1, v2, 4, s15
  ds_write_b128 v1, v[44:47]
  v_lshrrev_b32 v1, 4, v2
  v_lshl_add_u32 v1, v1, 4, s15
  s_lshl_b32 s30, s12, 4
  s_add_u32 s30, s30, s6
  s_lshl_b32 s30, s30, 5
  s_add_u32 s30, s30, 0x18a8000
  s_lshl_b32 s31, s7, 3
  s_add_u32 s31, s31, s3
  s_lshl_b32 s31, s31, 7
  s_add_u32 s31, s31, 0x18a8000
  s_lshl_b32 s29, s12, 13
  s_add_u32 s29, s29, 0x10e0000
  s_lshl_b32 s13, s6, 9
  s_add_u32 s28, s29, s13
  v_and_b32 v7, 15, v2
  v_lshlrev_b32 v7, 4, v7
  s_mov_b32 s20, 0x22222222
  s_mov_b32 s21, 0x22222222
  s_mov_b32 s22, 0x44444444
  s_mov_b32 s23, 0x44444444
  s_mov_b32 s24, 0x88888888
  s_mov_b32 s25, 0x88888888
  s_mov_b32 s26, 0x00f0000f
  s_mov_b32 s27, 0xf0000f00
  s_lshl_b32 s12, s5, 3
  s_lshl_b32 s13, s3, 1
  s_add_u32 s12, s12, s13
  s_mul_i32 s12, s12, 57344
  s_mul_i32 s13, s6, 3584
  s_add_u32 s12, s12, s13
  s_add_u32 s12, s12, 0x11a0000
  s_mov_b32 s68, s12
  s_and_b32 s13, s6, 1
  s_lshl_b32 s14, s13, 9
  s_add_u32 s14, s14, s12
  v_lshl_add_u32 v252, v2, 4, s14
  v_add_u32 v253, 0xe000, v252
  s_cmp_eq_u32 s13, 0
  s_cselect_b32 s14, 3072, 0
  s_add_u32 s14, s14, s12
  v_add_u32 v13, s14, v7
  v_bfe_u32 v14, v2, 4, 1
  v_mul_u32_u24 v14, 0xe000, v14
  v_lshrrev_b32 v15, 5, v2
  v_lshl_add_u32 v13, v15, 8, v13
  v_add_u32 v254, v13, v14
  s_add_u32 s12, s3, 0
  s_and_b32 s12, s12, 3
  s_lshl_b32 s13, s7, 2
  s_add_u32 s12, s12, s13
  s_mul_i32 s12, s12, 57344
  s_add_u32 s12, s12, 0x11a0000
  v_lshl_add_u32 v8, v2, 4, s12
  s_add_u32 s12, s3, 1
  s_and_b32 s12, s12, 3
  s_lshl_b32 s13, s7, 2
  s_add_u32 s12, s12, s13
  s_mul_i32 s12, s12, 57344
  s_add_u32 s12, s12, 0x11a0000
  v_lshl_add_u32 v9, v2, 4, s12
  s_add_u32 s12, s3, 2
  s_and_b32 s12, s12, 3
  s_lshl_b32 s13, s7, 2
  s_add_u32 s12, s12, s13
  s_mul_i32 s12, s12, 57344
  s_add_u32 s12, s12, 0x11a0000
  v_lshl_add_u32 v10, v2, 4, s12
  s_add_u32 s12, s3, 3
  s_and_b32 s12, s12, 3
  s_lshl_b32 s13, s7, 2
  s_add_u32 s12, s12, s13
  s_mul_i32 s12, s12, 57344
  s_add_u32 s12, s12, 0x11a0000
  v_lshl_add_u32 v11, v2, 4, s12
  buffer_load_dwordx4 v[116:119], v3, s[44:47], s16 offen offset:0 sc1
  buffer_load_dwordx4 v[120:123], v3, s[44:47], s16 offen offset:1024 sc1
  buffer_load_dwordx4 v[124:127], v4, s[44:47], s16 offen offset:0 sc1
  buffer_load_dwordx4 v[128:131], v4, s[44:47], s16 offen offset:1024 sc1
  buffer_load_dwordx4 v[132:135], v5, s[44:47], s16 offen offset:0 sc1
  buffer_load_dwordx4 v[136:139], v5, s[44:47], s16 offen offset:1024 sc1
  buffer_load_dwordx4 v[140:143], v6, s[44:47], s16 offen offset:0 sc1
  buffer_load_dwordx4 v[144:147], v6, s[44:47], s16 offen offset:1024 sc1
  buffer_load_dwordx4 v[148:151], v3, s[44:47], s17 offen offset:0 sc1
  buffer_load_dwordx4 v[152:155], v3, s[44:47], s17 offen offset:1024 sc1
  buffer_load_dwordx4 v[156:159], v4, s[44:47], s17 offen offset:0 sc1
  buffer_load_dwordx4 v[160:163], v4, s[44:47], s17 offen offset:1024 sc1
  s_waitcnt vmcnt(8)
  v_max3_u32 v111, v116, v118, v120
  v_max3_u32 v111, v111, v122, v124
  v_max3_u32 v111, v111, v126, v128
  v_max_u32 v111, v111, v130
  v_cmp_eq_u32 vcc, -1, v111
  s_cbranch_vccnz RSg12x0
BSg12x0:
  v_swap_b32 v117, v120
  v_swap_b32 v119, v122
  s_nop 1
  v_mfma_f32_16x16x32_bf16 v[228:231], v[244:247], v[116:119], 0
  v_swap_b32 v125, v128
  v_swap_b32 v127, v130
  v_mfma_f32_16x16x32_bf16 v[232:235], v[116:119], v[116:119], 0
  buffer_load_dwordx4 v[164:167], v5, s[44:47], s17 offen offset:0 sc1
  buffer_load_dwordx4 v[168:171], v5, s[44:47], s17 offen offset:1024 sc1
  v_mfma_f32_16x16x32_bf16 v[236:239], v[244:247], v[120:123], 0
  s_nop 4
  v_cndmask_b32 v232, v232, v233, s[20:21]
  v_mfma_f32_16x16x32_bf16 v[240:243], v[120:123], v[120:123], 0
  v_cndmask_b32 v232, v232, v234, s[22:23]
  v_cndmask_b32 v229, v232, v235, s[24:25]
  s_waitcnt lgkmcnt(11)
  v_mfma_f32_16x16x32_bf16 v[16:19], v[72:75], v[116:119], 0
  v_mov_b32 v230, s10
  v_mov_b32 v231, s11
  s_nop 1
  v_cndmask_b32 v240, v240, v241, s[20:21]
  v_mfma_f32_16x16x32_bf16 v[20:23], v[72:75], v[120:123], 0
  v_cndmask_b32 v240, v240, v242, s[22:23]
  v_cndmask_b32 v237, v240, v243, s[24:25]
  v_mfma_f32_16x16x32_bf16 v[24:27], v[76:79], v[116:119], 0
  ds_read_b64_tr_b16 v[72:73], v100 offset:7168
  v_mov_b32 v238, s10
  v_mfma_f32_16x16x32_bf16 v[28:31], v[76:79], v[120:123], 0
  ds_read_b64_tr_b16 v[74:75], v100 offset:10752
  s_waitcnt lgkmcnt(9)
  v_mfma_f32_16x16x32_bf16 v[32:35], v[80:83], v[116:119], 0
  ds_read_b64_tr_b16 v[76:77], v100 offset:7200
  v_mov_b32 v239, s11
  v_mfma_f32_16x16x32_bf16 v[36:39], v[80:83], v[120:123], 0
  ds_read_b64_tr_b16 v[78:79], v100 offset:10784
  s_mov_b64 exec, s[26:27]
  buffer_store_dwordx4 v[228:231], v7, s[44:47], s28 offen offset:0 sc1
  buffer_store_dwordx4 v[236:239], v7, s[44:47], s28 offen offset:256 sc1
  s_mov_b64 exec, -1
  v_mfma_f32_16x16x32_bf16 v[40:43], v[84:87], v[116:119], 0
  ds_read_b64_tr_b16 v[80:81], v100 offset:7232
  v_bfe_u32 v12, v2, 4, 1
  v_mfma_f32_16x16x32_bf16 v[44:47], v[84:87], v[120:123], 0
  ds_read_b64_tr_b16 v[82:83], v100 offset:10816
  s_waitcnt lgkmcnt(9)
  v_mfma_f32_16x16x32_bf16 v[48:51], v[88:91], v[116:119], 0
  ds_read_b64_tr_b16 v[84:85], v100 offset:7264
  v_lshl_add_u32 v7, v12, 12, v7
  v_mfma_f32_16x16x32_bf16 v[52:55], v[88:91], v[120:123], 0
  ds_read_b64_tr_b16 v[86:87], v100 offset:10848
  v_lshrrev_b32 v12, 5, v2
  v_mfma_f32_16x16x32_bf16 v[56:59], v[92:95], v[116:119], 0
  ds_read_b64_tr_b16 v[88:89], v100 offset:7296
  v_lshl_add_u32 v7, v12, 8, v7
  v_mfma_f32_16x16x32_bf16 v[60:63], v[92:95], v[120:123], 0
  ds_read_b64_tr_b16 v[90:91], v100 offset:10880
  s_waitcnt lgkmcnt(11)
  v_mfma_f32_16x16x32_bf16 v[64:67], v[96:99], v[116:119], 0
  ds_read_b64_tr_b16 v[92:93], v100 offset:7328
  v_mfma_f32_16x16x32_bf16 v[68:71], v[96:99], v[120:123], 0
  ds_read_b64_tr_b16 v[94:95], v100 offset:10912
  s_waitcnt lgkmcnt(8)
  v_mfma_f32_16x16x32_bf16 v[16:19], v[72:75], v[124:127], v[16:19]
  ds_read_b64_tr_b16 v[96:97], v101 offset:7168
  s_waitcnt vmcnt(8)
  v_max3_u32 v111, v132, v134, v136
  v_mfma_f32_16x16x32_bf16 v[20:23], v[72:75], v[128:131], v[20:23]
  ds_read_b64_tr_b16 v[98:99], v101 offset:10752
  v_max3_u32 v111, v111, v138, v140
  v_max3_u32 v111, v111, v142, v144
  v_mfma_f32_16x16x32_bf16 v[24:27], v[76:79], v[124:127], v[24:27]
  ds_read_b64_tr_b16 v[72:73], v100 offset:14336
  v_max_u32 v111, v111, v146
  v_mfma_f32_16x16x32_bf16 v[28:31], v[76:79], v[128:131], v[28:31]
  ds_read_b64_tr_b16 v[74:75], v100 offset:17920
  s_waitcnt lgkmcnt(8)
  v_mfma_f32_16x16x32_bf16 v[32:35], v[80:83], v[124:127], v[32:35]
  ds_read_b64_tr_b16 v[76:77], v100 offset:14368
  v_cmp_eq_u32 vcc, -1, v111
  v_mfma_f32_16x16x32_bf16 v[36:39], v[80:83], v[128:131], v[36:39]
  ds_read_b64_tr_b16 v[78:79], v100 offset:17952
  s_cbranch_vccnz RSg12x1
BSg12x1:
  v_mfma_f32_16x16x32_bf16 v[40:43], v[84:87], v[124:127], v[40:43]
  ds_read_b64_tr_b16 v[80:81], v100 offset:14400
  v_swap_b32 v133, v136
  v_mfma_f32_16x16x32_bf16 v[44:47], v[84:87], v[128:131], v[44:47]
  ds_read_b64_tr_b16 v[82:83], v100 offset:17984
  s_waitcnt lgkmcnt(8)
  v_mfma_f32_16x16x32_bf16 v[48:51], v[88:91], v[124:127], v[48:51]
  ds_read_b64_tr_b16 v[84:85], v100 offset:14432
  v_swap_b32 v135, v138
  v_mfma_f32_16x16x32_bf16 v[52:55], v[88:91], v[128:131], v[52:55]
  ds_read_b64_tr_b16 v[86:87], v100 offset:18016
  buffer_load_dwordx4 v[172:175], v6, s[44:47], s17 offen offset:0 sc1
  v_mfma_f32_16x16x32_bf16 v[56:59], v[92:95], v[124:127], v[56:59]
  ds_read_b64_tr_b16 v[88:89], v100 offset:14464
  buffer_load_dwordx4 v[176:179], v6, s[44:47], s17 offen offset:1024 sc1
  v_mfma_f32_16x16x32_bf16 v[60:63], v[92:95], v[128:131], v[60:63]
  ds_read_b64_tr_b16 v[90:91], v100 offset:18048
  s_waitcnt lgkmcnt(10)
  v_mfma_f32_16x16x32_bf16 v[64:67], v[96:99], v[124:127], v[64:67]
  ds_read_b64_tr_b16 v[92:93], v100 offset:14496
  v_mfma_f32_16x16x32_bf16 v[68:71], v[96:99], v[128:131], v[68:71]
  ds_read_b64_tr_b16 v[94:95], v100 offset:18080
  s_waitcnt lgkmcnt(8)
  v_mfma_f32_16x16x32_bf16 v[16:19], v[72:75], v[132:135], v[16:19]
  ds_read_b64_tr_b16 v[96:97], v101 offset:14336
  v_swap_b32 v141, v144
  v_mfma_f32_16x16x32_bf16 v[20:23], v[72:75], v[136:139], v[20:23]
  ds_read_b64_tr_b16 v[98:99], v101 offset:17920
  v_swap_b32 v143, v146
  v_mfma_f32_16x16x32_bf16 v[24:27], v[76:79], v[132:135], v[24:27]
  ds_read_b64_tr_b16 v[72:73], v100 offset:21504
  buffer_load_dwordx4 v[180:183], v3, s[44:47], s18 offen offset:0 sc1
  v_mfma_f32_16x16x32_bf16 v[28:31], v[76:79], v[136:139], v[28:31]
  ds_read_b64_tr_b16 v[74:75], v100 offset:25088
  s_waitcnt lgkmcnt(8)
  v_mfma_f32_16x16x32_bf16 v[32:35], v[80:83], v[132:135], v[32:35]
  ds_read_b64_tr_b16 v[76:77], v100 offset:21536
  buffer_load_dwordx4 v[184:187], v3, s[44:47], s18 offen offset:1024 sc1
  v_mfma_f32_16x16x32_bf16 v[36:39], v[80:83], v[136:139], v[36:39]
  ds_read_b64_tr_b16 v[78:79], v100 offset:25120
  v_mfma_f32_16x16x32_bf16 v[40:43], v[84:87], v[132:135], v[40:43]
  ds_read_b64_tr_b16 v[80:81], v100 offset:21568
  v_mfma_f32_16x16x32_bf16 v[44:47], v[84:87], v[136:139], v[44:47]
  ds_read_b64_tr_b16 v[82:83], v100 offset:25152
  s_waitcnt lgkmcnt(8)
  v_mfma_f32_16x16x32_bf16 v[48:51], v[88:91], v[132:135], v[48:51]
  ds_read_b64_tr_b16 v[84:85], v100 offset:21600
  v_mfma_f32_16x16x32_bf16 v[52:55], v[88:91], v[136:139], v[52:55]
  ds_read_b64_tr_b16 v[86:87], v100 offset:25184
  v_mfma_f32_16x16x32_bf16 v[56:59], v[92:95], v[132:135], v[56:59]
  ds_read_b64_tr_b16 v[88:89], v100 offset:21632
  v_mfma_f32_16x16x32_bf16 v[60:63], v[92:95], v[136:139], v[60:63]
  ds_read_b64_tr_b16 v[90:91], v100 offset:25216
  s_waitcnt lgkmcnt(10)
  v_mfma_f32_16x16x32_bf16 v[64:67], v[96:99], v[132:135], v[64:67]
  ds_read_b64_tr_b16 v[92:93], v100 offset:21664
  v_mfma_f32_16x16x32_bf16 v[68:71], v[96:99], v[136:139], v[68:71]
  ds_read_b64_tr_b16 v[94:95], v100 offset:25248
  s_waitcnt lgkmcnt(8)
  v_mfma_f32_16x16x32_bf16 v[16:19], v[72:75], v[140:143], v[16:19]
  ds_read_b64_tr_b16 v[96:97], v101 offset:21504
  s_waitcnt vmcnt(8)
  v_max3_u32 v111, v148, v150, v152
  v_mfma_f32_16x16x32_bf16 v[20:23], v[72:75], v[144:147], v[20:23]
  ds_read_b64_tr_b16 v[98:99], v101 offset:25088
  v_max3_u32 v111, v111, v154, v156
  v_max3_u32 v111, v111, v158, v160
  v_mfma_f32_16x16x32_bf16 v[24:27], v[76:79], v[140:143], v[24:27]
  ds_read_b64_tr_b16 v[72:73], v102 offset:0
  v_max_u32 v111, v111, v162
  v_mfma_f32_16x16x32_bf16 v[28:31], v[76:79], v[144:147], v[28:31]
  ds_read_b64_tr_b16 v[74:75], v102 offset:3584
  s_waitcnt lgkmcnt(8)
  v_mfma_f32_16x16x32_bf16 v[32:35], v[80:83], v[140:143], v[32:35]
  ds_read_b64_tr_b16 v[76:77], v102 offset:32
  v_cmp_eq_u32 vcc, -1, v111
  v_mfma_f32_16x16x32_bf16 v[36:39], v[80:83], v[144:147], v[36:39]
  ds_read_b64_tr_b16 v[78:79], v102 offset:3616
  s_cbranch_vccnz RSg12x2
BSg12x2:
  v_mfma_f32_16x16x32_bf16 v[40:43], v[84:87], v[140:143], v[40:43]
  ds_read_b64_tr_b16 v[80:81], v102 offset:64
  v_swap_b32 v149, v152
  v_mfma_f32_16x16x32_bf16 v[44:47], v[84:87], v[144:147], v[44:47]
  ds_read_b64_tr_b16 v[82:83], v102 offset:3648
  s_waitcnt lgkmcnt(8)
  v_mfma_f32_16x16x32_bf16 v[48:51], v[88:91], v[140:143], v[48:51]
  ds_read_b64_tr_b16 v[84:85], v102 offset:96
  v_swap_b32 v151, v154
  v_mfma_f32_16x16x32_bf16 v[52:55], v[88:91], v[144:147], v[52:55]
  ds_read_b64_tr_b16 v[86:87], v102 offset:3680
  buffer_load_dwordx4 v[188:191], v4, s[44:47], s18 offen offset:0 sc1
  v_mfma_f32_16x16x32_bf16 v[56:59], v[92:95], v[140:143], v[56:59]
  ds_read_b64_tr_b16 v[88:89], v102 offset:128
  buffer_load_dwordx4 v[192:195], v4, s[44:47], s18 offen offset:1024 sc1
  v_mfma_f32_16x16x32_bf16 v[60:63], v[92:95], v[144:147], v[60:63]
  ds_read_b64_tr_b16 v[90:91], v102 offset:3712
  s_waitcnt lgkmcnt(10)
  v_mfma_f32_16x16x32_bf16 v[64:67], v[96:99], v[140:143], v[64:67]
  ds_read_b64_tr_b16 v[92:93], v102 offset:160
  v_mfma_f32_16x16x32_bf16 v[68:71], v[96:99], v[144:147], v[68:71]
  ds_read_b64_tr_b16 v[94:95], v102 offset:3744
  s_waitcnt lgkmcnt(8)
  v_mfma_f32_16x16x32_bf16 v[16:19], v[72:75], v[148:151], v[16:19]
  ds_read_b64_tr_b16 v[96:97], v103 offset:0
  v_swap_b32 v157, v160
  v_mfma_f32_16x16x32_bf16 v[20:23], v[72:75], v[152:155], v[20:23]
  ds_read_b64_tr_b16 v[98:99], v103 offset:3584
  v_swap_b32 v159, v162
  v_mfma_f32_16x16x32_bf16 v[24:27], v[76:79], v[148:151], v[24:27]
  ds_read_b64_tr_b16 v[72:73], v102 offset:7168
  buffer_load_dwordx4 v[196:199], v5, s[44:47], s18 offen offset:0 sc1
  v_mfma_f32_16x16x32_bf16 v[28:31], v[76:79], v[152:155], v[28:31]
  ds_read_b64_tr_b16 v[74:75], v102 offset:10752
  s_waitcnt lgkmcnt(8)
  v_mfma_f32_16x16x32_bf16 v[32:35], v[80:83], v[148:151], v[32:35]
  ds_read_b64_tr_b16 v[76:77], v102 offset:7200
  buffer_load_dwordx4 v[200:203], v5, s[44:47], s18 offen offset:1024 sc1
  v_mfma_f32_16x16x32_bf16 v[36:39], v[80:83], v[152:155], v[36:39]
  ds_read_b64_tr_b16 v[78:79], v102 offset:10784
  v_mfma_f32_16x16x32_bf16 v[40:43], v[84:87], v[148:151], v[40:43]
  ds_read_b64_tr_b16 v[80:81], v102 offset:7232
  v_mfma_f32_16x16x32_bf16 v[44:47], v[84:87], v[152:155], v[44:47]
  ds_read_b64_tr_b16 v[82:83], v102 offset:10816
  s_waitcnt lgkmcnt(8)
  v_mfma_f32_16x16x32_bf16 v[48:51], v[88:91], v[148:151], v[48:51]
  ds_read_b64_tr_b16 v[84:85], v102 offset:7264
  v_mfma_f32_16x16x32_bf16 v[52:55], v[88:91], v[152:155], v[52:55]
  ds_read_b64_tr_b16 v[86:87], v102 offset:10848
  v_mfma_f32_16x16x32_bf16 v[56:59], v[92:95], v[148:151], v[56:59]
  ds_read_b64_tr_b16 v[88:89], v102 offset:7296
  v_mfma_f32_16x16x32_bf16 v[60:63], v[92:95], v[152:155], v[60:63]
  ds_read_b64_tr_b16 v[90:91], v102 offset:10880
  s_waitcnt lgkmcnt(10)
  v_mfma_f32_16x16x32_bf16 v[64:67], v[96:99], v[148:151], v[64:67]
  ds_read_b64_tr_b16 v[92:93], v102 offset:7328
  v_mfma_f32_16x16x32_bf16 v[68:71], v[96:99], v[152:155], v[68:71]
  ds_read_b64_tr_b16 v[94:95], v102 offset:10912
  s_waitcnt lgkmcnt(8)
  v_mfma_f32_16x16x32_bf16 v[16:19], v[72:75], v[156:159], v[16:19]
  ds_read_b64_tr_b16 v[96:97], v103 offset:7168
  s_waitcnt vmcnt(6)
  v_max3_u32 v111, v164, v166, v168
  v_mfma_f32_16x16x32_bf16 v[20:23], v[72:75], v[160:163], v[20:23]
  ds_read_b64_tr_b16 v[98:99], v103 offset:10752
  v_max3_u32 v111, v111, v170, v172
  v_max3_u32 v111, v111, v174, v176
  v_mfma_f32_16x16x32_bf16 v[24:27], v[76:79], v[156:159], v[24:27]
  ds_read_b64_tr_b16 v[72:73], v102 offset:14336
  v_max_u32 v111, v111, v178
  v_mfma_f32_16x16x32_bf16 v[28:31], v[76:79], v[160:163], v[28:31]
  ds_read_b64_tr_b16 v[74:75], v102 offset:17920
  s_waitcnt lgkmcnt(8)
  v_mfma_f32_16x16x32_bf16 v[32:35], v[80:83], v[156:159], v[32:35]
  ds_read_b64_tr_b16 v[76:77], v102 offset:14368
  v_cmp_eq_u32 vcc, -1, v111
  v_mfma_f32_16x16x32_bf16 v[36:39], v[80:83], v[160:163], v[36:39]
  ds_read_b64_tr_b16 v[78:79], v102 offset:17952
  s_cbranch_vccnz RSg12x3
BSg12x3:
  v_mfma_f32_16x16x32_bf16 v[40:43], v[84:87], v[156:159], v[40:43]
  ds_read_b64_tr_b16 v[80:81], v102 offset:14400
  v_swap_b32 v165, v168
  v_mfma_f32_16x16x32_bf16 v[44:47], v[84:87], v[160:163], v[44:47]
  ds_read_b64_tr_b16 v[82:83], v102 offset:17984
  s_waitcnt lgkmcnt(8)
  v_mfma_f32_16x16x32_bf16 v[48:51], v[88:91], v[156:159], v[48:51]
  ds_read_b64_tr_b16 v[84:85], v102 offset:14432
  v_swap_b32 v167, v170
  v_mfma_f32_16x16x32_bf16 v[52:55], v[88:91], v[160:163], v[52:55]
  ds_read_b64_tr_b16 v[86:87], v102 offset:18016
  buffer_load_dwordx4 v[204:207], v6, s[44:47], s18 offen offset:0 sc1
  v_mfma_f32_16x16x32_bf16 v[56:59], v[92:95], v[156:159], v[56:59]
  ds_read_b64_tr_b16 v[88:89], v102 offset:14464
  buffer_load_dwordx4 v[208:211], v6, s[44:47], s18 offen offset:1024 sc1
  v_mfma_f32_16x16x32_bf16 v[60:63], v[92:95], v[160:163], v[60:63]
  ds_read_b64_tr_b16 v[90:91], v102 offset:18048
  s_waitcnt lgkmcnt(10)
  v_mfma_f32_16x16x32_bf16 v[64:67], v[96:99], v[156:159], v[64:67]
  ds_read_b64_tr_b16 v[92:93], v102 offset:14496
  v_mfma_f32_16x16x32_bf16 v[68:71], v[96:99], v[160:163], v[68:71]
  ds_read_b64_tr_b16 v[94:95], v102 offset:18080
  s_waitcnt lgkmcnt(8)
  v_mfma_f32_16x16x32_bf16 v[16:19], v[72:75], v[164:167], v[16:19]
  ds_read_b64_tr_b16 v[96:97], v103 offset:14336
  v_swap_b32 v173, v176
  v_mfma_f32_16x16x32_bf16 v[20:23], v[72:75], v[168:171], v[20:23]
  ds_read_b64_tr_b16 v[98:99], v103 offset:17920
  v_swap_b32 v175, v178
  v_mfma_f32_16x16x32_bf16 v[24:27], v[76:79], v[164:167], v[24:27]
  ds_read_b64_tr_b16 v[72:73], v102 offset:21504
  buffer_load_dwordx4 v[212:215], v3, s[44:47], s19 offen offset:0 sc1
  v_mfma_f32_16x16x32_bf16 v[28:31], v[76:79], v[168:171], v[28:31]
  ds_read_b64_tr_b16 v[74:75], v102 offset:25088
  s_waitcnt lgkmcnt(8)
  v_mfma_f32_16x16x32_bf16 v[32:35], v[80:83], v[164:167], v[32:35]
  ds_read_b64_tr_b16 v[76:77], v102 offset:21536
  buffer_load_dwordx4 v[216:219], v3, s[44:47], s19 offen offset:1024 sc1
  v_mfma_f32_16x16x32_bf16 v[36:39], v[80:83], v[168:171], v[36:39]
  ds_read_b64_tr_b16 v[78:79], v102 offset:25120
  v_mfma_f32_16x16x32_bf16 v[40:43], v[84:87], v[164:167], v[40:43]
  ds_read_b64_tr_b16 v[80:81], v102 offset:21568
  v_mfma_f32_16x16x32_bf16 v[44:47], v[84:87], v[168:171], v[44:47]
  ds_read_b64_tr_b16 v[82:83], v102 offset:25152
  s_waitcnt lgkmcnt(8)
  v_mfma_f32_16x16x32_bf16 v[48:51], v[88:91], v[164:167], v[48:51]
  ds_read_b64_tr_b16 v[84:85], v102 offset:21600
  v_mfma_f32_16x16x32_bf16 v[52:55], v[88:91], v[168:171], v[52:55]
  ds_read_b64_tr_b16 v[86:87], v102 offset:25184
  v_mfma_f32_16x16x32_bf16 v[56:59], v[92:95], v[164:167], v[56:59]
  ds_read_b64_tr_b16 v[88:89], v102 offset:21632
  v_mfma_f32_16x16x32_bf16 v[60:63], v[92:95], v[168:171], v[60:63]
  ds_read_b64_tr_b16 v[90:91], v102 offset:25216
  s_waitcnt lgkmcnt(10)
  v_mfma_f32_16x16x32_bf16 v[64:67], v[96:99], v[164:167], v[64:67]
  ds_read_b64_tr_b16 v[92:93], v102 offset:21664
  v_mfma_f32_16x16x32_bf16 v[68:71], v[96:99], v[168:171], v[68:71]
  ds_read_b64_tr_b16 v[94:95], v102 offset:25248
  s_waitcnt lgkmcnt(8)
  v_mfma_f32_16x16x32_bf16 v[16:19], v[72:75], v[172:175], v[16:19]
  ds_read_b64_tr_b16 v[96:97], v103 offset:21504
  s_waitcnt vmcnt(6)
  v_max3_u32 v111, v180, v182, v184
  v_mfma_f32_16x16x32_bf16 v[20:23], v[72:75], v[176:179], v[20:23]
  ds_read_b64_tr_b16 v[98:99], v103 offset:25088
  v_max3_u32 v111, v111, v186, v188
  v_max3_u32 v111, v111, v190, v192
  v_mfma_f32_16x16x32_bf16 v[24:27], v[76:79], v[172:175], v[24:27]
  ds_read_b64_tr_b16 v[72:73], v104 offset:0
  v_max_u32 v111, v111, v194
  v_mfma_f32_16x16x32_bf16 v[28:31], v[76:79], v[176:179], v[28:31]
  ds_read_b64_tr_b16 v[74:75], v104 offset:3584
  s_waitcnt lgkmcnt(8)
  v_mfma_f32_16x16x32_bf16 v[32:35], v[80:83], v[172:175], v[32:35]
  ds_read_b64_tr_b16 v[76:77], v104 offset:32
  v_cmp_eq_u32 vcc, -1, v111
  v_mfma_f32_16x16x32_bf16 v[36:39], v[80:83], v[176:179], v[36:39]
  ds_read_b64_tr_b16 v[78:79], v104 offset:3616
  s_cbranch_vccnz RSg12x4
BSg12x4:
  v_mfma_f32_16x16x32_bf16 v[40:43], v[84:87], v[172:175], v[40:43]
  ds_read_b64_tr_b16 v[80:81], v104 offset:64
  v_swap_b32 v181, v184
  v_mfma_f32_16x16x32_bf16 v[44:47], v[84:87], v[176:179], v[44:47]
  ds_read_b64_tr_b16 v[82:83], v104 offset:3648
  s_waitcnt lgkmcnt(8)
  v_mfma_f32_16x16x32_bf16 v[48:51], v[88:91], v[172:175], v[48:51]
  ds_read_b64_tr_b16 v[84:85], v104 offset:96
  v_swap_b32 v183, v186
  v_mfma_f32_16x16x32_bf16 v[52:55], v[88:91], v[176:179], v[52:55]
  ds_read_b64_tr_b16 v[86:87], v104 offset:3680
  buffer_load_dwordx4 v[220:223], v4, s[44:47], s19 offen offset:0 sc1
  v_mfma_f32_16x16x32_bf16 v[56:59], v[92:95], v[172:175], v[56:59]
  ds_read_b64_tr_b16 v[88:89], v104 offset:128
  buffer_load_dwordx4 v[224:227], v4, s[44:47], s19 offen offset:1024 sc1
  v_mfma_f32_16x16x32_bf16 v[60:63], v[92:95], v[176:179], v[60:63]
  ds_read_b64_tr_b16 v[90:91], v104 offset:3712
  s_waitcnt lgkmcnt(10)
  v_mfma_f32_16x16x32_bf16 v[64:67], v[96:99], v[172:175], v[64:67]
  ds_read_b64_tr_b16 v[92:93], v104 offset:160
  v_mfma_f32_16x16x32_bf16 v[68:71], v[96:99], v[176:179], v[68:71]
  ds_read_b64_tr_b16 v[94:95], v104 offset:3744
  s_waitcnt lgkmcnt(8)
  v_mfma_f32_16x16x32_bf16 v[16:19], v[72:75], v[180:183], v[16:19]
  ds_read_b64_tr_b16 v[96:97], v105 offset:0
  v_swap_b32 v189, v192
  v_mfma_f32_16x16x32_bf16 v[20:23], v[72:75], v[184:187], v[20:23]
  ds_read_b64_tr_b16 v[98:99], v105 offset:3584
  v_swap_b32 v191, v194
  v_mfma_f32_16x16x32_bf16 v[24:27], v[76:79], v[180:183], v[24:27]
  ds_read_b64_tr_b16 v[72:73], v104 offset:7168
  buffer_load_dwordx4 v[228:231], v5, s[44:47], s19 offen offset:0 sc1
  v_mfma_f32_16x16x32_bf16 v[28:31], v[76:79], v[184:187], v[28:31]
  ds_read_b64_tr_b16 v[74:75], v104 offset:10752
  s_waitcnt lgkmcnt(8)
  v_mfma_f32_16x16x32_bf16 v[32:35], v[80:83], v[180:183], v[32:35]
  ds_read_b64_tr_b16 v[76:77], v104 offset:7200
  buffer_load_dwordx4 v[232:235], v5, s[44:47], s19 offen offset:1024 sc1
  v_mfma_f32_16x16x32_bf16 v[36:39], v[80:83], v[184:187], v[36:39]
  ds_read_b64_tr_b16 v[78:79], v104 offset:10784
  v_mfma_f32_16x16x32_bf16 v[40:43], v[84:87], v[180:183], v[40:43]
  ds_read_b64_tr_b16 v[80:81], v104 offset:7232
  v_mfma_f32_16x16x32_bf16 v[44:47], v[84:87], v[184:187], v[44:47]
  ds_read_b64_tr_b16 v[82:83], v104 offset:10816
  s_waitcnt lgkmcnt(8)
  v_mfma_f32_16x16x32_bf16 v[48:51], v[88:91], v[180:183], v[48:51]
  ds_read_b64_tr_b16 v[84:85], v104 offset:7264
  v_mfma_f32_16x16x32_bf16 v[52:55], v[88:91], v[184:187], v[52:55]
  ds_read_b64_tr_b16 v[86:87], v104 offset:10848
  v_mfma_f32_16x16x32_bf16 v[56:59], v[92:95], v[180:183], v[56:59]
  ds_read_b64_tr_b16 v[88:89], v104 offset:7296
  v_mfma_f32_16x16x32_bf16 v[60:63], v[92:95], v[184:187], v[60:63]
  ds_read_b64_tr_b16 v[90:91], v104 offset:10880
  s_waitcnt lgkmcnt(10)
  v_mfma_f32_16x16x32_bf16 v[64:67], v[96:99], v[180:183], v[64:67]
  ds_read_b64_tr_b16 v[92:93], v104 offset:7328
  v_mfma_f32_16x16x32_bf16 v[68:71], v[96:99], v[184:187], v[68:71]
  ds_read_b64_tr_b16 v[94:95], v104 offset:10912
  s_waitcnt lgkmcnt(8)
  v_mfma_f32_16x16x32_bf16 v[16:19], v[72:75], v[188:191], v[16:19]
  ds_read_b64_tr_b16 v[96:97], v105 offset:7168
  s_waitcnt vmcnt(6)
  v_max3_u32 v111, v196, v198, v200
  v_mfma_f32_16x16x32_bf16 v[20:23], v[72:75], v[192:195], v[20:23]
  ds_read_b64_tr_b16 v[98:99], v105 offset:10752
  v_max3_u32 v111, v111, v202, v204
  v_max3_u32 v111, v111, v206, v208
  v_mfma_f32_16x16x32_bf16 v[24:27], v[76:79], v[188:191], v[24:27]
  ds_read_b64_tr_b16 v[72:73], v104 offset:14336
  v_max_u32 v111, v111, v210
  v_mfma_f32_16x16x32_bf16 v[28:31], v[76:79], v[192:195], v[28:31]
  ds_read_b64_tr_b16 v[74:75], v104 offset:17920
  s_waitcnt lgkmcnt(8)
  v_mfma_f32_16x16x32_bf16 v[32:35], v[80:83], v[188:191], v[32:35]
  ds_read_b64_tr_b16 v[76:77], v104 offset:14368
  v_cmp_eq_u32 vcc, -1, v111
  v_mfma_f32_16x16x32_bf16 v[36:39], v[80:83], v[192:195], v[36:39]
  ds_read_b64_tr_b16 v[78:79], v104 offset:17952
  s_cbranch_vccnz RSg12x5
BSg12x5:
  v_mfma_f32_16x16x32_bf16 v[40:43], v[84:87], v[188:191], v[40:43]
  ds_read_b64_tr_b16 v[80:81], v104 offset:14400
  v_swap_b32 v197, v200
  v_mfma_f32_16x16x32_bf16 v[44:47], v[84:87], v[192:195], v[44:47]
  ds_read_b64_tr_b16 v[82:83], v104 offset:17984
  s_waitcnt lgkmcnt(8)
  v_mfma_f32_16x16x32_bf16 v[48:51], v[88:91], v[188:191], v[48:51]
  ds_read_b64_tr_b16 v[84:85], v104 offset:14432
  v_swap_b32 v199, v202
  v_mfma_f32_16x16x32_bf16 v[52:55], v[88:91], v[192:195], v[52:55]
  ds_read_b64_tr_b16 v[86:87], v104 offset:18016
  buffer_load_dwordx4 v[236:239], v6, s[44:47], s19 offen offset:0 sc1
  v_mfma_f32_16x16x32_bf16 v[56:59], v[92:95], v[188:191], v[56:59]
  ds_read_b64_tr_b16 v[88:89], v104 offset:14464
  buffer_load_dwordx4 v[240:243], v6, s[44:47], s19 offen offset:1024 sc1
  v_mfma_f32_16x16x32_bf16 v[60:63], v[92:95], v[192:195], v[60:63]
  ds_read_b64_tr_b16 v[90:91], v104 offset:18048
  s_waitcnt lgkmcnt(10)
  v_mfma_f32_16x16x32_bf16 v[64:67], v[96:99], v[188:191], v[64:67]
  ds_read_b64_tr_b16 v[92:93], v104 offset:14496
  v_mfma_f32_16x16x32_bf16 v[68:71], v[96:99], v[192:195], v[68:71]
  ds_read_b64_tr_b16 v[94:95], v104 offset:18080
  s_waitcnt lgkmcnt(8)
  v_mfma_f32_16x16x32_bf16 v[16:19], v[72:75], v[196:199], v[16:19]
  ds_read_b64_tr_b16 v[96:97], v105 offset:14336
  v_swap_b32 v205, v208
  v_mfma_f32_16x16x32_bf16 v[20:23], v[72:75], v[200:203], v[20:23]
  ds_read_b64_tr_b16 v[98:99], v105 offset:17920
  v_swap_b32 v207, v210
  v_mfma_f32_16x16x32_bf16 v[24:27], v[76:79], v[196:199], v[24:27]
  ds_read_b64_tr_b16 v[72:73], v104 offset:21504
  buffer_load_dwordx4 v[116:119], v7, s[44:47], s29 offen offset:0 sc1
  v_mfma_f32_16x16x32_bf16 v[28:31], v[76:79], v[200:203], v[28:31]
  ds_read_b64_tr_b16 v[74:75], v104 offset:25088
  s_waitcnt lgkmcnt(8)
  v_mfma_f32_16x16x32_bf16 v[32:35], v[80:83], v[196:199], v[32:35]
  ds_read_b64_tr_b16 v[76:77], v104 offset:21536
  buffer_load_dwordx4 v[120:123], v7, s[44:47], s29 offen offset:512 sc1
  v_mfma_f32_16x16x32_bf16 v[36:39], v[80:83], v[200:203], v[36:39]
  ds_read_b64_tr_b16 v[78:79], v104 offset:25120
  buffer_load_dwordx4 v[124:127], v7, s[44:47], s29 offen offset:1024 sc1
  v_mfma_f32_16x16x32_bf16 v[40:43], v[84:87], v[196:199], v[40:43]
  ds_read_b64_tr_b16 v[80:81], v104 offset:21568
  buffer_load_dwordx4 v[128:131], v7, s[44:47], s29 offen offset:1536 sc1
  v_mfma_f32_16x16x32_bf16 v[44:47], v[84:87], v[200:203], v[44:47]
  ds_read_b64_tr_b16 v[82:83], v104 offset:25152
  s_waitcnt lgkmcnt(8)
  v_mfma_f32_16x16x32_bf16 v[48:51], v[88:91], v[196:199], v[48:51]
  ds_read_b64_tr_b16 v[84:85], v104 offset:21600
  buffer_load_dwordx4 v[132:135], v7, s[44:47], s29 offen offset:2048 sc1
  v_mfma_f32_16x16x32_bf16 v[52:55], v[88:91], v[200:203], v[52:55]
  ds_read_b64_tr_b16 v[86:87], v104 offset:25184
  buffer_load_dwordx4 v[136:139], v7, s[44:47], s29 offen offset:2560 sc1
  v_mfma_f32_16x16x32_bf16 v[56:59], v[92:95], v[196:199], v[56:59]
  ds_read_b64_tr_b16 v[88:89], v104 offset:21632
  buffer_load_dwordx4 v[140:143], v7, s[44:47], s29 offen offset:3072 sc1
  v_mfma_f32_16x16x32_bf16 v[60:63], v[92:95], v[200:203], v[60:63]
  ds_read_b64_tr_b16 v[90:91], v104 offset:25216
  s_waitcnt lgkmcnt(10)
  v_mfma_f32_16x16x32_bf16 v[64:67], v[96:99], v[196:199], v[64:67]
  ds_read_b64_tr_b16 v[92:93], v104 offset:21664
  buffer_load_dwordx4 v[144:147], v7, s[44:47], s29 offen offset:3584 sc1
  v_mfma_f32_16x16x32_bf16 v[68:71], v[96:99], v[200:203], v[68:71]
  ds_read_b64_tr_b16 v[94:95], v104 offset:25248
  s_waitcnt lgkmcnt(8)
  v_mfma_f32_16x16x32_bf16 v[16:19], v[72:75], v[204:207], v[16:19]
  ds_read_b64_tr_b16 v[96:97], v105 offset:21504
  s_waitcnt vmcnt(12)
  v_max3_u32 v111, v212, v214, v216
  v_mfma_f32_16x16x32_bf16 v[20:23], v[72:75], v[208:211], v[20:23]
  ds_read_b64_tr_b16 v[98:99], v105 offset:25088
  v_max3_u32 v111, v111, v218, v220
  v_mfma_f32_16x16x32_bf16 v[24:27], v[76:79], v[204:207], v[24:27]
  ds_read_b64_tr_b16 v[72:73], v106 offset:0
  v_max3_u32 v111, v111, v222, v224
  v_mfma_f32_16x16x32_bf16 v[28:31], v[76:79], v[208:211], v[28:31]
  ds_read_b64_tr_b16 v[74:75], v106 offset:3584
  s_waitcnt lgkmcnt(8)
  v_mfma_f32_16x16x32_bf16 v[32:35], v[80:83], v[204:207], v[32:35]
  ds_read_b64_tr_b16 v[76:77], v106 offset:32
  v_max_u32 v111, v111, v226
  v_mfma_f32_16x16x32_bf16 v[36:39], v[80:83], v[208:211], v[36:39]
  ds_read_b64_tr_b16 v[78:79], v106 offset:3616
  v_cmp_eq_u32 vcc, -1, v111
  v_mfma_f32_16x16x32_bf16 v[40:43], v[84:87], v[204:207], v[40:43]
  ds_read_b64_tr_b16 v[80:81], v106 offset:64
  s_cbranch_vccnz RSg12x6
BSg12x6:
  v_mfma_f32_16x16x32_bf16 v[44:47], v[84:87], v[208:211], v[44:47]
  ds_read_b64_tr_b16 v[82:83], v106 offset:3648
  s_waitcnt lgkmcnt(8)
  v_mfma_f32_16x16x32_bf16 v[48:51], v[88:91], v[204:207], v[48:51]
  ds_read_b64_tr_b16 v[84:85], v106 offset:96
  v_swap_b32 v213, v216
  v_mfma_f32_16x16x32_bf16 v[52:55], v[88:91], v[208:211], v[52:55]
  ds_read_b64_tr_b16 v[86:87], v106 offset:3680
  v_swap_b32 v215, v218
  v_mfma_f32_16x16x32_bf16 v[56:59], v[92:95], v[204:207], v[56:59]
  ds_read_b64_tr_b16 v[88:89], v106 offset:128
  v_mfma_f32_16x16x32_bf16 v[60:63], v[92:95], v[208:211], v[60:63]
  ds_read_b64_tr_b16 v[90:91], v106 offset:3712
  s_waitcnt lgkmcnt(10)
  v_mfma_f32_16x16x32_bf16 v[64:67], v[96:99], v[204:207], v[64:67]
  ds_read_b64_tr_b16 v[92:93], v106 offset:160
  v_mfma_f32_16x16x32_bf16 v[68:71], v[96:99], v[208:211], v[68:71]
  ds_read_b64_tr_b16 v[94:95], v106 offset:3744
  s_waitcnt lgkmcnt(8)
  v_mfma_f32_16x16x32_bf16 v[16:19], v[72:75], v[212:215], v[16:19]
  ds_read_b64_tr_b16 v[96:97], v107 offset:0
  v_swap_b32 v221, v224
  v_mfma_f32_16x16x32_bf16 v[20:23], v[72:75], v[216:219], v[20:23]
  ds_read_b64_tr_b16 v[98:99], v107 offset:3584
  v_swap_b32 v223, v226
  v_mfma_f32_16x16x32_bf16 v[24:27], v[76:79], v[212:215], v[24:27]
  ds_read_b64_tr_b16 v[72:73], v106 offset:7168
  v_mfma_f32_16x16x32_bf16 v[28:31], v[76:79], v[216:219], v[28:31]
  ds_read_b64_tr_b16 v[74:75], v106 offset:10752
  s_waitcnt lgkmcnt(8)
  v_mfma_f32_16x16x32_bf16 v[32:35], v[80:83], v[212:215], v[32:35]
  ds_read_b64_tr_b16 v[76:77], v106 offset:7200
  v_mfma_f32_16x16x32_bf16 v[36:39], v[80:83], v[216:219], v[36:39]
  ds_read_b64_tr_b16 v[78:79], v106 offset:10784
  v_mfma_f32_16x16x32_bf16 v[40:43], v[84:87], v[212:215], v[40:43]
  ds_read_b64_tr_b16 v[80:81], v106 offset:7232
  v_mfma_f32_16x16x32_bf16 v[44:47], v[84:87], v[216:219], v[44:47]
  ds_read_b64_tr_b16 v[82:83], v106 offset:10816
  s_waitcnt lgkmcnt(8)
  v_mfma_f32_16x16x32_bf16 v[48:51], v[88:91], v[212:215], v[48:51]
  ds_read_b64_tr_b16 v[84:85], v106 offset:7264
  v_mfma_f32_16x16x32_bf16 v[52:55], v[88:91], v[216:219], v[52:55]
  ds_read_b64_tr_b16 v[86:87], v106 offset:10848
  v_mfma_f32_16x16x32_bf16 v[56:59], v[92:95], v[212:215], v[56:59]
  ds_read_b64_tr_b16 v[88:89], v106 offset:7296
  v_mfma_f32_16x16x32_bf16 v[60:63], v[92:95], v[216:219], v[60:63]
  ds_read_b64_tr_b16 v[90:91], v106 offset:10880
  s_waitcnt lgkmcnt(10)
  v_mfma_f32_16x16x32_bf16 v[64:67], v[96:99], v[212:215], v[64:67]
  ds_read_b64_tr_b16 v[92:93], v106 offset:7328
  v_mfma_f32_16x16x32_bf16 v[68:71], v[96:99], v[216:219], v[68:71]
  ds_read_b64_tr_b16 v[94:95], v106 offset:10912
  s_waitcnt lgkmcnt(8)
  v_mfma_f32_16x16x32_bf16 v[16:19], v[72:75], v[220:223], v[16:19]
  ds_read_b64_tr_b16 v[96:97], v107 offset:7168
  s_waitcnt vmcnt(8)
  v_max3_u32 v111, v228, v230, v232
  v_mfma_f32_16x16x32_bf16 v[20:23], v[72:75], v[224:227], v[20:23]
  ds_read_b64_tr_b16 v[98:99], v107 offset:10752
  v_max3_u32 v111, v111, v234, v236
  v_mfma_f32_16x16x32_bf16 v[24:27], v[76:79], v[220:223], v[24:27]
  ds_read_b64_tr_b16 v[72:73], v106 offset:14336
  v_max3_u32 v111, v111, v238, v240
  v_mfma_f32_16x16x32_bf16 v[28:31], v[76:79], v[224:227], v[28:31]
  ds_read_b64_tr_b16 v[74:75], v106 offset:17920
  s_waitcnt lgkmcnt(8)
  v_mfma_f32_16x16x32_bf16 v[32:35], v[80:83], v[220:223], v[32:35]
  ds_read_b64_tr_b16 v[76:77], v106 offset:14368
  v_max_u32 v111, v111, v242
  v_mfma_f32_16x16x32_bf16 v[36:39], v[80:83], v[224:227], v[36:39]
  ds_read_b64_tr_b16 v[78:79], v106 offset:17952
  v_cmp_eq_u32 vcc, -1, v111
  v_mfma_f32_16x16x32_bf16 v[40:43], v[84:87], v[220:223], v[40:43]
  ds_read_b64_tr_b16 v[80:81], v106 offset:14400
  s_cbranch_vccnz RSg12x7
BSg12x7:
  v_mfma_f32_16x16x32_bf16 v[44:47], v[84:87], v[224:227], v[44:47]
  ds_read_b64_tr_b16 v[82:83], v106 offset:17984
  s_waitcnt lgkmcnt(8)
  v_mfma_f32_16x16x32_bf16 v[48:51], v[88:91], v[220:223], v[48:51]
  ds_read_b64_tr_b16 v[84:85], v106 offset:14432
  v_swap_b32 v229, v232
  v_mfma_f32_16x16x32_bf16 v[52:55], v[88:91], v[224:227], v[52:55]
  ds_read_b64_tr_b16 v[86:87], v106 offset:18016
  v_swap_b32 v231, v234
  v_mfma_f32_16x16x32_bf16 v[56:59], v[92:95], v[220:223], v[56:59]
  ds_read_b64_tr_b16 v[88:89], v106 offset:14464
  v_mfma_f32_16x16x32_bf16 v[60:63], v[92:95], v[224:227], v[60:63]
  ds_read_b64_tr_b16 v[90:91], v106 offset:18048
  s_waitcnt lgkmcnt(10)
  v_mfma_f32_16x16x32_bf16 v[64:67], v[96:99], v[220:223], v[64:67]
  ds_read_b64_tr_b16 v[92:93], v106 offset:14496
  v_mfma_f32_16x16x32_bf16 v[68:71], v[96:99], v[224:227], v[68:71]
  ds_read_b64_tr_b16 v[94:95], v106 offset:18080
  s_waitcnt lgkmcnt(8)
  v_mfma_f32_16x16x32_bf16 v[16:19], v[72:75], v[228:231], v[16:19]
  ds_read_b64_tr_b16 v[96:97], v107 offset:14336
  v_swap_b32 v237, v240
  v_mfma_f32_16x16x32_bf16 v[20:23], v[72:75], v[232:235], v[20:23]
  ds_read_b64_tr_b16 v[98:99], v107 offset:17920
  v_swap_b32 v239, v242
  v_mfma_f32_16x16x32_bf16 v[24:27], v[76:79], v[228:231], v[24:27]
  ds_read_b64_tr_b16 v[72:73], v106 offset:21504
  v_mov_b32 v4, s10
  v_mfma_f32_16x16x32_bf16 v[28:31], v[76:79], v[232:235], v[28:31]
  ds_read_b64_tr_b16 v[74:75], v106 offset:25088
  s_waitcnt lgkmcnt(8)
  v_mfma_f32_16x16x32_bf16 v[32:35], v[80:83], v[228:231], v[32:35]
  ds_read_b64_tr_b16 v[76:77], v106 offset:21536
  v_mov_b32 v5, s11
  v_mfma_f32_16x16x32_bf16 v[36:39], v[80:83], v[232:235], v[36:39]
  ds_read_b64_tr_b16 v[78:79], v106 offset:25120
  v_lshlrev_b32 v6, 26, v2
  v_mfma_f32_16x16x32_bf16 v[40:43], v[84:87], v[228:231], v[40:43]
  ds_read_b64_tr_b16 v[80:81], v106 offset:21568
  v_and_b32 v3, 15, v2
  v_mfma_f32_16x16x32_bf16 v[44:47], v[84:87], v[232:235], v[44:47]
  ds_read_b64_tr_b16 v[82:83], v106 offset:25152
  s_waitcnt lgkmcnt(8)
  v_mfma_f32_16x16x32_bf16 v[48:51], v[88:91], v[228:231], v[48:51]
  ds_read_b64_tr_b16 v[84:85], v106 offset:21600
  v_bfe_u32 v111, v2, 4, 1
  v_mfma_f32_16x16x32_bf16 v[52:55], v[88:91], v[232:235], v[52:55]
  ds_read_b64_tr_b16 v[86:87], v106 offset:25184
  v_lshlrev_b32 v3, 3, v3
  v_mfma_f32_16x16x32_bf16 v[56:59], v[92:95], v[228:231], v[56:59]
  ds_read_b64_tr_b16 v[88:89], v106 offset:21632
  v_lshl_add_u32 v3, v111, 9, v3
  v_mfma_f32_16x16x32_bf16 v[60:63], v[92:95], v[232:235], v[60:63]
  ds_read_b64_tr_b16 v[90:91], v106 offset:25216
  s_waitcnt lgkmcnt(10)
  v_mfma_f32_16x16x32_bf16 v[64:67], v[96:99], v[228:231], v[64:67]
  ds_read_b64_tr_b16 v[92:93], v106 offset:21664
  buffer_load_dwordx2 v[108:109], v3, s[44:47], s31 offen sc1
  v_mfma_f32_16x16x32_bf16 v[68:71], v[96:99], v[232:235], v[68:71]
  ds_read_b64_tr_b16 v[94:95], v106 offset:25248
  s_waitcnt lgkmcnt(8)
  v_mfma_f32_16x16x32_bf16 v[16:19], v[72:75], v[236:239], v[16:19]
  ds_read_b64_tr_b16 v[96:97], v107 offset:21504
  s_waitcnt vmcnt(1)
  v_cmp_ne_u64 s[24:25], s[10:11], v[118:119]
  v_mfma_f32_16x16x32_bf16 v[20:23], v[72:75], v[240:243], v[20:23]
  ds_read_b64_tr_b16 v[98:99], v107 offset:25088
  v_cmp_ne_u64 s[22:23], s[10:11], v[122:123]
  v_mfma_f32_16x16x32_bf16 v[24:27], v[76:79], v[236:239], v[24:27]
  ds_read_b128 v[148:151], v1 offset:0
  v_cmp_ne_u64 s[20:21], s[10:11], v[126:127]
  v_mfma_f32_16x16x32_bf16 v[28:31], v[76:79], v[240:243], v[28:31]
  ds_read_b128 v[176:179], v1 offset:448
  s_waitcnt lgkmcnt(8)
  v_mfma_f32_16x16x32_bf16 v[32:35], v[80:83], v[236:239], v[32:35]
  ds_read_b128 v[152:155], v1 offset:64
  s_or_b64 s[24:25], s[24:25], s[22:23]
  v_mfma_f32_16x16x32_bf16 v[36:39], v[80:83], v[240:243], v[36:39]
  ds_read_b128 v[180:183], v1 offset:512
  v_cmp_ne_u64 s[22:23], s[10:11], v[130:131]
  v_mfma_f32_16x16x32_bf16 v[40:43], v[84:87], v[236:239], v[40:43]
  ds_read_b128 v[156:159], v1 offset:128
  s_or_b64 s[24:25], s[24:25], s[20:21]
  v_mfma_f32_16x16x32_bf16 v[44:47], v[84:87], v[240:243], v[44:47]
  ds_read_b128 v[184:187], v1 offset:576
  s_waitcnt lgkmcnt(8)
  v_mfma_f32_16x16x32_bf16 v[48:51], v[88:91], v[236:239], v[48:51]
  ds_read_b128 v[160:163], v1 offset:192
  v_cmp_ne_u64 s[20:21], s[10:11], v[134:135]
  v_mfma_f32_16x16x32_bf16 v[52:55], v[88:91], v[240:243], v[52:55]
  ds_read_b128 v[188:191], v1 offset:640
  s_or_b64 s[24:25], s[24:25], s[22:23]
  v_mfma_f32_16x16x32_bf16 v[56:59], v[92:95], v[236:239], v[56:59]
  ds_read_b128 v[164:167], v1 offset:256
  v_cmp_ne_u64 s[22:23], s[10:11], v[138:139]
  v_mfma_f32_16x16x32_bf16 v[60:63], v[92:95], v[240:243], v[60:63]
  ds_read_b128 v[192:195], v1 offset:704
  s_waitcnt lgkmcnt(10)
  v_mfma_f32_16x16x32_bf16 v[64:67], v[96:99], v[236:239], v[64:67]
  ds_read_b128 v[168:171], v1 offset:320
  s_or_b64 s[24:25], s[24:25], s[20:21]
  v_mfma_f32_16x16x32_bf16 v[68:71], v[96:99], v[240:243], v[68:71]
  ds_read_b128 v[196:199], v1 offset:768
  ds_read_b128 v[172:175], v1 offset:384
  ds_read_b128 v[200:203], v1 offset:832
  v_cmp_ne_u64 s[20:21], s[10:11], v[142:143]
  s_or_b64 s[24:25], s[24:25], s[22:23]
  v_cmp_ne_u64 s[22:23], s[10:11], v[146:147]
  s_or_b64 s[24:25], s[24:25], s[20:21]
  s_or_b64 vcc, s[24:25], s[22:23]
  s_cbranch_vccnz RSg12p
BSg12p:
  v_add_f32 v116, v116, v120
  v_add_f32 v117, v117, v121
  v_add_f32 v124, v124, v128
  v_add_f32 v125, v125, v129
  v_add_f32 v132, v132, v136
  v_add_f32 v133, v133, v137
  v_add_f32 v140, v140, v144
  v_add_f32 v141, v141, v145
  v_add_f32 v116, v116, v124
  v_add_f32 v117, v117, v125
  v_add_f32 v132, v132, v140
  v_add_f32 v133, v133, v141
  v_add_f32 v116, v116, v132
  v_add_f32 v117, v117, v133
  v_mov_b32 v120, v116
  v_mov_b32 v121, v117
  s_nop 0
  v_permlane16_swap_b32 v116, v120
  v_permlane16_swap_b32 v117, v121
  v_add_f32 v116, v116, v120
  v_add_f32 v117, v117, v121
  v_mul_f32 v116, 0x3b000000, v116
  v_mul_f32 v117, 0x3b000000, v117
  v_fma_f32 v117, -v116, v116, v117
  v_max_f32 v117, 0, v117
  v_cvt_pk_bf16_f32 v119, 0, v117
  v_add_f32 v119, 0x3727c5ac, v119
  v_cvt_pk_bf16_f32 v119, 0, v119
  v_sqrt_f32 v119, v119
  s_nop 0
  v_cvt_pk_bf16_f32 v118, v116, v119
  v_and_b32 v13, 0xffff0000, v118
  v_rcp_f32 v13, v13
  v_lshlrev_b32 v12, 16, v118
  v_mul_f32 v12, v12, v13
  v_mul_f32 v13, 0x3fb8aa3b, v13
  v_mov_b32 v14, v12
  v_mov_b32 v15, v13
  s_nop 0
  v_permlane32_swap_b32 v12, v14
  v_permlane32_swap_b32 v13, v15
  s_mov_b32 s20, 1.0
  s_mov_b32 s21, 1.0
  s_mov_b32 s22, 0x3f317218
  s_mov_b32 s23, 0xbfb17218
  s_waitcnt lgkmcnt(0)
  v_pk_fma_f32 v[204:205], v[148:149], v[12:13], v[176:177] op_sel:[0,0,0] op_sel_hi:[1,0,1] neg_lo:[0,1,0] neg_hi:[0,1,0]
  v_pk_fma_f32 v[206:207], v[150:151], v[12:13], v[178:179] op_sel:[0,0,0] op_sel_hi:[1,0,1] neg_lo:[0,1,0] neg_hi:[0,1,0]
  v_pk_fma_f32 v[212:213], v[152:153], v[12:13], v[180:181] op_sel:[0,0,0] op_sel_hi:[1,0,1] neg_lo:[0,1,0] neg_hi:[0,1,0]
  v_pk_fma_f32 v[214:215], v[154:155], v[12:13], v[182:183] op_sel:[0,0,0] op_sel_hi:[1,0,1] neg_lo:[0,1,0] neg_hi:[0,1,0]
  v_pk_fma_f32 v[204:205], v[16:17], v[12:13], v[204:205] op_sel:[0,1,0] op_sel_hi:[1,1,1]
  v_pk_fma_f32 v[206:207], v[18:19], v[12:13], v[206:207] op_sel:[0,1,0] op_sel_hi:[1,1,1]
  v_pk_fma_f32 v[212:213], v[24:25], v[12:13], v[212:213] op_sel:[0,1,0] op_sel_hi:[1,1,1]
  v_pk_fma_f32 v[214:215], v[26:27], v[12:13], v[214:215] op_sel:[0,1,0] op_sel_hi:[1,1,1]
  v_exp_f32 v208, v204
  v_exp_f32 v209, v205
  v_exp_f32 v216, v212
  v_exp_f32 v217, v213
  v_exp_f32 v210, v206
  v_exp_f32 v211, v207
  v_exp_f32 v218, v214
  v_exp_f32 v219, v215
  v_pk_add_f32 v[208:209], v[208:209], s[20:21]
  v_pk_add_f32 v[210:211], v[210:211], s[20:21]
  v_pk_add_f32 v[216:217], v[216:217], s[20:21]
  v_pk_add_f32 v[218:219], v[218:219], s[20:21]
  v_pk_fma_f32 v[208:209], v[208:209], v[208:209], s[20:21]
  v_pk_fma_f32 v[210:211], v[210:211], v[210:211], s[20:21]
  v_pk_fma_f32 v[216:217], v[216:217], v[216:217], s[20:21]
  v_pk_fma_f32 v[218:219], v[218:219], v[218:219], s[20:21]
  v_rcp_f32 v208, v208
  v_rcp_f32 v209, v209
  v_rcp_f32 v216, v216
  v_rcp_f32 v217, v217
  v_rcp_f32 v210, v210
  v_rcp_f32 v211, v211
  v_rcp_f32 v218, v218
  v_rcp_f32 v219, v219
  v_pk_fma_f32 v[208:209], v[208:209], s[22:23], s[22:23] op_sel:[0,1,0] op_sel_hi:[1,1,0]
  v_pk_fma_f32 v[210:211], v[210:211], s[22:23], s[22:23] op_sel:[0,1,0] op_sel_hi:[1,1,0]
  v_pk_fma_f32 v[216:217], v[216:217], s[22:23], s[22:23] op_sel:[0,1,0] op_sel_hi:[1,1,0]
  v_pk_fma_f32 v[218:219], v[218:219], s[22:23], s[22:23] op_sel:[0,1,0] op_sel_hi:[1,1,0]
  v_pk_mul_f32 v[208:209], v[208:209], v[204:205]
  v_pk_mul_f32 v[210:211], v[210:211], v[206:207]
  v_pk_mul_f32 v[216:217], v[216:217], v[212:213]
  v_pk_mul_f32 v[218:219], v[218:219], v[214:215]
  v_cvt_pk_bf16_f32 v236, v208, v209
  v_cvt_pk_bf16_f32 v237, v210, v211
  v_cvt_pk_bf16_f32 v238, v216, v217
  v_cvt_pk_bf16_f32 v239, v218, v219
  buffer_store_dwordx4 v[236:239], v252, s[44:47], 0 offen offset:0 sc1
  v_pk_fma_f32 v[220:221], v[148:149], v[14:15], v[176:177] op_sel:[0,0,0] op_sel_hi:[1,0,1] neg_lo:[0,1,0] neg_hi:[0,1,0]
  v_pk_fma_f32 v[222:223], v[150:151], v[14:15], v[178:179] op_sel:[0,0,0] op_sel_hi:[1,0,1] neg_lo:[0,1,0] neg_hi:[0,1,0]
  v_pk_fma_f32 v[228:229], v[152:153], v[14:15], v[180:181] op_sel:[0,0,0] op_sel_hi:[1,0,1] neg_lo:[0,1,0] neg_hi:[0,1,0]
  v_pk_fma_f32 v[230:231], v[154:155], v[14:15], v[182:183] op_sel:[0,0,0] op_sel_hi:[1,0,1] neg_lo:[0,1,0] neg_hi:[0,1,0]
  v_pk_fma_f32 v[220:221], v[20:21], v[14:15], v[220:221] op_sel:[0,1,0] op_sel_hi:[1,1,1]
  v_pk_fma_f32 v[222:223], v[22:23], v[14:15], v[222:223] op_sel:[0,1,0] op_sel_hi:[1,1,1]
  v_pk_fma_f32 v[228:229], v[28:29], v[14:15], v[228:229] op_sel:[0,1,0] op_sel_hi:[1,1,1]
  v_pk_fma_f32 v[230:231], v[30:31], v[14:15], v[230:231] op_sel:[0,1,0] op_sel_hi:[1,1,1]
  v_exp_f32 v224, v220
  v_exp_f32 v225, v221
  v_exp_f32 v232, v228
  v_exp_f32 v233, v229
  v_exp_f32 v226, v222
  v_exp_f32 v227, v223
  v_exp_f32 v234, v230
  v_exp_f32 v235, v231
  v_pk_add_f32 v[224:225], v[224:225], s[20:21]
  v_pk_add_f32 v[226:227], v[226:227], s[20:21]
  v_pk_add_f32 v[232:233], v[232:233], s[20:21]
  v_pk_add_f32 v[234:235], v[234:235], s[20:21]
  v_pk_fma_f32 v[224:225], v[224:225], v[224:225], s[20:21]
  v_pk_fma_f32 v[226:227], v[226:227], v[226:227], s[20:21]
  v_pk_fma_f32 v[232:233], v[232:233], v[232:233], s[20:21]
  v_pk_fma_f32 v[234:235], v[234:235], v[234:235], s[20:21]
  v_rcp_f32 v224, v224
  v_rcp_f32 v225, v225
  v_rcp_f32 v232, v232
  v_rcp_f32 v233, v233
  v_rcp_f32 v226, v226
  v_rcp_f32 v227, v227
  v_rcp_f32 v234, v234
  v_rcp_f32 v235, v235
  v_pk_fma_f32 v[224:225], v[224:225], s[22:23], s[22:23] op_sel:[0,1,0] op_sel_hi:[1,1,0]
  v_pk_fma_f32 v[226:227], v[226:227], s[22:23], s[22:23] op_sel:[0,1,0] op_sel_hi:[1,1,0]
  v_pk_fma_f32 v[232:233], v[232:233], s[22:23], s[22:23] op_sel:[0,1,0] op_sel_hi:[1,1,0]
  v_pk_fma_f32 v[234:235], v[234:235], s[22:23], s[22:23] op_sel:[0,1,0] op_sel_hi:[1,1,0]
  v_pk_mul_f32 v[224:225], v[224:225], v[220:221]
  v_pk_mul_f32 v[226:227], v[226:227], v[222:223]
  v_pk_mul_f32 v[232:233], v[232:233], v[228:229]
  v_pk_mul_f32 v[234:235], v[234:235], v[230:231]
  v_cvt_pk_bf16_f32 v240, v224, v225
  v_cvt_pk_bf16_f32 v241, v226, v227
  v_cvt_pk_bf16_f32 v242, v232, v233
  v_cvt_pk_bf16_f32 v243, v234, v235
  buffer_store_dwordx4 v[240:243], v253, s[44:47], 0 offen offset:0 sc1
  v_pk_fma_f32 v[204:205], v[156:157], v[12:13], v[184:185] op_sel:[0,0,0] op_sel_hi:[1,0,1] neg_lo:[0,1,0] neg_hi:[0,1,0]
  v_pk_fma_f32 v[206:207], v[158:159], v[12:13], v[186:187] op_sel:[0,0,0] op_sel_hi:[1,0,1] neg_lo:[0,1,0] neg_hi:[0,1,0]
  v_pk_fma_f32 v[212:213], v[160:161], v[12:13], v[188:189] op_sel:[0,0,0] op_sel_hi:[1,0,1] neg_lo:[0,1,0] neg_hi:[0,1,0]
  v_pk_fma_f32 v[214:215], v[162:163], v[12:13], v[190:191] op_sel:[0,0,0] op_sel_hi:[1,0,1] neg_lo:[0,1,0] neg_hi:[0,1,0]
  v_pk_fma_f32 v[204:205], v[32:33], v[12:13], v[204:205] op_sel:[0,1,0] op_sel_hi:[1,1,1]
  v_pk_fma_f32 v[206:207], v[34:35], v[12:13], v[206:207] op_sel:[0,1,0] op_sel_hi:[1,1,1]
  v_pk_fma_f32 v[212:213], v[40:41], v[12:13], v[212:213] op_sel:[0,1,0] op_sel_hi:[1,1,1]
  v_pk_fma_f32 v[214:215], v[42:43], v[12:13], v[214:215] op_sel:[0,1,0] op_sel_hi:[1,1,1]
  v_exp_f32 v208, v204
  v_exp_f32 v209, v205
  v_exp_f32 v216, v212
  v_exp_f32 v217, v213
  v_exp_f32 v210, v206
  v_exp_f32 v211, v207
  v_exp_f32 v218, v214
  v_exp_f32 v219, v215
  v_pk_add_f32 v[208:209], v[208:209], s[20:21]
  v_pk_add_f32 v[210:211], v[210:211], s[20:21]
  v_pk_add_f32 v[216:217], v[216:217], s[20:21]
  v_pk_add_f32 v[218:219], v[218:219], s[20:21]
  v_pk_fma_f32 v[208:209], v[208:209], v[208:209], s[20:21]
  v_pk_fma_f32 v[210:211], v[210:211], v[210:211], s[20:21]
  v_pk_fma_f32 v[216:217], v[216:217], v[216:217], s[20:21]
  v_pk_fma_f32 v[218:219], v[218:219], v[218:219], s[20:21]
  v_rcp_f32 v208, v208
  v_rcp_f32 v209, v209
  v_rcp_f32 v216, v216
  v_rcp_f32 v217, v217
  v_rcp_f32 v210, v210
  v_rcp_f32 v211, v211
  v_rcp_f32 v218, v218
  v_rcp_f32 v219, v219
  v_pk_fma_f32 v[208:209], v[208:209], s[22:23], s[22:23] op_sel:[0,1,0] op_sel_hi:[1,1,0]
  v_pk_fma_f32 v[210:211], v[210:211], s[22:23], s[22:23] op_sel:[0,1,0] op_sel_hi:[1,1,0]
  v_pk_fma_f32 v[216:217], v[216:217], s[22:23], s[22:23] op_sel:[0,1,0] op_sel_hi:[1,1,0]
  v_pk_fma_f32 v[218:219], v[218:219], s[22:23], s[22:23] op_sel:[0,1,0] op_sel_hi:[1,1,0]
  v_pk_mul_f32 v[208:209], v[208:209], v[204:205]
  v_pk_mul_f32 v[210:211], v[210:211], v[206:207]
  v_pk_mul_f32 v[216:217], v[216:217], v[212:213]
  v_pk_mul_f32 v[218:219], v[218:219], v[214:215]
  v_cvt_pk_bf16_f32 v236, v208, v209
  v_cvt_pk_bf16_f32 v237, v210, v211
  v_cvt_pk_bf16_f32 v238, v216, v217
  v_cvt_pk_bf16_f32 v239, v218, v219
  buffer_store_dwordx4 v[236:239], v252, s[44:47], 0 offen offset:1024 sc1
  s_waitcnt vmcnt(1)
  buffer_store_dwordx2 v[4:5], v6, s[44:47], s30 offen offset:0 sc1
  v_pk_fma_f32 v[220:221], v[156:157], v[14:15], v[184:185] op_sel:[0,0,0] op_sel_hi:[1,0,1] neg_lo:[0,1,0] neg_hi:[0,1,0]
  v_pk_fma_f32 v[222:223], v[158:159], v[14:15], v[186:187] op_sel:[0,0,0] op_sel_hi:[1,0,1] neg_lo:[0,1,0] neg_hi:[0,1,0]
  v_pk_fma_f32 v[228:229], v[160:161], v[14:15], v[188:189] op_sel:[0,0,0] op_sel_hi:[1,0,1] neg_lo:[0,1,0] neg_hi:[0,1,0]
  v_pk_fma_f32 v[230:231], v[162:163], v[14:15], v[190:191] op_sel:[0,0,0] op_sel_hi:[1,0,1] neg_lo:[0,1,0] neg_hi:[0,1,0]
  v_pk_fma_f32 v[220:221], v[36:37], v[14:15], v[220:221] op_sel:[0,1,0] op_sel_hi:[1,1,1]
  v_pk_fma_f32 v[222:223], v[38:39], v[14:15], v[222:223] op_sel:[0,1,0] op_sel_hi:[1,1,1]
  v_pk_fma_f32 v[228:229], v[44:45], v[14:15], v[228:229] op_sel:[0,1,0] op_sel_hi:[1,1,1]
  v_pk_fma_f32 v[230:231], v[46:47], v[14:15], v[230:231] op_sel:[0,1,0] op_sel_hi:[1,1,1]
  v_exp_f32 v224, v220
  v_exp_f32 v225, v221
  v_exp_f32 v232, v228
  v_exp_f32 v233, v229
  v_exp_f32 v226, v222
  v_exp_f32 v227, v223
  v_exp_f32 v234, v230
  v_exp_f32 v235, v231
  v_pk_add_f32 v[224:225], v[224:225], s[20:21]
  v_pk_add_f32 v[226:227], v[226:227], s[20:21]
  v_pk_add_f32 v[232:233], v[232:233], s[20:21]
  v_pk_add_f32 v[234:235], v[234:235], s[20:21]
  v_pk_fma_f32 v[224:225], v[224:225], v[224:225], s[20:21]
  v_pk_fma_f32 v[226:227], v[226:227], v[226:227], s[20:21]
  v_pk_fma_f32 v[232:233], v[232:233], v[232:233], s[20:21]
  v_pk_fma_f32 v[234:235], v[234:235], v[234:235], s[20:21]
  v_rcp_f32 v224, v224
  v_rcp_f32 v225, v225
  v_rcp_f32 v232, v232
  v_rcp_f32 v233, v233
  v_rcp_f32 v226, v226
  v_rcp_f32 v227, v227
  v_rcp_f32 v234, v234
  v_rcp_f32 v235, v235
  v_pk_fma_f32 v[224:225], v[224:225], s[22:23], s[22:23] op_sel:[0,1,0] op_sel_hi:[1,1,0]
  v_pk_fma_f32 v[226:227], v[226:227], s[22:23], s[22:23] op_sel:[0,1,0] op_sel_hi:[1,1,0]
  v_pk_fma_f32 v[232:233], v[232:233], s[22:23], s[22:23] op_sel:[0,1,0] op_sel_hi:[1,1,0]
  v_pk_fma_f32 v[234:235], v[234:235], s[22:23], s[22:23] op_sel:[0,1,0] op_sel_hi:[1,1,0]
  v_pk_mul_f32 v[224:225], v[224:225], v[220:221]
  v_pk_mul_f32 v[226:227], v[226:227], v[222:223]
  v_pk_mul_f32 v[232:233], v[232:233], v[228:229]
  v_pk_mul_f32 v[234:235], v[234:235], v[230:231]
  v_cvt_pk_bf16_f32 v240, v224, v225
  v_cvt_pk_bf16_f32 v241, v226, v227
  v_cvt_pk_bf16_f32 v242, v232, v233
  v_cvt_pk_bf16_f32 v243, v234, v235
  buffer_store_dwordx4 v[240:243], v253, s[44:47], 0 offen offset:1024 sc1
  buffer_load_dwordx2 v[72:73], v3, s[44:47], s31 offen sc1
  v_pk_fma_f32 v[204:205], v[164:165], v[12:13], v[192:193] op_sel:[0,0,0] op_sel_hi:[1,0,1] neg_lo:[0,1,0] neg_hi:[0,1,0]
  v_pk_fma_f32 v[206:207], v[166:167], v[12:13], v[194:195] op_sel:[0,0,0] op_sel_hi:[1,0,1] neg_lo:[0,1,0] neg_hi:[0,1,0]
  v_pk_fma_f32 v[212:213], v[168:169], v[12:13], v[196:197] op_sel:[0,0,0] op_sel_hi:[1,0,1] neg_lo:[0,1,0] neg_hi:[0,1,0]
  v_pk_fma_f32 v[214:215], v[170:171], v[12:13], v[198:199] op_sel:[0,0,0] op_sel_hi:[1,0,1] neg_lo:[0,1,0] neg_hi:[0,1,0]
  v_pk_fma_f32 v[204:205], v[48:49], v[12:13], v[204:205] op_sel:[0,1,0] op_sel_hi:[1,1,1]
  v_pk_fma_f32 v[206:207], v[50:51], v[12:13], v[206:207] op_sel:[0,1,0] op_sel_hi:[1,1,1]
  v_pk_fma_f32 v[212:213], v[56:57], v[12:13], v[212:213] op_sel:[0,1,0] op_sel_hi:[1,1,1]
  v_pk_fma_f32 v[214:215], v[58:59], v[12:13], v[214:215] op_sel:[0,1,0] op_sel_hi:[1,1,1]
  v_exp_f32 v208, v204
  v_exp_f32 v209, v205
  v_exp_f32 v216, v212
  v_exp_f32 v217, v213
  v_exp_f32 v210, v206
  v_exp_f32 v211, v207
  v_exp_f32 v218, v214
  v_exp_f32 v219, v215
  v_pk_add_f32 v[208:209], v[208:209], s[20:21]
  v_pk_add_f32 v[210:211], v[210:211], s[20:21]
  v_pk_add_f32 v[216:217], v[216:217], s[20:21]
  v_pk_add_f32 v[218:219], v[218:219], s[20:21]
  v_pk_fma_f32 v[208:209], v[208:209], v[208:209], s[20:21]
  v_pk_fma_f32 v[210:211], v[210:211], v[210:211], s[20:21]
  v_pk_fma_f32 v[216:217], v[216:217], v[216:217], s[20:21]
  v_pk_fma_f32 v[218:219], v[218:219], v[218:219], s[20:21]
  v_rcp_f32 v208, v208
  v_rcp_f32 v209, v209
  v_rcp_f32 v216, v216
  v_rcp_f32 v217, v217
  v_rcp_f32 v210, v210
  v_rcp_f32 v211, v211
  v_rcp_f32 v218, v218
  v_rcp_f32 v219, v219
  v_pk_fma_f32 v[208:209], v[208:209], s[22:23], s[22:23] op_sel:[0,1,0] op_sel_hi:[1,1,0]
  v_pk_fma_f32 v[210:211], v[210:211], s[22:23], s[22:23] op_sel:[0,1,0] op_sel_hi:[1,1,0]
  v_pk_fma_f32 v[216:217], v[216:217], s[22:23], s[22:23] op_sel:[0,1,0] op_sel_hi:[1,1,0]
  v_pk_fma_f32 v[218:219], v[218:219], s[22:23], s[22:23] op_sel:[0,1,0] op_sel_hi:[1,1,0]
  v_pk_mul_f32 v[208:209], v[208:209], v[204:205]
  v_pk_mul_f32 v[210:211], v[210:211], v[206:207]
  v_pk_mul_f32 v[216:217], v[216:217], v[212:213]
  v_pk_mul_f32 v[218:219], v[218:219], v[214:215]
  v_cvt_pk_bf16_f32 v236, v208, v209
  v_cvt_pk_bf16_f32 v237, v210, v211
  v_cvt_pk_bf16_f32 v238, v216, v217
  v_cvt_pk_bf16_f32 v239, v218, v219
  buffer_store_dwordx4 v[236:239], v252, s[44:47], 0 offen offset:2048 sc1
  s_waitcnt vmcnt(2)
  buffer_store_dwordx2 v[4:5], v6, s[44:47], s30 offen offset:8 sc1
  s_waitcnt vmcnt(2)
  v_cmp_ne_u64 vcc, s[10:11], v[72:73]
  s_nop 0
  s_and_b32 s12, vcc_lo, 0x11111111
  s_cbranch_scc1 RSg22f0
BSg22f0:
  v_pk_fma_f32 v[220:221], v[164:165], v[14:15], v[192:193] op_sel:[0,0,0] op_sel_hi:[1,0,1] neg_lo:[0,1,0] neg_hi:[0,1,0]
  v_pk_fma_f32 v[222:223], v[166:167], v[14:15], v[194:195] op_sel:[0,0,0] op_sel_hi:[1,0,1] neg_lo:[0,1,0] neg_hi:[0,1,0]
  v_pk_fma_f32 v[228:229], v[168:169], v[14:15], v[196:197] op_sel:[0,0,0] op_sel_hi:[1,0,1] neg_lo:[0,1,0] neg_hi:[0,1,0]
  v_pk_fma_f32 v[230:231], v[170:171], v[14:15], v[198:199] op_sel:[0,0,0] op_sel_hi:[1,0,1] neg_lo:[0,1,0] neg_hi:[0,1,0]
  buffer_load_dwordx4 v[80:83], v8, s[44:47], s52 offen sc1
  v_pk_fma_f32 v[220:221], v[52:53], v[14:15], v[220:221] op_sel:[0,1,0] op_sel_hi:[1,1,1]
  v_pk_fma_f32 v[222:223], v[54:55], v[14:15], v[222:223] op_sel:[0,1,0] op_sel_hi:[1,1,1]
  v_pk_fma_f32 v[228:229], v[60:61], v[14:15], v[228:229] op_sel:[0,1,0] op_sel_hi:[1,1,1]
  v_pk_fma_f32 v[230:231], v[62:63], v[14:15], v[230:231] op_sel:[0,1,0] op_sel_hi:[1,1,1]
  buffer_load_dwordx4 v[84:87], v9, s[44:47], s52 offen sc1
  v_exp_f32 v224, v220
  v_exp_f32 v225, v221
  v_exp_f32 v232, v228
  v_exp_f32 v233, v229
  buffer_load_dwordx4 v[88:91], v10, s[44:47], s52 offen sc1
  v_exp_f32 v226, v222
  v_exp_f32 v227, v223
  v_exp_f32 v234, v230
  v_exp_f32 v235, v231
  buffer_load_dwordx4 v[92:95], v11, s[44:47], s52 offen sc1
  v_pk_add_f32 v[224:225], v[224:225], s[20:21]
  v_pk_add_f32 v[226:227], v[226:227], s[20:21]
  v_pk_add_f32 v[232:233], v[232:233], s[20:21]
  v_pk_add_f32 v[234:235], v[234:235], s[20:21]
  buffer_load_dwordx4 v[96:99], v8, s[44:47], s53 offen sc1
  v_pk_fma_f32 v[224:225], v[224:225], v[224:225], s[20:21]
  v_pk_fma_f32 v[226:227], v[226:227], v[226:227], s[20:21]
  v_pk_fma_f32 v[232:233], v[232:233], v[232:233], s[20:21]
  v_pk_fma_f32 v[234:235], v[234:235], v[234:235], s[20:21]
  buffer_load_dwordx4 v[100:103], v9, s[44:47], s53 offen sc1
  v_rcp_f32 v224, v224
  v_rcp_f32 v225, v225
  v_rcp_f32 v232, v232
  v_rcp_f32 v233, v233
  buffer_load_dwordx4 v[104:107], v10, s[44:47], s53 offen sc1
  v_rcp_f32 v226, v226
  v_rcp_f32 v227, v227
  v_rcp_f32 v234, v234
  v_rcp_f32 v235, v235
  buffer_load_dwordx4 v[108:111], v11, s[44:47], s53 offen sc1
  v_pk_fma_f32 v[224:225], v[224:225], s[22:23], s[22:23] op_sel:[0,1,0] op_sel_hi:[1,1,0]
  v_pk_fma_f32 v[226:227], v[226:227], s[22:23], s[22:23] op_sel:[0,1,0] op_sel_hi:[1,1,0]
  v_pk_fma_f32 v[232:233], v[232:233], s[22:23], s[22:23] op_sel:[0,1,0] op_sel_hi:[1,1,0]
  v_pk_fma_f32 v[234:235], v[234:235], s[22:23], s[22:23] op_sel:[0,1,0] op_sel_hi:[1,1,0]
  v_pk_mul_f32 v[224:225], v[224:225], v[220:221]
  v_pk_mul_f32 v[226:227], v[226:227], v[222:223]
  v_pk_mul_f32 v[232:233], v[232:233], v[228:229]
  v_pk_mul_f32 v[234:235], v[234:235], v[230:231]
  v_cvt_pk_bf16_f32 v240, v224, v225
  v_cvt_pk_bf16_f32 v241, v226, v227
  v_cvt_pk_bf16_f32 v242, v232, v233
  v_cvt_pk_bf16_f32 v243, v234, v235
  buffer_store_dwordx4 v[240:243], v253, s[44:47], 0 offen offset:2048 sc1
  v_pk_fma_f32 v[204:205], v[172:173], v[12:13], v[200:201] op_sel:[0,0,0] op_sel_hi:[1,0,1] neg_lo:[0,1,0] neg_hi:[0,1,0]
  v_pk_fma_f32 v[206:207], v[174:175], v[12:13], v[202:203] op_sel:[0,0,0] op_sel_hi:[1,0,1] neg_lo:[0,1,0] neg_hi:[0,1,0]
  v_pk_fma_f32 v[212:213], v[172:173], v[14:15], v[200:201] op_sel:[0,0,0] op_sel_hi:[1,0,1] neg_lo:[0,1,0] neg_hi:[0,1,0]
  v_pk_fma_f32 v[214:215], v[174:175], v[14:15], v[202:203] op_sel:[0,0,0] op_sel_hi:[1,0,1] neg_lo:[0,1,0] neg_hi:[0,1,0]
  buffer_load_dwordx2 v[74:75], v3, s[44:47], s31 offen sc1
  v_pk_fma_f32 v[204:205], v[64:65], v[12:13], v[204:205] op_sel:[0,1,0] op_sel_hi:[1,1,1]
  v_pk_fma_f32 v[206:207], v[66:67], v[12:13], v[206:207] op_sel:[0,1,0] op_sel_hi:[1,1,1]
  v_pk_fma_f32 v[212:213], v[68:69], v[14:15], v[212:213] op_sel:[0,1,0] op_sel_hi:[1,1,1]
  v_pk_fma_f32 v[214:215], v[70:71], v[14:15], v[214:215] op_sel:[0,1,0] op_sel_hi:[1,1,1]
  buffer_load_dwordx4 v[112:115], v8, s[44:47], s54 offen sc1
  v_exp_f32 v208, v204
  v_exp_f32 v209, v205
  v_exp_f32 v216, v212
  v_exp_f32 v217, v213
  buffer_load_dwordx4 v[116:119], v9, s[44:47], s54 offen sc1
  v_exp_f32 v210, v206
  v_exp_f32 v211, v207
  v_exp_f32 v218, v214
  v_exp_f32 v219, v215
  buffer_load_dwordx4 v[120:123], v10, s[44:47], s54 offen sc1
  v_pk_add_f32 v[208:209], v[208:209], s[20:21]
  v_pk_add_f32 v[210:211], v[210:211], s[20:21]
  v_pk_add_f32 v[216:217], v[216:217], s[20:21]
  v_pk_add_f32 v[218:219], v[218:219], s[20:21]
  buffer_load_dwordx4 v[124:127], v11, s[44:47], s54 offen sc1
  v_pk_fma_f32 v[208:209], v[208:209], v[208:209], s[20:21]
  v_pk_fma_f32 v[210:211], v[210:211], v[210:211], s[20:21]
  v_pk_fma_f32 v[216:217], v[216:217], v[216:217], s[20:21]
  v_pk_fma_f32 v[218:219], v[218:219], v[218:219], s[20:21]
  buffer_load_dwordx4 v[128:131], v8, s[44:47], s55 offen sc1
  v_rcp_f32 v208, v208
  v_rcp_f32 v209, v209
  v_rcp_f32 v216, v216
  v_rcp_f32 v217, v217
  buffer_load_dwordx4 v[132:135], v9, s[44:47], s55 offen sc1
  v_rcp_f32 v210, v210
  v_rcp_f32 v211, v211
  v_rcp_f32 v218, v218
  v_rcp_f32 v219, v219
  buffer_load_dwordx4 v[136:139], v10, s[44:47], s55 offen sc1
  v_pk_fma_f32 v[208:209], v[208:209], s[22:23], s[22:23] op_sel:[0,1,0] op_sel_hi:[1,1,0]
  v_pk_fma_f32 v[210:211], v[210:211], s[22:23], s[22:23] op_sel:[0,1,0] op_sel_hi:[1,1,0]
  v_pk_fma_f32 v[216:217], v[216:217], s[22:23], s[22:23] op_sel:[0,1,0] op_sel_hi:[1,1,0]
  v_pk_fma_f32 v[218:219], v[218:219], s[22:23], s[22:23] op_sel:[0,1,0] op_sel_hi:[1,1,0]
  buffer_load_dwordx4 v[140:143], v11, s[44:47], s55 offen sc1
  v_pk_mul_f32 v[208:209], v[208:209], v[204:205]
  v_pk_mul_f32 v[210:211], v[210:211], v[206:207]
  v_pk_mul_f32 v[216:217], v[216:217], v[212:213]
  v_pk_mul_f32 v[218:219], v[218:219], v[214:215]
  v_cvt_pk_bf16_f32 v236, v208, v209
  v_cvt_pk_bf16_f32 v237, v210, v211
  v_cvt_pk_bf16_f32 v238, v216, v217
  v_cvt_pk_bf16_f32 v239, v218, v219
  s_nop 0
  v_permlane16_swap_b32 v236, v238
  v_permlane16_swap_b32 v237, v239
  buffer_store_dwordx4 v[236:239], v254, s[44:47], 0 offen sc1
  s_lshl_b32 s12, s7, 1
  s_lshr_b32 s13, s3, 1
  s_add_u32 s12, s12, s13
  s_mul_i32 s12, s12, 33024
  s_lshl_b32 s13, s8, 12
  s_add_u32 s12, s12, s13
  s_and_b32 s13, s3, 1
  s_lshl_b32 s13, s13, 2
  s_add_u32 s12, s12, s13
  s_add_u32 s17, s12, 0x210000
  v_lshlrev_b32 v7, 4, v2
  s_waitcnt vmcnt(9)
  v_cmp_ne_u64 vcc, s[10:11], v[74:75]
  s_nop 0
  s_and_b32 s12, vcc_lo, 0x22222222
  s_cbranch_scc1 RSg22f1
BSg22f1:
  v_mfma_f32_16x16x32_bf16 v[16:19], a[0:3], v[80:83], 0
  buffer_load_dwordx4 v[144:147], v8, s[44:47], s56 offen sc1
  v_mfma_f32_16x16x32_bf16 v[20:23], a[4:7], v[80:83], 0
  v_mfma_f32_16x16x32_bf16 v[24:27], a[8:11], v[80:83], 0
  v_mfma_f32_16x16x32_bf16 v[28:31], a[12:15], v[80:83], 0
  v_mfma_f32_16x16x32_bf16 v[32:35], a[0:3], v[84:87], 0
  buffer_store_dwordx2 v[4:5], v6, s[44:47], s30 offen offset:16 sc1
  v_mfma_f32_16x16x32_bf16 v[36:39], a[4:7], v[84:87], 0
  v_mfma_f32_16x16x32_bf16 v[40:43], a[8:11], v[84:87], 0
  v_mfma_f32_16x16x32_bf16 v[44:47], a[12:15], v[84:87], 0
  buffer_load_dwordx4 v[148:151], v9, s[44:47], s56 offen sc1
  v_mfma_f32_16x16x32_bf16 v[48:51], a[0:3], v[88:91], 0
  v_mfma_f32_16x16x32_bf16 v[52:55], a[4:7], v[88:91], 0
  v_mfma_f32_16x16x32_bf16 v[56:59], a[8:11], v[88:91], 0
  s_waitcnt vmcnt(3)
  buffer_store_dwordx2 v[4:5], v6, s[44:47], s30 offen offset:24 sc1
  v_mfma_f32_16x16x32_bf16 v[60:63], a[12:15], v[88:91], 0
  v_mfma_f32_16x16x32_bf16 v[64:67], a[0:3], v[92:95], 0
  v_mfma_f32_16x16x32_bf16 v[68:71], a[4:7], v[92:95], 0
  buffer_load_dwordx4 v[152:155], v10, s[44:47], s56 offen sc1
  v_mfma_f32_16x16x32_bf16 v[72:75], a[8:11], v[92:95], 0
  v_mfma_f32_16x16x32_bf16 v[76:79], a[12:15], v[92:95], 0
  v_mfma_f32_16x16x32_bf16 v[16:19], a[16:19], v[96:99], v[16:19]
  buffer_load_dwordx4 v[156:159], v11, s[44:47], s56 offen sc1
  v_mfma_f32_16x16x32_bf16 v[20:23], a[20:23], v[96:99], v[20:23]
  v_mfma_f32_16x16x32_bf16 v[24:27], a[24:27], v[96:99], v[24:27]
  v_mfma_f32_16x16x32_bf16 v[28:31], a[28:31], v[96:99], v[28:31]
  v_mfma_f32_16x16x32_bf16 v[32:35], a[16:19], v[100:103], v[32:35]
  buffer_load_dwordx2 v[12:13], v3, s[44:47], s31 offen sc1
  v_mfma_f32_16x16x32_bf16 v[36:39], a[20:23], v[100:103], v[36:39]
  v_mfma_f32_16x16x32_bf16 v[40:43], a[24:27], v[100:103], v[40:43]
  v_mfma_f32_16x16x32_bf16 v[44:47], a[28:31], v[100:103], v[44:47]
  buffer_load_dwordx4 v[160:163], v8, s[44:47], s57 offen sc1
  v_mfma_f32_16x16x32_bf16 v[48:51], a[16:19], v[104:107], v[48:51]
  v_mfma_f32_16x16x32_bf16 v[52:55], a[20:23], v[104:107], v[52:55]
  v_mfma_f32_16x16x32_bf16 v[56:59], a[24:27], v[104:107], v[56:59]
  buffer_load_dwordx4 v[164:167], v9, s[44:47], s57 offen sc1
  v_mfma_f32_16x16x32_bf16 v[60:63], a[28:31], v[104:107], v[60:63]
  v_mfma_f32_16x16x32_bf16 v[64:67], a[16:19], v[108:111], v[64:67]
  v_mfma_f32_16x16x32_bf16 v[68:71], a[20:23], v[108:111], v[68:71]
  buffer_load_dwordx4 v[168:171], v10, s[44:47], s57 offen sc1
  v_mfma_f32_16x16x32_bf16 v[72:75], a[24:27], v[108:111], v[72:75]
  v_mfma_f32_16x16x32_bf16 v[76:79], a[28:31], v[108:111], v[76:79]
  v_mfma_f32_16x16x32_bf16 v[16:19], a[32:35], v[112:115], v[16:19]
  buffer_load_dwordx4 v[172:175], v11, s[44:47], s57 offen sc1
  v_mfma_f32_16x16x32_bf16 v[20:23], a[36:39], v[112:115], v[20:23]
  v_mfma_f32_16x16x32_bf16 v[24:27], a[40:43], v[112:115], v[24:27]
  v_mfma_f32_16x16x32_bf16 v[28:31], a[44:47], v[112:115], v[28:31]
  v_mfma_f32_16x16x32_bf16 v[32:35], a[32:35], v[116:119], v[32:35]
  buffer_load_dwordx4 v[176:179], v8, s[44:47], s58 offen sc1
  v_mfma_f32_16x16x32_bf16 v[36:39], a[36:39], v[116:119], v[36:39]
  v_mfma_f32_16x16x32_bf16 v[40:43], a[40:43], v[116:119], v[40:43]
  v_mfma_f32_16x16x32_bf16 v[44:47], a[44:47], v[116:119], v[44:47]
  buffer_load_dwordx4 v[180:183], v9, s[44:47], s58 offen sc1
  v_mfma_f32_16x16x32_bf16 v[48:51], a[32:35], v[120:123], v[48:51]
  v_mfma_f32_16x16x32_bf16 v[52:55], a[36:39], v[120:123], v[52:55]
  v_mfma_f32_16x16x32_bf16 v[56:59], a[40:43], v[120:123], v[56:59]
  buffer_load_dwordx4 v[184:187], v10, s[44:47], s58 offen sc1
  v_mfma_f32_16x16x32_bf16 v[60:63], a[44:47], v[120:123], v[60:63]
  v_mfma_f32_16x16x32_bf16 v[64:67], a[32:35], v[124:127], v[64:67]
  v_mfma_f32_16x16x32_bf16 v[68:71], a[36:39], v[124:127], v[68:71]
  buffer_load_dwordx4 v[188:191], v11, s[44:47], s58 offen sc1
  v_mfma_f32_16x16x32_bf16 v[72:75], a[40:43], v[124:127], v[72:75]
  v_mfma_f32_16x16x32_bf16 v[76:79], a[44:47], v[124:127], v[76:79]
  v_mfma_f32_16x16x32_bf16 v[16:19], a[48:51], v[128:131], v[16:19]
  buffer_load_dwordx4 v[192:195], v8, s[44:47], s59 offen sc1
  v_mfma_f32_16x16x32_bf16 v[20:23], a[52:55], v[128:131], v[20:23]
  v_mfma_f32_16x16x32_bf16 v[24:27], a[56:59], v[128:131], v[24:27]
  v_mfma_f32_16x16x32_bf16 v[28:31], a[60:63], v[128:131], v[28:31]
  v_mfma_f32_16x16x32_bf16 v[32:35], a[48:51], v[132:135], v[32:35]
  buffer_load_dwordx4 v[196:199], v9, s[44:47], s59 offen sc1
  v_mfma_f32_16x16x32_bf16 v[36:39], a[52:55], v[132:135], v[36:39]
  v_mfma_f32_16x16x32_bf16 v[40:43], a[56:59], v[132:135], v[40:43]
  v_mfma_f32_16x16x32_bf16 v[44:47], a[60:63], v[132:135], v[44:47]
  buffer_load_dwordx4 v[200:203], v10, s[44:47], s59 offen sc1
  v_mfma_f32_16x16x32_bf16 v[48:51], a[48:51], v[136:139], v[48:51]
  v_mfma_f32_16x16x32_bf16 v[52:55], a[52:55], v[136:139], v[52:55]
  v_mfma_f32_16x16x32_bf16 v[56:59], a[56:59], v[136:139], v[56:59]
  buffer_load_dwordx4 v[204:207], v11, s[44:47], s59 offen sc1
  v_mfma_f32_16x16x32_bf16 v[60:63], a[60:63], v[136:139], v[60:63]
  v_mfma_f32_16x16x32_bf16 v[64:67], a[48:51], v[140:143], v[64:67]
  v_mfma_f32_16x16x32_bf16 v[68:71], a[52:55], v[140:143], v[68:71]
  s_waitcnt vmcnt(12)
  v_cmp_ne_u64 vcc, s[10:11], v[12:13]
  s_nop 0
  s_and_b32 s12, vcc_lo, 0x44444444
  s_cbranch_scc1 RSg22f2
BSg22f2:
  v_mfma_f32_16x16x32_bf16 v[72:75], a[56:59], v[140:143], v[72:75]
  v_mfma_f32_16x16x32_bf16 v[76:79], a[60:63], v[140:143], v[76:79]
  v_mfma_f32_16x16x32_bf16 v[16:19], a[64:67], v[144:147], v[16:19]
  buffer_load_dwordx4 v[208:211], v8, s[44:47], s60 offen sc1
  v_mfma_f32_16x16x32_bf16 v[20:23], a[68:71], v[144:147], v[20:23]
  v_mfma_f32_16x16x32_bf16 v[24:27], a[72:75], v[144:147], v[24:27]
  v_mfma_f32_16x16x32_bf16 v[28:31], a[76:79], v[144:147], v[28:31]
  v_mfma_f32_16x16x32_bf16 v[32:35], a[64:67], v[148:151], v[32:35]
  buffer_load_dwordx4 v[212:215], v9, s[44:47], s60 offen sc1
  v_mfma_f32_16x16x32_bf16 v[36:39], a[68:71], v[148:151], v[36:39]
  v_mfma_f32_16x16x32_bf16 v[40:43], a[72:75], v[148:151], v[40:43]
  v_mfma_f32_16x16x32_bf16 v[44:47], a[76:79], v[148:151], v[44:47]
  buffer_load_dwordx4 v[216:219], v10, s[44:47], s60 offen sc1
  v_mfma_f32_16x16x32_bf16 v[48:51], a[64:67], v[152:155], v[48:51]
  v_mfma_f32_16x16x32_bf16 v[52:55], a[68:71], v[152:155], v[52:55]
  v_mfma_f32_16x16x32_bf16 v[56:59], a[72:75], v[152:155], v[56:59]
  buffer_load_dwordx4 v[220:223], v11, s[44:47], s60 offen sc1
  v_mfma_f32_16x16x32_bf16 v[60:63], a[76:79], v[152:155], v[60:63]
  v_mfma_f32_16x16x32_bf16 v[64:67], a[64:67], v[156:159], v[64:67]
  v_mfma_f32_16x16x32_bf16 v[68:71], a[68:71], v[156:159], v[68:71]
  buffer_load_dwordx2 v[12:13], v3, s[44:47], s31 offen sc1
  v_mfma_f32_16x16x32_bf16 v[72:75], a[72:75], v[156:159], v[72:75]
  v_mfma_f32_16x16x32_bf16 v[76:79], a[76:79], v[156:159], v[76:79]
  s_waitcnt vmcnt(13)
  v_mfma_f32_16x16x32_bf16 v[16:19], a[80:83], v[160:163], v[16:19]
  buffer_load_dwordx4 v[224:227], v8, s[44:47], s61 offen sc1
  v_mfma_f32_16x16x32_bf16 v[20:23], a[84:87], v[160:163], v[20:23]
  v_mfma_f32_16x16x32_bf16 v[24:27], a[88:91], v[160:163], v[24:27]
  v_mfma_f32_16x16x32_bf16 v[28:31], a[92:95], v[160:163], v[28:31]
  v_mfma_f32_16x16x32_bf16 v[32:35], a[80:83], v[164:167], v[32:35]
  buffer_load_dwordx4 v[228:231], v9, s[44:47], s61 offen sc1
  v_mfma_f32_16x16x32_bf16 v[36:39], a[84:87], v[164:167], v[36:39]
  v_mfma_f32_16x16x32_bf16 v[40:43], a[88:91], v[164:167], v[40:43]
  v_mfma_f32_16x16x32_bf16 v[44:47], a[92:95], v[164:167], v[44:47]
  buffer_load_dwordx4 v[232:235], v10, s[44:47], s61 offen sc1
  v_mfma_f32_16x16x32_bf16 v[48:51], a[80:83], v[168:171], v[48:51]
  v_mfma_f32_16x16x32_bf16 v[52:55], a[84:87], v[168:171], v[52:55]
  v_mfma_f32_16x16x32_bf16 v[56:59], a[88:91], v[168:171], v[56:59]
  buffer_load_dwordx4 v[236:239], v11, s[44:47], s61 offen sc1
  v_mfma_f32_16x16x32_bf16 v[60:63], a[92:95], v[168:171], v[60:63]
  v_mfma_f32_16x16x32_bf16 v[64:67], a[80:83], v[172:175], v[64:67]
  v_mfma_f32_16x16x32_bf16 v[68:71], a[84:87], v[172:175], v[68:71]
  buffer_load_dwordx4 v[240:243], v8, s[44:47], s62 offen sc1
  v_mfma_f32_16x16x32_bf16 v[72:75], a[88:91], v[172:175], v[72:75]
  v_mfma_f32_16x16x32_bf16 v[76:79], a[92:95], v[172:175], v[76:79]
  s_waitcnt vmcnt(14)
  v_mfma_f32_16x16x32_bf16 v[16:19], a[96:99], v[176:179], v[16:19]
  buffer_load_dwordx4 v[244:247], v9, s[44:47], s62 offen sc1
  v_mfma_f32_16x16x32_bf16 v[20:23], a[100:103], v[176:179], v[20:23]
  v_mfma_f32_16x16x32_bf16 v[24:27], a[104:107], v[176:179], v[24:27]
  v_mfma_f32_16x16x32_bf16 v[28:31], a[108:111], v[176:179], v[28:31]
  v_mfma_f32_16x16x32_bf16 v[32:35], a[96:99], v[180:183], v[32:35]
  buffer_load_dwordx4 v[248:251], v10, s[44:47], s62 offen sc1
  v_mfma_f32_16x16x32_bf16 v[36:39], a[100:103], v[180:183], v[36:39]
  v_mfma_f32_16x16x32_bf16 v[40:43], a[104:107], v[180:183], v[40:43]
  v_mfma_f32_16x16x32_bf16 v[44:47], a[108:111], v[180:183], v[44:47]
  buffer_load_dwordx4 v[252:255], v11, s[44:47], s62 offen sc1
  v_mfma_f32_16x16x32_bf16 v[48:51], a[96:99], v[184:187], v[48:51]
  v_mfma_f32_16x16x32_bf16 v[52:55], a[100:103], v[184:187], v[52:55]
  v_mfma_f32_16x16x32_bf16 v[56:59], a[104:107], v[184:187], v[56:59]
  buffer_load_dwordx4 v[80:83], v8, s[44:47], s63 offen sc1
  v_mfma_f32_16x16x32_bf16 v[60:63], a[108:111], v[184:187], v[60:63]
  v_mfma_f32_16x16x32_bf16 v[64:67], a[96:99], v[188:191], v[64:67]
  v_mfma_f32_16x16x32_bf16 v[68:71], a[100:103], v[188:191], v[68:71]
  buffer_load_dwordx4 v[84:87], v9, s[44:47], s63 offen sc1
  v_mfma_f32_16x16x32_bf16 v[72:75], a[104:107], v[188:191], v[72:75]
  v_mfma_f32_16x16x32_bf16 v[76:79], a[108:111], v[188:191], v[76:79]
  s_waitcnt vmcnt(15)
  v_mfma_f32_16x16x32_bf16 v[16:19], a[112:115], v[192:195], v[16:19]
  buffer_load_dwordx4 v[88:91], v10, s[44:47], s63 offen sc1
  v_mfma_f32_16x16x32_bf16 v[20:23], a[116:119], v[192:195], v[20:23]
  v_mfma_f32_16x16x32_bf16 v[24:27], a[120:123], v[192:195], v[24:27]
  v_mfma_f32_16x16x32_bf16 v[28:31], a[124:127], v[192:195], v[28:31]
  v_mfma_f32_16x16x32_bf16 v[32:35], a[112:115], v[196:199], v[32:35]
  buffer_load_dwordx4 v[92:95], v11, s[44:47], s63 offen sc1
  v_mfma_f32_16x16x32_bf16 v[36:39], a[116:119], v[196:199], v[36:39]
  v_mfma_f32_16x16x32_bf16 v[40:43], a[120:123], v[196:199], v[40:43]
  v_mfma_f32_16x16x32_bf16 v[44:47], a[124:127], v[196:199], v[44:47]
  s_waitcnt vmcnt(12)
  v_cmp_ne_u64 vcc, s[10:11], v[12:13]
  s_nop 0
  s_and_b32 s12, vcc_lo, 0x88888888
  s_cbranch_scc1 RSg22f3
BSg22f3:
  v_mfma_f32_16x16x32_bf16 v[48:51], a[112:115], v[200:203], v[48:51]
  v_mfma_f32_16x16x32_bf16 v[52:55], a[116:119], v[200:203], v[52:55]
  v_mfma_f32_16x16x32_bf16 v[56:59], a[120:123], v[200:203], v[56:59]
  s_add_u32 s12, s3, 0
  v_mfma_f32_16x16x32_bf16 v[60:63], a[124:127], v[200:203], v[60:63]
  s_and_b32 s12, s12, 3
  s_mul_i32 s13, s12, 12288
  v_mfma_f32_16x16x32_bf16 v[64:67], a[112:115], v[204:207], v[64:67]
  s_add_u32 s13, s13, 114688
  v_lshl_add_u32 v3, v2, 4, s13
  v_mfma_f32_16x16x32_bf16 v[68:71], a[116:119], v[204:207], v[68:71]
  buffer_load_dwordx4 v[96:99], v8, s[44:47], s64 offen sc1
  s_add_u32 s12, s3, 1
  v_mfma_f32_16x16x32_bf16 v[72:75], a[120:123], v[204:207], v[72:75]
  s_and_b32 s12, s12, 3
  s_mul_i32 s13, s12, 12288
  v_mfma_f32_16x16x32_bf16 v[76:79], a[124:127], v[204:207], v[76:79]
  s_add_u32 s18, s13, 114688
  v_lshl_add_u32 v4, v2, 4, s18
  v_mfma_f32_16x16x32_bf16 v[16:19], a[128:131], v[208:211], v[16:19]
  buffer_load_dwordx4 v[100:103], v9, s[44:47], s64 offen sc1
  s_add_u32 s12, s3, 2
  v_mfma_f32_16x16x32_bf16 v[20:23], a[132:135], v[208:211], v[20:23]
  s_and_b32 s12, s12, 3
  s_mul_i32 s13, s12, 12288
  v_mfma_f32_16x16x32_bf16 v[24:27], a[136:139], v[208:211], v[24:27]
  s_add_u32 s13, s13, 114688
  v_lshl_add_u32 v5, v2, 4, s13
  v_mfma_f32_16x16x32_bf16 v[28:31], a[140:143], v[208:211], v[28:31]
  s_add_u32 s12, s3, 3
  s_and_b32 s12, s12, 3
  v_mfma_f32_16x16x32_bf16 v[32:35], a[128:131], v[212:215], v[32:35]
  buffer_load_dwordx4 v[104:107], v10, s[44:47], s64 offen sc1
  s_mul_i32 s13, s12, 12288
  v_mfma_f32_16x16x32_bf16 v[36:39], a[132:135], v[212:215], v[36:39]
  s_add_u32 s13, s13, 114688
  v_lshl_add_u32 v6, v2, 4, s13
  v_mfma_f32_16x16x32_bf16 v[40:43], a[136:139], v[212:215], v[40:43]
  v_mfma_f32_16x16x32_bf16 v[44:47], a[140:143], v[212:215], v[44:47]
  buffer_load_dwordx4 v[108:111], v11, s[44:47], s64 offen sc1
  v_mfma_f32_16x16x32_bf16 v[48:51], a[128:131], v[216:219], v[48:51]
  v_mfma_f32_16x16x32_bf16 v[52:55], a[132:135], v[216:219], v[52:55]
  v_mfma_f32_16x16x32_bf16 v[56:59], a[136:139], v[216:219], v[56:59]
  buffer_load_dwordx4 v[112:115], v8, s[44:47], s65 offen sc1
  v_mfma_f32_16x16x32_bf16 v[60:63], a[140:143], v[216:219], v[60:63]
  v_mfma_f32_16x16x32_bf16 v[64:67], a[128:131], v[220:223], v[64:67]
  v_mfma_f32_16x16x32_bf16 v[68:71], a[132:135], v[220:223], v[68:71]
  buffer_load_dwordx4 v[116:119], v9, s[44:47], s65 offen sc1
  v_mfma_f32_16x16x32_bf16 v[72:75], a[136:139], v[220:223], v[72:75]
  v_mfma_f32_16x16x32_bf16 v[76:79], a[140:143], v[220:223], v[76:79]
  s_waitcnt vmcnt(14)
  v_mfma_f32_16x16x32_bf16 v[16:19], a[144:147], v[224:227], v[16:19]
  buffer_load_dwordx4 v[120:123], v10, s[44:47], s65 offen sc1
  v_mfma_f32_16x16x32_bf16 v[20:23], a[148:151], v[224:227], v[20:23]
  v_mfma_f32_16x16x32_bf16 v[24:27], a[152:155], v[224:227], v[24:27]
  v_mfma_f32_16x16x32_bf16 v[28:31], a[156:159], v[224:227], v[28:31]
  v_mfma_f32_16x16x32_bf16 v[32:35], a[144:147], v[228:231], v[32:35]
  buffer_load_dwordx4 v[124:127], v11, s[44:47], s65 offen sc1
  v_mfma_f32_16x16x32_bf16 v[36:39], a[148:151], v[228:231], v[36:39]
  v_mfma_f32_16x16x32_bf16 v[40:43], a[152:155], v[228:231], v[40:43]
  v_mfma_f32_16x16x32_bf16 v[44:47], a[156:159], v[228:231], v[44:47]
  buffer_load_dwordx3 v[128:130], v7, s[44:47], s17 offen offset:0 sc1
  v_mfma_f32_16x16x32_bf16 v[48:51], a[144:147], v[232:235], v[48:51]
  v_mfma_f32_16x16x32_bf16 v[52:55], a[148:151], v[232:235], v[52:55]
  v_mfma_f32_16x16x32_bf16 v[56:59], a[152:155], v[232:235], v[56:59]
  buffer_load_dwordx3 v[132:134], v7, s[44:47], s17 offen offset:1024 sc1
  v_mfma_f32_16x16x32_bf16 v[60:63], a[156:159], v[232:235], v[60:63]
  v_mfma_f32_16x16x32_bf16 v[64:67], a[144:147], v[236:239], v[64:67]
  v_mfma_f32_16x16x32_bf16 v[68:71], a[148:151], v[236:239], v[68:71]
  buffer_load_dwordx3 v[136:138], v7, s[44:47], s17 offen offset:2048 sc1
  v_mfma_f32_16x16x32_bf16 v[72:75], a[152:155], v[236:239], v[72:75]
  v_mfma_f32_16x16x32_bf16 v[76:79], a[156:159], v[236:239], v[76:79]
  s_waitcnt vmcnt(15)
  v_mfma_f32_16x16x32_bf16 v[16:19], a[160:163], v[240:243], v[16:19]
  buffer_load_dwordx3 v[140:142], v7, s[44:47], s17 offen offset:3072 sc1
  v_mfma_f32_16x16x32_bf16 v[20:23], a[164:167], v[240:243], v[20:23]
  v_mfma_f32_16x16x32_bf16 v[24:27], a[168:171], v[240:243], v[24:27]
  v_mfma_f32_16x16x32_bf16 v[28:31], a[172:175], v[240:243], v[28:31]
  v_mfma_f32_16x16x32_bf16 v[32:35], a[160:163], v[244:247], v[32:35]
  v_mfma_f32_16x16x32_bf16 v[36:39], a[164:167], v[244:247], v[36:39]
  v_mfma_f32_16x16x32_bf16 v[40:43], a[168:171], v[244:247], v[40:43]
  v_mfma_f32_16x16x32_bf16 v[44:47], a[172:175], v[244:247], v[44:47]
  v_mfma_f32_16x16x32_bf16 v[48:51], a[160:163], v[248:251], v[48:51]
  v_mfma_f32_16x16x32_bf16 v[52:55], a[164:167], v[248:251], v[52:55]
  v_mfma_f32_16x16x32_bf16 v[56:59], a[168:171], v[248:251], v[56:59]
  v_mfma_f32_16x16x32_bf16 v[60:63], a[172:175], v[248:251], v[60:63]
  v_mfma_f32_16x16x32_bf16 v[64:67], a[160:163], v[252:255], v[64:67]
  v_mfma_f32_16x16x32_bf16 v[68:71], a[164:167], v[252:255], v[68:71]
  v_mfma_f32_16x16x32_bf16 v[72:75], a[168:171], v[252:255], v[72:75]
  v_mfma_f32_16x16x32_bf16 v[76:79], a[172:175], v[252:255], v[76:79]
  s_waitcnt vmcnt(12)
  v_mfma_f32_16x16x32_bf16 v[16:19], a[176:179], v[80:83], v[16:19]
  v_mfma_f32_16x16x32_bf16 v[20:23], a[180:183], v[80:83], v[20:23]
  v_mfma_f32_16x16x32_bf16 v[24:27], a[184:187], v[80:83], v[24:27]
  v_mfma_f32_16x16x32_bf16 v[28:31], a[188:191], v[80:83], v[28:31]
  v_mfma_f32_16x16x32_bf16 v[32:35], a[176:179], v[84:87], v[32:35]
  v_mfma_f32_16x16x32_bf16 v[36:39], a[180:183], v[84:87], v[36:39]
  v_mfma_f32_16x16x32_bf16 v[40:43], a[184:187], v[84:87], v[40:43]
  v_mfma_f32_16x16x32_bf16 v[44:47], a[188:191], v[84:87], v[44:47]
  v_mfma_f32_16x16x32_bf16 v[48:51], a[176:179], v[88:91], v[48:51]
  v_mfma_f32_16x16x32_bf16 v[52:55], a[180:183], v[88:91], v[52:55]
  v_mfma_f32_16x16x32_bf16 v[56:59], a[184:187], v[88:91], v[56:59]
  v_mfma_f32_16x16x32_bf16 v[60:63], a[188:191], v[88:91], v[60:63]
  v_mfma_f32_16x16x32_bf16 v[64:67], a[176:179], v[92:95], v[64:67]
  v_mfma_f32_16x16x32_bf16 v[68:71], a[180:183], v[92:95], v[68:71]
  v_mfma_f32_16x16x32_bf16 v[72:75], a[184:187], v[92:95], v[72:75]
  v_mfma_f32_16x16x32_bf16 v[76:79], a[188:191], v[92:95], v[76:79]
  s_waitcnt vmcnt(8)
  v_mfma_f32_16x16x32_bf16 v[32:35], a[192:195], v[100:103], v[32:35]
  v_mfma_f32_16x16x32_bf16 v[36:39], a[196:199], v[100:103], v[36:39]
  v_mfma_f32_16x16x32_bf16 v[40:43], a[200:203], v[100:103], v[40:43]
  v_mfma_f32_16x16x32_bf16 v[44:47], a[204:207], v[100:103], v[44:47]
  s_waitcnt vmcnt(4)
  v_mfma_f32_16x16x32_bf16 v[32:35], a[208:211], v[116:119], v[32:35]
  v_mfma_f32_16x16x32_bf16 v[36:39], a[212:215], v[116:119], v[36:39]
  v_mfma_f32_16x16x32_bf16 v[40:43], a[216:219], v[116:119], v[40:43]
  v_mfma_f32_16x16x32_bf16 v[44:47], a[220:223], v[116:119], v[44:47]
  v_mfma_f32_16x16x32_bf16 v[48:51], a[192:195], v[104:107], v[48:51]
  v_mfma_f32_16x16x32_bf16 v[52:55], a[196:199], v[104:107], v[52:55]
  s_nop 2
  ds_write_b128 v4, v[32:35] offset:0
  v_mfma_f32_16x16x32_bf16 v[56:59], a[200:203], v[104:107], v[56:59]
  v_mfma_f32_16x16x32_bf16 v[60:63], a[204:207], v[104:107], v[60:63]
  v_mfma_f32_16x16x32_bf16 v[48:51], a[208:211], v[120:123], v[48:51]
  ds_write_b128 v4, v[36:39] offset:1024
  v_mfma_f32_16x16x32_bf16 v[52:55], a[212:215], v[120:123], v[52:55]
  v_mfma_f32_16x16x32_bf16 v[56:59], a[216:219], v[120:123], v[56:59]
  v_mfma_f32_16x16x32_bf16 v[60:63], a[220:223], v[120:123], v[60:63]
  ds_write_b128 v4, v[40:43] offset:2048
  ds_write_b128 v4, v[44:47] offset:3072
  v_mfma_f32_16x16x32_bf16 v[64:67], a[192:195], v[108:111], v[64:67]
  s_waitcnt vmcnt(0)
  v_lshlrev_b32 v144, 16, v128
  v_and_b32 v145, 0xffff0000, v128
  v_mfma_f32_16x16x32_bf16 v[68:71], a[196:199], v[108:111], v[68:71]
  ds_write_b128 v5, v[48:51] offset:4096
  v_mfma_f32_16x16x32_bf16 v[72:75], a[200:203], v[108:111], v[72:75]
  v_lshlrev_b32 v146, 16, v132
  v_and_b32 v147, 0xffff0000, v132
  v_mfma_f32_16x16x32_bf16 v[76:79], a[204:207], v[108:111], v[76:79]
  v_lshlrev_b32 v148, 16, v130
  v_and_b32 v149, 0xffff0000, v130
  v_mfma_f32_16x16x32_bf16 v[64:67], a[208:211], v[124:127], v[64:67]
  ds_write_b128 v5, v[52:55] offset:5120
  v_mfma_f32_16x16x32_bf16 v[68:71], a[212:215], v[124:127], v[68:71]
  v_lshlrev_b32 v150, 16, v134
  v_and_b32 v151, 0xffff0000, v134
  v_mfma_f32_16x16x32_bf16 v[72:75], a[216:219], v[124:127], v[72:75]
  v_lshlrev_b32 v152, 16, v136
  v_and_b32 v153, 0xffff0000, v136
  v_mfma_f32_16x16x32_bf16 v[76:79], a[220:223], v[124:127], v[76:79]
  ds_write_b128 v5, v[56:59] offset:6144
  ds_write_b128 v5, v[60:63] offset:7168
  v_mfma_f32_16x16x32_bf16 v[16:19], a[192:195], v[96:99], v[16:19]
  v_lshlrev_b32 v154, 16, v140
  v_and_b32 v155, 0xffff0000, v140
  v_mfma_f32_16x16x32_bf16 v[20:23], a[196:199], v[96:99], v[20:23]
  ds_write_b128 v6, v[64:67] offset:8192
  v_mfma_f32_16x16x32_bf16 v[24:27], a[200:203], v[96:99], v[24:27]
  v_lshlrev_b32 v156, 16, v138
  v_and_b32 v157, 0xffff0000, v138
  v_mfma_f32_16x16x32_bf16 v[28:31], a[204:207], v[96:99], v[28:31]
  v_lshlrev_b32 v158, 16, v142
  v_and_b32 v159, 0xffff0000, v142
  v_mfma_f32_16x16x32_bf16 v[16:19], a[208:211], v[112:115], v[16:19]
  ds_write_b128 v6, v[68:71] offset:9216
  v_mfma_f32_16x16x32_bf16 v[20:23], a[212:215], v[112:115], v[20:23]
  v_mfma_f32_16x16x32_bf16 v[24:27], a[216:219], v[112:115], v[24:27]
  v_mfma_f32_16x16x32_bf16 v[28:31], a[220:223], v[112:115], v[28:31]
  ds_write_b128 v6, v[72:75] offset:10240
  ds_write_b128 v6, v[76:79] offset:11264
  s_waitcnt lgkmcnt(0)
  s_barrier
  ds_read_b128 v[160:163], v3 offset:0
  ds_read_b128 v[164:167], v3 offset:1024
  ds_read_b128 v[168:171], v3 offset:2048
  ds_read_b128 v[172:175], v3 offset:3072
  ds_read_b128 v[176:179], v3 offset:4096
  ds_read_b128 v[180:183], v3 offset:5120
  ds_read_b128 v[184:187], v3 offset:6144
  ds_read_b128 v[188:191], v3 offset:7168
  ds_read_b128 v[192:195], v3 offset:8192
  ds_read_b128 v[196:199], v3 offset:9216
  ds_read_b128 v[200:203], v3 offset:10240
  ds_read_b128 v[204:207], v3 offset:11264
  v_and_b32 v4, 15, v2
  v_lshrrev_b32 v5, 4, v2
  s_waitcnt lgkmcnt(8)
  v_pk_add_f32 v[16:17], v[16:17], v[160:161]
  v_pk_add_f32 v[18:19], v[18:19], v[162:163]
  v_pk_add_f32 v[20:21], v[20:21], v[164:165]
  v_pk_add_f32 v[22:23], v[22:23], v[166:167]
  v_pk_add_f32 v[24:25], v[24:25], v[168:169]
  v_pk_add_f32 v[26:27], v[26:27], v[170:171]
  v_pk_add_f32 v[28:29], v[28:29], v[172:173]
  v_pk_add_f32 v[30:31], v[30:31], v[174:175]
  s_waitcnt lgkmcnt(4)
  v_pk_add_f32 v[16:17], v[16:17], v[176:177]
  v_pk_add_f32 v[18:19], v[18:19], v[178:179]
  v_pk_add_f32 v[20:21], v[20:21], v[180:181]
  v_pk_add_f32 v[22:23], v[22:23], v[182:183]
  v_pk_add_f32 v[24:25], v[24:25], v[184:185]
  v_pk_add_f32 v[26:27], v[26:27], v[186:187]
  v_pk_add_f32 v[28:29], v[28:29], v[188:189]
  v_pk_add_f32 v[30:31], v[30:31], v[190:191]
  s_waitcnt lgkmcnt(0)
  v_pk_add_f32 v[16:17], v[16:17], v[192:193]
  v_pk_add_f32 v[18:19], v[18:19], v[194:195]
  v_pk_add_f32 v[20:21], v[20:21], v[196:197]
  v_pk_add_f32 v[22:23], v[22:23], v[198:199]
  v_pk_add_f32 v[24:25], v[24:25], v[200:201]
  v_pk_add_f32 v[26:27], v[26:27], v[202:203]
  v_pk_add_f32 v[28:29], v[28:29], v[204:205]
  v_pk_add_f32 v[30:31], v[30:31], v[206:207]
  v_cvt_pk_bf16_f32 v16, v16, v17
  v_cvt_pk_bf16_f32 v18, v18, v19
  v_cvt_pk_bf16_f32 v20, v20, v21
  v_cvt_pk_bf16_f32 v22, v22, v23
  v_cvt_pk_bf16_f32 v24, v24, v25
  v_cvt_pk_bf16_f32 v26, v26, v27
  v_cvt_pk_bf16_f32 v28, v28, v29
  v_cvt_pk_bf16_f32 v30, v30, v31
  v_and_b32 v17, 0xffff0000, v16
  v_lshlrev_b32 v16, 16, v16
  v_and_b32 v19, 0xffff0000, v18
  v_lshlrev_b32 v18, 16, v18
  v_and_b32 v21, 0xffff0000, v20
  v_lshlrev_b32 v20, 16, v20
  v_and_b32 v23, 0xffff0000, v22
  v_lshlrev_b32 v22, 16, v22
  v_and_b32 v25, 0xffff0000, v24
  v_lshlrev_b32 v24, 16, v24
  v_and_b32 v27, 0xffff0000, v26
  v_lshlrev_b32 v26, 16, v26
  v_and_b32 v29, 0xffff0000, v28
  v_lshlrev_b32 v28, 16, v28
  v_and_b32 v31, 0xffff0000, v30
  v_lshlrev_b32 v30, 16, v30
  v_pk_add_f32 v[16:17], v[16:17], v[144:145]
  v_pk_add_f32 v[18:19], v[18:19], v[146:147]
  v_pk_add_f32 v[20:21], v[20:21], v[148:149]
  v_pk_add_f32 v[22:23], v[22:23], v[150:151]
  v_pk_add_f32 v[24:25], v[24:25], v[152:153]
  v_pk_add_f32 v[26:27], v[26:27], v[154:155]
  v_pk_add_f32 v[28:29], v[28:29], v[156:157]
  v_pk_add_f32 v[30:31], v[30:31], v[158:159]
  v_cvt_pk_bf16_f32 v32, v16, v17
  v_cvt_pk_bf16_f32 v33, v18, v19
  v_cvt_pk_bf16_f32 v34, v20, v21
  v_cvt_pk_bf16_f32 v35, v22, v23
  v_cvt_pk_bf16_f32 v36, v24, v25
  v_cvt_pk_bf16_f32 v37, v26, v27
  v_cvt_pk_bf16_f32 v38, v28, v29
  v_cvt_pk_bf16_f32 v39, v30, v31
  v_permlane16_swap_b32 v32, v34
  v_permlane16_swap_b32 v33, v35
  v_permlane16_swap_b32 v36, v38
  v_permlane16_swap_b32 v37, v39
  s_lshl_b32 s12, s7, 16
  s_lshl_b32 s13, s3, 14
  s_add_u32 s12, s12, s13
  s_lshl_b32 s13, s8, 7
  s_add_u32 s12, s12, s13
  v_lshl_add_u32 v3, v4, 10, s12
  v_and_b32 v8, 1, v5
  v_lshl_add_u32 v3, v8, 5, v3
  v_lshrrev_b32 v6, 1, v5
  v_lshl_add_u32 v3, v6, 4, v3
  global_store_dwordx4 v3, v[32:35], s[38:39] sc1
  global_store_dwordx4 v3, v[36:39], s[38:39] offset:64 sc1
ALL_fin:
ALL_end:
  s_endpgm
RSg11x0:
  s_cmp_eq_u32 s9, 0
  s_cbranch_scc1 QSg11x0
  s_sub_u32 s9, s9, 1
  s_mov_b64 exec, vcc
  buffer_load_dwordx4 v[116:119], v3, s[44:47], s16 offen offset:0 sc1
  buffer_load_dwordx4 v[120:123], v3, s[44:47], s16 offen offset:1024 sc1
  buffer_load_dwordx4 v[124:127], v4, s[44:47], s16 offen offset:0 sc1
  buffer_load_dwordx4 v[128:131], v4, s[44:47], s16 offen offset:1024 sc1
  s_waitcnt vmcnt(0)
  v_max3_u32 v111, v116, v118, v120
  v_max3_u32 v111, v111, v122, v124
  v_max3_u32 v111, v111, v126, v128
  v_max_u32 v111, v111, v130
  v_cmp_eq_u32 vcc, -1, v111
  s_cbranch_vccnz RSg11x0
QSg11x0:
  s_mov_b64 exec, -1
  buffer_load_dwordx4 v[132:135], v5, s[44:47], s16 offen offset:0 sc1
  buffer_load_dwordx4 v[136:139], v5, s[44:47], s16 offen offset:1024 sc1
  buffer_load_dwordx4 v[140:143], v6, s[44:47], s16 offen offset:0 sc1
  buffer_load_dwordx4 v[144:147], v6, s[44:47], s16 offen offset:1024 sc1
  buffer_load_dwordx4 v[148:151], v3, s[44:47], s17 offen offset:0 sc1
  buffer_load_dwordx4 v[152:155], v3, s[44:47], s17 offen offset:1024 sc1
  buffer_load_dwordx4 v[156:159], v4, s[44:47], s17 offen offset:0 sc1
  buffer_load_dwordx4 v[160:163], v4, s[44:47], s17 offen offset:1024 sc1
  s_nop 4
  s_branch BSg11x0
RSg11x1:
  s_cmp_eq_u32 s9, 0
  s_cbranch_scc1 QSg11x1
  s_sub_u32 s9, s9, 1
  s_mov_b64 exec, vcc
  buffer_load_dwordx4 v[132:135], v5, s[44:47], s16 offen offset:0 sc1
  buffer_load_dwordx4 v[136:139], v5, s[44:47], s16 offen offset:1024 sc1
  buffer_load_dwordx4 v[140:143], v6, s[44:47], s16 offen offset:0 sc1
  buffer_load_dwordx4 v[144:147], v6, s[44:47], s16 offen offset:1024 sc1
  s_waitcnt vmcnt(0)
  v_max3_u32 v111, v132, v134, v136
  v_max3_u32 v111, v111, v138, v140
  v_max3_u32 v111, v111, v142, v144
  v_max_u32 v111, v111, v146
  v_cmp_eq_u32 vcc, -1, v111
  s_cbranch_vccnz RSg11x1
QSg11x1:
  s_mov_b64 exec, -1
  buffer_load_dwordx4 v[148:151], v3, s[44:47], s17 offen offset:0 sc1
  buffer_load_dwordx4 v[152:155], v3, s[44:47], s17 offen offset:1024 sc1
  buffer_load_dwordx4 v[156:159], v4, s[44:47], s17 offen offset:0 sc1
  buffer_load_dwordx4 v[160:163], v4, s[44:47], s17 offen offset:1024 sc1
  buffer_load_dwordx4 v[164:167], v5, s[44:47], s17 offen offset:0 sc1
  buffer_load_dwordx4 v[168:171], v5, s[44:47], s17 offen offset:1024 sc1
  s_mov_b64 exec, 1
  buffer_load_dword a255, v3, s[44:47], s16 offen sc1
  buffer_load_dword a255, v3, s[44:47], s16 offen sc1
  buffer_load_dword a255, v3, s[44:47], s16 offen sc1
  s_mov_b64 exec, -1
  s_nop 4
  s_branch BSg11x1
RSg11x2:
  s_cmp_eq_u32 s9, 0
  s_cbranch_scc1 QSg11x2
  s_sub_u32 s9, s9, 1
  s_mov_b64 exec, vcc
  buffer_load_dwordx4 v[148:151], v3, s[44:47], s17 offen offset:0 sc1
  buffer_load_dwordx4 v[152:155], v3, s[44:47], s17 offen offset:1024 sc1
  buffer_load_dwordx4 v[156:159], v4, s[44:47], s17 offen offset:0 sc1
  buffer_load_dwordx4 v[160:163], v4, s[44:47], s17 offen offset:1024 sc1
  s_waitcnt vmcnt(0)
  v_max3_u32 v111, v148, v150, v152
  v_max3_u32 v111, v111, v154, v156
  v_max3_u32 v111, v111, v158, v160
  v_max_u32 v111, v111, v162
  v_cmp_eq_u32 vcc, -1, v111
  s_cbranch_vccnz RSg11x2
QSg11x2:
  s_mov_b64 exec, -1
  buffer_load_dwordx4 v[164:167], v5, s[44:47], s17 offen offset:0 sc1
  buffer_load_dwordx4 v[168:171], v5, s[44:47], s17 offen offset:1024 sc1
  buffer_load_dwordx4 v[172:175], v6, s[44:47], s17 offen offset:0 sc1
  buffer_load_dwordx4 v[176:179], v6, s[44:47], s17 offen offset:1024 sc1
  buffer_load_dwordx4 v[180:183], v3, s[44:47], s18 offen offset:0 sc1
  buffer_load_dwordx4 v[184:187], v3, s[44:47], s18 offen offset:1024 sc1
  s_mov_b64 exec, 1
  buffer_load_dword a255, v3, s[44:47], s16 offen sc1
  buffer_load_dword a255, v3, s[44:47], s16 offen sc1
  buffer_load_dword a255, v3, s[44:47], s16 offen sc1
  buffer_load_dword a255, v3, s[44:47], s16 offen sc1
  buffer_load_dword a255, v3, s[44:47], s16 offen sc1
  s_mov_b64 exec, -1
  s_nop 4
  s_branch BSg11x2
RSg11x3:
  s_cmp_eq_u32 s9, 0
  s_cbranch_scc1 QSg11x3
  s_sub_u32 s9, s9, 1
  s_mov_b64 exec, vcc
  buffer_load_dwordx4 v[164:167], v5, s[44:47], s17 offen offset:0 sc1
  buffer_load_dwordx4 v[168:171], v5, s[44:47], s17 offen offset:1024 sc1
  buffer_load_dwordx4 v[172:175], v6, s[44:47], s17 offen offset:0 sc1
  buffer_load_dwordx4 v[176:179], v6, s[44:47], s17 offen offset:1024 sc1
  s_waitcnt vmcnt(0)
  v_max3_u32 v111, v164, v166, v168
  v_max3_u32 v111, v111, v170, v172
  v_max3_u32 v111, v111, v174, v176
  v_max_u32 v111, v111, v178
  v_cmp_eq_u32 vcc, -1, v111
  s_cbranch_vccnz RSg11x3
QSg11x3:
  s_mov_b64 exec, -1
  buffer_load_dwordx4 v[180:183], v3, s[44:47], s18 offen offset:0 sc1
  buffer_load_dwordx4 v[184:187], v3, s[44:47], s18 offen offset:1024 sc1
  buffer_load_dwordx4 v[188:191], v4, s[44:47], s18 offen offset:0 sc1
  buffer_load_dwordx4 v[192:195], v4, s[44:47], s18 offen offset:1024 sc1
  buffer_load_dwordx4 v[196:199], v5, s[44:47], s18 offen offset:0 sc1
  buffer_load_dwordx4 v[200:203], v5, s[44:47], s18 offen offset:1024 sc1
  s_mov_b64 exec, 1
  buffer_load_dword a255, v3, s[44:47], s16 offen sc1
  buffer_load_dword a255, v3, s[44:47], s16 offen sc1
  s_mov_b64 exec, -1
  s_nop 4
  s_branch BSg11x3
RSg11x4:
  s_cmp_eq_u32 s9, 0
  s_cbranch_scc1 QSg11x4
  s_sub_u32 s9, s9, 1
  s_mov_b64 exec, vcc
  buffer_load_dwordx4 v[180:183], v3, s[44:47], s18 offen offset:0 sc1
  buffer_load_dwordx4 v[184:187], v3, s[44:47], s18 offen offset:1024 sc1
  buffer_load_dwordx4 v[188:191], v4, s[44:47], s18 offen offset:0 sc1
  buffer_load_dwordx4 v[192:195], v4, s[44:47], s18 offen offset:1024 sc1
  s_waitcnt vmcnt(0)
  v_max3_u32 v111, v180, v182, v184
  v_max3_u32 v111, v111, v186, v188
  v_max3_u32 v111, v111, v190, v192
  v_max_u32 v111, v111, v194
  v_cmp_eq_u32 vcc, -1, v111
  s_cbranch_vccnz RSg11x4
QSg11x4:
  s_mov_b64 exec, -1
  buffer_load_dwordx4 v[196:199], v5, s[44:47], s18 offen offset:0 sc1
  buffer_load_dwordx4 v[200:203], v5, s[44:47], s18 offen offset:1024 sc1
  buffer_load_dwordx4 v[204:207], v6, s[44:47], s18 offen offset:0 sc1
  buffer_load_dwordx4 v[208:211], v6, s[44:47], s18 offen offset:1024 sc1
  buffer_load_dwordx4 v[212:215], v3, s[44:47], s19 offen offset:0 sc1
  buffer_load_dwordx4 v[216:219], v3, s[44:47], s19 offen offset:1024 sc1
  s_nop 4
  s_branch BSg11x4
RSg11x5:
  s_cmp_eq_u32 s9, 0
  s_cbranch_scc1 QSg11x5
  s_sub_u32 s9, s9, 1
  s_mov_b64 exec, vcc
  buffer_load_dwordx4 v[196:199], v5, s[44:47], s18 offen offset:0 sc1
  buffer_load_dwordx4 v[200:203], v5, s[44:47], s18 offen offset:1024 sc1
  buffer_load_dwordx4 v[204:207], v6, s[44:47], s18 offen offset:0 sc1
  buffer_load_dwordx4 v[208:211], v6, s[44:47], s18 offen offset:1024 sc1
  s_waitcnt vmcnt(0)
  v_max3_u32 v111, v196, v198, v200
  v_max3_u32 v111, v111, v202, v204
  v_max3_u32 v111, v111, v206, v208
  v_max_u32 v111, v111, v210
  v_cmp_eq_u32 vcc, -1, v111
  s_cbranch_vccnz RSg11x5
QSg11x5:
  s_mov_b64 exec, -1
  buffer_load_dwordx4 v[212:215], v3, s[44:47], s19 offen offset:0 sc1
  buffer_load_dwordx4 v[216:219], v3, s[44:47], s19 offen offset:1024 sc1
  buffer_load_dwordx4 v[220:223], v4, s[44:47], s19 offen offset:0 sc1
  buffer_load_dwordx4 v[224:227], v4, s[44:47], s19 offen offset:1024 sc1
  buffer_load_dwordx4 v[228:231], v5, s[44:47], s19 offen offset:0 sc1
  buffer_load_dwordx4 v[232:235], v5, s[44:47], s19 offen offset:1024 sc1
  s_nop 4
  s_branch BSg11x5
RSg11x6:
  s_cmp_eq_u32 s9, 0
  s_cbranch_scc1 QSg11x6
  s_sub_u32 s9, s9, 1
  s_mov_b64 exec, vcc
  buffer_load_dwordx4 v[212:215], v3, s[44:47], s19 offen offset:0 sc1
  buffer_load_dwordx4 v[216:219], v3, s[44:47], s19 offen offset:1024 sc1
  buffer_load_dwordx4 v[220:223], v4, s[44:47], s19 offen offset:0 sc1
  buffer_load_dwordx4 v[224:227], v4, s[44:47], s19 offen offset:1024 sc1
  s_waitcnt vmcnt(0)
  v_max3_u32 v111, v212, v214, v216
  v_max3_u32 v111, v111, v218, v220
  v_max3_u32 v111, v111, v222, v224
  v_max_u32 v111, v111, v226
  v_cmp_eq_u32 vcc, -1, v111
  s_cbranch_vccnz RSg11x6
QSg11x6:
  s_mov_b64 exec, -1
  buffer_load_dwordx4 v[228:231], v5, s[44:47], s19 offen offset:0 sc1
  buffer_load_dwordx4 v[232:235], v5, s[44:47], s19 offen offset:1024 sc1
  buffer_load_dwordx4 v[236:239], v6, s[44:47], s19 offen offset:0 sc1
  buffer_load_dwordx4 v[240:243], v6, s[44:47], s19 offen offset:1024 sc1
  s_waitcnt vmcnt(0)
  s_nop 4
  s_branch BSg11x6
RSg11x7:
  s_cmp_eq_u32 s9, 0
  s_cbranch_scc1 QSg11x7
  s_sub_u32 s9, s9, 1
  s_mov_b64 exec, vcc
  buffer_load_dwordx4 v[228:231], v5, s[44:47], s19 offen offset:0 sc1
  buffer_load_dwordx4 v[232:235], v5, s[44:47], s19 offen offset:1024 sc1
  buffer_load_dwordx4 v[236:239], v6, s[44:47], s19 offen offset:0 sc1
  buffer_load_dwordx4 v[240:243], v6, s[44:47], s19 offen offset:1024 sc1
  s_waitcnt vmcnt(0)
  v_max3_u32 v111, v228, v230, v232
  v_max3_u32 v111, v111, v234, v236
  v_max3_u32 v111, v111, v238, v240
  v_max_u32 v111, v111, v242
  v_cmp_eq_u32 vcc, -1, v111
  s_cbranch_vccnz RSg11x7
QSg11x7:
  s_mov_b64 exec, -1
  s_nop 4
  s_branch BSg11x7
RSg11p:
  s_cmp_eq_u32 s9, 0
  s_cbranch_scc1 QSg11p
  s_sub_u32 s9, s9, 1
  buffer_load_dwordx4 v[116:119], v7, s[44:47], s29 offen offset:0 sc1
  buffer_load_dwordx4 v[120:123], v7, s[44:47], s29 offen offset:512 sc1
  buffer_load_dwordx4 v[124:127], v7, s[44:47], s29 offen offset:1024 sc1
  buffer_load_dwordx4 v[128:131], v7, s[44:47], s29 offen offset:1536 sc1
  buffer_load_dwordx4 v[132:135], v7, s[44:47], s29 offen offset:2048 sc1
  buffer_load_dwordx4 v[136:139], v7, s[44:47], s29 offen offset:2560 sc1
  buffer_load_dwordx4 v[140:143], v7, s[44:47], s29 offen offset:3072 sc1
  buffer_load_dwordx4 v[144:147], v7, s[44:47], s29 offen offset:3584 sc1
  s_waitcnt vmcnt(0)
  v_cmp_ne_u64 s[24:25], s[10:11], v[118:119]
  v_cmp_ne_u64 s[22:23], s[10:11], v[122:123]
  v_cmp_ne_u64 s[20:21], s[10:11], v[126:127]
  s_or_b64 s[24:25], s[24:25], s[22:23]
  v_cmp_ne_u64 s[22:23], s[10:11], v[130:131]
  s_or_b64 s[24:25], s[24:25], s[20:21]
  v_cmp_ne_u64 s[20:21], s[10:11], v[134:135]
  s_or_b64 s[24:25], s[24:25], s[22:23]
  v_cmp_ne_u64 s[22:23], s[10:11], v[138:139]
  s_or_b64 s[24:25], s[24:25], s[20:21]
  v_cmp_ne_u64 s[20:21], s[10:11], v[142:143]
  s_or_b64 s[24:25], s[24:25], s[22:23]
  v_cmp_ne_u64 s[22:23], s[10:11], v[146:147]
  s_or_b64 s[24:25], s[24:25], s[20:21]
  s_or_b64 vcc, s[24:25], s[22:23]
  s_cbranch_vccnz RSg11p
QSg11p:
  s_nop 4
  s_branch BSg11p
RSg21f0:
  s_cmp_eq_u32 s9, 0
  s_cbranch_scc1 QSg21f0
  s_sub_u32 s9, s9, 1
  buffer_load_dwordx2 v[72:73], v3, s[44:47], s31 offen sc1
  s_waitcnt vmcnt(0)
  v_cmp_ne_u64 vcc, s[10:11], v[72:73]
  s_nop 0
  s_and_b32 s12, vcc_lo, 0x11111111
  s_cbranch_scc1 RSg21f0
QSg21f0:
  s_nop 4
  s_branch BSg21f0
RSg21f1:
  s_cmp_eq_u32 s9, 0
  s_cbranch_scc1 QSg21f1
  s_sub_u32 s9, s9, 1
  buffer_load_dwordx2 v[12:13], v3, s[44:47], s31 offen sc1
  s_waitcnt vmcnt(0)
  v_cmp_ne_u64 vcc, s[10:11], v[12:13]
  s_nop 0
  s_and_b32 s12, vcc_lo, 0x22222222
  s_cbranch_scc1 RSg21f1
QSg21f1:
  s_nop 4
  s_branch BSg21f1
RSg21f2:
  s_cmp_eq_u32 s9, 0
  s_cbranch_scc1 QSg21f2
  s_sub_u32 s9, s9, 1
  buffer_load_dwordx2 v[12:13], v3, s[44:47], s31 offen sc1
  s_waitcnt vmcnt(0)
  v_cmp_ne_u64 vcc, s[10:11], v[12:13]
  s_nop 0
  s_and_b32 s12, vcc_lo, 0x44444444
  s_cbranch_scc1 RSg21f2
QSg21f2:
  s_nop 4
  s_branch BSg21f2
RSg21f3:
  s_cmp_eq_u32 s9, 0
  s_cbranch_scc1 QSg21f3
  s_sub_u32 s9, s9, 1
  buffer_load_dwordx2 v[12:13], v3, s[44:47], s31 offen sc1
  s_waitcnt vmcnt(0)
  v_cmp_ne_u64 vcc, s[10:11], v[12:13]
  s_nop 0
  s_and_b32 s12, vcc_lo, 0x88888888
  s_cbranch_scc1 RSg21f3
QSg21f3:
  s_nop 4
  s_branch BSg21f3
RSmidfb:
  s_cmp_eq_u32 s9, 0
  s_cbranch_scc1 QSmidfb
  s_sub_u32 s9, s9, 1
  buffer_load_dwordx4 v[112:115], v120, s[44:47], 0 offen offset:0 sc1
  buffer_load_dwordx4 v[116:119], v120, s[44:47], 0 offen offset:16 sc1
  s_waitcnt vmcnt(0)
  v_cmp_ne_u64 vcc, s[10:11], v[112:113]
  v_cmp_ne_u64 s[26:27], s[10:11], v[114:115]
  v_cmp_ne_u64 s[24:25], s[10:11], v[116:117]
  s_or_b64 vcc, vcc, s[26:27]
  v_cmp_ne_u64 s[26:27], s[10:11], v[118:119]
  s_or_b64 vcc, vcc, s[24:25]
  s_or_b64 vcc, vcc, s[26:27]
  s_cbranch_vccnz RSmidfb
QSmidfb:
  s_nop 4
  s_branch BSmidfb
RSmid:
  s_cmp_eq_u32 s9, 0
  s_cbranch_scc1 QSmid
  s_sub_u32 s9, s9, 1
  buffer_load_dwordx4 v[80:83], v94, s[44:47], s19 offen offset:0 sc1
  buffer_load_dwordx4 v[84:87], v94, s[44:47], s19 offen offset:256 sc1
  s_waitcnt vmcnt(0)
  v_cmp_ne_u64 vcc, s[10:11], v[82:83]
  v_cmp_ne_u64 s[20:21], s[10:11], v[86:87]
  s_nop 0
  s_or_b64 vcc, vcc, s[20:21]
  s_cbranch_vccnz RSmid
QSmid:
  s_nop 4
  s_branch BSmid
RSc2s0:
  s_cmp_eq_u32 s9, 0
  s_cbranch_scc1 QSc2s0
  s_sub_u32 s9, s9, 1
  buffer_load_dwordx4 v[112:115], v12, s[44:47], s28 offen sc1
  s_waitcnt vmcnt(0)
  v_cmp_eq_u32 vcc, -1, v112
  s_cbranch_vccnz RSc2s0
QSc2s0:
  s_nop 4
  s_branch BSc2s0
RSc2s1:
  s_cmp_eq_u32 s9, 0
  s_cbranch_scc1 QSc2s1
  s_sub_u32 s9, s9, 1
  buffer_load_dwordx4 v[116:119], v12, s[44:47], s29 offen sc1
  s_waitcnt vmcnt(0)
  v_cmp_eq_u32 vcc, -1, v116
  s_cbranch_vccnz RSc2s1
QSc2s1:
  s_nop 4
  s_branch BSc2s1
RSc2s2:
  s_cmp_eq_u32 s9, 0
  s_cbranch_scc1 QSc2s2
  s_sub_u32 s9, s9, 1
  buffer_load_dwordx4 v[120:123], v12, s[44:47], s30 offen sc1
  s_waitcnt vmcnt(0)
  v_cmp_eq_u32 vcc, -1, v120
  s_cbranch_vccnz RSc2s2
QSc2s2:
  s_nop 4
  s_branch BSc2s2
RSc2s3:
  s_cmp_eq_u32 s9, 0
  s_cbranch_scc1 QSc2s3
  s_sub_u32 s9, s9, 1
  buffer_load_dwordx4 v[124:127], v12, s[44:47], s31 offen sc1
  s_waitcnt vmcnt(0)
  v_cmp_eq_u32 vcc, -1, v124
  s_cbranch_vccnz RSc2s3
QSc2s3:
  s_nop 4
  s_branch BSc2s3
RSg12x0:
  s_cmp_eq_u32 s9, 0
  s_cbranch_scc1 QSg12x0
  s_sub_u32 s9, s9, 1
  s_mov_b64 exec, vcc
  buffer_load_dwordx4 v[116:119], v3, s[44:47], s16 offen offset:0 sc1
  buffer_load_dwordx4 v[120:123], v3, s[44:47], s16 offen offset:1024 sc1
  buffer_load_dwordx4 v[124:127], v4, s[44:47], s16 offen offset:0 sc1
  buffer_load_dwordx4 v[128:131], v4, s[44:47], s16 offen offset:1024 sc1
  s_waitcnt vmcnt(0)
  v_max3_u32 v111, v116, v118, v120
  v_max3_u32 v111, v111, v122, v124
  v_max3_u32 v111, v111, v126, v128
  v_max_u32 v111, v111, v130
  v_cmp_eq_u32 vcc, -1, v111
  s_cbranch_vccnz RSg12x0
QSg12x0:
  s_mov_b64 exec, -1
  buffer_load_dwordx4 v[132:135], v5, s[44:47], s16 offen offset:0 sc1
  buffer_load_dwordx4 v[136:139], v5, s[44:47], s16 offen offset:1024 sc1
  buffer_load_dwordx4 v[140:143], v6, s[44:47], s16 offen offset:0 sc1
  buffer_load_dwordx4 v[144:147], v6, s[44:47], s16 offen offset:1024 sc1
  buffer_load_dwordx4 v[148:151], v3, s[44:47], s17 offen offset:0 sc1
  buffer_load_dwordx4 v[152:155], v3, s[44:47], s17 offen offset:1024 sc1
  buffer_load_dwordx4 v[156:159], v4, s[44:47], s17 offen offset:0 sc1
  buffer_load_dwordx4 v[160:163], v4, s[44:47], s17 offen offset:1024 sc1
  s_nop 4
  s_branch BSg12x0
RSg12x1:
  s_cmp_eq_u32 s9, 0
  s_cbranch_scc1 QSg12x1
  s_sub_u32 s9, s9, 1
  s_mov_b64 exec, vcc
  buffer_load_dwordx4 v[132:135], v5, s[44:47], s16 offen offset:0 sc1
  buffer_load_dwordx4 v[136:139], v5, s[44:47], s16 offen offset:1024 sc1
  buffer_load_dwordx4 v[140:143], v6, s[44:47], s16 offen offset:0 sc1
  buffer_load_dwordx4 v[144:147], v6, s[44:47], s16 offen offset:1024 sc1
  s_waitcnt vmcnt(0)
  v_max3_u32 v111, v132, v134, v136
  v_max3_u32 v111, v111, v138, v140
  v_max3_u32 v111, v111, v142, v144
  v_max_u32 v111, v111, v146
  v_cmp_eq_u32 vcc, -1, v111
  s_cbranch_vccnz RSg12x1
QSg12x1:
  s_mov_b64 exec, -1
  buffer_load_dwordx4 v[148:151], v3, s[44:47], s17 offen offset:0 sc1
  buffer_load_dwordx4 v[152:155], v3, s[44:47], s17 offen offset:1024 sc1
  buffer_load_dwordx4 v[156:159], v4, s[44:47], s17 offen offset:0 sc1
  buffer_load_dwordx4 v[160:163], v4, s[44:47], s17 offen offset:1024 sc1
  buffer_load_dwordx4 v[164:167], v5, s[44:47], s17 offen offset:0 sc1
  buffer_load_dwordx4 v[168:171], v5, s[44:47], s17 offen offset:1024 sc1
  s_mov_b64 exec, 1
  buffer_load_dword a255, v3, s[44:47], s16 offen sc1
  buffer_load_dword a255, v3, s[44:47], s16 offen sc1
  s_mov_b64 exec, -1
  s_nop 4
  s_branch BSg12x1
RSg12x2:
  s_cmp_eq_u32 s9, 0
  s_cbranch_scc1 QSg12x2
  s_sub_u32 s9, s9, 1
  s_mov_b64 exec, vcc
  buffer_load_dwordx4 v[148:151], v3, s[44:47], s17 offen offset:0 sc1
  buffer_load_dwordx4 v[152:155], v3, s[44:47], s17 offen offset:1024 sc1
  buffer_load_dwordx4 v[156:159], v4, s[44:47], s17 offen offset:0 sc1
  buffer_load_dwordx4 v[160:163], v4, s[44:47], s17 offen offset:1024 sc1
  s_waitcnt vmcnt(0)
  v_max3_u32 v111, v148, v150, v152
  v_max3_u32 v111, v111, v154, v156
  v_max3_u32 v111, v111, v158, v160
  v_max_u32 v111, v111, v162
  v_cmp_eq_u32 vcc, -1, v111
  s_cbranch_vccnz RSg12x2
QSg12x2:
  s_mov_b64 exec, -1
  buffer_load_dwordx4 v[164:167], v5, s[44:47], s17 offen offset:0 sc1
  buffer_load_dwordx4 v[168:171], v5, s[44:47], s17 offen offset:1024 sc1
  buffer_load_dwordx4 v[172:175], v6, s[44:47], s17 offen offset:0 sc1
  buffer_load_dwordx4 v[176:179], v6, s[44:47], s17 offen offset:1024 sc1
  buffer_load_dwordx4 v[180:183], v3, s[44:47], s18 offen offset:0 sc1
  buffer_load_dwordx4 v[184:187], v3, s[44:47], s18 offen offset:1024 sc1
  s_mov_b64 exec, 1
  buffer_load_dword a255, v3, s[44:47], s16 offen sc1
  buffer_load_dword a255, v3, s[44:47], s16 offen sc1
  s_mov_b64 exec, -1
  s_nop 4
  s_branch BSg12x2
RSg12x3:
  s_cmp_eq_u32 s9, 0
  s_cbranch_scc1 QSg12x3
  s_sub_u32 s9, s9, 1
  s_mov_b64 exec, vcc
  buffer_load_dwordx4 v[164:167], v5, s[44:47], s17 offen offset:0 sc1
  buffer_load_dwordx4 v[168:171], v5, s[44:47], s17 offen offset:1024 sc1
  buffer_load_dwordx4 v[172:175], v6, s[44:47], s17 offen offset:0 sc1
  buffer_load_dwordx4 v[176:179], v6, s[44:47], s17 offen offset:1024 sc1
  s_waitcnt vmcnt(0)
  v_max3_u32 v111, v164, v166, v168
  v_max3_u32 v111, v111, v170, v172
  v_max3_u32 v111, v111, v174, v176
  v_max_u32 v111, v111, v178
  v_cmp_eq_u32 vcc, -1, v111
  s_cbranch_vccnz RSg12x3
QSg12x3:
  s_mov_b64 exec, -1
  buffer_load_dwordx4 v[180:183], v3, s[44:47], s18 offen offset:0 sc1
  buffer_load_dwordx4 v[184:187], v3, s[44:47], s18 offen offset:1024 sc1
  buffer_load_dwordx4 v[188:191], v4, s[44:47], s18 offen offset:0 sc1
  buffer_load_dwordx4 v[192:195], v4, s[44:47], s18 offen offset:1024 sc1
  buffer_load_dwordx4 v[196:199], v5, s[44:47], s18 offen offset:0 sc1
  buffer_load_dwordx4 v[200:203], v5, s[44:47], s18 offen offset:1024 sc1
  s_nop 4
  s_branch BSg12x3
RSg12x4:
  s_cmp_eq_u32 s9, 0
  s_cbranch_scc1 QSg12x4
  s_sub_u32 s9, s9, 1
  s_mov_b64 exec, vcc
  buffer_load_dwordx4 v[180:183], v3, s[44:47], s18 offen offset:0 sc1
  buffer_load_dwordx4 v[184:187], v3, s[44:47], s18 offen offset:1024 sc1
  buffer_load_dwordx4 v[188:191], v4, s[44:47], s18 offen offset:0 sc1
  buffer_load_dwordx4 v[192:195], v4, s[44:47], s18 offen offset:1024 sc1
  s_waitcnt vmcnt(0)
  v_max3_u32 v111, v180, v182, v184
  v_max3_u32 v111, v111, v186, v188
  v_max3_u32 v111, v111, v190, v192
  v_max_u32 v111, v111, v194
  v_cmp_eq_u32 vcc, -1, v111
  s_cbranch_vccnz RSg12x4
QSg12x4:
  s_mov_b64 exec, -1
  buffer_load_dwordx4 v[196:199], v5, s[44:47], s18 offen offset:0 sc1
  buffer_load_dwordx4 v[200:203], v5, s[44:47], s18 offen offset:1024 sc1
  buffer_load_dwordx4 v[204:207], v6, s[44:47], s18 offen offset:0 sc1
  buffer_load_dwordx4 v[208:211], v6, s[44:47], s18 offen offset:1024 sc1
  buffer_load_dwordx4 v[212:215], v3, s[44:47], s19 offen offset:0 sc1
  buffer_load_dwordx4 v[216:219], v3, s[44:47], s19 offen offset:1024 sc1
  s_nop 4
  s_branch BSg12x4
RSg12x5:
  s_cmp_eq_u32 s9, 0
  s_cbranch_scc1 QSg12x5
  s_sub_u32 s9, s9, 1
  s_mov_b64 exec, vcc
  buffer_load_dwordx4 v[196:199], v5, s[44:47], s18 offen offset:0 sc1
  buffer_load_dwordx4 v[200:203], v5, s[44:47], s18 offen offset:1024 sc1
  buffer_load_dwordx4 v[204:207], v6, s[44:47], s18 offen offset:0 sc1
  buffer_load_dwordx4 v[208:211], v6, s[44:47], s18 offen offset:1024 sc1
  s_waitcnt vmcnt(0)
  v_max3_u32 v111, v196, v198, v200
  v_max3_u32 v111, v111, v202, v204
  v_max3_u32 v111, v111, v206, v208
  v_max_u32 v111, v111, v210
  v_cmp_eq_u32 vcc, -1, v111
  s_cbranch_vccnz RSg12x5
QSg12x5:
  s_mov_b64 exec, -1
  buffer_load_dwordx4 v[212:215], v3, s[44:47], s19 offen offset:0 sc1
  buffer_load_dwordx4 v[216:219], v3, s[44:47], s19 offen offset:1024 sc1
  buffer_load_dwordx4 v[220:223], v4, s[44:47], s19 offen offset:0 sc1
  buffer_load_dwordx4 v[224:227], v4, s[44:47], s19 offen offset:1024 sc1
  buffer_load_dwordx4 v[228:231], v5, s[44:47], s19 offen offset:0 sc1
  buffer_load_dwordx4 v[232:235], v5, s[44:47], s19 offen offset:1024 sc1
  s_nop 4
  s_branch BSg12x5
RSg12x6:
  s_cmp_eq_u32 s9, 0
  s_cbranch_scc1 QSg12x6
  s_sub_u32 s9, s9, 1
  s_mov_b64 exec, vcc
  buffer_load_dwordx4 v[212:215], v3, s[44:47], s19 offen offset:0 sc1
  buffer_load_dwordx4 v[216:219], v3, s[44:47], s19 offen offset:1024 sc1
  buffer_load_dwordx4 v[220:223], v4, s[44:47], s19 offen offset:0 sc1
  buffer_load_dwordx4 v[224:227], v4, s[44:47], s19 offen offset:1024 sc1
  s_waitcnt vmcnt(0)
  v_max3_u32 v111, v212, v214, v216
  v_max3_u32 v111, v111, v218, v220
  v_max3_u32 v111, v111, v222, v224
  v_max_u32 v111, v111, v226
  v_cmp_eq_u32 vcc, -1, v111
  s_cbranch_vccnz RSg12x6
QSg12x6:
  s_mov_b64 exec, -1
  buffer_load_dwordx4 v[228:231], v5, s[44:47], s19 offen offset:0 sc1
  buffer_load_dwordx4 v[232:235], v5, s[44:47], s19 offen offset:1024 sc1
  buffer_load_dwordx4 v[236:239], v6, s[44:47], s19 offen offset:0 sc1
  buffer_load_dwordx4 v[240:243], v6, s[44:47], s19 offen offset:1024 sc1
  s_mov_b64 exec, 1
  buffer_load_dword a255, v3, s[44:47], s16 offen sc1
  buffer_load_dword a255, v3, s[44:47], s16 offen sc1
  buffer_load_dword a255, v3, s[44:47], s16 offen sc1
  buffer_load_dword a255, v3, s[44:47], s16 offen sc1
  buffer_load_dword a255, v3, s[44:47], s16 offen sc1
  buffer_load_dword a255, v3, s[44:47], s16 offen sc1
  buffer_load_dword a255, v3, s[44:47], s16 offen sc1
  buffer_load_dword a255, v3, s[44:47], s16 offen sc1
  s_mov_b64 exec, -1
  s_nop 4
  s_branch BSg12x6
RSg12x7:
  s_cmp_eq_u32 s9, 0
  s_cbranch_scc1 QSg12x7
  s_sub_u32 s9, s9, 1
  s_mov_b64 exec, vcc
  buffer_load_dwordx4 v[228:231], v5, s[44:47], s19 offen offset:0 sc1
  buffer_load_dwordx4 v[232:235], v5, s[44:47], s19 offen offset:1024 sc1
  buffer_load_dwordx4 v[236:239], v6, s[44:47], s19 offen offset:0 sc1
  buffer_load_dwordx4 v[240:243], v6, s[44:47], s19 offen offset:1024 sc1
  s_waitcnt vmcnt(0)
  v_max3_u32 v111, v228, v230, v232
  v_max3_u32 v111, v111, v234, v236
  v_max3_u32 v111, v111, v238, v240
  v_max_u32 v111, v111, v242
  v_cmp_eq_u32 vcc, -1, v111
  s_cbranch_vccnz RSg12x7
QSg12x7:
  s_mov_b64 exec, -1
  s_nop 4
  s_branch BSg12x7
RSg12p:
  s_cmp_eq_u32 s9, 0
  s_cbranch_scc1 QSg12p
  s_sub_u32 s9, s9, 1
  buffer_load_dwordx4 v[116:119], v7, s[44:47], s29 offen offset:0 sc1
  buffer_load_dwordx4 v[120:123], v7, s[44:47], s29 offen offset:512 sc1
  buffer_load_dwordx4 v[124:127], v7, s[44:47], s29 offen offset:1024 sc1
  buffer_load_dwordx4 v[128:131], v7, s[44:47], s29 offen offset:1536 sc1
  buffer_load_dwordx4 v[132:135], v7, s[44:47], s29 offen offset:2048 sc1
  buffer_load_dwordx4 v[136:139], v7, s[44:47], s29 offen offset:2560 sc1
  buffer_load_dwordx4 v[140:143], v7, s[44:47], s29 offen offset:3072 sc1
  buffer_load_dwordx4 v[144:147], v7, s[44:47], s29 offen offset:3584 sc1
  s_waitcnt vmcnt(0)
  v_cmp_ne_u64 s[24:25], s[10:11], v[118:119]
  v_cmp_ne_u64 s[22:23], s[10:11], v[122:123]
  v_cmp_ne_u64 s[20:21], s[10:11], v[126:127]
  s_or_b64 s[24:25], s[24:25], s[22:23]
  v_cmp_ne_u64 s[22:23], s[10:11], v[130:131]
  s_or_b64 s[24:25], s[24:25], s[20:21]
  v_cmp_ne_u64 s[20:21], s[10:11], v[134:135]
  s_or_b64 s[24:25], s[24:25], s[22:23]
  v_cmp_ne_u64 s[22:23], s[10:11], v[138:139]
  s_or_b64 s[24:25], s[24:25], s[20:21]
  v_cmp_ne_u64 s[20:21], s[10:11], v[142:143]
  s_or_b64 s[24:25], s[24:25], s[22:23]
  v_cmp_ne_u64 s[22:23], s[10:11], v[146:147]
  s_or_b64 s[24:25], s[24:25], s[20:21]
  s_or_b64 vcc, s[24:25], s[22:23]
  s_cbranch_vccnz RSg12p
QSg12p:
  s_nop 4
  s_branch BSg12p
RSg22f0:
  s_cmp_eq_u32 s9, 0
  s_cbranch_scc1 QSg22f0
  s_sub_u32 s9, s9, 1
  buffer_load_dwordx2 v[72:73], v3, s[44:47], s31 offen sc1
  s_waitcnt vmcnt(0)
  v_cmp_ne_u64 vcc, s[10:11], v[72:73]
  s_nop 0
  s_and_b32 s12, vcc_lo, 0x11111111
  s_cbranch_scc1 RSg22f0
QSg22f0:
  s_nop 4
  s_branch BSg22f0
RSg22f1:
  s_cmp_eq_u32 s9, 0
  s_cbranch_scc1 QSg22f1
  s_sub_u32 s9, s9, 1
  buffer_load_dwordx2 v[74:75], v3, s[44:47], s31 offen sc1
  s_waitcnt vmcnt(0)
  v_cmp_ne_u64 vcc, s[10:11], v[74:75]
  s_nop 0
  s_and_b32 s12, vcc_lo, 0x22222222
  s_cbranch_scc1 RSg22f1
QSg22f1:
  s_nop 4
  s_branch BSg22f1
RSg22f2:
  s_cmp_eq_u32 s9, 0
  s_cbranch_scc1 QSg22f2
  s_sub_u32 s9, s9, 1
  buffer_load_dwordx2 v[12:13], v3, s[44:47], s31 offen sc1
  s_waitcnt vmcnt(0)
  v_cmp_ne_u64 vcc, s[10:11], v[12:13]
  s_nop 0
  s_and_b32 s12, vcc_lo, 0x44444444
  s_cbranch_scc1 RSg22f2
QSg22f2:
  s_nop 4
  s_branch BSg22f2
RSg22f3:
  s_cmp_eq_u32 s9, 0
  s_cbranch_scc1 QSg22f3
  s_sub_u32 s9, s9, 1
  buffer_load_dwordx2 v[12:13], v3, s[44:47], s31 offen sc1
  s_waitcnt vmcnt(0)
  v_cmp_ne_u64 vcc, s[10:11], v[12:13]
  s_nop 0
  s_and_b32 s12, vcc_lo, 0x88888888
  s_cbranch_scc1 RSg22f3
QSg22f3:
  s_nop 4
  s_branch BSg22f3
  v_accvgpr_write_b32 a255, v255
  s_endpgm

.section .rodata,"a"
.p2align 6
.amdhsa_kernel interleave_layers__ssm_conv_s4d__dense_activation_mish__prompt_kernel
  .amdhsa_next_free_vgpr 512
  .amdhsa_next_free_sgpr 70
  .amdhsa_accum_offset 256
  .amdhsa_group_segment_fixed_size 0
  .amdhsa_kernarg_size 112
  .amdhsa_user_sgpr_count 2
  .amdhsa_user_sgpr_kernarg_segment_ptr 1
  .amdhsa_system_sgpr_workgroup_id_x 1
.end_amdhsa_kernel
```
